```python
import torch

def _softmax(x, axis=-1):
    return torch.softmax(x, dim=axis)

def _gelu(x):
    return torch.nn.functional.gelu(x, approximate='tanh')

def _silu(x):
    return torch.nn.functional.silu(x)

def _sigmoid(x):
    return torch.sigmoid(x)

def _layernorm(x, axis=-1, eps=1e-05):
    m = x.mean(dim=axis, keepdim=True)
    v = x.var(dim=axis, keepdim=True, unbiased=False)
    return (x - m) / torch.sqrt(v + eps)

def _scatter_add(tgt, idx, src, axis=0):
    return tgt.clone().index_add_(axis, idx, src)

def _segment_sum(src, seg, n):
    out = torch.zeros((n,) + src.shape[1:], dtype=src.dtype)
    return out.index_add_(0, seg, src)

def _pad(x, pw):
    flat = tuple((v for pair in reversed(pw) for v in pair))
    return torch.nn.functional.pad(x, flat)
kernel_name = 'adaLN_cond__compressed_kv_cla__dense_activation_silu__prompt'

def setup_inputs():

    _w = lambda a: (lambda t: t.to(torch.bfloat16) if t.is_floating_point() else t)(torch.as_tensor(a))

    def _A_setup():
        B, H, Sq, Sk, D, M = (1, 16, 2048, 2048, 256, 448)
        Dc = 4 * D
        return {'x': _w((lambda *s: torch.randn(*s, dtype=torch.bfloat16) * 0.05)(B, Sq, M)), 'c_kv': _w((lambda *s: torch.randn(*s, dtype=torch.bfloat16) * 0.8)(B, Sk, Dc)), 'w_q': _w((lambda *s: torch.randn(*s, dtype=torch.bfloat16) * 1.6)(M, H, D) * M ** (-0.5)), 'w_uk': _w((lambda *s: torch.randn(*s, dtype=torch.bfloat16) * 1.6)(Dc, H, D) * Dc ** (-0.5)), 'w_uv': _w((lambda *s: torch.randn(*s, dtype=torch.bfloat16) * 0.8)(Dc, H, D) * Dc ** (-0.5)), 'w_o': _w((lambda *s: torch.randn(*s, dtype=torch.bfloat16) * 0.8)(H, D, M) * (H * D) ** (-0.5))}
    _A_in = _A_setup()

    def _B_setup():
        B, S, D, F = (1, 2048, 448, 1792)
        return {'x': _w((lambda *s: torch.randn(*s, dtype=torch.bfloat16) * 0.05)(B, S, D)), 'w1': _w((lambda *s: torch.randn(*s, dtype=torch.bfloat16) * 1.6)(D, F) * D ** (-0.5)), 'w2': _w((lambda *s: torch.randn(*s, dtype=torch.bfloat16) * 0.2)(F, D) * F ** (-0.5))}
    _B_in = _B_setup()
    return {'A_x': _A_in['x'], 'A_c_kv': _A_in['c_kv'], 'A_w_q': _A_in['w_q'], 'A_w_uk': _A_in['w_uk'], 'A_w_uv': _A_in['w_uv'], 'A_w_o': _A_in['w_o'], 'B_x': _B_in['x'], 'B_w1': _B_in['w1'], 'B_w2': _B_in['w2'], 'c': _w((lambda *s: torch.randn(*s, dtype=torch.bfloat16) * 0.1)(1, 448) * 8.0), 'w_mod': _w((lambda *s: torch.randn(*s, dtype=torch.bfloat16) * 0.1)(448, 6 * 448) * 448 ** (-0.5) * 8.0)}

def reference(A_x, A_c_kv, A_w_q, A_w_uk, A_w_uv, A_w_o, B_x, B_w1, B_w2, c, w_mod):

    def _A_ref(x, c_kv, w_q, w_uk, w_uv, w_o):
        B, Sq, M = (x.shape[0], x.shape[1], x.shape[2])
        Sk = c_kv.shape[1]
        H, D = (w_q.shape[1], w_q.shape[2])
        q = torch.einsum('bqm,mhd->bhqd', x, w_q)
        k = torch.einsum('bkc,chd->bhkd', c_kv, w_uk)
        v = torch.einsum('bkc,chd->bhkd', c_kv, w_uv)
        scores = torch.einsum('bhqd,bhkd->bhqk', q, k) * D ** (-0.5)
        off = Sk - Sq
        qi = torch.arange(Sq)[:, None]
        kj = torch.arange(Sk)[None, :]
        cmask = kj <= qi + off
        scores = torch.where(cmask[None, None], scores, -1000000000.0)
        p = _softmax(scores, axis=-1)
        ctx = torch.einsum('bhqk,bhkd->bhqd', p, v)
        return torch.einsum('bhqd,hdm->bqm', ctx, w_o)

    def _B_ref(x, w1, w2):
        h = torch.einsum('bsd,df->bsf', x, w1)
        h = _silu(h)
        out = torch.einsum('bsf,fd->bsd', h, w2)
        return out
    x = A_x
    mod = (_silu(c) @ w_mod).reshape(c.shape[0], 6, 1, -1)
    sa, ca, ga, sb, cb, gb = (mod[:, 0].clone(), mod[:, 1].clone(), mod[:, 2].clone(), mod[:, 3].clone(), mod[:, 4].clone(), mod[:, 5].clone())
    h = _layernorm(x, axis=-1) * (1 + ca) + sa
    x = x + ga * _A_ref(h, A_c_kv, A_w_q, A_w_uk, A_w_uv, A_w_o)
    h = _layernorm(x, axis=-1) * (1 + cb) + sb
    x = x + gb * _B_ref(h, B_w1, B_w2)
    return x
```

```asm
; @launch grid=(256,1,1) block=(256,1,1) lds=163840
.amdgcn_target "amdgcn-amd-amdhsa--gfx950"
.text
.globl adaLN_cond__compressed_kv_cla__dense_activation_silu__prompt_kernel
.p2align 8
.type adaLN_cond__compressed_kv_cla__dense_activation_silu__prompt_kernel,@function
adaLN_cond__compressed_kv_cla__dense_activation_silu__prompt_kernel:
K_START:
    s_cmp_ge_u32 s2, 256
    s_cbranch_scc1 K_END
    s_load_dwordx4 s[48:51], s[0:1], 0
    s_load_dwordx2 s[52:53], s[0:1], 16
    s_load_dwordx4 s[40:43], s[0:1], 24
    s_load_dwordx2 s[54:55], s[0:1], 40
    s_load_dwordx4 s[56:59], s[0:1], 56
    s_load_dwordx4 s[36:39], s[0:1], 72
    s_load_dwordx2 s[60:61], s[0:1], 88
    s_load_dwordx2 s[16:17], s[0:1], 96
    s_load_dwordx2 s[62:63], s[0:1], 104
    v_and_b32 v1, 63, v0
    v_lshrrev_b32 v30, 6, v0
    s_nop 0
    v_readfirstlane_b32 s18, v30
    s_and_b32 s3, s2, 7
    s_lshr_b32 s20, s2, 3
    s_and_b32 s19, s20, 1
    s_lshl_b32 s3, s3, 1
    s_add_u32 s19, s19, s3
    s_lshr_b32 s20, s20, 1
    s_lshr_b32 s27, s20, 1
    s_mul_i32 s27, s27, 5
    s_and_b32 s27, s27, 7
    s_and_b32 s26, s20, 1
    v_lshrrev_b32 v31, 5, v1
    v_and_b32 v29, 31, v1
    v_lshrrev_b32 v28, 3, v0
    v_and_b32 v28, 0x18, v28
    v_lshrrev_b32 v24, 3, v1
    v_lshl_add_u32 v24, v28, 2, v24
    v_and_b32 v26, 7, v1
    v_lshrrev_b32 v25, 4, v1
    v_xor_b32 v25, v26, v25
    v_lshlrev_b32 v25, 4, v25
    v_lshl_add_u32 v6, v24, 11, v25
    v_xor_b32 v7, 64, v6
    v_add_u32 v7, 0x4000, v7
    v_add_u32 v8, 0x8000, v6
    v_add_u32 v9, 0x8000, v7
    v_add_u32 v24, v28, v31
    v_and_b32 v25, 8, v28
    v_lshl_add_u32 v25, v31, 1, v25
    v_xor_b32 v25, v29, v25
    v_lshlrev_b32 v25, 4, v25
    v_lshl_add_u32 v2, v24, 13, v25
    v_xor_b32 v3, 64, v2
    v_add_u32 v3, 0x4000, v3
    v_add_u32 v4, 0x8000, v2
    v_add_u32 v5, 0x8000, v3
    s_lshl_b32 s30, s18, 12
    s_add_u32 s31, s30, 0x10000
    s_lshl_b32 s28, s19, 9
    s_lshl_b32 s29, s27, 19
    s_add_u32 s35, s29, 0x40000
    s_mov_b32 s34, s31
    s_waitcnt lgkmcnt(0)
    s_mov_b32 s12, s50
    s_and_b32 s13, s51, 0xffff
    s_mov_b32 s14, 0x400000
    s_mov_b32 s15, 0x20000
    s_cmp_eq_u32 s26, 0
    s_cselect_b32 s40, s40, s42
    s_cselect_b32 s41, s41, s43
    s_mov_b32 s4, s40
    s_and_b32 s5, s41, 0xffff
    s_mov_b32 s6, 0x800000
    s_mov_b32 s7, 0x20000
    s_add_u32 m0, s34, 0
    v_lshlrev_b32 v24, 7, v31
    v_bfe_u32 v25, v1, 3, 2
    buffer_load_dwordx4 v6, s[12:15], s29 offen lds
    s_add_u32 m0, s34, 1024
    v_lshl_add_u32 v24, v25, 4, v24
    v_lshl_add_u32 v178, v30, 8, v24
    buffer_load_dwordx4 v7, s[12:15], s29 offen lds
    s_add_u32 m0, s34, 2048
    s_lshl_b32 s3, s2, 3
    v_and_b32 v27, 7, v1
    buffer_load_dwordx4 v8, s[12:15], s29 offen lds
    s_add_u32 m0, s34, 3072
    v_add_u32 v26, s3, v27
    v_mul_u32_u24 v26, 896, v26
    buffer_load_dwordx4 v9, s[12:15], s29 offen lds
    s_add_u32 m0, s30, 0
    v_lshrrev_b32 v28, 1, v178
    v_add_u32 v177, v26, v28
    buffer_load_dwordx4 v2, s[4:7], s28 offen lds
    s_add_u32 m0, s30, 1024
    s_lshr_b32 s3, s2, 1
    s_mul_i32 s3, s3, 14336
    buffer_load_dwordx4 v3, s[4:7], s28 offen lds
    s_add_u32 m0, s30, 2048
    v_lshlrev_b32 v26, 10, v31
    v_lshl_add_u32 v26, v25, 8, v26
    buffer_load_dwordx4 v4, s[4:7], s28 offen lds
    s_add_u32 m0, s30, 3072
    v_lshl_add_u32 v26, v27, 4, v26
    v_lshl_add_u32 v26, v30, 11, v26
    buffer_load_dwordx4 v5, s[4:7], s28 offen lds
    s_add_u32 m0, s34, 16384
    v_add_u32 v26, s3, v26
    s_and_b32 s3, s2, 1
    buffer_load_dwordx4 v6, s[12:15], s35 offen lds
    s_add_u32 m0, s34, 17408
    s_lshl_b32 s3, s3, 7
    v_add_u32 v179, s3, v26
    buffer_load_dwordx4 v7, s[12:15], s35 offen lds
    s_add_u32 m0, s34, 18432
    v_mov_b32 v213, 0
    v_lshlrev_b32 v212, 5, v27
    buffer_load_dwordx4 v8, s[12:15], s35 offen lds
    s_add_u32 m0, s34, 19456
    s_mov_b32 s50, s48
    s_mov_b32 s51, s49
    buffer_load_dwordx4 v9, s[12:15], s35 offen lds
    s_getpc_b64 s[44:45]
CT_1:
    s_sub_u32 s44, s44, CT_1-K_START
    s_subb_u32 s45, s45, 0
    s_and_b32 s45, s45, 0xffff
    s_mov_b32 s46, K_LAST-K_START
    s_mov_b32 s47, 0x20000
    s_lshr_b32 s3, s2, 3
    s_lshl_b32 s3, s3, 2
    s_add_u32 s3, s3, s18
    s_mul_i32 s3, s3, 640
    v_min_u32 v214, 4, v1
    v_lshlrev_b32 v214, 7, v214
    buffer_load_dword v221, v214, s[44:47], s3 offen
    s_mov_b32 s8, s62
    s_and_b32 s9, s63, 0xffff
    s_mov_b32 s10, 0x10000000
    s_mov_b32 s11, 0x20000
    s_sub_u32 s25, s20, 12
    s_lshl_b32 s25, s25, 4
    s_add_u32 s25, s25, s19
    s_cmp_lt_u32 s25, 42
    s_cbranch_scc0 KV_NOMOD1
    s_mov_b32 s44, s36
    s_and_b32 s45, s37, 0xffff
    s_mov_b32 s46, 0x380
    s_mov_b32 s47, 0x20000
    v_lshrrev_b32 v24, 3, v0
    v_mul_u32_u24 v25, 28, v24
    buffer_load_dwordx4 v[96:99], v25, s[44:47], 0 offen
    buffer_load_dwordx3 v[100:102], v25, s[44:47], 0 offen offset:16
    s_mov_b32 s44, s38
    s_and_b32 s45, s39, 0xffff
    s_mov_b32 s46, 0x24c000
    s_mov_b32 s47, 0x20000
    v_mul_u32_u24 v25, 75264, v24
    v_and_b32 v24, 7, v0
    v_lshl_add_u32 v25, v24, 4, v25
    s_lshl_b32 s3, s25, 7
    buffer_load_dwordx4 v[32:35], v25, s[44:47], s3 offen
    s_add_u32 s3, s3, 5376
    buffer_load_dwordx4 v[36:39], v25, s[44:47], s3 offen
    s_add_u32 s3, s3, 5376
    buffer_load_dwordx4 v[40:43], v25, s[44:47], s3 offen
    s_add_u32 s3, s3, 5376
    buffer_load_dwordx4 v[44:47], v25, s[44:47], s3 offen
    s_add_u32 s3, s3, 5376
    buffer_load_dwordx4 v[48:51], v25, s[44:47], s3 offen
    s_add_u32 s3, s3, 5376
    buffer_load_dwordx4 v[52:55], v25, s[44:47], s3 offen
    s_add_u32 s3, s3, 5376
    buffer_load_dwordx4 v[56:59], v25, s[44:47], s3 offen
    s_add_u32 s3, s3, 5376
    buffer_load_dwordx4 v[60:63], v25, s[44:47], s3 offen
    s_add_u32 s3, s3, 5376
    buffer_load_dwordx4 v[64:67], v25, s[44:47], s3 offen
    s_add_u32 s3, s3, 5376
    buffer_load_dwordx4 v[68:71], v25, s[44:47], s3 offen
    s_add_u32 s3, s3, 5376
    buffer_load_dwordx4 v[72:75], v25, s[44:47], s3 offen
    s_add_u32 s3, s3, 5376
    buffer_load_dwordx4 v[76:79], v25, s[44:47], s3 offen
    s_add_u32 s3, s3, 5376
    buffer_load_dwordx4 v[80:83], v25, s[44:47], s3 offen
    s_add_u32 s3, s3, 5376
    buffer_load_dwordx4 v[84:87], v25, s[44:47], s3 offen
    s_add_u32 s3, s3, 5376
KV_NOMOD1:
    s_mov_b32 s36, s31
    s_add_u32 s28, s28, 0x40000
    s_add_u32 s36, s36, 0x8000
    s_add_u32 s29, s29, 128
    s_add_u32 s35, s35, 128
    s_add_u32 m0, s30, 16384
    v_lshrrev_b32 v28, 1, v30
    v_and_b32 v27, 15, v1
    v_lshl_add_u32 v28, v28, 7, v27
    v_lshlrev_b32 v28, 7, v28
    buffer_load_dwordx4 v2, s[4:7], s28 offen lds
    s_add_u32 m0, s30, 17408
    v_add_u32 v28, 0x10000, v28
    v_bfe_u32 v24, v1, 1, 3
    v_lshrrev_b32 v26, 4, v1
    v_xor_b32 v25, v26, v24
    buffer_load_dwordx4 v3, s[4:7], s28 offen lds
    s_add_u32 m0, s30, 18432
    v_lshl_add_u32 v10, v25, 4, v28
    v_xor_b32 v11, 64, v10
    v_bfe_u32 v28, v1, 2, 2
    v_lshl_add_u32 v24, v26, 3, v28
    buffer_load_dwordx4 v4, s[4:7], s28 offen lds
    s_add_u32 m0, s30, 19456
    v_lshlrev_b32 v24, 9, v24
    v_and_b32 v25, 1, v30
    v_lshl_add_u32 v24, v25, 8, v24
    v_and_b32 v25, 3, v1
    buffer_load_dwordx4 v5, s[4:7], s28 offen lds
    s_add_u32 m0, s36, 0
    v_lshl_add_u32 v24, v25, 3, v24
    v_bfe_u32 v25, v1, 2, 3
    v_lshl_add_u32 v16, v25, 5, v24
    v_xor_b32 v17, 32, v16
    buffer_load_dwordx4 v6, s[12:15], s29 offen lds
    s_add_u32 m0, s36, 1024
    v_xor_b32 v18, 64, v16
    v_xor_b32 v19, 96, v16
    v_xor_b32 v20, 128, v16
    v_xor_b32 v21, 160, v16
    buffer_load_dwordx4 v7, s[12:15], s29 offen lds
    s_add_u32 m0, s36, 2048
    v_xor_b32 v22, 192, v16
    v_xor_b32 v23, 224, v16
    v_mov_b32 v216, 0
    v_mov_b32 v217, 0
    buffer_load_dwordx4 v8, s[12:15], s29 offen lds
    s_add_u32 m0, s36, 3072
    v_mov_b32 v218, 0
    v_mov_b32 v219, 0
    v_mov_b32 v14, v10
    s_nop 0
    buffer_load_dwordx4 v9, s[12:15], s29 offen lds
    s_mov_b32 s44, s52
    s_and_b32 s45, s53, 0xffff
    s_mov_b32 s46, 0x380000
    s_mov_b32 s47, 0x20000
    v_min_u32 v214, 27, v1
    v_lshlrev_b32 v214, 7, v214
    s_lshl_b32 s3, s2, 2
    s_add_u32 s3, s3, s18
    s_mul_i32 s3, s3, 3584
    buffer_load_dword v220, v214, s[44:47], s3 offen
    s_mov_b32 s34, 0x10000
    s_mov_b32 s32, 0
    s_mov_b32 s33, 8
    s_mov_b32 s44, s16
    s_and_b32 s45, s17, 0xffff
    s_mov_b32 s46, 0x100
    s_mov_b32 s47, 0x20000
    s_getreg_b32 s3, hwreg(HW_REG_XCC_ID, 0, 4)
    s_mul_i32 s37, s3, s3
    s_lshl_b32 s37, s37, 10
    s_add_u32 s37, s37, s3
    s_add_u32 s37, s37, 0x1000000
    s_lshl_b32 s96, s37, 5
    s_lshr_b32 s39, s19, 1
    s_lshl_b32 s39, s39, 2
    s_add_u32 s39, s39, 64
    s_cmp_lg_u32 s18, 0
    s_cbranch_scc1 KV_NOREG
    v_mov_b32 v214, s37
    s_mov_b64 exec, 1
    buffer_atomic_add v214, v213, s[44:47], s39 offen sc1
    s_mov_b64 exec, -1
KV_NOREG:
    s_waitcnt vmcnt(9)
    s_cmp_lt_u32 s25, 42
    s_cbranch_scc0 KV_NOMOD2
    v_lshlrev_b32 v104, 16, v96
    v_and_b32 v105, 0xffff0000, v96
    v_lshlrev_b32 v106, 16, v97
    v_and_b32 v107, 0xffff0000, v97
    v_lshlrev_b32 v108, 16, v98
    v_and_b32 v109, 0xffff0000, v98
    v_lshlrev_b32 v110, 16, v99
    v_and_b32 v111, 0xffff0000, v99
    v_lshlrev_b32 v112, 16, v100
    v_and_b32 v113, 0xffff0000, v100
    v_lshlrev_b32 v114, 16, v101
    v_and_b32 v115, 0xffff0000, v101
    v_lshlrev_b32 v116, 16, v102
    v_and_b32 v117, 0xffff0000, v102
    v_mul_f32 v128, 0xbfb8aa3b, v104
    v_mul_f32 v129, 0xbfb8aa3b, v105
    v_mul_f32 v130, 0xbfb8aa3b, v106
    v_mul_f32 v131, 0xbfb8aa3b, v107
    v_mul_f32 v132, 0xbfb8aa3b, v108
    v_mul_f32 v133, 0xbfb8aa3b, v109
    v_mul_f32 v134, 0xbfb8aa3b, v110
    v_mul_f32 v135, 0xbfb8aa3b, v111
    v_mul_f32 v136, 0xbfb8aa3b, v112
    v_mul_f32 v137, 0xbfb8aa3b, v113
    v_mul_f32 v138, 0xbfb8aa3b, v114
    v_mul_f32 v139, 0xbfb8aa3b, v115
    v_mul_f32 v140, 0xbfb8aa3b, v116
    v_mul_f32 v141, 0xbfb8aa3b, v117
    v_exp_f32 v128, v128
    v_exp_f32 v129, v129
    v_exp_f32 v130, v130
    v_exp_f32 v131, v131
    v_exp_f32 v132, v132
    v_exp_f32 v133, v133
    v_exp_f32 v134, v134
    v_exp_f32 v135, v135
    v_exp_f32 v136, v136
    v_exp_f32 v137, v137
    v_exp_f32 v138, v138
    v_exp_f32 v139, v139
    v_exp_f32 v140, v140
    v_exp_f32 v141, v141
    v_add_f32 v128, 1.0, v128
    v_add_f32 v129, 1.0, v129
    v_add_f32 v130, 1.0, v130
    v_add_f32 v131, 1.0, v131
    v_add_f32 v132, 1.0, v132
    v_add_f32 v133, 1.0, v133
    v_add_f32 v134, 1.0, v134
    v_add_f32 v135, 1.0, v135
    v_add_f32 v136, 1.0, v136
    v_add_f32 v137, 1.0, v137
    v_add_f32 v138, 1.0, v138
    v_add_f32 v139, 1.0, v139
    v_add_f32 v140, 1.0, v140
    v_add_f32 v141, 1.0, v141
    v_rcp_f32 v128, v128
    v_rcp_f32 v129, v129
    v_rcp_f32 v130, v130
    v_rcp_f32 v131, v131
    v_rcp_f32 v132, v132
    v_rcp_f32 v133, v133
    v_rcp_f32 v134, v134
    v_rcp_f32 v135, v135
    v_rcp_f32 v136, v136
    v_rcp_f32 v137, v137
    v_rcp_f32 v138, v138
    v_rcp_f32 v139, v139
    v_rcp_f32 v140, v140
    v_rcp_f32 v141, v141
    v_mul_f32 v104, v104, v128
    v_mul_f32 v105, v105, v129
    v_mul_f32 v106, v106, v130
    v_mul_f32 v107, v107, v131
    v_mul_f32 v108, v108, v132
    v_mul_f32 v109, v109, v133
    v_mul_f32 v110, v110, v134
    v_mul_f32 v111, v111, v135
    v_mul_f32 v112, v112, v136
    v_mul_f32 v113, v113, v137
    v_mul_f32 v114, v114, v138
    v_mul_f32 v115, v115, v139
    v_mul_f32 v116, v116, v140
    v_mul_f32 v117, v117, v141
    v_cvt_pk_bf16_f32 v128, v104, v213
    v_cvt_pk_bf16_f32 v144, v213, v104
    v_cvt_pk_bf16_f32 v129, v105, v213
    v_cvt_pk_bf16_f32 v145, v213, v105
    v_cvt_pk_bf16_f32 v130, v106, v213
    v_cvt_pk_bf16_f32 v146, v213, v106
    v_cvt_pk_bf16_f32 v131, v107, v213
    v_cvt_pk_bf16_f32 v147, v213, v107
    v_cvt_pk_bf16_f32 v132, v108, v213
    v_cvt_pk_bf16_f32 v148, v213, v108
    v_cvt_pk_bf16_f32 v133, v109, v213
    v_cvt_pk_bf16_f32 v149, v213, v109
    v_cvt_pk_bf16_f32 v134, v110, v213
    v_cvt_pk_bf16_f32 v150, v213, v110
    v_cvt_pk_bf16_f32 v135, v111, v213
    v_cvt_pk_bf16_f32 v151, v213, v111
    v_cvt_pk_bf16_f32 v136, v112, v213
    v_cvt_pk_bf16_f32 v152, v213, v112
    v_cvt_pk_bf16_f32 v137, v113, v213
    v_cvt_pk_bf16_f32 v153, v213, v113
    v_cvt_pk_bf16_f32 v138, v114, v213
    v_cvt_pk_bf16_f32 v154, v213, v114
    v_cvt_pk_bf16_f32 v139, v115, v213
    v_cvt_pk_bf16_f32 v155, v213, v115
    v_cvt_pk_bf16_f32 v140, v116, v213
    v_cvt_pk_bf16_f32 v156, v213, v116
    v_cvt_pk_bf16_f32 v141, v117, v213
    v_cvt_pk_bf16_f32 v157, v213, v117
    v_mov_b32 v120, 0
    v_mov_b32 v121, 0
    v_mov_b32 v122, 0
    v_mov_b32 v123, 0
    v_mov_b32 v124, 0
    v_mov_b32 v125, 0
    v_mov_b32 v126, 0
    v_mov_b32 v127, 0
    v_dot2c_f32_bf16 v120, v128, v32
    v_dot2c_f32_bf16 v121, v144, v32
    v_dot2c_f32_bf16 v122, v128, v33
    v_dot2c_f32_bf16 v123, v144, v33
    v_dot2c_f32_bf16 v124, v128, v34
    v_dot2c_f32_bf16 v125, v144, v34
    v_dot2c_f32_bf16 v126, v128, v35
    v_dot2c_f32_bf16 v127, v144, v35
    v_dot2c_f32_bf16 v120, v129, v36
    v_dot2c_f32_bf16 v121, v145, v36
    v_dot2c_f32_bf16 v122, v129, v37
    v_dot2c_f32_bf16 v123, v145, v37
    v_dot2c_f32_bf16 v124, v129, v38
    v_dot2c_f32_bf16 v125, v145, v38
    v_dot2c_f32_bf16 v126, v129, v39
    v_dot2c_f32_bf16 v127, v145, v39
    v_dot2c_f32_bf16 v120, v130, v40
    v_dot2c_f32_bf16 v121, v146, v40
    v_dot2c_f32_bf16 v122, v130, v41
    v_dot2c_f32_bf16 v123, v146, v41
    v_dot2c_f32_bf16 v124, v130, v42
    v_dot2c_f32_bf16 v125, v146, v42
    v_dot2c_f32_bf16 v126, v130, v43
    v_dot2c_f32_bf16 v127, v146, v43
    v_dot2c_f32_bf16 v120, v131, v44
    v_dot2c_f32_bf16 v121, v147, v44
    v_dot2c_f32_bf16 v122, v131, v45
    v_dot2c_f32_bf16 v123, v147, v45
    v_dot2c_f32_bf16 v124, v131, v46
    v_dot2c_f32_bf16 v125, v147, v46
    v_dot2c_f32_bf16 v126, v131, v47
    v_dot2c_f32_bf16 v127, v147, v47
    v_dot2c_f32_bf16 v120, v132, v48
    v_dot2c_f32_bf16 v121, v148, v48
    v_dot2c_f32_bf16 v122, v132, v49
    v_dot2c_f32_bf16 v123, v148, v49
    v_dot2c_f32_bf16 v124, v132, v50
    v_dot2c_f32_bf16 v125, v148, v50
    v_dot2c_f32_bf16 v126, v132, v51
    v_dot2c_f32_bf16 v127, v148, v51
    v_dot2c_f32_bf16 v120, v133, v52
    v_dot2c_f32_bf16 v121, v149, v52
    v_dot2c_f32_bf16 v122, v133, v53
    v_dot2c_f32_bf16 v123, v149, v53
    v_dot2c_f32_bf16 v124, v133, v54
    v_dot2c_f32_bf16 v125, v149, v54
    v_dot2c_f32_bf16 v126, v133, v55
    v_dot2c_f32_bf16 v127, v149, v55
    v_dot2c_f32_bf16 v120, v134, v56
    v_dot2c_f32_bf16 v121, v150, v56
    v_dot2c_f32_bf16 v122, v134, v57
    v_dot2c_f32_bf16 v123, v150, v57
    v_dot2c_f32_bf16 v124, v134, v58
    v_dot2c_f32_bf16 v125, v150, v58
    v_dot2c_f32_bf16 v126, v134, v59
    v_dot2c_f32_bf16 v127, v150, v59
    v_dot2c_f32_bf16 v120, v135, v60
    v_dot2c_f32_bf16 v121, v151, v60
    v_dot2c_f32_bf16 v122, v135, v61
    v_dot2c_f32_bf16 v123, v151, v61
    v_dot2c_f32_bf16 v124, v135, v62
    v_dot2c_f32_bf16 v125, v151, v62
    v_dot2c_f32_bf16 v126, v135, v63
    v_dot2c_f32_bf16 v127, v151, v63
    v_dot2c_f32_bf16 v120, v136, v64
    v_dot2c_f32_bf16 v121, v152, v64
    v_dot2c_f32_bf16 v122, v136, v65
    v_dot2c_f32_bf16 v123, v152, v65
    v_dot2c_f32_bf16 v124, v136, v66
    v_dot2c_f32_bf16 v125, v152, v66
    v_dot2c_f32_bf16 v126, v136, v67
    v_dot2c_f32_bf16 v127, v152, v67
    v_dot2c_f32_bf16 v120, v137, v68
    v_dot2c_f32_bf16 v121, v153, v68
    v_dot2c_f32_bf16 v122, v137, v69
    v_dot2c_f32_bf16 v123, v153, v69
    v_dot2c_f32_bf16 v124, v137, v70
    v_dot2c_f32_bf16 v125, v153, v70
    v_dot2c_f32_bf16 v126, v137, v71
    v_dot2c_f32_bf16 v127, v153, v71
    v_dot2c_f32_bf16 v120, v138, v72
    v_dot2c_f32_bf16 v121, v154, v72
    v_dot2c_f32_bf16 v122, v138, v73
    v_dot2c_f32_bf16 v123, v154, v73
    v_dot2c_f32_bf16 v124, v138, v74
    v_dot2c_f32_bf16 v125, v154, v74
    v_dot2c_f32_bf16 v126, v138, v75
    v_dot2c_f32_bf16 v127, v154, v75
    v_dot2c_f32_bf16 v120, v139, v76
    v_dot2c_f32_bf16 v121, v155, v76
    v_dot2c_f32_bf16 v122, v139, v77
    v_dot2c_f32_bf16 v123, v155, v77
    v_dot2c_f32_bf16 v124, v139, v78
    v_dot2c_f32_bf16 v125, v155, v78
    v_dot2c_f32_bf16 v126, v139, v79
    v_dot2c_f32_bf16 v127, v155, v79
    v_dot2c_f32_bf16 v120, v140, v80
    v_dot2c_f32_bf16 v121, v156, v80
    v_dot2c_f32_bf16 v122, v140, v81
    v_dot2c_f32_bf16 v123, v156, v81
    v_dot2c_f32_bf16 v124, v140, v82
    v_dot2c_f32_bf16 v125, v156, v82
    v_dot2c_f32_bf16 v126, v140, v83
    v_dot2c_f32_bf16 v127, v156, v83
    v_dot2c_f32_bf16 v120, v141, v84
    v_dot2c_f32_bf16 v121, v157, v84
    v_dot2c_f32_bf16 v122, v141, v85
    v_dot2c_f32_bf16 v123, v157, v85
    v_dot2c_f32_bf16 v124, v141, v86
    v_dot2c_f32_bf16 v125, v157, v86
    v_dot2c_f32_bf16 v126, v141, v87
    v_dot2c_f32_bf16 v127, v157, v87
    v_lshlrev_b32 v24, 5, v0
    v_add_u32 v24, 0x24000, v24
    s_nop 1
    ds_write_b128 v24, v[120:123]
    ds_write_b128 v24, v[124:127] offset:16
    s_waitcnt lgkmcnt(0)
    s_barrier
    s_cmp_lg_u32 s18, 0
    s_cbranch_scc1 KV_NOMOD2
    v_lshlrev_b32 v25, 2, v1
    v_add_u32 v24, 0x24000, v25
    ds_read_b32 v32, v24 offset:0
    ds_read_b32 v33, v24 offset:256
    ds_read_b32 v34, v24 offset:512
    ds_read_b32 v35, v24 offset:768
    ds_read_b32 v36, v24 offset:1024
    ds_read_b32 v37, v24 offset:1280
    ds_read_b32 v38, v24 offset:1536
    ds_read_b32 v39, v24 offset:1792
    ds_read_b32 v40, v24 offset:2048
    ds_read_b32 v41, v24 offset:2304
    ds_read_b32 v42, v24 offset:2560
    ds_read_b32 v43, v24 offset:2816
    ds_read_b32 v44, v24 offset:3072
    ds_read_b32 v45, v24 offset:3328
    ds_read_b32 v46, v24 offset:3584
    ds_read_b32 v47, v24 offset:3840
    ds_read_b32 v48, v24 offset:4096
    ds_read_b32 v49, v24 offset:4352
    ds_read_b32 v50, v24 offset:4608
    ds_read_b32 v51, v24 offset:4864
    ds_read_b32 v52, v24 offset:5120
    ds_read_b32 v53, v24 offset:5376
    ds_read_b32 v54, v24 offset:5632
    ds_read_b32 v55, v24 offset:5888
    ds_read_b32 v56, v24 offset:6144
    ds_read_b32 v57, v24 offset:6400
    ds_read_b32 v58, v24 offset:6656
    ds_read_b32 v59, v24 offset:6912
    ds_read_b32 v60, v24 offset:7168
    ds_read_b32 v61, v24 offset:7424
    ds_read_b32 v62, v24 offset:7680
    ds_read_b32 v63, v24 offset:7936
    s_waitcnt lgkmcnt(0)
    v_add_f32 v32, v32, v33
    v_add_f32 v32, v32, v34
    v_add_f32 v32, v32, v35
    v_add_f32 v32, v32, v36
    v_add_f32 v32, v32, v37
    v_add_f32 v32, v32, v38
    v_add_f32 v32, v32, v39
    v_add_f32 v32, v32, v40
    v_add_f32 v32, v32, v41
    v_add_f32 v32, v32, v42
    v_add_f32 v32, v32, v43
    v_add_f32 v32, v32, v44
    v_add_f32 v32, v32, v45
    v_add_f32 v32, v32, v46
    v_add_f32 v32, v32, v47
    v_add_f32 v32, v32, v48
    v_add_f32 v32, v32, v49
    v_add_f32 v32, v32, v50
    v_add_f32 v32, v32, v51
    v_add_f32 v32, v32, v52
    v_add_f32 v32, v32, v53
    v_add_f32 v32, v32, v54
    v_add_f32 v32, v32, v55
    v_add_f32 v32, v32, v56
    v_add_f32 v32, v32, v57
    v_add_f32 v32, v32, v58
    v_add_f32 v32, v32, v59
    v_add_f32 v32, v32, v60
    v_add_f32 v32, v32, v61
    v_add_f32 v32, v32, v62
    v_add_f32 v32, v32, v63
    v_cvt_pk_bf16_f32 v32, v32, v32
    v_and_b32 v32, 0xffff0000, v32
    s_mul_i32 s3, s25, 37
    s_lshr_b32 s3, s3, 8
    s_cmp_eq_u32 s3, 1
    s_cselect_b32 s37, 1.0, 0
    s_cmp_eq_u32 s3, 4
    s_cselect_b32 s37, 1.0, s37
    v_add_f32 v32, s37, v32
    v_cvt_pk_bf16_f32 v32, v32, v32
    v_and_b32 v32, 0xffff0000, v32
    s_cmp_lt_u32 s3, 2
    s_cselect_b32 s37, 0x3db8aa3b, 1.0
    s_cmp_gt_u32 s3, 2
    s_cselect_b32 s37, 0x3fb8aa3b, s37
    s_cmp_eq_u32 s3, 5
    s_cselect_b32 s37, 0x3f317218, s37
    v_mul_f32 v32, s37, v32
    s_lshl_b32 s3, s25, 8
    buffer_store_dword v32, v25, s[8:11], s3 offen offset:0 sc1
    v_lshlrev_b32 v25, 4, v1
    s_and_b32 s3, s25, 31
    s_lshl_b32 s3, s3, 10
    s_add_u32 s3, s3, 0x8000
    buffer_store_dwordx4 v[216:219], v25, s[8:11], s3 offen sc1
    s_cmp_lg_u32 s25, 0
    s_cbranch_scc1 KV_NOMOD2
    s_mov_b32 s3, 0x4000
    buffer_store_dwordx4 v[216:219], v25, s[8:11], s3 offen sc1
    s_add_u32 s3, s3, 1024
    buffer_store_dwordx4 v[216:219], v25, s[8:11], s3 offen sc1
    s_add_u32 s3, s3, 1024
    buffer_store_dwordx4 v[216:219], v25, s[8:11], s3 offen sc1
    s_add_u32 s3, s3, 1024
    buffer_store_dwordx4 v[216:219], v25, s[8:11], s3 offen sc1
    s_add_u32 s3, s3, 1024
    buffer_store_dwordx4 v[216:219], v25, s[8:11], s3 offen sc1
    s_add_u32 s3, s3, 1024
    buffer_store_dwordx4 v[216:219], v25, s[8:11], s3 offen sc1
    s_add_u32 s3, s3, 1024
    buffer_store_dwordx4 v[216:219], v25, s[8:11], s3 offen sc1
    s_add_u32 s3, s3, 1024
    buffer_store_dwordx4 v[216:219], v25, s[8:11], s3 offen sc1
    s_add_u32 s3, s3, 1024
KV_NOMOD2:
    s_mov_b64 vcc, 0
    s_barrier
    ds_read_b128 v[32:35], v14 offset:0
    ds_read_b64_tr_b16 v[64:65], v16 offset:0
    ds_read_b64_tr_b16 v[66:67], v16 offset:2048
    ds_read_b128 v[36:39], v14 offset:2048
    ds_read_b64_tr_b16 v[68:69], v17 offset:0
    ds_read_b64_tr_b16 v[70:71], v17 offset:2048
    ds_read_b128 v[40:43], v14 offset:4096
    ds_read_b64_tr_b16 v[72:73], v18 offset:0
    ds_read_b64_tr_b16 v[74:75], v18 offset:2048
    ds_read_b128 v[44:47], v14 offset:6144
    ds_read_b64_tr_b16 v[76:77], v19 offset:0
    ds_read_b64_tr_b16 v[78:79], v19 offset:2048
    ds_read_b128 v[48:51], v14 offset:8192
    ds_read_b64_tr_b16 v[80:81], v20 offset:0
    ds_read_b64_tr_b16 v[82:83], v20 offset:2048
    ds_read_b128 v[52:55], v14 offset:10240
    ds_read_b64_tr_b16 v[84:85], v21 offset:0
    ds_read_b64_tr_b16 v[86:87], v21 offset:2048
    ds_read_b128 v[56:59], v14 offset:12288
    ds_read_b64_tr_b16 v[88:89], v22 offset:0
    ds_read_b64_tr_b16 v[90:91], v22 offset:2048
    ds_read_b128 v[60:63], v14 offset:14336
    ds_read_b64_tr_b16 v[92:93], v23 offset:0
    ds_read_b64_tr_b16 v[94:95], v23 offset:2048
    s_cmp_eq_u32 s26, 0
    s_cbranch_scc0 KV_ENT_V
KV_ENT_K:
    s_waitcnt lgkmcnt(0)
    v_mfma_f32_16x16x32_bf16 a[0:3], v[64:67], v[32:35], 0
    s_add_u32 s28, s28, 0x40000
    s_add_u32 m0, s30, 32768
    v_mfma_f32_16x16x32_bf16 a[4:7], v[68:71], v[32:35], 0
    buffer_load_dwordx4 v2, s[4:7], s28 offen lds
    v_mfma_f32_16x16x32_bf16 a[8:11], v[72:75], v[32:35], 0
    s_add_u32 m0, s30, 33792
    v_mfma_f32_16x16x32_bf16 a[12:15], v[76:79], v[32:35], 0
    buffer_load_dwordx4 v3, s[4:7], s28 offen lds
    v_mfma_f32_16x16x32_bf16 a[16:19], v[80:83], v[32:35], 0
    v_mfma_f32_16x16x32_bf16 a[20:23], v[84:87], v[32:35], 0
    s_add_u32 m0, s30, 34816
    v_mfma_f32_16x16x32_bf16 a[24:27], v[88:91], v[32:35], 0
    buffer_load_dwordx4 v4, s[4:7], s28 offen lds
    v_mfma_f32_16x16x32_bf16 a[28:31], v[92:95], v[32:35], 0
    s_add_u32 m0, s30, 35840
    v_mfma_f32_16x16x32_bf16 a[32:35], v[64:67], v[36:39], 0
    buffer_load_dwordx4 v5, s[4:7], s28 offen lds
    v_mfma_f32_16x16x32_bf16 a[36:39], v[68:71], v[36:39], 0
    v_mfma_f32_16x16x32_bf16 a[40:43], v[72:75], v[36:39], 0
    s_add_u32 m0, s36, 16384
    v_mfma_f32_16x16x32_bf16 a[44:47], v[76:79], v[36:39], 0
    buffer_load_dwordx4 v6, s[12:15], s35 offen lds
    v_add_u32 v14, s32, v11
    v_mfma_f32_16x16x32_bf16 a[48:51], v[80:83], v[36:39], 0
    s_add_u32 m0, s36, 17408
    s_waitcnt vmcnt(6)
    s_barrier
    v_mfma_f32_16x16x32_bf16 a[52:55], v[84:87], v[36:39], 0
    buffer_load_dwordx4 v7, s[12:15], s35 offen lds
    v_mfma_f32_16x16x32_bf16 a[56:59], v[88:91], v[36:39], 0
    ds_read_b128 v[96:99], v14 offset:0
    v_mfma_f32_16x16x32_bf16 a[60:63], v[92:95], v[36:39], 0
    s_add_u32 m0, s36, 18432
    ds_read_b64_tr_b16 v[128:129], v16 offset:16384
    v_mfma_f32_16x16x32_bf16 a[64:67], v[64:67], v[40:43], 0
    buffer_load_dwordx4 v8, s[12:15], s35 offen lds
    v_mfma_f32_16x16x32_bf16 a[68:71], v[68:71], v[40:43], 0
    ds_read_b64_tr_b16 v[130:131], v16 offset:18432
    v_mfma_f32_16x16x32_bf16 a[72:75], v[72:75], v[40:43], 0
    s_add_u32 m0, s36, 19456
    ds_read_b128 v[100:103], v14 offset:2048
    v_mfma_f32_16x16x32_bf16 a[76:79], v[76:79], v[40:43], 0
    buffer_load_dwordx4 v9, s[12:15], s35 offen lds
    v_mfma_f32_16x16x32_bf16 a[80:83], v[80:83], v[40:43], 0
    s_add_u32 s28, s28, 0x40000
    s_add_u32 s36, s36, 0x8000
    s_add_u32 s29, s29, 128
    s_add_u32 s35, s35, 128
    s_add_u32 m0, s30, 49152
    ds_read_b64_tr_b16 v[132:133], v17 offset:16384
    v_mfma_f32_16x16x32_bf16 a[84:87], v[84:87], v[40:43], 0
    buffer_load_dwordx4 v2, s[4:7], s28 offen lds
    v_mfma_f32_16x16x32_bf16 a[88:91], v[88:91], v[40:43], 0
    ds_read_b64_tr_b16 v[134:135], v17 offset:18432
    v_mfma_f32_16x16x32_bf16 a[92:95], v[92:95], v[40:43], 0
    s_add_u32 m0, s30, 50176
    ds_read_b128 v[104:107], v14 offset:4096
    v_mfma_f32_16x16x32_bf16 a[96:99], v[64:67], v[44:47], 0
    buffer_load_dwordx4 v3, s[4:7], s28 offen lds
    v_mfma_f32_16x16x32_bf16 a[100:103], v[68:71], v[44:47], 0
    s_add_u32 m0, s30, 51200
    ds_read_b64_tr_b16 v[136:137], v18 offset:16384
    v_mfma_f32_16x16x32_bf16 a[104:107], v[72:75], v[44:47], 0
    buffer_load_dwordx4 v4, s[4:7], s28 offen lds
    v_mfma_f32_16x16x32_bf16 a[108:111], v[76:79], v[44:47], 0
    ds_read_b64_tr_b16 v[138:139], v18 offset:18432
    v_mfma_f32_16x16x32_bf16 a[112:115], v[80:83], v[44:47], 0
    s_add_u32 m0, s30, 52224
    ds_read_b128 v[108:111], v14 offset:6144
    v_mfma_f32_16x16x32_bf16 a[116:119], v[84:87], v[44:47], 0
    buffer_load_dwordx4 v5, s[4:7], s28 offen lds
    v_mfma_f32_16x16x32_bf16 a[120:123], v[88:91], v[44:47], 0
    ds_read_b64_tr_b16 v[140:141], v19 offset:16384
    v_mfma_f32_16x16x32_bf16 a[124:127], v[92:95], v[44:47], 0
    s_add_u32 m0, s36, 0
    ds_read_b64_tr_b16 v[142:143], v19 offset:18432
    v_mfma_f32_16x16x32_bf16 a[128:131], v[64:67], v[48:51], 0
    buffer_load_dwordx4 v6, s[12:15], s29 offen lds
    v_mfma_f32_16x16x32_bf16 a[132:135], v[68:71], v[48:51], 0
    s_add_u32 m0, s36, 1024
    ds_read_b128 v[112:115], v14 offset:8192
    v_mfma_f32_16x16x32_bf16 a[136:139], v[72:75], v[48:51], 0
    buffer_load_dwordx4 v7, s[12:15], s29 offen lds
    v_mfma_f32_16x16x32_bf16 a[140:143], v[76:79], v[48:51], 0
    ds_read_b64_tr_b16 v[144:145], v20 offset:16384
    v_mfma_f32_16x16x32_bf16 a[144:147], v[80:83], v[48:51], 0
    s_add_u32 m0, s36, 2048
    ds_read_b64_tr_b16 v[146:147], v20 offset:18432
    v_mfma_f32_16x16x32_bf16 a[148:151], v[84:87], v[48:51], 0
    buffer_load_dwordx4 v8, s[12:15], s29 offen lds
    v_mfma_f32_16x16x32_bf16 a[152:155], v[88:91], v[48:51], 0
    s_add_u32 m0, s36, 3072
    ds_read_b128 v[116:119], v14 offset:10240
    v_mfma_f32_16x16x32_bf16 a[156:159], v[92:95], v[48:51], 0
    buffer_load_dwordx4 v9, s[12:15], s29 offen lds
    v_mfma_f32_16x16x32_bf16 a[160:163], v[64:67], v[52:55], 0
    ds_read_b64_tr_b16 v[148:149], v21 offset:16384
    v_mfma_f32_16x16x32_bf16 a[164:167], v[68:71], v[52:55], 0
    s_add_u32 s28, s28, 0x40000
    s_add_u32 m0, s30, 0
    ds_read_b64_tr_b16 v[150:151], v21 offset:18432
    v_mfma_f32_16x16x32_bf16 a[168:171], v[72:75], v[52:55], 0
    buffer_load_dwordx4 v2, s[4:7], s28 offen lds
    v_mfma_f32_16x16x32_bf16 a[172:175], v[76:79], v[52:55], 0
    s_add_u32 m0, s30, 1024
    ds_read_b128 v[120:123], v14 offset:12288
    v_mfma_f32_16x16x32_bf16 a[176:179], v[80:83], v[52:55], 0
    buffer_load_dwordx4 v3, s[4:7], s28 offen lds
    v_mfma_f32_16x16x32_bf16 a[180:183], v[84:87], v[52:55], 0
    ds_read_b64_tr_b16 v[152:153], v22 offset:16384
    v_mfma_f32_16x16x32_bf16 a[184:187], v[88:91], v[52:55], 0
    s_add_u32 m0, s30, 2048
    ds_read_b64_tr_b16 v[154:155], v22 offset:18432
    v_mfma_f32_16x16x32_bf16 a[188:191], v[92:95], v[52:55], 0
    buffer_load_dwordx4 v4, s[4:7], s28 offen lds
    v_mfma_f32_16x16x32_bf16 a[192:195], v[64:67], v[56:59], 0
    ds_read_b128 v[124:127], v14 offset:14336
    v_mfma_f32_16x16x32_bf16 a[196:199], v[68:71], v[56:59], 0
    s_add_u32 m0, s30, 3072
    ds_read_b64_tr_b16 v[156:157], v23 offset:16384
    v_mfma_f32_16x16x32_bf16 a[200:203], v[72:75], v[56:59], 0
    buffer_load_dwordx4 v5, s[4:7], s28 offen lds
    v_mfma_f32_16x16x32_bf16 a[204:207], v[76:79], v[56:59], 0
    s_add_u32 m0, s36, 16384
    ds_read_b64_tr_b16 v[158:159], v23 offset:18432
    v_mfma_f32_16x16x32_bf16 a[208:211], v[80:83], v[56:59], 0
    buffer_load_dwordx4 v6, s[12:15], s35 offen lds
    v_mfma_f32_16x16x32_bf16 a[212:215], v[84:87], v[56:59], 0
    v_mfma_f32_16x16x32_bf16 a[216:219], v[88:91], v[56:59], 0
    s_add_u32 m0, s36, 17408
    v_mfma_f32_16x16x32_bf16 a[220:223], v[92:95], v[56:59], 0
    buffer_load_dwordx4 v7, s[12:15], s35 offen lds
    v_mfma_f32_16x16x32_bf16 a[224:227], v[64:67], v[60:63], 0
    s_add_u32 m0, s36, 18432
    v_mfma_f32_16x16x32_bf16 a[228:231], v[68:71], v[60:63], 0
    buffer_load_dwordx4 v8, s[12:15], s35 offen lds
    v_mfma_f32_16x16x32_bf16 a[232:235], v[72:75], v[60:63], 0
    v_mfma_f32_16x16x32_bf16 a[236:239], v[76:79], v[60:63], 0
    s_add_u32 m0, s36, 19456
    v_mfma_f32_16x16x32_bf16 a[240:243], v[80:83], v[60:63], 0
    buffer_load_dwordx4 v9, s[12:15], s35 offen lds
    v_mfma_f32_16x16x32_bf16 a[244:247], v[84:87], v[60:63], 0
    v_mfma_f32_16x16x32_bf16 a[248:251], v[88:91], v[60:63], 0
    v_mfma_f32_16x16x32_bf16 a[252:255], v[92:95], v[60:63], 0
    s_add_u32 s28, s28, 0x40000
    s_branch KV_LOOP_K_T1
.p2align 6
KV_LOOP_K:
KV_LOOP_K_T0:
    s_waitcnt vmcnt(16) lgkmcnt(0)
KV_LOOP_K_R0:
    s_barrier
    v_mfma_f32_16x16x32_bf16 a[0:3], v[64:67], v[32:35], a[0:3]
    v_mfma_f32_16x16x32_bf16 a[4:7], v[68:71], v[32:35], a[4:7]
    v_add_u32 v14, s32, v11
    v_mfma_f32_16x16x32_bf16 a[8:11], v[72:75], v[32:35], a[8:11]
    ds_read_b128 v[96:99], v14 offset:0
    v_mfma_f32_16x16x32_bf16 a[12:15], v[76:79], v[32:35], a[12:15]
    v_mfma_f32_16x16x32_bf16 a[16:19], v[80:83], v[32:35], a[16:19]
    ds_read_b64_tr_b16 v[128:129], v16 offset:16384
    v_mfma_f32_16x16x32_bf16 a[20:23], v[84:87], v[32:35], a[20:23]
    v_mfma_f32_16x16x32_bf16 a[24:27], v[88:91], v[32:35], a[24:27]
    ds_read_b64_tr_b16 v[130:131], v16 offset:18432
    v_mfma_f32_16x16x32_bf16 a[28:31], v[92:95], v[32:35], a[28:31]
    v_mfma_f32_16x16x32_bf16 a[32:35], v[64:67], v[36:39], a[32:35]
    s_add_u32 m0, s30, 0
    ds_read_b128 v[100:103], v14 offset:2048
    v_mfma_f32_16x16x32_bf16 a[36:39], v[68:71], v[36:39], a[36:39]
    buffer_load_dwordx4 v2, s[4:7], s28 offen lds
    v_mfma_f32_16x16x32_bf16 a[40:43], v[72:75], v[36:39], a[40:43]
    ds_read_b64_tr_b16 v[132:133], v17 offset:16384
    v_mfma_f32_16x16x32_bf16 a[44:47], v[76:79], v[36:39], a[44:47]
    v_mfma_f32_16x16x32_bf16 a[48:51], v[80:83], v[36:39], a[48:51]
    ds_read_b64_tr_b16 v[134:135], v17 offset:18432
    v_mfma_f32_16x16x32_bf16 a[52:55], v[84:87], v[36:39], a[52:55]
    v_mfma_f32_16x16x32_bf16 a[56:59], v[88:91], v[36:39], a[56:59]
    s_add_u32 m0, s30, 1024
    ds_read_b128 v[104:107], v14 offset:4096
    v_mfma_f32_16x16x32_bf16 a[60:63], v[92:95], v[36:39], a[60:63]
    buffer_load_dwordx4 v3, s[4:7], s28 offen lds
    v_mfma_f32_16x16x32_bf16 a[64:67], v[64:67], v[40:43], a[64:67]
    ds_read_b64_tr_b16 v[136:137], v18 offset:16384
    v_mfma_f32_16x16x32_bf16 a[68:71], v[68:71], v[40:43], a[68:71]
    v_mfma_f32_16x16x32_bf16 a[72:75], v[72:75], v[40:43], a[72:75]
    ds_read_b64_tr_b16 v[138:139], v18 offset:18432
    v_mfma_f32_16x16x32_bf16 a[76:79], v[76:79], v[40:43], a[76:79]
    v_mfma_f32_16x16x32_bf16 a[80:83], v[80:83], v[40:43], a[80:83]
    s_add_u32 m0, s30, 2048
    ds_read_b128 v[108:111], v14 offset:6144
    v_mfma_f32_16x16x32_bf16 a[84:87], v[84:87], v[40:43], a[84:87]
    buffer_load_dwordx4 v4, s[4:7], s28 offen lds
    v_mfma_f32_16x16x32_bf16 a[88:91], v[88:91], v[40:43], a[88:91]
    ds_read_b64_tr_b16 v[140:141], v19 offset:16384
    v_mfma_f32_16x16x32_bf16 a[92:95], v[92:95], v[40:43], a[92:95]
    v_mfma_f32_16x16x32_bf16 a[96:99], v[64:67], v[44:47], a[96:99]
    ds_read_b64_tr_b16 v[142:143], v19 offset:18432
    v_mfma_f32_16x16x32_bf16 a[100:103], v[68:71], v[44:47], a[100:103]
    v_mfma_f32_16x16x32_bf16 a[104:107], v[72:75], v[44:47], a[104:107]
    s_add_u32 m0, s30, 3072
    ds_read_b128 v[112:115], v14 offset:8192
    v_mfma_f32_16x16x32_bf16 a[108:111], v[76:79], v[44:47], a[108:111]
    buffer_load_dwordx4 v5, s[4:7], s28 offen lds
    v_mfma_f32_16x16x32_bf16 a[112:115], v[80:83], v[44:47], a[112:115]
    ds_read_b64_tr_b16 v[144:145], v20 offset:16384
    v_mfma_f32_16x16x32_bf16 a[116:119], v[84:87], v[44:47], a[116:119]
    v_mfma_f32_16x16x32_bf16 a[120:123], v[88:91], v[44:47], a[120:123]
    ds_read_b64_tr_b16 v[146:147], v20 offset:18432
    v_mfma_f32_16x16x32_bf16 a[124:127], v[92:95], v[44:47], a[124:127]
    v_mfma_f32_16x16x32_bf16 a[128:131], v[64:67], v[48:51], a[128:131]
    s_add_u32 m0, s36, 16384
    ds_read_b128 v[116:119], v14 offset:10240
    v_mfma_f32_16x16x32_bf16 a[132:135], v[68:71], v[48:51], a[132:135]
    buffer_load_dwordx4 v6, s[12:15], s35 offen lds
    v_mfma_f32_16x16x32_bf16 a[136:139], v[72:75], v[48:51], a[136:139]
    ds_read_b64_tr_b16 v[148:149], v21 offset:16384
    v_mfma_f32_16x16x32_bf16 a[140:143], v[76:79], v[48:51], a[140:143]
    v_mfma_f32_16x16x32_bf16 a[144:147], v[80:83], v[48:51], a[144:147]
    ds_read_b64_tr_b16 v[150:151], v21 offset:18432
    v_mfma_f32_16x16x32_bf16 a[148:151], v[84:87], v[48:51], a[148:151]
    v_mfma_f32_16x16x32_bf16 a[152:155], v[88:91], v[48:51], a[152:155]
    s_add_u32 m0, s36, 17408
    ds_read_b128 v[120:123], v14 offset:12288
    v_mfma_f32_16x16x32_bf16 a[156:159], v[92:95], v[48:51], a[156:159]
    buffer_load_dwordx4 v7, s[12:15], s35 offen lds
    v_mfma_f32_16x16x32_bf16 a[160:163], v[64:67], v[52:55], a[160:163]
    ds_read_b64_tr_b16 v[152:153], v22 offset:16384
    v_mfma_f32_16x16x32_bf16 a[164:167], v[68:71], v[52:55], a[164:167]
    v_mfma_f32_16x16x32_bf16 a[168:171], v[72:75], v[52:55], a[168:171]
    ds_read_b64_tr_b16 v[154:155], v22 offset:18432
    v_mfma_f32_16x16x32_bf16 a[172:175], v[76:79], v[52:55], a[172:175]
    v_mfma_f32_16x16x32_bf16 a[176:179], v[80:83], v[52:55], a[176:179]
    s_add_u32 m0, s36, 18432
    ds_read_b128 v[124:127], v14 offset:14336
    v_mfma_f32_16x16x32_bf16 a[180:183], v[84:87], v[52:55], a[180:183]
    buffer_load_dwordx4 v8, s[12:15], s35 offen lds
    v_mfma_f32_16x16x32_bf16 a[184:187], v[88:91], v[52:55], a[184:187]
    ds_read_b64_tr_b16 v[156:157], v23 offset:16384
    v_mfma_f32_16x16x32_bf16 a[188:191], v[92:95], v[52:55], a[188:191]
    v_mfma_f32_16x16x32_bf16 a[192:195], v[64:67], v[56:59], a[192:195]
    ds_read_b64_tr_b16 v[158:159], v23 offset:18432
    v_mfma_f32_16x16x32_bf16 a[196:199], v[68:71], v[56:59], a[196:199]
    v_mfma_f32_16x16x32_bf16 a[200:203], v[72:75], v[56:59], a[200:203]
    s_add_u32 m0, s36, 19456
    v_mfma_f32_16x16x32_bf16 a[204:207], v[76:79], v[56:59], a[204:207]
    buffer_load_dwordx4 v9, s[12:15], s35 offen lds
    v_mfma_f32_16x16x32_bf16 a[208:211], v[80:83], v[56:59], a[208:211]
    v_mfma_f32_16x16x32_bf16 a[212:215], v[84:87], v[56:59], a[212:215]
    v_mfma_f32_16x16x32_bf16 a[216:219], v[88:91], v[56:59], a[216:219]
    v_mfma_f32_16x16x32_bf16 a[220:223], v[92:95], v[56:59], a[220:223]
    v_mfma_f32_16x16x32_bf16 a[224:227], v[64:67], v[60:63], a[224:227]
    v_mfma_f32_16x16x32_bf16 a[228:231], v[68:71], v[60:63], a[228:231]
    v_mfma_f32_16x16x32_bf16 a[232:235], v[72:75], v[60:63], a[232:235]
    v_mfma_f32_16x16x32_bf16 a[236:239], v[76:79], v[60:63], a[236:239]
    v_mfma_f32_16x16x32_bf16 a[240:243], v[80:83], v[60:63], a[240:243]
    v_mfma_f32_16x16x32_bf16 a[244:247], v[84:87], v[60:63], a[244:247]
    s_add_u32 s28, s28, 0x40000
    v_mfma_f32_16x16x32_bf16 a[248:251], v[88:91], v[60:63], a[248:251]
    v_mfma_f32_16x16x32_bf16 a[252:255], v[92:95], v[60:63], a[252:255]
KV_LOOP_K_T1:
    s_waitcnt vmcnt(16) lgkmcnt(0)
KV_LOOP_K_R1:
    s_barrier
    v_mfma_f32_16x16x32_bf16 a[0:3], v[128:131], v[96:99], a[0:3]
    s_add_u32 s32, s32, 0x8000
    s_cmp_eq_u32 s32, 0x18000
    s_cselect_b32 s32, 0, s32
    v_mfma_f32_16x16x32_bf16 a[4:7], v[132:135], v[96:99], a[4:7]
    v_add_u32 v14, s32, v10
    v_mfma_f32_16x16x32_bf16 a[8:11], v[136:139], v[96:99], a[8:11]
    ds_read_b128 v[32:35], v14 offset:0
    v_mfma_f32_16x16x32_bf16 a[12:15], v[140:143], v[96:99], a[12:15]
    s_add_u32 s34, s34, 0x8000
    s_cmp_eq_u32 s34, 0x18000
    s_cselect_b32 s34, 0, s34
    v_mfma_f32_16x16x32_bf16 a[16:19], v[144:147], v[96:99], a[16:19]
    ds_read_b64_tr_b16 v[64:65], v16 offset:32768
    v_mfma_f32_16x16x32_bf16 a[20:23], v[148:151], v[96:99], a[20:23]
    s_add_u32 s36, s31, s34
    s_add_u32 s29, s29, 128
    s_add_u32 s35, s35, 128
    v_mfma_f32_16x16x32_bf16 a[24:27], v[152:155], v[96:99], a[24:27]
    ds_read_b64_tr_b16 v[66:67], v16 offset:34816
    v_mfma_f32_16x16x32_bf16 a[28:31], v[156:159], v[96:99], a[28:31]
    v_mfma_f32_16x16x32_bf16 a[32:35], v[128:131], v[100:103], a[32:35]
    s_add_u32 m0, s30, 16384
    ds_read_b128 v[36:39], v14 offset:2048
    v_mfma_f32_16x16x32_bf16 a[36:39], v[132:135], v[100:103], a[36:39]
    buffer_load_dwordx4 v2, s[4:7], s28 offen lds
    v_mfma_f32_16x16x32_bf16 a[40:43], v[136:139], v[100:103], a[40:43]
    ds_read_b64_tr_b16 v[68:69], v17 offset:32768
    v_mfma_f32_16x16x32_bf16 a[44:47], v[140:143], v[100:103], a[44:47]
    v_mfma_f32_16x16x32_bf16 a[48:51], v[144:147], v[100:103], a[48:51]
    ds_read_b64_tr_b16 v[70:71], v17 offset:34816
    v_mfma_f32_16x16x32_bf16 a[52:55], v[148:151], v[100:103], a[52:55]
    v_mfma_f32_16x16x32_bf16 a[56:59], v[152:155], v[100:103], a[56:59]
    s_add_u32 m0, s30, 17408
    ds_read_b128 v[40:43], v14 offset:4096
    v_mfma_f32_16x16x32_bf16 a[60:63], v[156:159], v[100:103], a[60:63]
    buffer_load_dwordx4 v3, s[4:7], s28 offen lds
    v_mfma_f32_16x16x32_bf16 a[64:67], v[128:131], v[104:107], a[64:67]
    ds_read_b64_tr_b16 v[72:73], v18 offset:32768
    v_mfma_f32_16x16x32_bf16 a[68:71], v[132:135], v[104:107], a[68:71]
    v_mfma_f32_16x16x32_bf16 a[72:75], v[136:139], v[104:107], a[72:75]
    ds_read_b64_tr_b16 v[74:75], v18 offset:34816
    v_mfma_f32_16x16x32_bf16 a[76:79], v[140:143], v[104:107], a[76:79]
    v_mfma_f32_16x16x32_bf16 a[80:83], v[144:147], v[104:107], a[80:83]
    s_add_u32 m0, s30, 18432
    ds_read_b128 v[44:47], v14 offset:6144
    v_mfma_f32_16x16x32_bf16 a[84:87], v[148:151], v[104:107], a[84:87]
    buffer_load_dwordx4 v4, s[4:7], s28 offen lds
    v_mfma_f32_16x16x32_bf16 a[88:91], v[152:155], v[104:107], a[88:91]
    ds_read_b64_tr_b16 v[76:77], v19 offset:32768
    v_mfma_f32_16x16x32_bf16 a[92:95], v[156:159], v[104:107], a[92:95]
    v_mfma_f32_16x16x32_bf16 a[96:99], v[128:131], v[108:111], a[96:99]
    ds_read_b64_tr_b16 v[78:79], v19 offset:34816
    v_mfma_f32_16x16x32_bf16 a[100:103], v[132:135], v[108:111], a[100:103]
    v_mfma_f32_16x16x32_bf16 a[104:107], v[136:139], v[108:111], a[104:107]
    s_add_u32 m0, s30, 19456
    ds_read_b128 v[48:51], v14 offset:8192
    v_mfma_f32_16x16x32_bf16 a[108:111], v[140:143], v[108:111], a[108:111]
    buffer_load_dwordx4 v5, s[4:7], s28 offen lds
    v_mfma_f32_16x16x32_bf16 a[112:115], v[144:147], v[108:111], a[112:115]
    ds_read_b64_tr_b16 v[80:81], v20 offset:32768
    v_mfma_f32_16x16x32_bf16 a[116:119], v[148:151], v[108:111], a[116:119]
    v_mfma_f32_16x16x32_bf16 a[120:123], v[152:155], v[108:111], a[120:123]
    ds_read_b64_tr_b16 v[82:83], v20 offset:34816
    v_mfma_f32_16x16x32_bf16 a[124:127], v[156:159], v[108:111], a[124:127]
    v_mfma_f32_16x16x32_bf16 a[128:131], v[128:131], v[112:115], a[128:131]
    s_add_u32 m0, s36, 0
    ds_read_b128 v[52:55], v14 offset:10240
    v_mfma_f32_16x16x32_bf16 a[132:135], v[132:135], v[112:115], a[132:135]
    buffer_load_dwordx4 v6, s[12:15], s29 offen lds
    v_mfma_f32_16x16x32_bf16 a[136:139], v[136:139], v[112:115], a[136:139]
    ds_read_b64_tr_b16 v[84:85], v21 offset:32768
    v_mfma_f32_16x16x32_bf16 a[140:143], v[140:143], v[112:115], a[140:143]
    v_mfma_f32_16x16x32_bf16 a[144:147], v[144:147], v[112:115], a[144:147]
    ds_read_b64_tr_b16 v[86:87], v21 offset:34816
    v_mfma_f32_16x16x32_bf16 a[148:151], v[148:151], v[112:115], a[148:151]
    v_mfma_f32_16x16x32_bf16 a[152:155], v[152:155], v[112:115], a[152:155]
    s_add_u32 m0, s36, 1024
    ds_read_b128 v[56:59], v14 offset:12288
    v_mfma_f32_16x16x32_bf16 a[156:159], v[156:159], v[112:115], a[156:159]
    buffer_load_dwordx4 v7, s[12:15], s29 offen lds
    v_mfma_f32_16x16x32_bf16 a[160:163], v[128:131], v[116:119], a[160:163]
    ds_read_b64_tr_b16 v[88:89], v22 offset:32768
    v_mfma_f32_16x16x32_bf16 a[164:167], v[132:135], v[116:119], a[164:167]
    v_mfma_f32_16x16x32_bf16 a[168:171], v[136:139], v[116:119], a[168:171]
    ds_read_b64_tr_b16 v[90:91], v22 offset:34816
    v_mfma_f32_16x16x32_bf16 a[172:175], v[140:143], v[116:119], a[172:175]
    v_mfma_f32_16x16x32_bf16 a[176:179], v[144:147], v[116:119], a[176:179]
    s_add_u32 m0, s36, 2048
    ds_read_b128 v[60:63], v14 offset:14336
    v_mfma_f32_16x16x32_bf16 a[180:183], v[148:151], v[116:119], a[180:183]
    buffer_load_dwordx4 v8, s[12:15], s29 offen lds
    v_mfma_f32_16x16x32_bf16 a[184:187], v[152:155], v[116:119], a[184:187]
    ds_read_b64_tr_b16 v[92:93], v23 offset:32768
    v_mfma_f32_16x16x32_bf16 a[188:191], v[156:159], v[116:119], a[188:191]
    v_mfma_f32_16x16x32_bf16 a[192:195], v[128:131], v[120:123], a[192:195]
    ds_read_b64_tr_b16 v[94:95], v23 offset:34816
    v_mfma_f32_16x16x32_bf16 a[196:199], v[132:135], v[120:123], a[196:199]
    v_mfma_f32_16x16x32_bf16 a[200:203], v[136:139], v[120:123], a[200:203]
    s_add_u32 m0, s36, 3072
    v_mfma_f32_16x16x32_bf16 a[204:207], v[140:143], v[120:123], a[204:207]
    buffer_load_dwordx4 v9, s[12:15], s29 offen lds
    v_mfma_f32_16x16x32_bf16 a[208:211], v[144:147], v[120:123], a[208:211]
    v_mfma_f32_16x16x32_bf16 a[212:215], v[148:151], v[120:123], a[212:215]
    v_mfma_f32_16x16x32_bf16 a[216:219], v[152:155], v[120:123], a[216:219]
    v_mfma_f32_16x16x32_bf16 a[220:223], v[156:159], v[120:123], a[220:223]
    v_mfma_f32_16x16x32_bf16 a[224:227], v[128:131], v[124:127], a[224:227]
    v_mfma_f32_16x16x32_bf16 a[228:231], v[132:135], v[124:127], a[228:231]
    v_mfma_f32_16x16x32_bf16 a[232:235], v[136:139], v[124:127], a[232:235]
    v_mfma_f32_16x16x32_bf16 a[236:239], v[140:143], v[124:127], a[236:239]
    v_mfma_f32_16x16x32_bf16 a[240:243], v[144:147], v[124:127], a[240:243]
    v_mfma_f32_16x16x32_bf16 a[244:247], v[148:151], v[124:127], a[244:247]
    s_add_u32 s28, s28, 0x40000
    v_mfma_f32_16x16x32_bf16 a[248:251], v[152:155], v[124:127], a[248:251]
    v_mfma_f32_16x16x32_bf16 a[252:255], v[156:159], v[124:127], a[252:255]
KV_LOOP_K_T2:
    s_waitcnt vmcnt(16) lgkmcnt(0)
KV_LOOP_K_R2:
    s_barrier
    v_mfma_f32_16x16x32_bf16 a[0:3], v[64:67], v[32:35], a[0:3]
    v_mfma_f32_16x16x32_bf16 a[4:7], v[68:71], v[32:35], a[4:7]
    v_add_u32 v14, s32, v11
    v_mfma_f32_16x16x32_bf16 a[8:11], v[72:75], v[32:35], a[8:11]
    ds_read_b128 v[96:99], v14 offset:0
    v_mfma_f32_16x16x32_bf16 a[12:15], v[76:79], v[32:35], a[12:15]
    v_mfma_f32_16x16x32_bf16 a[16:19], v[80:83], v[32:35], a[16:19]
    ds_read_b64_tr_b16 v[128:129], v16 offset:49152
    v_mfma_f32_16x16x32_bf16 a[20:23], v[84:87], v[32:35], a[20:23]
    v_mfma_f32_16x16x32_bf16 a[24:27], v[88:91], v[32:35], a[24:27]
    ds_read_b64_tr_b16 v[130:131], v16 offset:51200
    v_mfma_f32_16x16x32_bf16 a[28:31], v[92:95], v[32:35], a[28:31]
    v_mfma_f32_16x16x32_bf16 a[32:35], v[64:67], v[36:39], a[32:35]
    s_add_u32 m0, s30, 32768
    ds_read_b128 v[100:103], v14 offset:2048
    v_mfma_f32_16x16x32_bf16 a[36:39], v[68:71], v[36:39], a[36:39]
    buffer_load_dwordx4 v2, s[4:7], s28 offen lds
    v_mfma_f32_16x16x32_bf16 a[40:43], v[72:75], v[36:39], a[40:43]
    ds_read_b64_tr_b16 v[132:133], v17 offset:49152
    v_mfma_f32_16x16x32_bf16 a[44:47], v[76:79], v[36:39], a[44:47]
    v_mfma_f32_16x16x32_bf16 a[48:51], v[80:83], v[36:39], a[48:51]
    ds_read_b64_tr_b16 v[134:135], v17 offset:51200
    v_mfma_f32_16x16x32_bf16 a[52:55], v[84:87], v[36:39], a[52:55]
    v_mfma_f32_16x16x32_bf16 a[56:59], v[88:91], v[36:39], a[56:59]
    s_add_u32 m0, s30, 33792
    ds_read_b128 v[104:107], v14 offset:4096
    v_mfma_f32_16x16x32_bf16 a[60:63], v[92:95], v[36:39], a[60:63]
    buffer_load_dwordx4 v3, s[4:7], s28 offen lds
    v_mfma_f32_16x16x32_bf16 a[64:67], v[64:67], v[40:43], a[64:67]
    ds_read_b64_tr_b16 v[136:137], v18 offset:49152
    v_mfma_f32_16x16x32_bf16 a[68:71], v[68:71], v[40:43], a[68:71]
    v_mfma_f32_16x16x32_bf16 a[72:75], v[72:75], v[40:43], a[72:75]
    ds_read_b64_tr_b16 v[138:139], v18 offset:51200
    v_mfma_f32_16x16x32_bf16 a[76:79], v[76:79], v[40:43], a[76:79]
    v_mfma_f32_16x16x32_bf16 a[80:83], v[80:83], v[40:43], a[80:83]
    s_add_u32 m0, s30, 34816
    ds_read_b128 v[108:111], v14 offset:6144
    v_mfma_f32_16x16x32_bf16 a[84:87], v[84:87], v[40:43], a[84:87]
    buffer_load_dwordx4 v4, s[4:7], s28 offen lds
    v_mfma_f32_16x16x32_bf16 a[88:91], v[88:91], v[40:43], a[88:91]
    ds_read_b64_tr_b16 v[140:141], v19 offset:49152
    v_mfma_f32_16x16x32_bf16 a[92:95], v[92:95], v[40:43], a[92:95]
    v_mfma_f32_16x16x32_bf16 a[96:99], v[64:67], v[44:47], a[96:99]
    ds_read_b64_tr_b16 v[142:143], v19 offset:51200
    v_mfma_f32_16x16x32_bf16 a[100:103], v[68:71], v[44:47], a[100:103]
    v_mfma_f32_16x16x32_bf16 a[104:107], v[72:75], v[44:47], a[104:107]
    s_add_u32 m0, s30, 35840
    ds_read_b128 v[112:115], v14 offset:8192
    v_mfma_f32_16x16x32_bf16 a[108:111], v[76:79], v[44:47], a[108:111]
    buffer_load_dwordx4 v5, s[4:7], s28 offen lds
    v_mfma_f32_16x16x32_bf16 a[112:115], v[80:83], v[44:47], a[112:115]
    ds_read_b64_tr_b16 v[144:145], v20 offset:49152
    v_mfma_f32_16x16x32_bf16 a[116:119], v[84:87], v[44:47], a[116:119]
    v_mfma_f32_16x16x32_bf16 a[120:123], v[88:91], v[44:47], a[120:123]
    ds_read_b64_tr_b16 v[146:147], v20 offset:51200
    v_mfma_f32_16x16x32_bf16 a[124:127], v[92:95], v[44:47], a[124:127]
    v_mfma_f32_16x16x32_bf16 a[128:131], v[64:67], v[48:51], a[128:131]
    s_add_u32 m0, s36, 16384
    ds_read_b128 v[116:119], v14 offset:10240
    v_mfma_f32_16x16x32_bf16 a[132:135], v[68:71], v[48:51], a[132:135]
    buffer_load_dwordx4 v6, s[12:15], s35 offen lds
    v_mfma_f32_16x16x32_bf16 a[136:139], v[72:75], v[48:51], a[136:139]
    ds_read_b64_tr_b16 v[148:149], v21 offset:49152
    v_mfma_f32_16x16x32_bf16 a[140:143], v[76:79], v[48:51], a[140:143]
    v_mfma_f32_16x16x32_bf16 a[144:147], v[80:83], v[48:51], a[144:147]
    ds_read_b64_tr_b16 v[150:151], v21 offset:51200
    v_mfma_f32_16x16x32_bf16 a[148:151], v[84:87], v[48:51], a[148:151]
    v_mfma_f32_16x16x32_bf16 a[152:155], v[88:91], v[48:51], a[152:155]
    s_add_u32 m0, s36, 17408
    ds_read_b128 v[120:123], v14 offset:12288
    v_mfma_f32_16x16x32_bf16 a[156:159], v[92:95], v[48:51], a[156:159]
    buffer_load_dwordx4 v7, s[12:15], s35 offen lds
    v_mfma_f32_16x16x32_bf16 a[160:163], v[64:67], v[52:55], a[160:163]
    ds_read_b64_tr_b16 v[152:153], v22 offset:49152
    v_mfma_f32_16x16x32_bf16 a[164:167], v[68:71], v[52:55], a[164:167]
    v_mfma_f32_16x16x32_bf16 a[168:171], v[72:75], v[52:55], a[168:171]
    ds_read_b64_tr_b16 v[154:155], v22 offset:51200
    v_mfma_f32_16x16x32_bf16 a[172:175], v[76:79], v[52:55], a[172:175]
    v_mfma_f32_16x16x32_bf16 a[176:179], v[80:83], v[52:55], a[176:179]
    s_add_u32 m0, s36, 18432
    ds_read_b128 v[124:127], v14 offset:14336
    v_mfma_f32_16x16x32_bf16 a[180:183], v[84:87], v[52:55], a[180:183]
    buffer_load_dwordx4 v8, s[12:15], s35 offen lds
    v_mfma_f32_16x16x32_bf16 a[184:187], v[88:91], v[52:55], a[184:187]
    ds_read_b64_tr_b16 v[156:157], v23 offset:49152
    v_mfma_f32_16x16x32_bf16 a[188:191], v[92:95], v[52:55], a[188:191]
    v_mfma_f32_16x16x32_bf16 a[192:195], v[64:67], v[56:59], a[192:195]
    ds_read_b64_tr_b16 v[158:159], v23 offset:51200
    v_mfma_f32_16x16x32_bf16 a[196:199], v[68:71], v[56:59], a[196:199]
    v_mfma_f32_16x16x32_bf16 a[200:203], v[72:75], v[56:59], a[200:203]
    s_add_u32 m0, s36, 19456
    v_mfma_f32_16x16x32_bf16 a[204:207], v[76:79], v[56:59], a[204:207]
    buffer_load_dwordx4 v9, s[12:15], s35 offen lds
    v_mfma_f32_16x16x32_bf16 a[208:211], v[80:83], v[56:59], a[208:211]
    v_mfma_f32_16x16x32_bf16 a[212:215], v[84:87], v[56:59], a[212:215]
    v_mfma_f32_16x16x32_bf16 a[216:219], v[88:91], v[56:59], a[216:219]
    v_mfma_f32_16x16x32_bf16 a[220:223], v[92:95], v[56:59], a[220:223]
    v_mfma_f32_16x16x32_bf16 a[224:227], v[64:67], v[60:63], a[224:227]
    v_mfma_f32_16x16x32_bf16 a[228:231], v[68:71], v[60:63], a[228:231]
    v_mfma_f32_16x16x32_bf16 a[232:235], v[72:75], v[60:63], a[232:235]
    v_mfma_f32_16x16x32_bf16 a[236:239], v[76:79], v[60:63], a[236:239]
    v_mfma_f32_16x16x32_bf16 a[240:243], v[80:83], v[60:63], a[240:243]
    v_mfma_f32_16x16x32_bf16 a[244:247], v[84:87], v[60:63], a[244:247]
    s_add_u32 s28, s28, 0x40000
    v_mfma_f32_16x16x32_bf16 a[248:251], v[88:91], v[60:63], a[248:251]
    v_mfma_f32_16x16x32_bf16 a[252:255], v[92:95], v[60:63], a[252:255]
KV_LOOP_K_T3:
    s_waitcnt vmcnt(16) lgkmcnt(0)
KV_LOOP_K_R3:
    s_barrier
    v_mfma_f32_16x16x32_bf16 a[0:3], v[128:131], v[96:99], a[0:3]
    s_add_u32 s32, s32, 0x8000
    s_cmp_eq_u32 s32, 0x18000
    s_cselect_b32 s32, 0, s32
    v_mfma_f32_16x16x32_bf16 a[4:7], v[132:135], v[96:99], a[4:7]
    v_add_u32 v14, s32, v10
    v_mfma_f32_16x16x32_bf16 a[8:11], v[136:139], v[96:99], a[8:11]
    ds_read_b128 v[32:35], v14 offset:0
    v_mfma_f32_16x16x32_bf16 a[12:15], v[140:143], v[96:99], a[12:15]
    s_add_u32 s34, s34, 0x8000
    s_cmp_eq_u32 s34, 0x18000
    s_cselect_b32 s34, 0, s34
    v_mfma_f32_16x16x32_bf16 a[16:19], v[144:147], v[96:99], a[16:19]
    ds_read_b64_tr_b16 v[64:65], v16 offset:0
    v_mfma_f32_16x16x32_bf16 a[20:23], v[148:151], v[96:99], a[20:23]
    s_add_u32 s36, s31, s34
    s_add_u32 s29, s29, 128
    s_add_u32 s35, s35, 128
    v_mfma_f32_16x16x32_bf16 a[24:27], v[152:155], v[96:99], a[24:27]
    ds_read_b64_tr_b16 v[66:67], v16 offset:2048
    v_mfma_f32_16x16x32_bf16 a[28:31], v[156:159], v[96:99], a[28:31]
    v_mfma_f32_16x16x32_bf16 a[32:35], v[128:131], v[100:103], a[32:35]
    s_add_u32 m0, s30, 49152
    ds_read_b128 v[36:39], v14 offset:2048
    v_mfma_f32_16x16x32_bf16 a[36:39], v[132:135], v[100:103], a[36:39]
    buffer_load_dwordx4 v2, s[4:7], s28 offen lds
    v_mfma_f32_16x16x32_bf16 a[40:43], v[136:139], v[100:103], a[40:43]
    ds_read_b64_tr_b16 v[68:69], v17 offset:0
    v_mfma_f32_16x16x32_bf16 a[44:47], v[140:143], v[100:103], a[44:47]
    v_mfma_f32_16x16x32_bf16 a[48:51], v[144:147], v[100:103], a[48:51]
    ds_read_b64_tr_b16 v[70:71], v17 offset:2048
    v_mfma_f32_16x16x32_bf16 a[52:55], v[148:151], v[100:103], a[52:55]
    v_mfma_f32_16x16x32_bf16 a[56:59], v[152:155], v[100:103], a[56:59]
    s_add_u32 m0, s30, 50176
    ds_read_b128 v[40:43], v14 offset:4096
    v_mfma_f32_16x16x32_bf16 a[60:63], v[156:159], v[100:103], a[60:63]
    buffer_load_dwordx4 v3, s[4:7], s28 offen lds
    v_mfma_f32_16x16x32_bf16 a[64:67], v[128:131], v[104:107], a[64:67]
    ds_read_b64_tr_b16 v[72:73], v18 offset:0
    v_mfma_f32_16x16x32_bf16 a[68:71], v[132:135], v[104:107], a[68:71]
    v_mfma_f32_16x16x32_bf16 a[72:75], v[136:139], v[104:107], a[72:75]
    ds_read_b64_tr_b16 v[74:75], v18 offset:2048
    v_mfma_f32_16x16x32_bf16 a[76:79], v[140:143], v[104:107], a[76:79]
    v_mfma_f32_16x16x32_bf16 a[80:83], v[144:147], v[104:107], a[80:83]
    s_add_u32 m0, s30, 51200
    ds_read_b128 v[44:47], v14 offset:6144
    v_mfma_f32_16x16x32_bf16 a[84:87], v[148:151], v[104:107], a[84:87]
    buffer_load_dwordx4 v4, s[4:7], s28 offen lds
    v_mfma_f32_16x16x32_bf16 a[88:91], v[152:155], v[104:107], a[88:91]
    ds_read_b64_tr_b16 v[76:77], v19 offset:0
    v_mfma_f32_16x16x32_bf16 a[92:95], v[156:159], v[104:107], a[92:95]
    v_mfma_f32_16x16x32_bf16 a[96:99], v[128:131], v[108:111], a[96:99]
    ds_read_b64_tr_b16 v[78:79], v19 offset:2048
    v_mfma_f32_16x16x32_bf16 a[100:103], v[132:135], v[108:111], a[100:103]
    v_mfma_f32_16x16x32_bf16 a[104:107], v[136:139], v[108:111], a[104:107]
    s_add_u32 m0, s30, 52224
    ds_read_b128 v[48:51], v14 offset:8192
    v_mfma_f32_16x16x32_bf16 a[108:111], v[140:143], v[108:111], a[108:111]
    buffer_load_dwordx4 v5, s[4:7], s28 offen lds
    v_mfma_f32_16x16x32_bf16 a[112:115], v[144:147], v[108:111], a[112:115]
    ds_read_b64_tr_b16 v[80:81], v20 offset:0
    v_mfma_f32_16x16x32_bf16 a[116:119], v[148:151], v[108:111], a[116:119]
    v_mfma_f32_16x16x32_bf16 a[120:123], v[152:155], v[108:111], a[120:123]
    ds_read_b64_tr_b16 v[82:83], v20 offset:2048
    v_mfma_f32_16x16x32_bf16 a[124:127], v[156:159], v[108:111], a[124:127]
    v_mfma_f32_16x16x32_bf16 a[128:131], v[128:131], v[112:115], a[128:131]
    s_add_u32 m0, s36, 0
    ds_read_b128 v[52:55], v14 offset:10240
    v_mfma_f32_16x16x32_bf16 a[132:135], v[132:135], v[112:115], a[132:135]
    buffer_load_dwordx4 v6, s[12:15], s29 offen lds
    v_mfma_f32_16x16x32_bf16 a[136:139], v[136:139], v[112:115], a[136:139]
    ds_read_b64_tr_b16 v[84:85], v21 offset:0
    v_mfma_f32_16x16x32_bf16 a[140:143], v[140:143], v[112:115], a[140:143]
    v_mfma_f32_16x16x32_bf16 a[144:147], v[144:147], v[112:115], a[144:147]
    ds_read_b64_tr_b16 v[86:87], v21 offset:2048
    v_mfma_f32_16x16x32_bf16 a[148:151], v[148:151], v[112:115], a[148:151]
    v_mfma_f32_16x16x32_bf16 a[152:155], v[152:155], v[112:115], a[152:155]
    s_add_u32 m0, s36, 1024
    ds_read_b128 v[56:59], v14 offset:12288
    v_mfma_f32_16x16x32_bf16 a[156:159], v[156:159], v[112:115], a[156:159]
    buffer_load_dwordx4 v7, s[12:15], s29 offen lds
    v_mfma_f32_16x16x32_bf16 a[160:163], v[128:131], v[116:119], a[160:163]
    ds_read_b64_tr_b16 v[88:89], v22 offset:0
    v_mfma_f32_16x16x32_bf16 a[164:167], v[132:135], v[116:119], a[164:167]
    v_mfma_f32_16x16x32_bf16 a[168:171], v[136:139], v[116:119], a[168:171]
    ds_read_b64_tr_b16 v[90:91], v22 offset:2048
    v_mfma_f32_16x16x32_bf16 a[172:175], v[140:143], v[116:119], a[172:175]
    v_mfma_f32_16x16x32_bf16 a[176:179], v[144:147], v[116:119], a[176:179]
    s_add_u32 m0, s36, 2048
    ds_read_b128 v[60:63], v14 offset:14336
    v_mfma_f32_16x16x32_bf16 a[180:183], v[148:151], v[116:119], a[180:183]
    buffer_load_dwordx4 v8, s[12:15], s29 offen lds
    v_mfma_f32_16x16x32_bf16 a[184:187], v[152:155], v[116:119], a[184:187]
    ds_read_b64_tr_b16 v[92:93], v23 offset:0
    v_mfma_f32_16x16x32_bf16 a[188:191], v[156:159], v[116:119], a[188:191]
    v_mfma_f32_16x16x32_bf16 a[192:195], v[128:131], v[120:123], a[192:195]
    ds_read_b64_tr_b16 v[94:95], v23 offset:2048
    v_mfma_f32_16x16x32_bf16 a[196:199], v[132:135], v[120:123], a[196:199]
    v_mfma_f32_16x16x32_bf16 a[200:203], v[136:139], v[120:123], a[200:203]
    s_add_u32 m0, s36, 3072
    v_mfma_f32_16x16x32_bf16 a[204:207], v[140:143], v[120:123], a[204:207]
    buffer_load_dwordx4 v9, s[12:15], s29 offen lds
    v_mfma_f32_16x16x32_bf16 a[208:211], v[144:147], v[120:123], a[208:211]
    v_mfma_f32_16x16x32_bf16 a[212:215], v[148:151], v[120:123], a[212:215]
    v_mfma_f32_16x16x32_bf16 a[216:219], v[152:155], v[120:123], a[216:219]
    v_mfma_f32_16x16x32_bf16 a[220:223], v[156:159], v[120:123], a[220:223]
    v_mfma_f32_16x16x32_bf16 a[224:227], v[128:131], v[124:127], a[224:227]
    v_mfma_f32_16x16x32_bf16 a[228:231], v[132:135], v[124:127], a[228:231]
    v_mfma_f32_16x16x32_bf16 a[232:235], v[136:139], v[124:127], a[232:235]
    v_mfma_f32_16x16x32_bf16 a[236:239], v[140:143], v[124:127], a[236:239]
    v_mfma_f32_16x16x32_bf16 a[240:243], v[144:147], v[124:127], a[240:243]
    v_mfma_f32_16x16x32_bf16 a[244:247], v[148:151], v[124:127], a[244:247]
    s_add_u32 s28, s28, 0x40000
    v_mfma_f32_16x16x32_bf16 a[248:251], v[152:155], v[124:127], a[248:251]
    s_sub_u32 s33, s33, 1
    v_mfma_f32_16x16x32_bf16 a[252:255], v[156:159], v[124:127], a[252:255]
    s_branch KV_STUB
KV_ENT_V:
    s_waitcnt lgkmcnt(0)
    v_mfma_f32_16x16x32_bf16 a[0:3], v[32:35], v[64:67], 0
    s_add_u32 s28, s28, 0x40000
    s_add_u32 m0, s30, 32768
    v_mfma_f32_16x16x32_bf16 a[32:35], v[32:35], v[68:71], 0
    buffer_load_dwordx4 v2, s[4:7], s28 offen lds
    v_mfma_f32_16x16x32_bf16 a[64:67], v[32:35], v[72:75], 0
    s_add_u32 m0, s30, 33792
    v_mfma_f32_16x16x32_bf16 a[96:99], v[32:35], v[76:79], 0
    buffer_load_dwordx4 v3, s[4:7], s28 offen lds
    v_mfma_f32_16x16x32_bf16 a[128:131], v[32:35], v[80:83], 0
    v_mfma_f32_16x16x32_bf16 a[160:163], v[32:35], v[84:87], 0
    s_add_u32 m0, s30, 34816
    v_mfma_f32_16x16x32_bf16 a[192:195], v[32:35], v[88:91], 0
    buffer_load_dwordx4 v4, s[4:7], s28 offen lds
    v_mfma_f32_16x16x32_bf16 a[224:227], v[32:35], v[92:95], 0
    s_add_u32 m0, s30, 35840
    v_mfma_f32_16x16x32_bf16 a[4:7], v[36:39], v[64:67], 0
    buffer_load_dwordx4 v5, s[4:7], s28 offen lds
    v_mfma_f32_16x16x32_bf16 a[36:39], v[36:39], v[68:71], 0
    v_mfma_f32_16x16x32_bf16 a[68:71], v[36:39], v[72:75], 0
    s_add_u32 m0, s36, 16384
    v_mfma_f32_16x16x32_bf16 a[100:103], v[36:39], v[76:79], 0
    buffer_load_dwordx4 v6, s[12:15], s35 offen lds
    v_add_u32 v14, s32, v11
    v_mfma_f32_16x16x32_bf16 a[132:135], v[36:39], v[80:83], 0
    s_add_u32 m0, s36, 17408
    s_waitcnt vmcnt(6)
    s_barrier
    v_mfma_f32_16x16x32_bf16 a[164:167], v[36:39], v[84:87], 0
    buffer_load_dwordx4 v7, s[12:15], s35 offen lds
    v_mfma_f32_16x16x32_bf16 a[196:199], v[36:39], v[88:91], 0
    ds_read_b128 v[96:99], v14 offset:0
    v_mfma_f32_16x16x32_bf16 a[228:231], v[36:39], v[92:95], 0
    s_add_u32 m0, s36, 18432
    ds_read_b64_tr_b16 v[128:129], v16 offset:16384
    v_mfma_f32_16x16x32_bf16 a[8:11], v[40:43], v[64:67], 0
    buffer_load_dwordx4 v8, s[12:15], s35 offen lds
    v_mfma_f32_16x16x32_bf16 a[40:43], v[40:43], v[68:71], 0
    ds_read_b64_tr_b16 v[130:131], v16 offset:18432
    v_mfma_f32_16x16x32_bf16 a[72:75], v[40:43], v[72:75], 0
    s_add_u32 m0, s36, 19456
    ds_read_b128 v[100:103], v14 offset:2048
    v_mfma_f32_16x16x32_bf16 a[104:107], v[40:43], v[76:79], 0
    buffer_load_dwordx4 v9, s[12:15], s35 offen lds
    v_mfma_f32_16x16x32_bf16 a[136:139], v[40:43], v[80:83], 0
    s_add_u32 s28, s28, 0x40000
    s_add_u32 s36, s36, 0x8000
    s_add_u32 s29, s29, 128
    s_add_u32 s35, s35, 128
    s_add_u32 m0, s30, 49152
    ds_read_b64_tr_b16 v[132:133], v17 offset:16384
    v_mfma_f32_16x16x32_bf16 a[168:171], v[40:43], v[84:87], 0
    buffer_load_dwordx4 v2, s[4:7], s28 offen lds
    v_mfma_f32_16x16x32_bf16 a[200:203], v[40:43], v[88:91], 0
    ds_read_b64_tr_b16 v[134:135], v17 offset:18432
    v_mfma_f32_16x16x32_bf16 a[232:235], v[40:43], v[92:95], 0
    s_add_u32 m0, s30, 50176
    ds_read_b128 v[104:107], v14 offset:4096
    v_mfma_f32_16x16x32_bf16 a[12:15], v[44:47], v[64:67], 0
    buffer_load_dwordx4 v3, s[4:7], s28 offen lds
    v_mfma_f32_16x16x32_bf16 a[44:47], v[44:47], v[68:71], 0
    s_add_u32 m0, s30, 51200
    ds_read_b64_tr_b16 v[136:137], v18 offset:16384
    v_mfma_f32_16x16x32_bf16 a[76:79], v[44:47], v[72:75], 0
    buffer_load_dwordx4 v4, s[4:7], s28 offen lds
    v_mfma_f32_16x16x32_bf16 a[108:111], v[44:47], v[76:79], 0
    ds_read_b64_tr_b16 v[138:139], v18 offset:18432
    v_mfma_f32_16x16x32_bf16 a[140:143], v[44:47], v[80:83], 0
    s_add_u32 m0, s30, 52224
    ds_read_b128 v[108:111], v14 offset:6144
    v_mfma_f32_16x16x32_bf16 a[172:175], v[44:47], v[84:87], 0
    buffer_load_dwordx4 v5, s[4:7], s28 offen lds
    v_mfma_f32_16x16x32_bf16 a[204:207], v[44:47], v[88:91], 0
    ds_read_b64_tr_b16 v[140:141], v19 offset:16384
    v_mfma_f32_16x16x32_bf16 a[236:239], v[44:47], v[92:95], 0
    s_add_u32 m0, s36, 0
    ds_read_b64_tr_b16 v[142:143], v19 offset:18432
    v_mfma_f32_16x16x32_bf16 a[16:19], v[48:51], v[64:67], 0
    buffer_load_dwordx4 v6, s[12:15], s29 offen lds
    v_mfma_f32_16x16x32_bf16 a[48:51], v[48:51], v[68:71], 0
    s_add_u32 m0, s36, 1024
    ds_read_b128 v[112:115], v14 offset:8192
    v_mfma_f32_16x16x32_bf16 a[80:83], v[48:51], v[72:75], 0
    buffer_load_dwordx4 v7, s[12:15], s29 offen lds
    v_mfma_f32_16x16x32_bf16 a[112:115], v[48:51], v[76:79], 0
    ds_read_b64_tr_b16 v[144:145], v20 offset:16384
    v_mfma_f32_16x16x32_bf16 a[144:147], v[48:51], v[80:83], 0
    s_add_u32 m0, s36, 2048
    ds_read_b64_tr_b16 v[146:147], v20 offset:18432
    v_mfma_f32_16x16x32_bf16 a[176:179], v[48:51], v[84:87], 0
    buffer_load_dwordx4 v8, s[12:15], s29 offen lds
    v_mfma_f32_16x16x32_bf16 a[208:211], v[48:51], v[88:91], 0
    s_add_u32 m0, s36, 3072
    ds_read_b128 v[116:119], v14 offset:10240
    v_mfma_f32_16x16x32_bf16 a[240:243], v[48:51], v[92:95], 0
    buffer_load_dwordx4 v9, s[12:15], s29 offen lds
    v_mfma_f32_16x16x32_bf16 a[20:23], v[52:55], v[64:67], 0
    ds_read_b64_tr_b16 v[148:149], v21 offset:16384
    v_mfma_f32_16x16x32_bf16 a[52:55], v[52:55], v[68:71], 0
    s_add_u32 s28, s28, 0x40000
    s_add_u32 m0, s30, 0
    ds_read_b64_tr_b16 v[150:151], v21 offset:18432
    v_mfma_f32_16x16x32_bf16 a[84:87], v[52:55], v[72:75], 0
    buffer_load_dwordx4 v2, s[4:7], s28 offen lds
    v_mfma_f32_16x16x32_bf16 a[116:119], v[52:55], v[76:79], 0
    s_add_u32 m0, s30, 1024
    ds_read_b128 v[120:123], v14 offset:12288
    v_mfma_f32_16x16x32_bf16 a[148:151], v[52:55], v[80:83], 0
    buffer_load_dwordx4 v3, s[4:7], s28 offen lds
    v_mfma_f32_16x16x32_bf16 a[180:183], v[52:55], v[84:87], 0
    ds_read_b64_tr_b16 v[152:153], v22 offset:16384
    v_mfma_f32_16x16x32_bf16 a[212:215], v[52:55], v[88:91], 0
    s_add_u32 m0, s30, 2048
    ds_read_b64_tr_b16 v[154:155], v22 offset:18432
    v_mfma_f32_16x16x32_bf16 a[244:247], v[52:55], v[92:95], 0
    buffer_load_dwordx4 v4, s[4:7], s28 offen lds
    v_mfma_f32_16x16x32_bf16 a[24:27], v[56:59], v[64:67], 0
    ds_read_b128 v[124:127], v14 offset:14336
    v_mfma_f32_16x16x32_bf16 a[56:59], v[56:59], v[68:71], 0
    s_add_u32 m0, s30, 3072
    ds_read_b64_tr_b16 v[156:157], v23 offset:16384
    v_mfma_f32_16x16x32_bf16 a[88:91], v[56:59], v[72:75], 0
    buffer_load_dwordx4 v5, s[4:7], s28 offen lds
    v_mfma_f32_16x16x32_bf16 a[120:123], v[56:59], v[76:79], 0
    s_add_u32 m0, s36, 16384
    ds_read_b64_tr_b16 v[158:159], v23 offset:18432
    v_mfma_f32_16x16x32_bf16 a[152:155], v[56:59], v[80:83], 0
    buffer_load_dwordx4 v6, s[12:15], s35 offen lds
    v_mfma_f32_16x16x32_bf16 a[184:187], v[56:59], v[84:87], 0
    v_mfma_f32_16x16x32_bf16 a[216:219], v[56:59], v[88:91], 0
    s_add_u32 m0, s36, 17408
    v_mfma_f32_16x16x32_bf16 a[248:251], v[56:59], v[92:95], 0
    buffer_load_dwordx4 v7, s[12:15], s35 offen lds
    v_mfma_f32_16x16x32_bf16 a[28:31], v[60:63], v[64:67], 0
    s_add_u32 m0, s36, 18432
    v_mfma_f32_16x16x32_bf16 a[60:63], v[60:63], v[68:71], 0
    buffer_load_dwordx4 v8, s[12:15], s35 offen lds
    v_mfma_f32_16x16x32_bf16 a[92:95], v[60:63], v[72:75], 0
    v_mfma_f32_16x16x32_bf16 a[124:127], v[60:63], v[76:79], 0
    s_add_u32 m0, s36, 19456
    v_mfma_f32_16x16x32_bf16 a[156:159], v[60:63], v[80:83], 0
    buffer_load_dwordx4 v9, s[12:15], s35 offen lds
    v_mfma_f32_16x16x32_bf16 a[188:191], v[60:63], v[84:87], 0
    v_mfma_f32_16x16x32_bf16 a[220:223], v[60:63], v[88:91], 0
    v_mfma_f32_16x16x32_bf16 a[252:255], v[60:63], v[92:95], 0
    s_add_u32 s28, s28, 0x40000
    s_branch KV_LOOP_V_T1
.p2align 6
KV_LOOP_V:
KV_LOOP_V_T0:
    s_waitcnt vmcnt(16) lgkmcnt(0)
KV_LOOP_V_R0:
    s_barrier
    v_mfma_f32_16x16x32_bf16 a[0:3], v[32:35], v[64:67], a[0:3]
    v_mfma_f32_16x16x32_bf16 a[32:35], v[32:35], v[68:71], a[32:35]
    v_add_u32 v14, s32, v11
    v_mfma_f32_16x16x32_bf16 a[64:67], v[32:35], v[72:75], a[64:67]
    ds_read_b128 v[96:99], v14 offset:0
    v_mfma_f32_16x16x32_bf16 a[96:99], v[32:35], v[76:79], a[96:99]
    v_mfma_f32_16x16x32_bf16 a[128:131], v[32:35], v[80:83], a[128:131]
    ds_read_b64_tr_b16 v[128:129], v16 offset:16384
    v_mfma_f32_16x16x32_bf16 a[160:163], v[32:35], v[84:87], a[160:163]
    v_mfma_f32_16x16x32_bf16 a[192:195], v[32:35], v[88:91], a[192:195]
    ds_read_b64_tr_b16 v[130:131], v16 offset:18432
    v_mfma_f32_16x16x32_bf16 a[224:227], v[32:35], v[92:95], a[224:227]
    v_mfma_f32_16x16x32_bf16 a[4:7], v[36:39], v[64:67], a[4:7]
    s_add_u32 m0, s30, 0
    ds_read_b128 v[100:103], v14 offset:2048
    v_mfma_f32_16x16x32_bf16 a[36:39], v[36:39], v[68:71], a[36:39]
    buffer_load_dwordx4 v2, s[4:7], s28 offen lds
    v_mfma_f32_16x16x32_bf16 a[68:71], v[36:39], v[72:75], a[68:71]
    ds_read_b64_tr_b16 v[132:133], v17 offset:16384
    v_mfma_f32_16x16x32_bf16 a[100:103], v[36:39], v[76:79], a[100:103]
    v_mfma_f32_16x16x32_bf16 a[132:135], v[36:39], v[80:83], a[132:135]
    ds_read_b64_tr_b16 v[134:135], v17 offset:18432
    v_mfma_f32_16x16x32_bf16 a[164:167], v[36:39], v[84:87], a[164:167]
    v_mfma_f32_16x16x32_bf16 a[196:199], v[36:39], v[88:91], a[196:199]
    s_add_u32 m0, s30, 1024
    ds_read_b128 v[104:107], v14 offset:4096
    v_mfma_f32_16x16x32_bf16 a[228:231], v[36:39], v[92:95], a[228:231]
    buffer_load_dwordx4 v3, s[4:7], s28 offen lds
    v_mfma_f32_16x16x32_bf16 a[8:11], v[40:43], v[64:67], a[8:11]
    ds_read_b64_tr_b16 v[136:137], v18 offset:16384
    v_mfma_f32_16x16x32_bf16 a[40:43], v[40:43], v[68:71], a[40:43]
    v_mfma_f32_16x16x32_bf16 a[72:75], v[40:43], v[72:75], a[72:75]
    ds_read_b64_tr_b16 v[138:139], v18 offset:18432
    v_mfma_f32_16x16x32_bf16 a[104:107], v[40:43], v[76:79], a[104:107]
    v_mfma_f32_16x16x32_bf16 a[136:139], v[40:43], v[80:83], a[136:139]
    s_add_u32 m0, s30, 2048
    ds_read_b128 v[108:111], v14 offset:6144
    v_mfma_f32_16x16x32_bf16 a[168:171], v[40:43], v[84:87], a[168:171]
    buffer_load_dwordx4 v4, s[4:7], s28 offen lds
    v_mfma_f32_16x16x32_bf16 a[200:203], v[40:43], v[88:91], a[200:203]
    ds_read_b64_tr_b16 v[140:141], v19 offset:16384
    v_mfma_f32_16x16x32_bf16 a[232:235], v[40:43], v[92:95], a[232:235]
    v_mfma_f32_16x16x32_bf16 a[12:15], v[44:47], v[64:67], a[12:15]
    ds_read_b64_tr_b16 v[142:143], v19 offset:18432
    v_mfma_f32_16x16x32_bf16 a[44:47], v[44:47], v[68:71], a[44:47]
    v_mfma_f32_16x16x32_bf16 a[76:79], v[44:47], v[72:75], a[76:79]
    s_add_u32 m0, s30, 3072
    ds_read_b128 v[112:115], v14 offset:8192
    v_mfma_f32_16x16x32_bf16 a[108:111], v[44:47], v[76:79], a[108:111]
    buffer_load_dwordx4 v5, s[4:7], s28 offen lds
    v_mfma_f32_16x16x32_bf16 a[140:143], v[44:47], v[80:83], a[140:143]
    ds_read_b64_tr_b16 v[144:145], v20 offset:16384
    v_mfma_f32_16x16x32_bf16 a[172:175], v[44:47], v[84:87], a[172:175]
    v_mfma_f32_16x16x32_bf16 a[204:207], v[44:47], v[88:91], a[204:207]
    ds_read_b64_tr_b16 v[146:147], v20 offset:18432
    v_mfma_f32_16x16x32_bf16 a[236:239], v[44:47], v[92:95], a[236:239]
    v_mfma_f32_16x16x32_bf16 a[16:19], v[48:51], v[64:67], a[16:19]
    s_add_u32 m0, s36, 16384
    ds_read_b128 v[116:119], v14 offset:10240
    v_mfma_f32_16x16x32_bf16 a[48:51], v[48:51], v[68:71], a[48:51]
    buffer_load_dwordx4 v6, s[12:15], s35 offen lds
    v_mfma_f32_16x16x32_bf16 a[80:83], v[48:51], v[72:75], a[80:83]
    ds_read_b64_tr_b16 v[148:149], v21 offset:16384
    v_mfma_f32_16x16x32_bf16 a[112:115], v[48:51], v[76:79], a[112:115]
    v_mfma_f32_16x16x32_bf16 a[144:147], v[48:51], v[80:83], a[144:147]
    ds_read_b64_tr_b16 v[150:151], v21 offset:18432
    v_mfma_f32_16x16x32_bf16 a[176:179], v[48:51], v[84:87], a[176:179]
    v_mfma_f32_16x16x32_bf16 a[208:211], v[48:51], v[88:91], a[208:211]
    s_add_u32 m0, s36, 17408
    ds_read_b128 v[120:123], v14 offset:12288
    v_mfma_f32_16x16x32_bf16 a[240:243], v[48:51], v[92:95], a[240:243]
    buffer_load_dwordx4 v7, s[12:15], s35 offen lds
    v_mfma_f32_16x16x32_bf16 a[20:23], v[52:55], v[64:67], a[20:23]
    ds_read_b64_tr_b16 v[152:153], v22 offset:16384
    v_mfma_f32_16x16x32_bf16 a[52:55], v[52:55], v[68:71], a[52:55]
    v_mfma_f32_16x16x32_bf16 a[84:87], v[52:55], v[72:75], a[84:87]
    ds_read_b64_tr_b16 v[154:155], v22 offset:18432
    v_mfma_f32_16x16x32_bf16 a[116:119], v[52:55], v[76:79], a[116:119]
    v_mfma_f32_16x16x32_bf16 a[148:151], v[52:55], v[80:83], a[148:151]
    s_add_u32 m0, s36, 18432
    ds_read_b128 v[124:127], v14 offset:14336
    v_mfma_f32_16x16x32_bf16 a[180:183], v[52:55], v[84:87], a[180:183]
    buffer_load_dwordx4 v8, s[12:15], s35 offen lds
    v_mfma_f32_16x16x32_bf16 a[212:215], v[52:55], v[88:91], a[212:215]
    ds_read_b64_tr_b16 v[156:157], v23 offset:16384
    v_mfma_f32_16x16x32_bf16 a[244:247], v[52:55], v[92:95], a[244:247]
    v_mfma_f32_16x16x32_bf16 a[24:27], v[56:59], v[64:67], a[24:27]
    ds_read_b64_tr_b16 v[158:159], v23 offset:18432
    v_mfma_f32_16x16x32_bf16 a[56:59], v[56:59], v[68:71], a[56:59]
    v_mfma_f32_16x16x32_bf16 a[88:91], v[56:59], v[72:75], a[88:91]
    s_add_u32 m0, s36, 19456
    v_mfma_f32_16x16x32_bf16 a[120:123], v[56:59], v[76:79], a[120:123]
    buffer_load_dwordx4 v9, s[12:15], s35 offen lds
    v_mfma_f32_16x16x32_bf16 a[152:155], v[56:59], v[80:83], a[152:155]
    v_mfma_f32_16x16x32_bf16 a[184:187], v[56:59], v[84:87], a[184:187]
    v_mfma_f32_16x16x32_bf16 a[216:219], v[56:59], v[88:91], a[216:219]
    v_mfma_f32_16x16x32_bf16 a[248:251], v[56:59], v[92:95], a[248:251]
    v_mfma_f32_16x16x32_bf16 a[28:31], v[60:63], v[64:67], a[28:31]
    v_mfma_f32_16x16x32_bf16 a[60:63], v[60:63], v[68:71], a[60:63]
    v_mfma_f32_16x16x32_bf16 a[92:95], v[60:63], v[72:75], a[92:95]
    v_mfma_f32_16x16x32_bf16 a[124:127], v[60:63], v[76:79], a[124:127]
    v_mfma_f32_16x16x32_bf16 a[156:159], v[60:63], v[80:83], a[156:159]
    v_mfma_f32_16x16x32_bf16 a[188:191], v[60:63], v[84:87], a[188:191]
    s_add_u32 s28, s28, 0x40000
    v_mfma_f32_16x16x32_bf16 a[220:223], v[60:63], v[88:91], a[220:223]
    v_mfma_f32_16x16x32_bf16 a[252:255], v[60:63], v[92:95], a[252:255]
KV_LOOP_V_T1:
    s_waitcnt vmcnt(16) lgkmcnt(0)
KV_LOOP_V_R1:
    s_barrier
    v_mfma_f32_16x16x32_bf16 a[0:3], v[96:99], v[128:131], a[0:3]
    s_add_u32 s32, s32, 0x8000
    s_cmp_eq_u32 s32, 0x18000
    s_cselect_b32 s32, 0, s32
    v_mfma_f32_16x16x32_bf16 a[32:35], v[96:99], v[132:135], a[32:35]
    v_add_u32 v14, s32, v10
    v_mfma_f32_16x16x32_bf16 a[64:67], v[96:99], v[136:139], a[64:67]
    ds_read_b128 v[32:35], v14 offset:0
    v_mfma_f32_16x16x32_bf16 a[96:99], v[96:99], v[140:143], a[96:99]
    s_add_u32 s34, s34, 0x8000
    s_cmp_eq_u32 s34, 0x18000
    s_cselect_b32 s34, 0, s34
    v_mfma_f32_16x16x32_bf16 a[128:131], v[96:99], v[144:147], a[128:131]
    ds_read_b64_tr_b16 v[64:65], v16 offset:32768
    v_mfma_f32_16x16x32_bf16 a[160:163], v[96:99], v[148:151], a[160:163]
    s_add_u32 s36, s31, s34
    s_add_u32 s29, s29, 128
    s_add_u32 s35, s35, 128
    v_mfma_f32_16x16x32_bf16 a[192:195], v[96:99], v[152:155], a[192:195]
    ds_read_b64_tr_b16 v[66:67], v16 offset:34816
    v_mfma_f32_16x16x32_bf16 a[224:227], v[96:99], v[156:159], a[224:227]
    v_mfma_f32_16x16x32_bf16 a[4:7], v[100:103], v[128:131], a[4:7]
    s_add_u32 m0, s30, 16384
    ds_read_b128 v[36:39], v14 offset:2048
    v_mfma_f32_16x16x32_bf16 a[36:39], v[100:103], v[132:135], a[36:39]
    buffer_load_dwordx4 v2, s[4:7], s28 offen lds
    v_mfma_f32_16x16x32_bf16 a[68:71], v[100:103], v[136:139], a[68:71]
    ds_read_b64_tr_b16 v[68:69], v17 offset:32768
    v_mfma_f32_16x16x32_bf16 a[100:103], v[100:103], v[140:143], a[100:103]
    v_mfma_f32_16x16x32_bf16 a[132:135], v[100:103], v[144:147], a[132:135]
    ds_read_b64_tr_b16 v[70:71], v17 offset:34816
    v_mfma_f32_16x16x32_bf16 a[164:167], v[100:103], v[148:151], a[164:167]
    v_mfma_f32_16x16x32_bf16 a[196:199], v[100:103], v[152:155], a[196:199]
    s_add_u32 m0, s30, 17408
    ds_read_b128 v[40:43], v14 offset:4096
    v_mfma_f32_16x16x32_bf16 a[228:231], v[100:103], v[156:159], a[228:231]
    buffer_load_dwordx4 v3, s[4:7], s28 offen lds
    v_mfma_f32_16x16x32_bf16 a[8:11], v[104:107], v[128:131], a[8:11]
    ds_read_b64_tr_b16 v[72:73], v18 offset:32768
    v_mfma_f32_16x16x32_bf16 a[40:43], v[104:107], v[132:135], a[40:43]
    v_mfma_f32_16x16x32_bf16 a[72:75], v[104:107], v[136:139], a[72:75]
    ds_read_b64_tr_b16 v[74:75], v18 offset:34816
    v_mfma_f32_16x16x32_bf16 a[104:107], v[104:107], v[140:143], a[104:107]
    v_mfma_f32_16x16x32_bf16 a[136:139], v[104:107], v[144:147], a[136:139]
    s_add_u32 m0, s30, 18432
    ds_read_b128 v[44:47], v14 offset:6144
    v_mfma_f32_16x16x32_bf16 a[168:171], v[104:107], v[148:151], a[168:171]
    buffer_load_dwordx4 v4, s[4:7], s28 offen lds
    v_mfma_f32_16x16x32_bf16 a[200:203], v[104:107], v[152:155], a[200:203]
    ds_read_b64_tr_b16 v[76:77], v19 offset:32768
    v_mfma_f32_16x16x32_bf16 a[232:235], v[104:107], v[156:159], a[232:235]
    v_mfma_f32_16x16x32_bf16 a[12:15], v[108:111], v[128:131], a[12:15]
    ds_read_b64_tr_b16 v[78:79], v19 offset:34816
    v_mfma_f32_16x16x32_bf16 a[44:47], v[108:111], v[132:135], a[44:47]
    v_mfma_f32_16x16x32_bf16 a[76:79], v[108:111], v[136:139], a[76:79]
    s_add_u32 m0, s30, 19456
    ds_read_b128 v[48:51], v14 offset:8192
    v_mfma_f32_16x16x32_bf16 a[108:111], v[108:111], v[140:143], a[108:111]
    buffer_load_dwordx4 v5, s[4:7], s28 offen lds
    v_mfma_f32_16x16x32_bf16 a[140:143], v[108:111], v[144:147], a[140:143]
    ds_read_b64_tr_b16 v[80:81], v20 offset:32768
    v_mfma_f32_16x16x32_bf16 a[172:175], v[108:111], v[148:151], a[172:175]
    v_mfma_f32_16x16x32_bf16 a[204:207], v[108:111], v[152:155], a[204:207]
    ds_read_b64_tr_b16 v[82:83], v20 offset:34816
    v_mfma_f32_16x16x32_bf16 a[236:239], v[108:111], v[156:159], a[236:239]
    v_mfma_f32_16x16x32_bf16 a[16:19], v[112:115], v[128:131], a[16:19]
    s_add_u32 m0, s36, 0
    ds_read_b128 v[52:55], v14 offset:10240
    v_mfma_f32_16x16x32_bf16 a[48:51], v[112:115], v[132:135], a[48:51]
    buffer_load_dwordx4 v6, s[12:15], s29 offen lds
    v_mfma_f32_16x16x32_bf16 a[80:83], v[112:115], v[136:139], a[80:83]
    ds_read_b64_tr_b16 v[84:85], v21 offset:32768
    v_mfma_f32_16x16x32_bf16 a[112:115], v[112:115], v[140:143], a[112:115]
    v_mfma_f32_16x16x32_bf16 a[144:147], v[112:115], v[144:147], a[144:147]
    ds_read_b64_tr_b16 v[86:87], v21 offset:34816
    v_mfma_f32_16x16x32_bf16 a[176:179], v[112:115], v[148:151], a[176:179]
    v_mfma_f32_16x16x32_bf16 a[208:211], v[112:115], v[152:155], a[208:211]
    s_add_u32 m0, s36, 1024
    ds_read_b128 v[56:59], v14 offset:12288
    v_mfma_f32_16x16x32_bf16 a[240:243], v[112:115], v[156:159], a[240:243]
    buffer_load_dwordx4 v7, s[12:15], s29 offen lds
    v_mfma_f32_16x16x32_bf16 a[20:23], v[116:119], v[128:131], a[20:23]
    ds_read_b64_tr_b16 v[88:89], v22 offset:32768
    v_mfma_f32_16x16x32_bf16 a[52:55], v[116:119], v[132:135], a[52:55]
    v_mfma_f32_16x16x32_bf16 a[84:87], v[116:119], v[136:139], a[84:87]
    ds_read_b64_tr_b16 v[90:91], v22 offset:34816
    v_mfma_f32_16x16x32_bf16 a[116:119], v[116:119], v[140:143], a[116:119]
    v_mfma_f32_16x16x32_bf16 a[148:151], v[116:119], v[144:147], a[148:151]
    s_add_u32 m0, s36, 2048
    ds_read_b128 v[60:63], v14 offset:14336
    v_mfma_f32_16x16x32_bf16 a[180:183], v[116:119], v[148:151], a[180:183]
    buffer_load_dwordx4 v8, s[12:15], s29 offen lds
    v_mfma_f32_16x16x32_bf16 a[212:215], v[116:119], v[152:155], a[212:215]
    ds_read_b64_tr_b16 v[92:93], v23 offset:32768
    v_mfma_f32_16x16x32_bf16 a[244:247], v[116:119], v[156:159], a[244:247]
    v_mfma_f32_16x16x32_bf16 a[24:27], v[120:123], v[128:131], a[24:27]
    ds_read_b64_tr_b16 v[94:95], v23 offset:34816
    v_mfma_f32_16x16x32_bf16 a[56:59], v[120:123], v[132:135], a[56:59]
    v_mfma_f32_16x16x32_bf16 a[88:91], v[120:123], v[136:139], a[88:91]
    s_add_u32 m0, s36, 3072
    v_mfma_f32_16x16x32_bf16 a[120:123], v[120:123], v[140:143], a[120:123]
    buffer_load_dwordx4 v9, s[12:15], s29 offen lds
    v_mfma_f32_16x16x32_bf16 a[152:155], v[120:123], v[144:147], a[152:155]
    v_mfma_f32_16x16x32_bf16 a[184:187], v[120:123], v[148:151], a[184:187]
    v_mfma_f32_16x16x32_bf16 a[216:219], v[120:123], v[152:155], a[216:219]
    v_mfma_f32_16x16x32_bf16 a[248:251], v[120:123], v[156:159], a[248:251]
    v_mfma_f32_16x16x32_bf16 a[28:31], v[124:127], v[128:131], a[28:31]
    v_mfma_f32_16x16x32_bf16 a[60:63], v[124:127], v[132:135], a[60:63]
    v_mfma_f32_16x16x32_bf16 a[92:95], v[124:127], v[136:139], a[92:95]
    v_mfma_f32_16x16x32_bf16 a[124:127], v[124:127], v[140:143], a[124:127]
    v_mfma_f32_16x16x32_bf16 a[156:159], v[124:127], v[144:147], a[156:159]
    v_mfma_f32_16x16x32_bf16 a[188:191], v[124:127], v[148:151], a[188:191]
    s_add_u32 s28, s28, 0x40000
    v_mfma_f32_16x16x32_bf16 a[220:223], v[124:127], v[152:155], a[220:223]
    v_mfma_f32_16x16x32_bf16 a[252:255], v[124:127], v[156:159], a[252:255]
KV_LOOP_V_T2:
    s_waitcnt vmcnt(16) lgkmcnt(0)
KV_LOOP_V_R2:
    s_barrier
    v_mfma_f32_16x16x32_bf16 a[0:3], v[32:35], v[64:67], a[0:3]
    v_mfma_f32_16x16x32_bf16 a[32:35], v[32:35], v[68:71], a[32:35]
    v_add_u32 v14, s32, v11
    v_mfma_f32_16x16x32_bf16 a[64:67], v[32:35], v[72:75], a[64:67]
    ds_read_b128 v[96:99], v14 offset:0
    v_mfma_f32_16x16x32_bf16 a[96:99], v[32:35], v[76:79], a[96:99]
    v_mfma_f32_16x16x32_bf16 a[128:131], v[32:35], v[80:83], a[128:131]
    ds_read_b64_tr_b16 v[128:129], v16 offset:49152
    v_mfma_f32_16x16x32_bf16 a[160:163], v[32:35], v[84:87], a[160:163]
    v_mfma_f32_16x16x32_bf16 a[192:195], v[32:35], v[88:91], a[192:195]
    ds_read_b64_tr_b16 v[130:131], v16 offset:51200
    v_mfma_f32_16x16x32_bf16 a[224:227], v[32:35], v[92:95], a[224:227]
    v_mfma_f32_16x16x32_bf16 a[4:7], v[36:39], v[64:67], a[4:7]
    s_add_u32 m0, s30, 32768
    ds_read_b128 v[100:103], v14 offset:2048
    v_mfma_f32_16x16x32_bf16 a[36:39], v[36:39], v[68:71], a[36:39]
    buffer_load_dwordx4 v2, s[4:7], s28 offen lds
    v_mfma_f32_16x16x32_bf16 a[68:71], v[36:39], v[72:75], a[68:71]
    ds_read_b64_tr_b16 v[132:133], v17 offset:49152
    v_mfma_f32_16x16x32_bf16 a[100:103], v[36:39], v[76:79], a[100:103]
    v_mfma_f32_16x16x32_bf16 a[132:135], v[36:39], v[80:83], a[132:135]
    ds_read_b64_tr_b16 v[134:135], v17 offset:51200
    v_mfma_f32_16x16x32_bf16 a[164:167], v[36:39], v[84:87], a[164:167]
    v_mfma_f32_16x16x32_bf16 a[196:199], v[36:39], v[88:91], a[196:199]
    s_add_u32 m0, s30, 33792
    ds_read_b128 v[104:107], v14 offset:4096
    v_mfma_f32_16x16x32_bf16 a[228:231], v[36:39], v[92:95], a[228:231]
    buffer_load_dwordx4 v3, s[4:7], s28 offen lds
    v_mfma_f32_16x16x32_bf16 a[8:11], v[40:43], v[64:67], a[8:11]
    ds_read_b64_tr_b16 v[136:137], v18 offset:49152
    v_mfma_f32_16x16x32_bf16 a[40:43], v[40:43], v[68:71], a[40:43]
    v_mfma_f32_16x16x32_bf16 a[72:75], v[40:43], v[72:75], a[72:75]
    ds_read_b64_tr_b16 v[138:139], v18 offset:51200
    v_mfma_f32_16x16x32_bf16 a[104:107], v[40:43], v[76:79], a[104:107]
    v_mfma_f32_16x16x32_bf16 a[136:139], v[40:43], v[80:83], a[136:139]
    s_add_u32 m0, s30, 34816
    ds_read_b128 v[108:111], v14 offset:6144
    v_mfma_f32_16x16x32_bf16 a[168:171], v[40:43], v[84:87], a[168:171]
    buffer_load_dwordx4 v4, s[4:7], s28 offen lds
    v_mfma_f32_16x16x32_bf16 a[200:203], v[40:43], v[88:91], a[200:203]
    ds_read_b64_tr_b16 v[140:141], v19 offset:49152
    v_mfma_f32_16x16x32_bf16 a[232:235], v[40:43], v[92:95], a[232:235]
    v_mfma_f32_16x16x32_bf16 a[12:15], v[44:47], v[64:67], a[12:15]
    ds_read_b64_tr_b16 v[142:143], v19 offset:51200
    v_mfma_f32_16x16x32_bf16 a[44:47], v[44:47], v[68:71], a[44:47]
    v_mfma_f32_16x16x32_bf16 a[76:79], v[44:47], v[72:75], a[76:79]
    s_add_u32 m0, s30, 35840
    ds_read_b128 v[112:115], v14 offset:8192
    v_mfma_f32_16x16x32_bf16 a[108:111], v[44:47], v[76:79], a[108:111]
    buffer_load_dwordx4 v5, s[4:7], s28 offen lds
    v_mfma_f32_16x16x32_bf16 a[140:143], v[44:47], v[80:83], a[140:143]
    ds_read_b64_tr_b16 v[144:145], v20 offset:49152
    v_mfma_f32_16x16x32_bf16 a[172:175], v[44:47], v[84:87], a[172:175]
    v_mfma_f32_16x16x32_bf16 a[204:207], v[44:47], v[88:91], a[204:207]
    ds_read_b64_tr_b16 v[146:147], v20 offset:51200
    v_mfma_f32_16x16x32_bf16 a[236:239], v[44:47], v[92:95], a[236:239]
    v_mfma_f32_16x16x32_bf16 a[16:19], v[48:51], v[64:67], a[16:19]
    s_add_u32 m0, s36, 16384
    ds_read_b128 v[116:119], v14 offset:10240
    v_mfma_f32_16x16x32_bf16 a[48:51], v[48:51], v[68:71], a[48:51]
    buffer_load_dwordx4 v6, s[12:15], s35 offen lds
    v_mfma_f32_16x16x32_bf16 a[80:83], v[48:51], v[72:75], a[80:83]
    ds_read_b64_tr_b16 v[148:149], v21 offset:49152
    v_mfma_f32_16x16x32_bf16 a[112:115], v[48:51], v[76:79], a[112:115]
    v_mfma_f32_16x16x32_bf16 a[144:147], v[48:51], v[80:83], a[144:147]
    ds_read_b64_tr_b16 v[150:151], v21 offset:51200
    v_mfma_f32_16x16x32_bf16 a[176:179], v[48:51], v[84:87], a[176:179]
    v_mfma_f32_16x16x32_bf16 a[208:211], v[48:51], v[88:91], a[208:211]
    s_add_u32 m0, s36, 17408
    ds_read_b128 v[120:123], v14 offset:12288
    v_mfma_f32_16x16x32_bf16 a[240:243], v[48:51], v[92:95], a[240:243]
    buffer_load_dwordx4 v7, s[12:15], s35 offen lds
    v_mfma_f32_16x16x32_bf16 a[20:23], v[52:55], v[64:67], a[20:23]
    ds_read_b64_tr_b16 v[152:153], v22 offset:49152
    v_mfma_f32_16x16x32_bf16 a[52:55], v[52:55], v[68:71], a[52:55]
    v_mfma_f32_16x16x32_bf16 a[84:87], v[52:55], v[72:75], a[84:87]
    ds_read_b64_tr_b16 v[154:155], v22 offset:51200
    v_mfma_f32_16x16x32_bf16 a[116:119], v[52:55], v[76:79], a[116:119]
    v_mfma_f32_16x16x32_bf16 a[148:151], v[52:55], v[80:83], a[148:151]
    s_add_u32 m0, s36, 18432
    ds_read_b128 v[124:127], v14 offset:14336
    v_mfma_f32_16x16x32_bf16 a[180:183], v[52:55], v[84:87], a[180:183]
    buffer_load_dwordx4 v8, s[12:15], s35 offen lds
    v_mfma_f32_16x16x32_bf16 a[212:215], v[52:55], v[88:91], a[212:215]
    ds_read_b64_tr_b16 v[156:157], v23 offset:49152
    v_mfma_f32_16x16x32_bf16 a[244:247], v[52:55], v[92:95], a[244:247]
    v_mfma_f32_16x16x32_bf16 a[24:27], v[56:59], v[64:67], a[24:27]
    ds_read_b64_tr_b16 v[158:159], v23 offset:51200
    v_mfma_f32_16x16x32_bf16 a[56:59], v[56:59], v[68:71], a[56:59]
    v_mfma_f32_16x16x32_bf16 a[88:91], v[56:59], v[72:75], a[88:91]
    s_add_u32 m0, s36, 19456
    v_mfma_f32_16x16x32_bf16 a[120:123], v[56:59], v[76:79], a[120:123]
    buffer_load_dwordx4 v9, s[12:15], s35 offen lds
    v_mfma_f32_16x16x32_bf16 a[152:155], v[56:59], v[80:83], a[152:155]
    v_mfma_f32_16x16x32_bf16 a[184:187], v[56:59], v[84:87], a[184:187]
    v_mfma_f32_16x16x32_bf16 a[216:219], v[56:59], v[88:91], a[216:219]
    v_mfma_f32_16x16x32_bf16 a[248:251], v[56:59], v[92:95], a[248:251]
    v_mfma_f32_16x16x32_bf16 a[28:31], v[60:63], v[64:67], a[28:31]
    v_mfma_f32_16x16x32_bf16 a[60:63], v[60:63], v[68:71], a[60:63]
    v_mfma_f32_16x16x32_bf16 a[92:95], v[60:63], v[72:75], a[92:95]
    v_mfma_f32_16x16x32_bf16 a[124:127], v[60:63], v[76:79], a[124:127]
    v_mfma_f32_16x16x32_bf16 a[156:159], v[60:63], v[80:83], a[156:159]
    v_mfma_f32_16x16x32_bf16 a[188:191], v[60:63], v[84:87], a[188:191]
    s_add_u32 s28, s28, 0x40000
    v_mfma_f32_16x16x32_bf16 a[220:223], v[60:63], v[88:91], a[220:223]
    v_mfma_f32_16x16x32_bf16 a[252:255], v[60:63], v[92:95], a[252:255]
KV_LOOP_V_T3:
    s_waitcnt vmcnt(16) lgkmcnt(0)
KV_LOOP_V_R3:
    s_barrier
    v_mfma_f32_16x16x32_bf16 a[0:3], v[96:99], v[128:131], a[0:3]
    s_add_u32 s32, s32, 0x8000
    s_cmp_eq_u32 s32, 0x18000
    s_cselect_b32 s32, 0, s32
    v_mfma_f32_16x16x32_bf16 a[32:35], v[96:99], v[132:135], a[32:35]
    v_add_u32 v14, s32, v10
    v_mfma_f32_16x16x32_bf16 a[64:67], v[96:99], v[136:139], a[64:67]
    ds_read_b128 v[32:35], v14 offset:0
    v_mfma_f32_16x16x32_bf16 a[96:99], v[96:99], v[140:143], a[96:99]
    s_add_u32 s34, s34, 0x8000
    s_cmp_eq_u32 s34, 0x18000
    s_cselect_b32 s34, 0, s34
    v_mfma_f32_16x16x32_bf16 a[128:131], v[96:99], v[144:147], a[128:131]
    ds_read_b64_tr_b16 v[64:65], v16 offset:0
    v_mfma_f32_16x16x32_bf16 a[160:163], v[96:99], v[148:151], a[160:163]
    s_add_u32 s36, s31, s34
    s_add_u32 s29, s29, 128
    s_add_u32 s35, s35, 128
    v_mfma_f32_16x16x32_bf16 a[192:195], v[96:99], v[152:155], a[192:195]
    ds_read_b64_tr_b16 v[66:67], v16 offset:2048
    v_mfma_f32_16x16x32_bf16 a[224:227], v[96:99], v[156:159], a[224:227]
    v_mfma_f32_16x16x32_bf16 a[4:7], v[100:103], v[128:131], a[4:7]
    s_add_u32 m0, s30, 49152
    ds_read_b128 v[36:39], v14 offset:2048
    v_mfma_f32_16x16x32_bf16 a[36:39], v[100:103], v[132:135], a[36:39]
    buffer_load_dwordx4 v2, s[4:7], s28 offen lds
    v_mfma_f32_16x16x32_bf16 a[68:71], v[100:103], v[136:139], a[68:71]
    ds_read_b64_tr_b16 v[68:69], v17 offset:0
    v_mfma_f32_16x16x32_bf16 a[100:103], v[100:103], v[140:143], a[100:103]
    v_mfma_f32_16x16x32_bf16 a[132:135], v[100:103], v[144:147], a[132:135]
    ds_read_b64_tr_b16 v[70:71], v17 offset:2048
    v_mfma_f32_16x16x32_bf16 a[164:167], v[100:103], v[148:151], a[164:167]
    v_mfma_f32_16x16x32_bf16 a[196:199], v[100:103], v[152:155], a[196:199]
    s_add_u32 m0, s30, 50176
    ds_read_b128 v[40:43], v14 offset:4096
    v_mfma_f32_16x16x32_bf16 a[228:231], v[100:103], v[156:159], a[228:231]
    buffer_load_dwordx4 v3, s[4:7], s28 offen lds
    v_mfma_f32_16x16x32_bf16 a[8:11], v[104:107], v[128:131], a[8:11]
    ds_read_b64_tr_b16 v[72:73], v18 offset:0
    v_mfma_f32_16x16x32_bf16 a[40:43], v[104:107], v[132:135], a[40:43]
    v_mfma_f32_16x16x32_bf16 a[72:75], v[104:107], v[136:139], a[72:75]
    ds_read_b64_tr_b16 v[74:75], v18 offset:2048
    v_mfma_f32_16x16x32_bf16 a[104:107], v[104:107], v[140:143], a[104:107]
    v_mfma_f32_16x16x32_bf16 a[136:139], v[104:107], v[144:147], a[136:139]
    s_add_u32 m0, s30, 51200
    ds_read_b128 v[44:47], v14 offset:6144
    v_mfma_f32_16x16x32_bf16 a[168:171], v[104:107], v[148:151], a[168:171]
    buffer_load_dwordx4 v4, s[4:7], s28 offen lds
    v_mfma_f32_16x16x32_bf16 a[200:203], v[104:107], v[152:155], a[200:203]
    ds_read_b64_tr_b16 v[76:77], v19 offset:0
    v_mfma_f32_16x16x32_bf16 a[232:235], v[104:107], v[156:159], a[232:235]
    v_mfma_f32_16x16x32_bf16 a[12:15], v[108:111], v[128:131], a[12:15]
    ds_read_b64_tr_b16 v[78:79], v19 offset:2048
    v_mfma_f32_16x16x32_bf16 a[44:47], v[108:111], v[132:135], a[44:47]
    v_mfma_f32_16x16x32_bf16 a[76:79], v[108:111], v[136:139], a[76:79]
    s_add_u32 m0, s30, 52224
    ds_read_b128 v[48:51], v14 offset:8192
    v_mfma_f32_16x16x32_bf16 a[108:111], v[108:111], v[140:143], a[108:111]
    buffer_load_dwordx4 v5, s[4:7], s28 offen lds
    v_mfma_f32_16x16x32_bf16 a[140:143], v[108:111], v[144:147], a[140:143]
    ds_read_b64_tr_b16 v[80:81], v20 offset:0
    v_mfma_f32_16x16x32_bf16 a[172:175], v[108:111], v[148:151], a[172:175]
    v_mfma_f32_16x16x32_bf16 a[204:207], v[108:111], v[152:155], a[204:207]
    ds_read_b64_tr_b16 v[82:83], v20 offset:2048
    v_mfma_f32_16x16x32_bf16 a[236:239], v[108:111], v[156:159], a[236:239]
    v_mfma_f32_16x16x32_bf16 a[16:19], v[112:115], v[128:131], a[16:19]
    s_add_u32 m0, s36, 0
    ds_read_b128 v[52:55], v14 offset:10240
    v_mfma_f32_16x16x32_bf16 a[48:51], v[112:115], v[132:135], a[48:51]
    buffer_load_dwordx4 v6, s[12:15], s29 offen lds
    v_mfma_f32_16x16x32_bf16 a[80:83], v[112:115], v[136:139], a[80:83]
    ds_read_b64_tr_b16 v[84:85], v21 offset:0
    v_mfma_f32_16x16x32_bf16 a[112:115], v[112:115], v[140:143], a[112:115]
    v_mfma_f32_16x16x32_bf16 a[144:147], v[112:115], v[144:147], a[144:147]
    ds_read_b64_tr_b16 v[86:87], v21 offset:2048
    v_mfma_f32_16x16x32_bf16 a[176:179], v[112:115], v[148:151], a[176:179]
    v_mfma_f32_16x16x32_bf16 a[208:211], v[112:115], v[152:155], a[208:211]
    s_add_u32 m0, s36, 1024
    ds_read_b128 v[56:59], v14 offset:12288
    v_mfma_f32_16x16x32_bf16 a[240:243], v[112:115], v[156:159], a[240:243]
    buffer_load_dwordx4 v7, s[12:15], s29 offen lds
    v_mfma_f32_16x16x32_bf16 a[20:23], v[116:119], v[128:131], a[20:23]
    ds_read_b64_tr_b16 v[88:89], v22 offset:0
    v_mfma_f32_16x16x32_bf16 a[52:55], v[116:119], v[132:135], a[52:55]
    v_mfma_f32_16x16x32_bf16 a[84:87], v[116:119], v[136:139], a[84:87]
    ds_read_b64_tr_b16 v[90:91], v22 offset:2048
    v_mfma_f32_16x16x32_bf16 a[116:119], v[116:119], v[140:143], a[116:119]
    v_mfma_f32_16x16x32_bf16 a[148:151], v[116:119], v[144:147], a[148:151]
    s_add_u32 m0, s36, 2048
    ds_read_b128 v[60:63], v14 offset:14336
    v_mfma_f32_16x16x32_bf16 a[180:183], v[116:119], v[148:151], a[180:183]
    buffer_load_dwordx4 v8, s[12:15], s29 offen lds
    v_mfma_f32_16x16x32_bf16 a[212:215], v[116:119], v[152:155], a[212:215]
    ds_read_b64_tr_b16 v[92:93], v23 offset:0
    v_mfma_f32_16x16x32_bf16 a[244:247], v[116:119], v[156:159], a[244:247]
    v_mfma_f32_16x16x32_bf16 a[24:27], v[120:123], v[128:131], a[24:27]
    ds_read_b64_tr_b16 v[94:95], v23 offset:2048
    v_mfma_f32_16x16x32_bf16 a[56:59], v[120:123], v[132:135], a[56:59]
    v_mfma_f32_16x16x32_bf16 a[88:91], v[120:123], v[136:139], a[88:91]
    s_add_u32 m0, s36, 3072
    v_mfma_f32_16x16x32_bf16 a[120:123], v[120:123], v[140:143], a[120:123]
    buffer_load_dwordx4 v9, s[12:15], s29 offen lds
    v_mfma_f32_16x16x32_bf16 a[152:155], v[120:123], v[144:147], a[152:155]
    v_mfma_f32_16x16x32_bf16 a[184:187], v[120:123], v[148:151], a[184:187]
    v_mfma_f32_16x16x32_bf16 a[216:219], v[120:123], v[152:155], a[216:219]
    v_mfma_f32_16x16x32_bf16 a[248:251], v[120:123], v[156:159], a[248:251]
    v_mfma_f32_16x16x32_bf16 a[28:31], v[124:127], v[128:131], a[28:31]
    v_mfma_f32_16x16x32_bf16 a[60:63], v[124:127], v[132:135], a[60:63]
    v_mfma_f32_16x16x32_bf16 a[92:95], v[124:127], v[136:139], a[92:95]
    v_mfma_f32_16x16x32_bf16 a[124:127], v[124:127], v[140:143], a[124:127]
    v_mfma_f32_16x16x32_bf16 a[156:159], v[124:127], v[144:147], a[156:159]
    v_mfma_f32_16x16x32_bf16 a[188:191], v[124:127], v[148:151], a[188:191]
    s_add_u32 s28, s28, 0x40000
    v_mfma_f32_16x16x32_bf16 a[220:223], v[124:127], v[152:155], a[220:223]
    s_sub_u32 s33, s33, 1
    v_mfma_f32_16x16x32_bf16 a[252:255], v[124:127], v[156:159], a[252:255]
    s_branch KV_STUB
KV_STUB:
    s_mov_b64 vcc, 0
    s_cmp_eq_u32 s33, 7
    s_cbranch_scc0 KV_ST6
    s_mov_b32 s40, s50
    s_and_b32 s41, s51, 0xffff
    s_mov_b32 s42, 0x1c0000
    s_mov_b32 s43, 0x20000
    s_cmp_eq_u32 s18, 3
    s_cselect_b32 s3, 0x70000000, 0
    buffer_load_dwordx2 v[180:181], v177, s[40:43], 0 offen offset:0
    buffer_load_dwordx2 v[182:183], v177, s[40:43], 0 offen offset:32
    buffer_load_dwordx2 v[184:185], v177, s[40:43], s3 offen offset:512
    buffer_load_dwordx2 v[186:187], v177, s[40:43], s3 offen offset:544
    s_cmp_lt_u32 s25, 42
    s_cbranch_scc0 KV_STRET
    s_mov_b32 s3, 0
    s_cmp_lg_u32 s18, 0
    s_cbranch_scc1 KV_SIGMOD
    v_mov_b32 v214, 1
    v_mov_b32 v215, 0
    s_mov_b64 exec, 1
    buffer_atomic_add v214, v215, s[44:47], s3 offen sc1
    s_mov_b64 exec, -1
KV_SIGMOD:
    s_branch KV_STRET
KV_ST6:
    s_cmp_eq_u32 s33, 6
    s_cbranch_scc0 KV_ST6B
    v_lshlrev_b32 v160, 16, v180
    v_and_b32 v161, 0xffff0000, v180
    v_lshlrev_b32 v162, 16, v181
    v_and_b32 v163, 0xffff0000, v181
    v_lshlrev_b32 v164, 16, v182
    v_and_b32 v165, 0xffff0000, v182
    v_lshlrev_b32 v166, 16, v183
    v_and_b32 v167, 0xffff0000, v183
    v_lshlrev_b32 v168, 16, v184
    v_and_b32 v169, 0xffff0000, v184
    v_lshlrev_b32 v170, 16, v185
    v_and_b32 v171, 0xffff0000, v185
    v_lshlrev_b32 v172, 16, v186
    v_and_b32 v173, 0xffff0000, v186
    v_lshlrev_b32 v174, 16, v187
    v_and_b32 v175, 0xffff0000, v187
    s_add_u32 s3, s34, 0x14000
    v_add_u32 v226, s3, v212
    s_lshl_b32 s3, s18, 3
    v_add_u32 v227, s3, v226
    s_cmp_eq_u32 s18, 3
    s_mov_b32 s37, 0x3c000000
    s_cselect_b32 s37, 0x3c800000, s37
    s_cselect_b32 s38, 0, 1.0
    v_pk_add_f32 v[24:25], v[160:161], v[162:163]
    v_pk_add_f32 v[24:25], v[24:25], v[164:165]
    v_pk_add_f32 v[24:25], v[24:25], v[166:167]
    v_pk_add_f32 v[24:25], v[24:25], v[168:169]
    v_pk_add_f32 v[24:25], v[24:25], v[170:171]
    v_pk_add_f32 v[24:25], v[24:25], v[172:173]
    v_pk_add_f32 v[24:25], v[24:25], v[174:175]
    v_add_f32 v24, v24, v25
    s_nop 1
    v_add_f32_dpp v24, v24, v24 row_ror:8 row_mask:0xf bank_mask:0xf
    v_mov_b32 v26, v24
    s_nop 1
    v_permlane16_swap_b32 v24, v26
    v_add_f32 v24, v24, v26
    v_mov_b32 v26, v24
    s_nop 1
    v_permlane32_swap_b32 v24, v26
    v_add_f32 v24, v24, v26
    v_mul_f32 v28, s37, v24
    v_mov_b32 v25, 0
    v_mov_b32 v27, 0
    v_sub_f32 v26, v160, v28
    v_fmac_f32 v25, v26, v26
    v_sub_f32 v26, v161, v28
    v_fmac_f32 v25, v26, v26
    v_sub_f32 v26, v162, v28
    v_fmac_f32 v25, v26, v26
    v_sub_f32 v26, v163, v28
    v_fmac_f32 v25, v26, v26
    v_sub_f32 v26, v164, v28
    v_fmac_f32 v25, v26, v26
    v_sub_f32 v26, v165, v28
    v_fmac_f32 v25, v26, v26
    v_sub_f32 v26, v166, v28
    v_fmac_f32 v25, v26, v26
    v_sub_f32 v26, v167, v28
    v_fmac_f32 v25, v26, v26
    v_sub_f32 v26, v168, v28
    v_fmac_f32 v27, v26, v26
    v_sub_f32 v26, v169, v28
    v_fmac_f32 v27, v26, v26
    v_sub_f32 v26, v170, v28
    v_fmac_f32 v27, v26, v26
    v_sub_f32 v26, v171, v28
    v_fmac_f32 v27, v26, v26
    v_sub_f32 v26, v172, v28
    v_fmac_f32 v27, v26, v26
    v_sub_f32 v26, v173, v28
    v_fmac_f32 v27, v26, v26
    v_sub_f32 v26, v174, v28
    v_fmac_f32 v27, v26, v26
    v_sub_f32 v26, v175, v28
    v_fmac_f32 v27, v26, v26
    v_fmac_f32 v25, s38, v27
    s_nop 1
    v_add_f32_dpp v25, v25, v25 row_ror:8 row_mask:0xf bank_mask:0xf
    v_mov_b32 v26, v25
    s_nop 1
    v_permlane16_swap_b32 v25, v26
    v_add_f32 v25, v25, v26
    v_mov_b32 v26, v25
    s_nop 1
    v_permlane32_swap_b32 v25, v26
    v_add_f32 v25, v25, v26
    ds_write_b64 v227, v[24:25]
    s_waitcnt lgkmcnt(0)
    s_barrier
    ds_read_b128 v[228:231], v226
    ds_read_b128 v[232:235], v226 offset:16
    s_waitcnt lgkmcnt(0)
    v_add_f32 v24, v228, v230
    v_add_f32 v25, v232, v234
    v_add_f32 v24, v24, v25
    v_mul_f32 v24, 0x3b124925, v24
    v_add_f32 v25, v229, v231
    v_add_f32 v26, v233, v235
    v_add_f32 v25, v25, v26
    v_mul_f32 v26, 0x3c000000, v228
    v_sub_f32 v26, v26, v24
    v_mul_f32 v26, v26, v26
    v_fmac_f32 v25, 0x43000000, v26
    v_mul_f32 v26, 0x3c000000, v230
    v_sub_f32 v26, v26, v24
    v_mul_f32 v26, v26, v26
    v_fmac_f32 v25, 0x43000000, v26
    v_mul_f32 v26, 0x3c000000, v232
    v_sub_f32 v26, v26, v24
    v_mul_f32 v26, v26, v26
    v_fmac_f32 v25, 0x43000000, v26
    v_mul_f32 v26, 0x3c800000, v234
    v_sub_f32 v26, v26, v24
    v_mul_f32 v26, v26, v26
    v_fmac_f32 v25, 0x42800000, v26
    v_mov_b32 v26, 0x3727c5ac
    v_fmac_f32 v26, 0x3b124925, v25
    v_rsq_f32 v26, v26
    v_pk_add_f32 v[160:161], v[160:161], v[24:25] op_sel_hi:[1,0] neg_lo:[0,1] neg_hi:[0,1]
    v_pk_add_f32 v[162:163], v[162:163], v[24:25] op_sel_hi:[1,0] neg_lo:[0,1] neg_hi:[0,1]
    v_pk_add_f32 v[164:165], v[164:165], v[24:25] op_sel_hi:[1,0] neg_lo:[0,1] neg_hi:[0,1]
    v_pk_add_f32 v[166:167], v[166:167], v[24:25] op_sel_hi:[1,0] neg_lo:[0,1] neg_hi:[0,1]
    v_pk_add_f32 v[168:169], v[168:169], v[24:25] op_sel_hi:[1,0] neg_lo:[0,1] neg_hi:[0,1]
    v_pk_add_f32 v[170:171], v[170:171], v[24:25] op_sel_hi:[1,0] neg_lo:[0,1] neg_hi:[0,1]
    v_pk_add_f32 v[172:173], v[172:173], v[24:25] op_sel_hi:[1,0] neg_lo:[0,1] neg_hi:[0,1]
    v_pk_add_f32 v[174:175], v[174:175], v[24:25] op_sel_hi:[1,0] neg_lo:[0,1] neg_hi:[0,1]
    v_pk_mul_f32 v[160:161], v[160:161], v[26:27] op_sel_hi:[1,0]
    v_pk_mul_f32 v[162:163], v[162:163], v[26:27] op_sel_hi:[1,0]
    v_pk_mul_f32 v[164:165], v[164:165], v[26:27] op_sel_hi:[1,0]
    v_pk_mul_f32 v[166:167], v[166:167], v[26:27] op_sel_hi:[1,0]
    v_pk_mul_f32 v[168:169], v[168:169], v[26:27] op_sel_hi:[1,0]
    v_pk_mul_f32 v[170:171], v[170:171], v[26:27] op_sel_hi:[1,0]
    v_pk_mul_f32 v[172:173], v[172:173], v[26:27] op_sel_hi:[1,0]
    v_pk_mul_f32 v[174:175], v[174:175], v[26:27] op_sel_hi:[1,0]
    s_branch KV_STRET
KV_ST6B:
    s_cmp_eq_u32 s33, 5
    s_cbranch_scc0 KV_ST5
    buffer_load_dword v176, v213, s[44:47], 0 offen sc1
    buffer_load_dword v215, v213, s[44:47], s39 offen sc1
    s_branch KV_STRET
KV_ST5:
    s_cmp_eq_u32 s33, 4
    s_cbranch_scc0 KV_ST4
    s_mov_b32 s38, 0
    s_branch KV_POLLX_CHK
KV_POLLX:
    buffer_load_dword v215, v213, s[44:47], s39 offen sc1
    s_waitcnt vmcnt(0)
KV_POLLX_CHK:
    v_readfirstlane_b32 s37, v215
    s_nop 0
    s_cmp_ge_u32 s37, 536870912
    s_cbranch_scc1 KV_POLLX_OK
    s_add_u32 s38, s38, 1
    s_cmp_ge_u32 s38, 0x40000
    s_cbranch_scc1 KV_POLLX_OK
    s_sleep 2
    s_branch KV_POLLX
KV_POLLX_OK:
    s_cmp_eq_u32 s37, s96
    s_cselect_b32 s96, 1, 0
    s_mov_b32 s3, 0
    s_mov_b32 s38, 0
    s_branch KV_POLLMOD_CHK
KV_POLLMOD:
    buffer_load_dword v176, v213, s[44:47], s3 offen sc1
    s_waitcnt vmcnt(0)
KV_POLLMOD_CHK:
    v_readfirstlane_b32 s37, v176
    s_nop 0
    s_cmp_ge_u32 s37, 42
    s_cbranch_scc1 KV_POLLMOD_OK
    s_add_u32 s38, s38, 1
    s_cmp_ge_u32 s38, 0x40000
    s_cbranch_scc1 KV_POLLMOD_OK
    s_sleep 2
    s_branch KV_POLLMOD
KV_POLLMOD_OK:
    buffer_load_dwordx4 v[180:183], v178, s[8:11], 0 offen offset:1792 sc1
    buffer_load_dwordx4 v[184:187], v178, s[8:11], 0 offen offset:1856 sc1
    buffer_load_dwordx4 v[188:191], v178, s[8:11], 0 offen offset:2816 sc1
    buffer_load_dwordx4 v[192:195], v178, s[8:11], 0 offen offset:2880 sc1
    buffer_load_dwordx4 v[196:199], v178, s[8:11], 0 offen offset:0 sc1
    buffer_load_dwordx4 v[200:203], v178, s[8:11], 0 offen offset:64 sc1
    buffer_load_dwordx4 v[204:207], v178, s[8:11], 0 offen offset:1024 sc1
    buffer_load_dwordx4 v[208:211], v178, s[8:11], 0 offen offset:1088 sc1
    s_branch KV_STRET
KV_ST4:
    s_cmp_eq_u32 s33, 3
    s_cbranch_scc0 KV_ST3
    v_pk_fma_f32 v[160:161], v[160:161], v[180:181], v[196:197]
    v_pk_fma_f32 v[162:163], v[162:163], v[182:183], v[198:199]
    v_pk_fma_f32 v[164:165], v[164:165], v[184:185], v[200:201]
    v_pk_fma_f32 v[166:167], v[166:167], v[186:187], v[202:203]
    v_pk_fma_f32 v[168:169], v[168:169], v[188:189], v[204:205]
    v_pk_fma_f32 v[170:171], v[170:171], v[190:191], v[206:207]
    v_pk_fma_f32 v[172:173], v[172:173], v[192:193], v[208:209]
    v_pk_fma_f32 v[174:175], v[174:175], v[194:195], v[210:211]
    v_cvt_pk_bf16_f32 v180, v160, v161
    v_cvt_pk_bf16_f32 v181, v162, v163
    v_cvt_pk_bf16_f32 v182, v164, v165
    v_cvt_pk_bf16_f32 v183, v166, v167
    v_cvt_pk_bf16_f32 v184, v168, v169
    v_cvt_pk_bf16_f32 v185, v170, v171
    v_cvt_pk_bf16_f32 v186, v172, v173
    v_cvt_pk_bf16_f32 v187, v174, v175
    s_mov_b32 s3, 0x100000
    buffer_store_dwordx4 v[180:183], v179, s[8:11], s3 offen sc1
    s_cmp_eq_u32 s18, 3
    s_cselect_b32 s3, 0x70000000, 0
    s_add_u32 s3, s3, 0x102000
    buffer_store_dwordx4 v[184:187], v179, s[8:11], s3 offen sc1
    s_branch KV_STRET
KV_ST3:
    s_cmp_eq_u32 s33, 2
    s_cbranch_scc0 KV_ST2
    s_lshr_b32 s37, s2, 4
    s_lshl_b32 s3, s37, 6
    s_add_u32 s3, s3, 0x4000
    s_cmp_lg_u32 s18, 0
    s_cbranch_scc1 KV_SIGH
    v_mov_b32 v214, 1
    v_mov_b32 v215, 0
    s_mov_b64 exec, 1
    buffer_atomic_add v214, v215, s[8:11], s3 offen sc1
    s_mov_b64 exec, -1
KV_SIGH:
    s_branch KV_STRET
KV_ST2:
KV_ST1:
    s_cmp_eq_u32 s33, 0
    s_cbranch_scc1 KV_DONE
    s_cmp_eq_u32 s33, 1
    s_cbranch_scc0 KV_STRET
    s_mov_b32 s4, s52
    s_and_b32 s5, s53, 0xffff
    s_mov_b32 s6, 0x380000
    s_lshl_b32 s28, s19, 9
    s_add_u32 s30, s30, 98304
    s_mov_b32 s12, s4
    s_mov_b32 s13, s5
    s_mov_b32 s14, s6
    s_sub_u32 s31, s31, 0x20000
    s_mov_b32 s34, 0x8000
    s_mov_b32 s36, 0x28000
    s_add_u32 s29, s28, 0xfff80
    s_add_u32 s35, s29, 0x40000
    v_lshlrev_b32 v28, 3, v30
    v_add_u32 v28, v28, v31
    v_add_u32 v24, 0, v28
    v_and_b32 v25, 7, v24
    v_lshlrev_b32 v25, 1, v25
    v_xor_b32 v25, v29, v25
    v_lshlrev_b32 v25, 4, v25
    v_lshl_add_u32 v2, v24, 13, v25
    v_mov_b32 v6, v2
    v_add_u32 v24, 2, v28
    v_and_b32 v25, 7, v24
    v_lshlrev_b32 v25, 1, v25
    v_xor_b32 v25, v29, v25
    v_lshlrev_b32 v25, 4, v25
    v_lshl_add_u32 v3, v24, 13, v25
    v_mov_b32 v7, v3
    v_add_u32 v24, 4, v28
    v_and_b32 v25, 7, v24
    v_lshlrev_b32 v25, 1, v25
    v_xor_b32 v25, v29, v25
    v_lshlrev_b32 v25, 4, v25
    v_lshl_add_u32 v4, v24, 13, v25
    v_mov_b32 v8, v4
    v_add_u32 v24, 6, v28
    v_and_b32 v25, 7, v24
    v_lshlrev_b32 v25, 1, v25
    v_xor_b32 v25, v29, v25
    v_lshlrev_b32 v25, 4, v25
    v_lshl_add_u32 v5, v24, 13, v25
    v_mov_b32 v9, v5
    s_getpc_b64 s[40:41]
CT_2:
    s_sub_u32 s40, s40, CT_2-K_START
    s_subb_u32 s41, s41, 0
    s_and_b32 s41, s41, 0xffff
    s_mov_b32 s42, K_LAST-K_START
    s_mov_b32 s43, 0x20000
    s_lshr_b32 s3, s2, 3
    s_lshl_b32 s3, s3, 2
    s_add_u32 s3, s3, s18
    s_mul_i32 s3, s3, 640
    v_min_u32 v214, 4, v1
    v_lshlrev_b32 v214, 7, v214
    buffer_load_dword v221, v214, s[40:43], s3 offen
    s_sub_u32 s21, 11, s20
    s_add_u32 s22, s20, 10
    s_cmp_lt_u32 s20, 6
    s_cselect_b32 s21, s22, s21
    s_sub_u32 s22, s20, 6
    s_cmp_lt_u32 s20, 12
    s_cselect_b32 s21, s21, s22
    s_lshl_b32 s23, s21, 6
    s_add_u32 s23, s23, 0x4000
    buffer_load_dword v12, v213, s[8:11], s23 offen sc1
KV_STRET:
    s_cmp_eq_u32 s26, 0
    s_cbranch_scc1 KV_LOOP_K
    s_branch KV_LOOP_V
KV_DONE:
    v_lshlrev_b32 v2, 4, v1
    s_mov_b32 s38, 0
    s_branch AT_POLLH_CHK
AT_POLLH:
    buffer_load_dword v12, v213, s[8:11], s23 offen sc1
    s_waitcnt vmcnt(0)
AT_POLLH_CHK:
    v_readfirstlane_b32 s37, v12
    s_nop 0
    s_cmp_ge_u32 s37, 16
    s_cbranch_scc1 AT_POLLH_OK
    s_add_u32 s38, s38, 1
    s_cmp_ge_u32 s38, 0x40000
    s_cbranch_scc1 AT_POLLH_OK
    s_sleep 2
    s_branch AT_POLLH
AT_POLLH_OK:
    s_mov_b32 s26, s21
    s_waitcnt lgkmcnt(0)
    v_accvgpr_read_b32 v240, a0
    v_accvgpr_read_b32 v241, a1
    v_accvgpr_read_b32 v242, a2
    v_accvgpr_read_b32 v243, a3
    v_accvgpr_read_b32 v244, a4
    v_accvgpr_read_b32 v245, a5
    v_accvgpr_read_b32 v246, a6
    v_accvgpr_read_b32 v247, a7
    v_cvt_pk_bf16_f32 v64, v240, v241
    v_cvt_pk_bf16_f32 v65, v242, v243
    v_cvt_pk_bf16_f32 v66, v244, v245
    v_cvt_pk_bf16_f32 v67, v246, v247
    s_lshl_b32 s37, s26, 3
    s_lshl_b32 s38, s18, 1
    s_add_u32 s37, s37, s38
    s_mul_i32 s37, s37, 14336
    s_add_u32 s37, s37, 0x100000
    s_add_u32 s38, s37, 0
    buffer_load_dwordx4 v[176:179], v2, s[8:11], s38 offen offset:0 sc1
    s_add_u32 s38, s37, 12288
    buffer_load_dwordx4 v[180:183], v2, s[8:11], s38 offen offset:2048 sc1
    v_accvgpr_read_b32 v248, a8
    v_accvgpr_read_b32 v249, a9
    v_accvgpr_read_b32 v250, a10
    v_accvgpr_read_b32 v251, a11
    v_accvgpr_read_b32 v252, a12
    v_accvgpr_read_b32 v253, a13
    v_accvgpr_read_b32 v254, a14
    v_accvgpr_read_b32 v255, a15
    v_cvt_pk_bf16_f32 v68, v248, v249
    v_cvt_pk_bf16_f32 v69, v250, v251
    v_cvt_pk_bf16_f32 v70, v252, v253
    v_cvt_pk_bf16_f32 v71, v254, v255
    s_add_u32 s38, s37, 0
    buffer_load_dwordx4 v[184:187], v2, s[8:11], s38 offen offset:1024 sc1
    s_add_u32 s38, s37, 12288
    buffer_load_dwordx4 v[188:191], v2, s[8:11], s38 offen offset:3072 sc1
    v_accvgpr_read_b32 v240, a16
    v_accvgpr_read_b32 v241, a17
    v_accvgpr_read_b32 v242, a18
    v_accvgpr_read_b32 v243, a19
    v_accvgpr_read_b32 v244, a20
    v_accvgpr_read_b32 v245, a21
    v_accvgpr_read_b32 v246, a22
    v_accvgpr_read_b32 v247, a23
    v_cvt_pk_bf16_f32 v72, v240, v241
    v_cvt_pk_bf16_f32 v73, v242, v243
    v_cvt_pk_bf16_f32 v74, v244, v245
    v_cvt_pk_bf16_f32 v75, v246, v247
    s_add_u32 s38, s37, 0
    buffer_load_dwordx4 v[192:195], v2, s[8:11], s38 offen offset:2048 sc1
    s_add_u32 s38, s37, 16384
    buffer_load_dwordx4 v[196:199], v2, s[8:11], s38 offen offset:0 sc1
    v_accvgpr_read_b32 v248, a24
    v_accvgpr_read_b32 v249, a25
    v_accvgpr_read_b32 v250, a26
    v_accvgpr_read_b32 v251, a27
    v_accvgpr_read_b32 v252, a28
    v_accvgpr_read_b32 v253, a29
    v_accvgpr_read_b32 v254, a30
    v_accvgpr_read_b32 v255, a31
    v_cvt_pk_bf16_f32 v76, v248, v249
    v_cvt_pk_bf16_f32 v77, v250, v251
    v_cvt_pk_bf16_f32 v78, v252, v253
    v_cvt_pk_bf16_f32 v79, v254, v255
    s_add_u32 s38, s37, 0
    buffer_load_dwordx4 v[200:203], v2, s[8:11], s38 offen offset:3072 sc1
    s_add_u32 s38, s37, 16384
    buffer_load_dwordx4 v[204:207], v2, s[8:11], s38 offen offset:1024 sc1
    v_accvgpr_read_b32 v240, a32
    v_accvgpr_read_b32 v241, a33
    v_accvgpr_read_b32 v242, a34
    v_accvgpr_read_b32 v243, a35
    v_accvgpr_read_b32 v244, a36
    v_accvgpr_read_b32 v245, a37
    v_accvgpr_read_b32 v246, a38
    v_accvgpr_read_b32 v247, a39
    v_cvt_pk_bf16_f32 v80, v240, v241
    v_cvt_pk_bf16_f32 v81, v242, v243
    v_cvt_pk_bf16_f32 v82, v244, v245
    v_cvt_pk_bf16_f32 v83, v246, v247
    s_add_u32 s38, s37, 4096
    buffer_load_dwordx4 v[208:211], v2, s[8:11], s38 offen offset:0 sc1
    s_add_u32 s38, s37, 16384
    buffer_load_dwordx4 v[212:215], v2, s[8:11], s38 offen offset:2048 sc1
    v_accvgpr_read_b32 v248, a40
    v_accvgpr_read_b32 v249, a41
    v_accvgpr_read_b32 v250, a42
    v_accvgpr_read_b32 v251, a43
    v_accvgpr_read_b32 v252, a44
    v_accvgpr_read_b32 v253, a45
    v_accvgpr_read_b32 v254, a46
    v_accvgpr_read_b32 v255, a47
    v_cvt_pk_bf16_f32 v84, v248, v249
    v_cvt_pk_bf16_f32 v85, v250, v251
    v_cvt_pk_bf16_f32 v86, v252, v253
    v_cvt_pk_bf16_f32 v87, v254, v255
    s_add_u32 s38, s37, 4096
    buffer_load_dwordx4 v[216:219], v2, s[8:11], s38 offen offset:1024 sc1
    s_add_u32 s38, s37, 16384
    buffer_load_dwordx4 v[220:223], v2, s[8:11], s38 offen offset:3072 sc1
    v_accvgpr_read_b32 v240, a48
    v_accvgpr_read_b32 v241, a49
    v_accvgpr_read_b32 v242, a50
    v_accvgpr_read_b32 v243, a51
    v_accvgpr_read_b32 v244, a52
    v_accvgpr_read_b32 v245, a53
    v_accvgpr_read_b32 v246, a54
    v_accvgpr_read_b32 v247, a55
    v_cvt_pk_bf16_f32 v88, v240, v241
    v_cvt_pk_bf16_f32 v89, v242, v243
    v_cvt_pk_bf16_f32 v90, v244, v245
    v_cvt_pk_bf16_f32 v91, v246, v247
    s_add_u32 s38, s37, 4096
    buffer_load_dwordx4 v[224:227], v2, s[8:11], s38 offen offset:2048 sc1
    s_add_u32 s38, s37, 20480
    buffer_load_dwordx4 v[228:231], v2, s[8:11], s38 offen offset:0 sc1
    v_accvgpr_read_b32 v248, a56
    v_accvgpr_read_b32 v249, a57
    v_accvgpr_read_b32 v250, a58
    v_accvgpr_read_b32 v251, a59
    v_accvgpr_read_b32 v252, a60
    v_accvgpr_read_b32 v253, a61
    v_accvgpr_read_b32 v254, a62
    v_accvgpr_read_b32 v255, a63
    v_cvt_pk_bf16_f32 v92, v248, v249
    v_cvt_pk_bf16_f32 v93, v250, v251
    v_cvt_pk_bf16_f32 v94, v252, v253
    v_cvt_pk_bf16_f32 v95, v254, v255
    s_add_u32 s38, s37, 4096
    buffer_load_dwordx4 v[232:235], v2, s[8:11], s38 offen offset:3072 sc1
    s_add_u32 s38, s37, 20480
    buffer_load_dwordx4 v[236:239], v2, s[8:11], s38 offen offset:1024 sc1
    s_lshl_b32 s23, s19, 6
    s_lshr_b32 s16, s20, 1
    s_mul_i32 s16, s16, 5
    s_and_b32 s16, s16, 7
    s_lshl_b32 s16, s16, 3
    s_add_u32 s23, s23, s16
    s_lshr_b32 s16, s18, 1
    s_lshl_b32 s16, s16, 2
    s_add_u32 s23, s23, s16
    s_lshl_b32 s23, s23, 15
    s_add_u32 s23, s23, 0x2000000
    s_and_b32 s16, s18, 1
    s_lshl_b32 s16, s16, 12
    s_add_u32 s23, s23, s16
    s_add_u32 s17, s23, s16
    s_add_u32 s17, s17, 16384
    s_bitcmp0_b32 s20, 0
    s_cselect_b32 s23, s23, s17
    s_mov_b32 s16, 32768
    s_cselect_b32 s46, 1024, s16
    s_mov_b32 s16, -97280
    s_cselect_b32 s47, 5120, s16
    s_cselect_b32 s17, 21504, s16
    v_accvgpr_read_b32 v240, a64
    v_accvgpr_read_b32 v241, a65
    v_accvgpr_read_b32 v242, a66
    v_accvgpr_read_b32 v243, a67
    v_accvgpr_read_b32 v244, a68
    v_accvgpr_read_b32 v245, a69
    v_accvgpr_read_b32 v246, a70
    v_accvgpr_read_b32 v247, a71
    v_cvt_pk_bf16_f32 v96, v240, v241
    v_cvt_pk_bf16_f32 v97, v242, v243
    v_cvt_pk_bf16_f32 v98, v244, v245
    v_cvt_pk_bf16_f32 v99, v246, v247
    buffer_store_dwordx4 v[64:67], v2, s[8:11], s23 offen sc1
    s_add_u32 s23, s23, s46
    v_accvgpr_read_b32 v248, a72
    v_accvgpr_read_b32 v249, a73
    v_accvgpr_read_b32 v250, a74
    v_accvgpr_read_b32 v251, a75
    v_accvgpr_read_b32 v252, a76
    v_accvgpr_read_b32 v253, a77
    v_accvgpr_read_b32 v254, a78
    v_accvgpr_read_b32 v255, a79
    v_cvt_pk_bf16_f32 v100, v248, v249
    v_cvt_pk_bf16_f32 v101, v250, v251
    v_cvt_pk_bf16_f32 v102, v252, v253
    v_cvt_pk_bf16_f32 v103, v254, v255
    v_accvgpr_read_b32 v240, a80
    v_accvgpr_read_b32 v241, a81
    v_accvgpr_read_b32 v242, a82
    v_accvgpr_read_b32 v243, a83
    v_accvgpr_read_b32 v244, a84
    v_accvgpr_read_b32 v245, a85
    v_accvgpr_read_b32 v246, a86
    v_accvgpr_read_b32 v247, a87
    v_cvt_pk_bf16_f32 v104, v240, v241
    v_cvt_pk_bf16_f32 v105, v242, v243
    v_cvt_pk_bf16_f32 v106, v244, v245
    v_cvt_pk_bf16_f32 v107, v246, v247
    v_accvgpr_read_b32 v248, a88
    v_accvgpr_read_b32 v249, a89
    v_accvgpr_read_b32 v250, a90
    v_accvgpr_read_b32 v251, a91
    v_accvgpr_read_b32 v252, a92
    v_accvgpr_read_b32 v253, a93
    v_accvgpr_read_b32 v254, a94
    v_accvgpr_read_b32 v255, a95
    v_cvt_pk_bf16_f32 v108, v248, v249
    v_cvt_pk_bf16_f32 v109, v250, v251
    v_cvt_pk_bf16_f32 v110, v252, v253
    v_cvt_pk_bf16_f32 v111, v254, v255
    buffer_store_dwordx4 v[68:71], v2, s[8:11], s23 offen sc1
    s_add_u32 s23, s23, s46
    v_accvgpr_read_b32 v240, a96
    v_accvgpr_read_b32 v241, a97
    v_accvgpr_read_b32 v242, a98
    v_accvgpr_read_b32 v243, a99
    v_accvgpr_read_b32 v244, a100
    v_accvgpr_read_b32 v245, a101
    v_accvgpr_read_b32 v246, a102
    v_accvgpr_read_b32 v247, a103
    v_cvt_pk_bf16_f32 v48, v240, v241
    v_cvt_pk_bf16_f32 v49, v242, v243
    v_cvt_pk_bf16_f32 v50, v244, v245
    v_cvt_pk_bf16_f32 v51, v246, v247
    v_accvgpr_read_b32 v248, a104
    v_accvgpr_read_b32 v249, a105
    v_accvgpr_read_b32 v250, a106
    v_accvgpr_read_b32 v251, a107
    v_accvgpr_read_b32 v252, a108
    v_accvgpr_read_b32 v253, a109
    v_accvgpr_read_b32 v254, a110
    v_accvgpr_read_b32 v255, a111
    v_cvt_pk_bf16_f32 v52, v248, v249
    v_cvt_pk_bf16_f32 v53, v250, v251
    v_cvt_pk_bf16_f32 v54, v252, v253
    v_cvt_pk_bf16_f32 v55, v254, v255
    v_accvgpr_read_b32 v240, a112
    v_accvgpr_read_b32 v241, a113
    v_accvgpr_read_b32 v242, a114
    v_accvgpr_read_b32 v243, a115
    v_accvgpr_read_b32 v244, a116
    v_accvgpr_read_b32 v245, a117
    v_accvgpr_read_b32 v246, a118
    v_accvgpr_read_b32 v247, a119
    v_cvt_pk_bf16_f32 v56, v240, v241
    v_cvt_pk_bf16_f32 v57, v242, v243
    v_cvt_pk_bf16_f32 v58, v244, v245
    v_cvt_pk_bf16_f32 v59, v246, v247
    buffer_store_dwordx4 v[72:75], v2, s[8:11], s23 offen sc1
    s_add_u32 s23, s23, s46
    v_accvgpr_read_b32 v248, a120
    v_accvgpr_read_b32 v249, a121
    v_accvgpr_read_b32 v250, a122
    v_accvgpr_read_b32 v251, a123
    v_accvgpr_read_b32 v252, a124
    v_accvgpr_read_b32 v253, a125
    v_accvgpr_read_b32 v254, a126
    v_accvgpr_read_b32 v255, a127
    v_cvt_pk_bf16_f32 v60, v248, v249
    v_cvt_pk_bf16_f32 v61, v250, v251
    v_cvt_pk_bf16_f32 v62, v252, v253
    v_cvt_pk_bf16_f32 v63, v254, v255
    v_accvgpr_read_b32 v240, a128
    v_accvgpr_read_b32 v241, a129
    v_accvgpr_read_b32 v242, a130
    v_accvgpr_read_b32 v243, a131
    v_accvgpr_read_b32 v244, a132
    v_accvgpr_read_b32 v245, a133
    v_accvgpr_read_b32 v246, a134
    v_accvgpr_read_b32 v247, a135
    v_cvt_pk_bf16_f32 v112, v240, v241
    v_cvt_pk_bf16_f32 v113, v242, v243
    v_cvt_pk_bf16_f32 v114, v244, v245
    v_cvt_pk_bf16_f32 v115, v246, v247
    v_accvgpr_read_b32 v248, a136
    v_accvgpr_read_b32 v249, a137
    v_accvgpr_read_b32 v250, a138
    v_accvgpr_read_b32 v251, a139
    v_accvgpr_read_b32 v252, a140
    v_accvgpr_read_b32 v253, a141
    v_accvgpr_read_b32 v254, a142
    v_accvgpr_read_b32 v255, a143
    v_cvt_pk_bf16_f32 v116, v248, v249
    v_cvt_pk_bf16_f32 v117, v250, v251
    v_cvt_pk_bf16_f32 v118, v252, v253
    v_cvt_pk_bf16_f32 v119, v254, v255
    v_accvgpr_read_b32 v240, a144
    v_accvgpr_read_b32 v241, a145
    v_accvgpr_read_b32 v242, a146
    v_accvgpr_read_b32 v243, a147
    v_accvgpr_read_b32 v244, a148
    v_accvgpr_read_b32 v245, a149
    v_accvgpr_read_b32 v246, a150
    v_accvgpr_read_b32 v247, a151
    v_cvt_pk_bf16_f32 v120, v240, v241
    v_cvt_pk_bf16_f32 v121, v242, v243
    v_cvt_pk_bf16_f32 v122, v244, v245
    v_cvt_pk_bf16_f32 v123, v246, v247
    buffer_store_dwordx4 v[76:79], v2, s[8:11], s23 offen sc1
    s_add_u32 s23, s23, s47
    v_accvgpr_read_b32 v248, a152
    v_accvgpr_read_b32 v249, a153
    v_accvgpr_read_b32 v250, a154
    v_accvgpr_read_b32 v251, a155
    v_accvgpr_read_b32 v252, a156
    v_accvgpr_read_b32 v253, a157
    v_accvgpr_read_b32 v254, a158
    v_accvgpr_read_b32 v255, a159
    v_cvt_pk_bf16_f32 v124, v248, v249
    v_cvt_pk_bf16_f32 v125, v250, v251
    v_cvt_pk_bf16_f32 v126, v252, v253
    v_cvt_pk_bf16_f32 v127, v254, v255
    v_accvgpr_read_b32 v240, a160
    v_accvgpr_read_b32 v241, a161
    v_accvgpr_read_b32 v242, a162
    v_accvgpr_read_b32 v243, a163
    v_accvgpr_read_b32 v244, a164
    v_accvgpr_read_b32 v245, a165
    v_accvgpr_read_b32 v246, a166
    v_accvgpr_read_b32 v247, a167
    v_cvt_pk_bf16_f32 v128, v240, v241
    v_cvt_pk_bf16_f32 v129, v242, v243
    v_cvt_pk_bf16_f32 v130, v244, v245
    v_cvt_pk_bf16_f32 v131, v246, v247
    v_accvgpr_read_b32 v248, a168
    v_accvgpr_read_b32 v249, a169
    v_accvgpr_read_b32 v250, a170
    v_accvgpr_read_b32 v251, a171
    v_accvgpr_read_b32 v252, a172
    v_accvgpr_read_b32 v253, a173
    v_accvgpr_read_b32 v254, a174
    v_accvgpr_read_b32 v255, a175
    v_cvt_pk_bf16_f32 v132, v248, v249
    v_cvt_pk_bf16_f32 v133, v250, v251
    v_cvt_pk_bf16_f32 v134, v252, v253
    v_cvt_pk_bf16_f32 v135, v254, v255
    buffer_store_dwordx4 v[80:83], v2, s[8:11], s23 offen sc1
    s_add_u32 s23, s23, s46
    v_accvgpr_read_b32 v240, a176
    v_accvgpr_read_b32 v241, a177
    v_accvgpr_read_b32 v242, a178
    v_accvgpr_read_b32 v243, a179
    v_accvgpr_read_b32 v244, a180
    v_accvgpr_read_b32 v245, a181
    v_accvgpr_read_b32 v246, a182
    v_accvgpr_read_b32 v247, a183
    v_cvt_pk_bf16_f32 v136, v240, v241
    v_cvt_pk_bf16_f32 v137, v242, v243
    v_cvt_pk_bf16_f32 v138, v244, v245
    v_cvt_pk_bf16_f32 v139, v246, v247
    v_accvgpr_read_b32 v248, a184
    v_accvgpr_read_b32 v249, a185
    v_accvgpr_read_b32 v250, a186
    v_accvgpr_read_b32 v251, a187
    v_accvgpr_read_b32 v252, a188
    v_accvgpr_read_b32 v253, a189
    v_accvgpr_read_b32 v254, a190
    v_accvgpr_read_b32 v255, a191
    v_cvt_pk_bf16_f32 v140, v248, v249
    v_cvt_pk_bf16_f32 v141, v250, v251
    v_cvt_pk_bf16_f32 v142, v252, v253
    v_cvt_pk_bf16_f32 v143, v254, v255
    v_accvgpr_read_b32 v240, a192
    v_accvgpr_read_b32 v241, a193
    v_accvgpr_read_b32 v242, a194
    v_accvgpr_read_b32 v243, a195
    v_accvgpr_read_b32 v244, a196
    v_accvgpr_read_b32 v245, a197
    v_accvgpr_read_b32 v246, a198
    v_accvgpr_read_b32 v247, a199
    v_cvt_pk_bf16_f32 v144, v240, v241
    v_cvt_pk_bf16_f32 v145, v242, v243
    v_cvt_pk_bf16_f32 v146, v244, v245
    v_cvt_pk_bf16_f32 v147, v246, v247
    v_accvgpr_read_b32 v248, a200
    v_accvgpr_read_b32 v249, a201
    v_accvgpr_read_b32 v250, a202
    v_accvgpr_read_b32 v251, a203
    v_accvgpr_read_b32 v252, a204
    v_accvgpr_read_b32 v253, a205
    v_accvgpr_read_b32 v254, a206
    v_accvgpr_read_b32 v255, a207
    v_cvt_pk_bf16_f32 v148, v248, v249
    v_cvt_pk_bf16_f32 v149, v250, v251
    v_cvt_pk_bf16_f32 v150, v252, v253
    v_cvt_pk_bf16_f32 v151, v254, v255
    buffer_store_dwordx4 v[84:87], v2, s[8:11], s23 offen sc1
    s_add_u32 s23, s23, s46
    v_accvgpr_read_b32 v240, a208
    v_accvgpr_read_b32 v241, a209
    v_accvgpr_read_b32 v242, a210
    v_accvgpr_read_b32 v243, a211
    v_accvgpr_read_b32 v244, a212
    v_accvgpr_read_b32 v245, a213
    v_accvgpr_read_b32 v246, a214
    v_accvgpr_read_b32 v247, a215
    v_cvt_pk_bf16_f32 v152, v240, v241
    v_cvt_pk_bf16_f32 v153, v242, v243
    v_cvt_pk_bf16_f32 v154, v244, v245
    v_cvt_pk_bf16_f32 v155, v246, v247
    v_accvgpr_read_b32 v248, a216
    v_accvgpr_read_b32 v249, a217
    v_accvgpr_read_b32 v250, a218
    v_accvgpr_read_b32 v251, a219
    v_accvgpr_read_b32 v252, a220
    v_accvgpr_read_b32 v253, a221
    v_accvgpr_read_b32 v254, a222
    v_accvgpr_read_b32 v255, a223
    v_cvt_pk_bf16_f32 v156, v248, v249
    v_cvt_pk_bf16_f32 v157, v250, v251
    v_cvt_pk_bf16_f32 v158, v252, v253
    v_cvt_pk_bf16_f32 v159, v254, v255
    v_accvgpr_read_b32 v240, a224
    v_accvgpr_read_b32 v241, a225
    v_accvgpr_read_b32 v242, a226
    v_accvgpr_read_b32 v243, a227
    v_accvgpr_read_b32 v244, a228
    v_accvgpr_read_b32 v245, a229
    v_accvgpr_read_b32 v246, a230
    v_accvgpr_read_b32 v247, a231
    v_cvt_pk_bf16_f32 v160, v240, v241
    v_cvt_pk_bf16_f32 v161, v242, v243
    v_cvt_pk_bf16_f32 v162, v244, v245
    v_cvt_pk_bf16_f32 v163, v246, v247
    buffer_store_dwordx4 v[88:91], v2, s[8:11], s23 offen sc1
    s_add_u32 s23, s23, s46
    v_accvgpr_read_b32 v248, a232
    v_accvgpr_read_b32 v249, a233
    v_accvgpr_read_b32 v250, a234
    v_accvgpr_read_b32 v251, a235
    v_accvgpr_read_b32 v252, a236
    v_accvgpr_read_b32 v253, a237
    v_accvgpr_read_b32 v254, a238
    v_accvgpr_read_b32 v255, a239
    v_cvt_pk_bf16_f32 v164, v248, v249
    v_cvt_pk_bf16_f32 v165, v250, v251
    v_cvt_pk_bf16_f32 v166, v252, v253
    v_cvt_pk_bf16_f32 v167, v254, v255
    v_lshrrev_b32 v38, 5, v0
    v_lshlrev_b32 v39, 1, v38
    v_and_b32 v40, 31, v1
    v_xor_b32 v39, v39, v40
    v_lshlrev_b32 v39, 4, v39
    v_lshl_add_u32 v4, v38, 13, v39
    s_mov_b32 s4, s52
    s_and_b32 s5, s53, 0xffff
    s_mov_b32 s6, 0x380000
    s_mov_b32 s22, 0x80000
    s_lshl_b32 s21, s19, 9
    v_mov_b32 v6, v4
    v_add_u32 v7, 0x10000, v4
    v_add_u32 v8, 0x20000, v4
    v_add_u32 v9, 0x30000, v4
    v_add_u32 v10, 0x40000, v4
    v_add_u32 v11, 0x50000, v4
    v_add_u32 v12, 0x60000, v4
    v_add_u32 v13, 0x70000, v4
    s_add_u32 s21, s21, 0x180000
    s_lshl_b32 s49, s18, 10
    s_add_u32 s24, s49, 0x8000
    s_mov_b32 s25, 98304
    v_accvgpr_read_b32 v240, a240
    v_accvgpr_read_b32 v241, a241
    v_accvgpr_read_b32 v242, a242
    v_accvgpr_read_b32 v243, a243
    v_accvgpr_read_b32 v244, a244
    v_accvgpr_read_b32 v245, a245
    v_accvgpr_read_b32 v246, a246
    v_accvgpr_read_b32 v247, a247
    v_cvt_pk_bf16_f32 v168, v240, v241
    v_cvt_pk_bf16_f32 v169, v242, v243
    v_cvt_pk_bf16_f32 v170, v244, v245
    v_cvt_pk_bf16_f32 v171, v246, v247
    v_lshrrev_b32 v38, 2, v1
    v_lshlrev_b32 v39, 9, v38
    v_and_b32 v40, 3, v1
    v_lshl_add_u32 v39, v40, 3, v39
    v_and_b32 v40, 7, v38
    v_lshl_add_u32 v39, v40, 5, v39
    v_xor_b32 v16, 0, v39
    v_xor_b32 v17, 32, v39
    v_xor_b32 v18, 64, v39
    v_xor_b32 v19, 96, v39
    v_xor_b32 v20, 128, v39
    v_xor_b32 v21, 160, v39
    v_xor_b32 v22, 192, v39
    v_xor_b32 v23, 224, v39
    v_add_u32 v28, s25, v16
    v_add_u32 v29, s25, v17
    v_add_u32 v30, s25, v18
    v_add_u32 v31, s25, v19
    v_add_u32 v32, s25, v20
    v_add_u32 v33, s25, v21
    v_add_u32 v34, s25, v22
    v_add_u32 v35, s25, v23
    s_lshr_b32 s43, s20, 1
    v_accvgpr_read_b32 v248, a248
    v_accvgpr_read_b32 v249, a249
    v_accvgpr_read_b32 v250, a250
    v_accvgpr_read_b32 v251, a251
    v_accvgpr_read_b32 v252, a252
    v_accvgpr_read_b32 v253, a253
    v_accvgpr_read_b32 v254, a254
    v_accvgpr_read_b32 v255, a255
    v_cvt_pk_bf16_f32 v172, v248, v249
    v_cvt_pk_bf16_f32 v173, v250, v251
    v_cvt_pk_bf16_f32 v174, v252, v253
    v_cvt_pk_bf16_f32 v175, v254, v255
    s_cmp_eq_u32 s43, 0
    s_cbranch_scc0 AT_NOPRIO
    buffer_store_dwordx4 v[92:95], v2, s[8:11], s23 offen sc1
    s_add_u32 s23, s23, s17
    buffer_store_dwordx4 v[96:99], v2, s[8:11], s23 offen sc1
    s_add_u32 s23, s23, s46
    buffer_store_dwordx4 v[100:103], v2, s[8:11], s23 offen sc1
    s_add_u32 s23, s23, s46
    buffer_store_dwordx4 v[104:107], v2, s[8:11], s23 offen sc1
    s_add_u32 s23, s23, s46
    buffer_store_dwordx4 v[108:111], v2, s[8:11], s23 offen sc1
    s_add_u32 s23, s23, s47
    buffer_store_dwordx4 v[48:51], v2, s[8:11], s23 offen sc1
    s_add_u32 s23, s23, s46
    buffer_store_dwordx4 v[52:55], v2, s[8:11], s23 offen sc1
    s_add_u32 s23, s23, s46
    buffer_store_dwordx4 v[56:59], v2, s[8:11], s23 offen sc1
    s_add_u32 s23, s23, s46
    buffer_store_dwordx4 v[60:63], v2, s[8:11], s23 offen sc1
    s_add_u32 s23, s23, s17
    buffer_store_dwordx4 v[112:115], v2, s[8:11], s23 offen sc1
    s_add_u32 s23, s23, s46
    buffer_store_dwordx4 v[116:119], v2, s[8:11], s23 offen sc1
    s_add_u32 s23, s23, s46
    buffer_store_dwordx4 v[120:123], v2, s[8:11], s23 offen sc1
    s_add_u32 s23, s23, s46
    buffer_store_dwordx4 v[124:127], v2, s[8:11], s23 offen sc1
    s_add_u32 s23, s23, s47
    buffer_store_dwordx4 v[128:131], v2, s[8:11], s23 offen sc1
    s_add_u32 s23, s23, s46
    buffer_store_dwordx4 v[132:135], v2, s[8:11], s23 offen sc1
    s_add_u32 s23, s23, s46
    buffer_store_dwordx4 v[136:139], v2, s[8:11], s23 offen sc1
    s_add_u32 s23, s23, s46
    buffer_store_dwordx4 v[140:143], v2, s[8:11], s23 offen sc1
    s_add_u32 s23, s23, s17
    buffer_store_dwordx4 v[144:147], v2, s[8:11], s23 offen sc1
    s_add_u32 s23, s23, s46
    buffer_store_dwordx4 v[148:151], v2, s[8:11], s23 offen sc1
    s_add_u32 s23, s23, s46
    buffer_store_dwordx4 v[152:155], v2, s[8:11], s23 offen sc1
    s_add_u32 s23, s23, s46
    buffer_store_dwordx4 v[156:159], v2, s[8:11], s23 offen sc1
    s_add_u32 s23, s23, s47
    buffer_store_dwordx4 v[160:163], v2, s[8:11], s23 offen sc1
    s_add_u32 s23, s23, s46
    buffer_store_dwordx4 v[164:167], v2, s[8:11], s23 offen sc1
    s_add_u32 s23, s23, s46
    buffer_store_dwordx4 v[168:171], v2, s[8:11], s23 offen sc1
    s_add_u32 s23, s23, s46
    buffer_store_dwordx4 v[172:175], v2, s[8:11], s23 offen sc1
    s_add_u32 s23, s23, s17
    s_mov_b32 s23, 0xf0000000
    s_mov_b32 s46, 0
    s_mov_b32 s47, 0
    s_mov_b32 s17, 0
    s_waitcnt vmcnt(32)
    s_branch AT_PRIODONE
AT_NOPRIO:
    s_waitcnt vmcnt(7)
AT_PRIODONE:
    s_barrier
    ds_read_b64_tr_b16 a[128:129], v28 offset:0
    ds_read_b64_tr_b16 a[130:131], v28 offset:8192
    ds_read_b64_tr_b16 a[132:133], v29 offset:0
    ds_read_b64_tr_b16 a[134:135], v29 offset:8192
    ds_read_b64_tr_b16 a[136:137], v30 offset:0
    ds_read_b64_tr_b16 a[138:139], v30 offset:8192
    ds_read_b64_tr_b16 a[140:141], v31 offset:0
    ds_read_b64_tr_b16 a[142:143], v31 offset:8192
    ds_read_b64_tr_b16 a[144:145], v32 offset:0
    ds_read_b64_tr_b16 a[146:147], v32 offset:8192
    ds_read_b64_tr_b16 a[148:149], v33 offset:0
    ds_read_b64_tr_b16 a[150:151], v33 offset:8192
    ds_read_b64_tr_b16 a[152:153], v34 offset:0
    ds_read_b64_tr_b16 a[154:155], v34 offset:8192
    ds_read_b64_tr_b16 a[156:157], v35 offset:0
    ds_read_b64_tr_b16 a[158:159], v35 offset:8192
    ds_read_b64_tr_b16 a[160:161], v28 offset:256
    ds_read_b64_tr_b16 a[162:163], v28 offset:8448
    ds_read_b64_tr_b16 a[164:165], v29 offset:256
    ds_read_b64_tr_b16 a[166:167], v29 offset:8448
    ds_read_b64_tr_b16 a[168:169], v30 offset:256
    ds_read_b64_tr_b16 a[170:171], v30 offset:8448
    ds_read_b64_tr_b16 a[172:173], v31 offset:256
    ds_read_b64_tr_b16 a[174:175], v31 offset:8448
    ds_read_b64_tr_b16 a[176:177], v32 offset:256
    ds_read_b64_tr_b16 a[178:179], v32 offset:8448
    ds_read_b64_tr_b16 a[180:181], v33 offset:256
    ds_read_b64_tr_b16 a[182:183], v33 offset:8448
    ds_read_b64_tr_b16 a[184:185], v34 offset:256
    ds_read_b64_tr_b16 a[186:187], v34 offset:8448
    ds_read_b64_tr_b16 a[188:189], v35 offset:256
    ds_read_b64_tr_b16 a[190:191], v35 offset:8448
    s_waitcnt lgkmcnt(0)
    v_mfma_f32_16x16x32_bf16 a[0:3], a[128:131], v[176:179], 0
    ds_read_b64_tr_b16 a[192:193], v28 offset:16384
    ds_read_b64_tr_b16 a[194:195], v28 offset:24576
    v_mfma_f32_16x16x32_bf16 a[4:7], a[128:131], v[180:183], 0
    s_add_u32 m0, s24, 0
    ds_read_b64_tr_b16 a[196:197], v29 offset:16384
    v_mov_b32 v44, 0
    v_mfma_f32_16x16x32_bf16 a[8:11], a[132:135], v[176:179], 0
    s_cmp_lt_u32 s20, 12
    s_cselect_b32 s29, 3, 0
    buffer_load_dwordx4 v6, s[4:7], s21 offen sc1 lds
    v_mfma_f32_16x16x32_bf16 a[12:15], a[132:135], v[180:183], 0
    ds_read_b64_tr_b16 a[198:199], v29 offset:24576
    v_mov_b32 v45, 0
    v_mfma_f32_16x16x32_bf16 a[16:19], a[136:139], v[176:179], 0
    s_cmp_lt_u32 s20, 6
    s_cselect_b32 s29, 1, s29
    ds_read_b64_tr_b16 a[200:201], v30 offset:16384
    ds_read_b64_tr_b16 a[202:203], v30 offset:24576
    v_mfma_f32_16x16x32_bf16 a[20:23], a[136:139], v[180:183], 0
    s_add_u32 m0, s24, 4096
    ds_read_b64_tr_b16 a[204:205], v31 offset:16384
    v_mov_b32 v46, 0
    v_mfma_f32_16x16x32_bf16 a[24:27], a[140:143], v[176:179], 0
    s_mov_b32 s27, 0
    buffer_load_dwordx4 v7, s[4:7], s21 offen sc1 lds
    v_mfma_f32_16x16x32_bf16 a[28:31], a[140:143], v[180:183], 0
    ds_read_b64_tr_b16 a[206:207], v31 offset:24576
    v_mov_b32 v47, 0
    v_mfma_f32_16x16x32_bf16 a[32:35], a[144:147], v[176:179], 0
    ds_read_b64_tr_b16 a[208:209], v32 offset:16384
    ds_read_b64_tr_b16 a[210:211], v32 offset:24576
    v_mfma_f32_16x16x32_bf16 a[36:39], a[144:147], v[180:183], 0
    s_add_u32 m0, s24, 8192
    ds_read_b64_tr_b16 a[212:213], v33 offset:16384
    v_add_u32 v3, s49, v2
    v_mfma_f32_16x16x32_bf16 a[40:43], a[148:151], v[176:179], 0
    buffer_load_dwordx4 v8, s[4:7], s21 offen sc1 lds
    v_mfma_f32_16x16x32_bf16 a[44:47], a[148:151], v[180:183], 0
    ds_read_b64_tr_b16 a[214:215], v33 offset:24576
    v_and_b32 v41, 15, v1
    v_mfma_f32_16x16x32_bf16 a[48:51], a[152:155], v[176:179], 0
    s_waitcnt lgkmcnt(8)
    ds_read_b64_tr_b16 a[216:217], v34 offset:16384
    ds_read_b64_tr_b16 a[218:219], v34 offset:24576
    v_mfma_f32_16x16x32_bf16 a[52:55], a[152:155], v[180:183], 0
    s_add_u32 m0, s24, 12288
    ds_read_b64_tr_b16 a[220:221], v35 offset:16384
    v_mfma_f32_16x16x32_bf16 a[56:59], a[156:159], v[176:179], 0
    s_lshl_b32 s35, s19, 6
    buffer_load_dwordx4 v9, s[4:7], s21 offen sc1 lds
    v_mfma_f32_16x16x32_bf16 a[60:63], a[156:159], v[180:183], 0
    ds_read_b64_tr_b16 a[222:223], v35 offset:24576
    v_lshlrev_b32 v41, 2, v41
    v_mfma_f32_16x16x32_bf16 a[64:67], a[160:163], v[176:179], 0
    s_add_u32 s35, s35, 0x4400
    ds_read_b64_tr_b16 a[224:225], v28 offset:16640
    ds_read_b64_tr_b16 a[226:227], v28 offset:24832
    v_mfma_f32_16x16x32_bf16 a[68:71], a[160:163], v[180:183], 0
    s_add_u32 m0, s24, 16384
    ds_read_b64_tr_b16 a[228:229], v29 offset:16640
    v_mfma_f32_16x16x32_bf16 a[72:75], a[164:167], v[176:179], 0
    buffer_load_dwordx4 v10, s[4:7], s21 offen sc1 lds
    v_mfma_f32_16x16x32_bf16 a[76:79], a[164:167], v[180:183], 0
    ds_read_b64_tr_b16 a[230:231], v29 offset:24832
    v_mfma_f32_16x16x32_bf16 a[80:83], a[168:171], v[176:179], 0
    ds_read_b64_tr_b16 a[232:233], v30 offset:16640
    ds_read_b64_tr_b16 a[234:235], v30 offset:24832
    v_mfma_f32_16x16x32_bf16 a[84:87], a[168:171], v[180:183], 0
    s_add_u32 m0, s24, 20480
    ds_read_b64_tr_b16 a[236:237], v31 offset:16640
    v_mfma_f32_16x16x32_bf16 a[88:91], a[172:175], v[176:179], 0
    buffer_load_dwordx4 v11, s[4:7], s21 offen sc1 lds
    v_mfma_f32_16x16x32_bf16 a[92:95], a[172:175], v[180:183], 0
    ds_read_b64_tr_b16 a[238:239], v31 offset:24832
    v_mfma_f32_16x16x32_bf16 a[96:99], a[176:179], v[176:179], 0
    s_add_u32 s25, s25, 0x8000
    ds_read_b64_tr_b16 a[240:241], v32 offset:16640
    ds_read_b64_tr_b16 a[242:243], v32 offset:24832
    v_mfma_f32_16x16x32_bf16 a[100:103], a[176:179], v[180:183], 0
    s_add_u32 m0, s24, 24576
    ds_read_b64_tr_b16 a[244:245], v33 offset:16640
    v_mfma_f32_16x16x32_bf16 a[104:107], a[180:183], v[176:179], 0
    buffer_load_dwordx4 v12, s[4:7], s21 offen sc1 lds
    v_mfma_f32_16x16x32_bf16 a[108:111], a[180:183], v[180:183], 0
    s_cmp_ge_u32 s25, 0x28000
    ds_read_b64_tr_b16 a[246:247], v33 offset:24832
    v_mfma_f32_16x16x32_bf16 a[112:115], a[184:187], v[176:179], 0
    s_cselect_b32 s25, 0, s25
    ds_read_b64_tr_b16 a[248:249], v34 offset:16640
    ds_read_b64_tr_b16 a[250:251], v34 offset:24832
    v_mfma_f32_16x16x32_bf16 a[116:119], a[184:187], v[180:183], 0
    s_add_u32 m0, s24, 28672
    ds_read_b64_tr_b16 a[252:253], v35 offset:16640
    v_mfma_f32_16x16x32_bf16 a[120:123], a[188:191], v[176:179], 0
    buffer_load_dwordx4 v13, s[4:7], s21 offen sc1 lds
    v_mfma_f32_16x16x32_bf16 a[124:127], a[188:191], v[180:183], 0
    s_waitcnt lgkmcnt(8)
    ds_read_b64_tr_b16 a[254:255], v35 offset:24832
    v_mfma_f32_16x16x32_bf16 a[0:3], a[192:195], v[184:187], a[0:3]
    s_barrier
    v_add_u32 v28, s25, v16
    v_add_u32 v29, s25, v17
    v_mfma_f32_16x16x32_bf16 a[4:7], a[192:195], v[188:191], a[4:7]
    ds_read_b64_tr_b16 a[128:129], v28 offset:0
    ds_read_b64_tr_b16 a[130:131], v28 offset:8192
    v_add_u32 v30, s25, v18
    v_mfma_f32_16x16x32_bf16 a[8:11], a[196:199], v[184:187], a[8:11]
    ds_read_b64_tr_b16 a[132:133], v29 offset:0
    v_add_u32 v31, s25, v19
    v_mfma_f32_16x16x32_bf16 a[12:15], a[196:199], v[188:191], a[12:15]
    s_add_u32 s21, s21, s22
    ds_read_b64_tr_b16 a[134:135], v29 offset:8192
    v_add_u32 v32, s25, v20
    v_mfma_f32_16x16x32_bf16 a[16:19], a[200:203], v[184:187], a[16:19]
    s_add_u32 s24, s24, 0x8000
    ds_read_b64_tr_b16 a[136:137], v30 offset:0
    v_add_u32 v33, s25, v21
    v_mfma_f32_16x16x32_bf16 a[20:23], a[200:203], v[188:191], a[20:23]
    ds_read_b64_tr_b16 a[138:139], v30 offset:8192
    ds_read_b64_tr_b16 a[140:141], v31 offset:0
    v_add_u32 v34, s25, v22
    v_mfma_f32_16x16x32_bf16 a[24:27], a[204:207], v[184:187], a[24:27]
    ds_read_b64_tr_b16 a[142:143], v31 offset:8192
    v_add_u32 v35, s25, v23
    v_mfma_f32_16x16x32_bf16 a[28:31], a[204:207], v[188:191], a[28:31]
    s_cmp_ge_u32 s24, 0x28000
    ds_read_b64_tr_b16 a[144:145], v32 offset:0
    v_mfma_f32_16x16x32_bf16 a[32:35], a[208:211], v[184:187], a[32:35]
    s_cselect_b32 s24, s49, s24
    ds_read_b64_tr_b16 a[146:147], v32 offset:8192
    v_mfma_f32_16x16x32_bf16 a[36:39], a[208:211], v[188:191], a[36:39]
    ds_read_b64_tr_b16 a[148:149], v33 offset:0
    ds_read_b64_tr_b16 a[150:151], v33 offset:8192
    v_mfma_f32_16x16x32_bf16 a[40:43], a[212:215], v[184:187], a[40:43]
    buffer_store_dwordx4 v[92:95], v2, s[8:11], s23 offen sc1
    v_mfma_f32_16x16x32_bf16 a[44:47], a[212:215], v[188:191], a[44:47]
    s_add_u32 s23, s23, s17
    ds_read_b64_tr_b16 a[152:153], v34 offset:0
    v_mfma_f32_16x16x32_bf16 a[48:51], a[216:219], v[184:187], a[48:51]
    s_waitcnt lgkmcnt(8)
    ds_read_b64_tr_b16 a[154:155], v34 offset:8192
    v_mfma_f32_16x16x32_bf16 a[52:55], a[216:219], v[188:191], a[52:55]
    ds_read_b64_tr_b16 a[156:157], v35 offset:0
    v_mfma_f32_16x16x32_bf16 a[56:59], a[220:223], v[184:187], a[56:59]
    ds_read_b64_tr_b16 a[158:159], v35 offset:8192
    v_mfma_f32_16x16x32_bf16 a[60:63], a[220:223], v[188:191], a[60:63]
    buffer_store_dwordx4 v[96:99], v2, s[8:11], s23 offen sc1
    v_mfma_f32_16x16x32_bf16 a[64:67], a[224:227], v[184:187], a[64:67]
    s_add_u32 s23, s23, s46
    ds_read_b64_tr_b16 a[160:161], v28 offset:256
    ds_read_b64_tr_b16 a[162:163], v28 offset:8448
    v_mfma_f32_16x16x32_bf16 a[68:71], a[224:227], v[188:191], a[68:71]
    ds_read_b64_tr_b16 a[164:165], v29 offset:256
    v_mfma_f32_16x16x32_bf16 a[72:75], a[228:231], v[184:187], a[72:75]
    ds_read_b64_tr_b16 a[166:167], v29 offset:8448
    v_mfma_f32_16x16x32_bf16 a[76:79], a[228:231], v[188:191], a[76:79]
    ds_read_b64_tr_b16 a[168:169], v30 offset:256
    v_mfma_f32_16x16x32_bf16 a[80:83], a[232:235], v[184:187], a[80:83]
    buffer_store_dwordx4 v[100:103], v2, s[8:11], s23 offen sc1
    v_mfma_f32_16x16x32_bf16 a[84:87], a[232:235], v[188:191], a[84:87]
    s_add_u32 s23, s23, s46
    ds_read_b64_tr_b16 a[170:171], v30 offset:8448
    ds_read_b64_tr_b16 a[172:173], v31 offset:256
    v_mfma_f32_16x16x32_bf16 a[88:91], a[236:239], v[184:187], a[88:91]
    ds_read_b64_tr_b16 a[174:175], v31 offset:8448
    v_mfma_f32_16x16x32_bf16 a[92:95], a[236:239], v[188:191], a[92:95]
    ds_read_b64_tr_b16 a[176:177], v32 offset:256
    v_mfma_f32_16x16x32_bf16 a[96:99], a[240:243], v[184:187], a[96:99]
    ds_read_b64_tr_b16 a[178:179], v32 offset:8448
    v_mfma_f32_16x16x32_bf16 a[100:103], a[240:243], v[188:191], a[100:103]
    buffer_store_dwordx4 v[104:107], v2, s[8:11], s23 offen sc1
    v_mfma_f32_16x16x32_bf16 a[104:107], a[244:247], v[184:187], a[104:107]
    s_add_u32 s23, s23, s46
    ds_read_b64_tr_b16 a[180:181], v33 offset:256
    ds_read_b64_tr_b16 a[182:183], v33 offset:8448
    v_mfma_f32_16x16x32_bf16 a[108:111], a[244:247], v[188:191], a[108:111]
    ds_read_b64_tr_b16 a[184:185], v34 offset:256
    v_mfma_f32_16x16x32_bf16 a[112:115], a[248:251], v[184:187], a[112:115]
    ds_read_b64_tr_b16 a[186:187], v34 offset:8448
    v_mfma_f32_16x16x32_bf16 a[116:119], a[248:251], v[188:191], a[116:119]
    s_waitcnt lgkmcnt(8)
    ds_read_b64_tr_b16 a[188:189], v35 offset:256
    v_mfma_f32_16x16x32_bf16 a[120:123], a[252:255], v[184:187], a[120:123]
    buffer_store_dwordx4 v[108:111], v2, s[8:11], s23 offen sc1
    v_mfma_f32_16x16x32_bf16 a[124:127], a[252:255], v[188:191], a[124:127]
    s_add_u32 s23, s23, s47
    ds_read_b64_tr_b16 a[190:191], v35 offset:8448
    v_mfma_f32_16x16x32_bf16 a[0:3], a[128:131], v[192:195], a[0:3]
    ds_read_b64_tr_b16 a[192:193], v28 offset:16384
    ds_read_b64_tr_b16 a[194:195], v28 offset:24576
    v_mfma_f32_16x16x32_bf16 a[4:7], a[128:131], v[196:199], a[4:7]
    s_add_u32 m0, s24, 0
    ds_read_b64_tr_b16 a[196:197], v29 offset:16384
    v_mfma_f32_16x16x32_bf16 a[8:11], a[132:135], v[192:195], a[8:11]
    buffer_load_dwordx4 v6, s[4:7], s21 offen sc1 lds
    v_mfma_f32_16x16x32_bf16 a[12:15], a[132:135], v[196:199], a[12:15]
    ds_read_b64_tr_b16 a[198:199], v29 offset:24576
    v_mfma_f32_16x16x32_bf16 a[16:19], a[136:139], v[192:195], a[16:19]
    ds_read_b64_tr_b16 a[200:201], v30 offset:16384
    ds_read_b64_tr_b16 a[202:203], v30 offset:24576
    v_mfma_f32_16x16x32_bf16 a[20:23], a[136:139], v[196:199], a[20:23]
    s_add_u32 m0, s24, 4096
    ds_read_b64_tr_b16 a[204:205], v31 offset:16384
    v_mfma_f32_16x16x32_bf16 a[24:27], a[140:143], v[192:195], a[24:27]
    buffer_load_dwordx4 v7, s[4:7], s21 offen sc1 lds
    v_mfma_f32_16x16x32_bf16 a[28:31], a[140:143], v[196:199], a[28:31]
    ds_read_b64_tr_b16 a[206:207], v31 offset:24576
    v_mfma_f32_16x16x32_bf16 a[32:35], a[144:147], v[192:195], a[32:35]
    ds_read_b64_tr_b16 a[208:209], v32 offset:16384
    ds_read_b64_tr_b16 a[210:211], v32 offset:24576
    v_mfma_f32_16x16x32_bf16 a[36:39], a[144:147], v[196:199], a[36:39]
    s_add_u32 m0, s24, 8192
    ds_read_b64_tr_b16 a[212:213], v33 offset:16384
    v_mfma_f32_16x16x32_bf16 a[40:43], a[148:151], v[192:195], a[40:43]
    buffer_load_dwordx4 v8, s[4:7], s21 offen sc1 lds
    v_mfma_f32_16x16x32_bf16 a[44:47], a[148:151], v[196:199], a[44:47]
    ds_read_b64_tr_b16 a[214:215], v33 offset:24576
    v_mfma_f32_16x16x32_bf16 a[48:51], a[152:155], v[192:195], a[48:51]
    s_waitcnt lgkmcnt(8)
    ds_read_b64_tr_b16 a[216:217], v34 offset:16384
    ds_read_b64_tr_b16 a[218:219], v34 offset:24576
    v_mfma_f32_16x16x32_bf16 a[52:55], a[152:155], v[196:199], a[52:55]
    s_add_u32 m0, s24, 12288
    ds_read_b64_tr_b16 a[220:221], v35 offset:16384
    v_mfma_f32_16x16x32_bf16 a[56:59], a[156:159], v[192:195], a[56:59]
    buffer_load_dwordx4 v9, s[4:7], s21 offen sc1 lds
    v_mfma_f32_16x16x32_bf16 a[60:63], a[156:159], v[196:199], a[60:63]
    ds_read_b64_tr_b16 a[222:223], v35 offset:24576
    v_mfma_f32_16x16x32_bf16 a[64:67], a[160:163], v[192:195], a[64:67]
    ds_read_b64_tr_b16 a[224:225], v28 offset:16640
    ds_read_b64_tr_b16 a[226:227], v28 offset:24832
    v_mfma_f32_16x16x32_bf16 a[68:71], a[160:163], v[196:199], a[68:71]
    s_add_u32 m0, s24, 16384
    ds_read_b64_tr_b16 a[228:229], v29 offset:16640
    v_mfma_f32_16x16x32_bf16 a[72:75], a[164:167], v[192:195], a[72:75]
    buffer_load_dwordx4 v10, s[4:7], s21 offen sc1 lds
    v_mfma_f32_16x16x32_bf16 a[76:79], a[164:167], v[196:199], a[76:79]
    ds_read_b64_tr_b16 a[230:231], v29 offset:24832
    v_mfma_f32_16x16x32_bf16 a[80:83], a[168:171], v[192:195], a[80:83]
    ds_read_b64_tr_b16 a[232:233], v30 offset:16640
    ds_read_b64_tr_b16 a[234:235], v30 offset:24832
    v_mfma_f32_16x16x32_bf16 a[84:87], a[168:171], v[196:199], a[84:87]
    s_add_u32 m0, s24, 20480
    ds_read_b64_tr_b16 a[236:237], v31 offset:16640
    v_mfma_f32_16x16x32_bf16 a[88:91], a[172:175], v[192:195], a[88:91]
    buffer_load_dwordx4 v11, s[4:7], s21 offen sc1 lds
    v_mfma_f32_16x16x32_bf16 a[92:95], a[172:175], v[196:199], a[92:95]
    ds_read_b64_tr_b16 a[238:239], v31 offset:24832
    v_mfma_f32_16x16x32_bf16 a[96:99], a[176:179], v[192:195], a[96:99]
    s_add_u32 s25, s25, 0x8000
    ds_read_b64_tr_b16 a[240:241], v32 offset:16640
    ds_read_b64_tr_b16 a[242:243], v32 offset:24832
    v_mfma_f32_16x16x32_bf16 a[100:103], a[176:179], v[196:199], a[100:103]
    s_add_u32 m0, s24, 24576
    ds_read_b64_tr_b16 a[244:245], v33 offset:16640
    v_mfma_f32_16x16x32_bf16 a[104:107], a[180:183], v[192:195], a[104:107]
    buffer_load_dwordx4 v12, s[4:7], s21 offen sc1 lds
    v_mfma_f32_16x16x32_bf16 a[108:111], a[180:183], v[196:199], a[108:111]
    s_cmp_ge_u32 s25, 0x28000
    ds_read_b64_tr_b16 a[246:247], v33 offset:24832
    v_mfma_f32_16x16x32_bf16 a[112:115], a[184:187], v[192:195], a[112:115]
    s_cselect_b32 s25, 0, s25
    ds_read_b64_tr_b16 a[248:249], v34 offset:16640
    ds_read_b64_tr_b16 a[250:251], v34 offset:24832
    v_mfma_f32_16x16x32_bf16 a[116:119], a[184:187], v[196:199], a[116:119]
    s_add_u32 m0, s24, 28672
    ds_read_b64_tr_b16 a[252:253], v35 offset:16640
    v_mfma_f32_16x16x32_bf16 a[120:123], a[188:191], v[192:195], a[120:123]
    buffer_load_dwordx4 v13, s[4:7], s21 offen sc1 lds
    v_mfma_f32_16x16x32_bf16 a[124:127], a[188:191], v[196:199], a[124:127]
    s_waitcnt vmcnt(21) lgkmcnt(8)
    ds_read_b64_tr_b16 a[254:255], v35 offset:24832
    s_barrier
    s_cmp_eq_u32 s43, 0
    s_cbranch_scc0 AT_SIGK1
    s_cmp_lg_u32 s18, 0
    s_cbranch_scc1 AT_SIGK1
    v_mov_b32 v42, 1
    v_lshlrev_b32 v43, 2, s20
    s_mov_b64 exec, 1
    s_cmp_eq_u32 s96, 1
    s_cbranch_scc0 AT_SIGK1_S
    buffer_store_dword v42, v43, s[8:11], s35 offen
    s_branch AT_SIGK1_D
AT_SIGK1_S:
    buffer_store_dword v42, v43, s[8:11], s35 offen sc1
AT_SIGK1_D:
    s_mov_b64 exec, -1
AT_SIGK1:
    v_mfma_f32_16x16x32_bf16 a[0:3], a[192:195], v[200:203], a[0:3]
    v_add_u32 v28, s25, v16
    v_add_u32 v29, s25, v17
    v_mfma_f32_16x16x32_bf16 a[4:7], a[192:195], v[204:207], a[4:7]
    ds_read_b64_tr_b16 a[128:129], v28 offset:0
    ds_read_b64_tr_b16 a[130:131], v28 offset:8192
    v_add_u32 v30, s25, v18
    v_mfma_f32_16x16x32_bf16 a[8:11], a[196:199], v[200:203], a[8:11]
    s_add_u32 s38, s37, 8192
    buffer_load_dwordx4 v[64:67], v2, s[8:11], s38 offen offset:0 sc1
    v_add_u32 v31, s25, v19
    v_mfma_f32_16x16x32_bf16 a[12:15], a[196:199], v[204:207], a[12:15]
    s_add_u32 s21, s21, s22
    ds_read_b64_tr_b16 a[132:133], v29 offset:0
    ds_read_b64_tr_b16 a[134:135], v29 offset:8192
    v_add_u32 v32, s25, v20
    v_mfma_f32_16x16x32_bf16 a[16:19], a[200:203], v[200:203], a[16:19]
    s_add_u32 s24, s24, 0x8000
    ds_read_b64_tr_b16 a[136:137], v30 offset:0
    v_add_u32 v33, s25, v21
    v_mfma_f32_16x16x32_bf16 a[20:23], a[200:203], v[204:207], a[20:23]
    ds_read_b64_tr_b16 a[138:139], v30 offset:8192
    ds_read_b64_tr_b16 a[140:141], v31 offset:0
    v_add_u32 v34, s25, v22
    v_mfma_f32_16x16x32_bf16 a[24:27], a[204:207], v[200:203], a[24:27]
    s_add_u32 s38, s37, 20480
    buffer_load_dwordx4 v[68:71], v2, s[8:11], s38 offen offset:2048 sc1
    v_add_u32 v35, s25, v23
    v_mfma_f32_16x16x32_bf16 a[28:31], a[204:207], v[204:207], a[28:31]
    s_cmp_ge_u32 s24, 0x28000
    ds_read_b64_tr_b16 a[142:143], v31 offset:8192
    v_mfma_f32_16x16x32_bf16 a[32:35], a[208:211], v[200:203], a[32:35]
    s_cselect_b32 s24, s49, s24
    ds_read_b64_tr_b16 a[144:145], v32 offset:0
    ds_read_b64_tr_b16 a[146:147], v32 offset:8192
    v_mfma_f32_16x16x32_bf16 a[36:39], a[208:211], v[204:207], a[36:39]
    ds_read_b64_tr_b16 a[148:149], v33 offset:0
    ds_read_b64_tr_b16 a[150:151], v33 offset:8192
    v_mfma_f32_16x16x32_bf16 a[40:43], a[212:215], v[200:203], a[40:43]
    buffer_store_dwordx4 v[48:51], v2, s[8:11], s23 offen sc1
    v_mfma_f32_16x16x32_bf16 a[44:47], a[212:215], v[204:207], a[44:47]
    s_add_u32 s23, s23, s46
    ds_read_b64_tr_b16 a[152:153], v34 offset:0
    v_mfma_f32_16x16x32_bf16 a[48:51], a[216:219], v[200:203], a[48:51]
    s_waitcnt lgkmcnt(8)
    ds_read_b64_tr_b16 a[154:155], v34 offset:8192
    ds_read_b64_tr_b16 a[156:157], v35 offset:0
    v_mfma_f32_16x16x32_bf16 a[52:55], a[216:219], v[204:207], a[52:55]
    s_add_u32 s38, s37, 8192
    buffer_load_dwordx4 v[72:75], v2, s[8:11], s38 offen offset:1024 sc1
    v_mfma_f32_16x16x32_bf16 a[56:59], a[220:223], v[200:203], a[56:59]
    ds_read_b64_tr_b16 a[158:159], v35 offset:8192
    v_mfma_f32_16x16x32_bf16 a[60:63], a[220:223], v[204:207], a[60:63]
    buffer_store_dwordx4 v[52:55], v2, s[8:11], s23 offen sc1
    v_mfma_f32_16x16x32_bf16 a[64:67], a[224:227], v[200:203], a[64:67]
    s_add_u32 s23, s23, s46
    ds_read_b64_tr_b16 a[160:161], v28 offset:256
    ds_read_b64_tr_b16 a[162:163], v28 offset:8448
    v_mfma_f32_16x16x32_bf16 a[68:71], a[224:227], v[204:207], a[68:71]
    ds_read_b64_tr_b16 a[164:165], v29 offset:256
    ds_read_b64_tr_b16 a[166:167], v29 offset:8448
    v_mfma_f32_16x16x32_bf16 a[72:75], a[228:231], v[200:203], a[72:75]
    s_add_u32 s38, s37, 20480
    buffer_load_dwordx4 v[76:79], v2, s[8:11], s38 offen offset:3072 sc1
    v_mfma_f32_16x16x32_bf16 a[76:79], a[228:231], v[204:207], a[76:79]
    ds_read_b64_tr_b16 a[168:169], v30 offset:256
    v_mfma_f32_16x16x32_bf16 a[80:83], a[232:235], v[200:203], a[80:83]
    buffer_store_dwordx4 v[56:59], v2, s[8:11], s23 offen sc1
    v_mfma_f32_16x16x32_bf16 a[84:87], a[232:235], v[204:207], a[84:87]
    s_add_u32 s23, s23, s46
    ds_read_b64_tr_b16 a[170:171], v30 offset:8448
    ds_read_b64_tr_b16 a[172:173], v31 offset:256
    v_mfma_f32_16x16x32_bf16 a[88:91], a[236:239], v[200:203], a[88:91]
    ds_read_b64_tr_b16 a[174:175], v31 offset:8448
    v_mfma_f32_16x16x32_bf16 a[92:95], a[236:239], v[204:207], a[92:95]
    s_add_u32 s38, s37, 8192
    buffer_load_dwordx4 v[80:83], v2, s[8:11], s38 offen offset:2048 sc1
    v_mfma_f32_16x16x32_bf16 a[96:99], a[240:243], v[200:203], a[96:99]
    ds_read_b64_tr_b16 a[176:177], v32 offset:256
    ds_read_b64_tr_b16 a[178:179], v32 offset:8448
    v_mfma_f32_16x16x32_bf16 a[100:103], a[240:243], v[204:207], a[100:103]
    buffer_store_dwordx4 v[60:63], v2, s[8:11], s23 offen sc1
    v_mfma_f32_16x16x32_bf16 a[104:107], a[244:247], v[200:203], a[104:107]
    s_add_u32 s23, s23, s17
    ds_read_b64_tr_b16 a[180:181], v33 offset:256
    ds_read_b64_tr_b16 a[182:183], v33 offset:8448
    v_mfma_f32_16x16x32_bf16 a[108:111], a[244:247], v[204:207], a[108:111]
    ds_read_b64_tr_b16 a[184:185], v34 offset:256
    v_mfma_f32_16x16x32_bf16 a[112:115], a[248:251], v[200:203], a[112:115]
    s_add_u32 s38, s37, 24576
    buffer_load_dwordx4 v[84:87], v2, s[8:11], s38 offen offset:0 sc1
    v_mfma_f32_16x16x32_bf16 a[116:119], a[248:251], v[204:207], a[116:119]
    s_waitcnt lgkmcnt(8)
    ds_read_b64_tr_b16 a[186:187], v34 offset:8448
    ds_read_b64_tr_b16 a[188:189], v35 offset:256
    v_mfma_f32_16x16x32_bf16 a[120:123], a[252:255], v[200:203], a[120:123]
    buffer_store_dwordx4 v[112:115], v2, s[8:11], s23 offen sc1
    v_mfma_f32_16x16x32_bf16 a[124:127], a[252:255], v[204:207], a[124:127]
    s_add_u32 s23, s23, s46
    ds_read_b64_tr_b16 a[190:191], v35 offset:8448
    v_mfma_f32_16x16x32_bf16 a[0:3], a[128:131], v[208:211], a[0:3]
    ds_read_b64_tr_b16 a[192:193], v28 offset:16384
    ds_read_b64_tr_b16 a[194:195], v28 offset:24576
    v_mfma_f32_16x16x32_bf16 a[4:7], a[128:131], v[212:215], a[4:7]
    s_add_u32 m0, s24, 0
    ds_read_b64_tr_b16 a[196:197], v29 offset:16384
    v_mfma_f32_16x16x32_bf16 a[8:11], a[132:135], v[208:211], a[8:11]
    buffer_load_dwordx4 v6, s[4:7], s21 offen sc1 lds
    v_mfma_f32_16x16x32_bf16 a[12:15], a[132:135], v[212:215], a[12:15]
    ds_read_b64_tr_b16 a[198:199], v29 offset:24576
    v_mfma_f32_16x16x32_bf16 a[16:19], a[136:139], v[208:211], a[16:19]
    ds_read_b64_tr_b16 a[200:201], v30 offset:16384
    ds_read_b64_tr_b16 a[202:203], v30 offset:24576
    v_mfma_f32_16x16x32_bf16 a[20:23], a[136:139], v[212:215], a[20:23]
    s_add_u32 m0, s24, 4096
    ds_read_b64_tr_b16 a[204:205], v31 offset:16384
    v_mfma_f32_16x16x32_bf16 a[24:27], a[140:143], v[208:211], a[24:27]
    buffer_load_dwordx4 v7, s[4:7], s21 offen sc1 lds
    v_mfma_f32_16x16x32_bf16 a[28:31], a[140:143], v[212:215], a[28:31]
    ds_read_b64_tr_b16 a[206:207], v31 offset:24576
    v_mfma_f32_16x16x32_bf16 a[32:35], a[144:147], v[208:211], a[32:35]
    ds_read_b64_tr_b16 a[208:209], v32 offset:16384
    ds_read_b64_tr_b16 a[210:211], v32 offset:24576
    v_mfma_f32_16x16x32_bf16 a[36:39], a[144:147], v[212:215], a[36:39]
    s_add_u32 m0, s24, 8192
    ds_read_b64_tr_b16 a[212:213], v33 offset:16384
    v_mfma_f32_16x16x32_bf16 a[40:43], a[148:151], v[208:211], a[40:43]
    buffer_load_dwordx4 v8, s[4:7], s21 offen sc1 lds
    v_mfma_f32_16x16x32_bf16 a[44:47], a[148:151], v[212:215], a[44:47]
    ds_read_b64_tr_b16 a[214:215], v33 offset:24576
    v_mfma_f32_16x16x32_bf16 a[48:51], a[152:155], v[208:211], a[48:51]
    s_waitcnt lgkmcnt(8)
    ds_read_b64_tr_b16 a[216:217], v34 offset:16384
    ds_read_b64_tr_b16 a[218:219], v34 offset:24576
    v_mfma_f32_16x16x32_bf16 a[52:55], a[152:155], v[212:215], a[52:55]
    s_add_u32 m0, s24, 12288
    ds_read_b64_tr_b16 a[220:221], v35 offset:16384
    v_mfma_f32_16x16x32_bf16 a[56:59], a[156:159], v[208:211], a[56:59]
    buffer_load_dwordx4 v9, s[4:7], s21 offen sc1 lds
    v_mfma_f32_16x16x32_bf16 a[60:63], a[156:159], v[212:215], a[60:63]
    ds_read_b64_tr_b16 a[222:223], v35 offset:24576
    v_mfma_f32_16x16x32_bf16 a[64:67], a[160:163], v[208:211], a[64:67]
    ds_read_b64_tr_b16 a[224:225], v28 offset:16640
    ds_read_b64_tr_b16 a[226:227], v28 offset:24832
    v_mfma_f32_16x16x32_bf16 a[68:71], a[160:163], v[212:215], a[68:71]
    s_add_u32 m0, s24, 16384
    ds_read_b64_tr_b16 a[228:229], v29 offset:16640
    v_mfma_f32_16x16x32_bf16 a[72:75], a[164:167], v[208:211], a[72:75]
    buffer_load_dwordx4 v10, s[4:7], s21 offen sc1 lds
    v_mfma_f32_16x16x32_bf16 a[76:79], a[164:167], v[212:215], a[76:79]
    ds_read_b64_tr_b16 a[230:231], v29 offset:24832
    v_mfma_f32_16x16x32_bf16 a[80:83], a[168:171], v[208:211], a[80:83]
    ds_read_b64_tr_b16 a[232:233], v30 offset:16640
    ds_read_b64_tr_b16 a[234:235], v30 offset:24832
    v_mfma_f32_16x16x32_bf16 a[84:87], a[168:171], v[212:215], a[84:87]
    s_add_u32 m0, s24, 20480
    ds_read_b64_tr_b16 a[236:237], v31 offset:16640
    v_mfma_f32_16x16x32_bf16 a[88:91], a[172:175], v[208:211], a[88:91]
    buffer_load_dwordx4 v11, s[4:7], s21 offen sc1 lds
    v_mfma_f32_16x16x32_bf16 a[92:95], a[172:175], v[212:215], a[92:95]
    ds_read_b64_tr_b16 a[238:239], v31 offset:24832
    v_mfma_f32_16x16x32_bf16 a[96:99], a[176:179], v[208:211], a[96:99]
    s_add_u32 s25, s25, 0x8000
    ds_read_b64_tr_b16 a[240:241], v32 offset:16640
    ds_read_b64_tr_b16 a[242:243], v32 offset:24832
    v_mfma_f32_16x16x32_bf16 a[100:103], a[176:179], v[212:215], a[100:103]
    s_add_u32 m0, s24, 24576
    ds_read_b64_tr_b16 a[244:245], v33 offset:16640
    v_mfma_f32_16x16x32_bf16 a[104:107], a[180:183], v[208:211], a[104:107]
    buffer_load_dwordx4 v12, s[4:7], s21 offen sc1 lds
    v_mfma_f32_16x16x32_bf16 a[108:111], a[180:183], v[212:215], a[108:111]
    s_cmp_ge_u32 s25, 0x28000
    ds_read_b64_tr_b16 a[246:247], v33 offset:24832
    v_mfma_f32_16x16x32_bf16 a[112:115], a[184:187], v[208:211], a[112:115]
    s_cselect_b32 s25, 0, s25
    ds_read_b64_tr_b16 a[248:249], v34 offset:16640
    ds_read_b64_tr_b16 a[250:251], v34 offset:24832
    v_mfma_f32_16x16x32_bf16 a[116:119], a[184:187], v[212:215], a[116:119]
    s_add_u32 m0, s24, 28672
    ds_read_b64_tr_b16 a[252:253], v35 offset:16640
    v_mfma_f32_16x16x32_bf16 a[120:123], a[188:191], v[208:211], a[120:123]
    buffer_load_dwordx4 v13, s[4:7], s21 offen sc1 lds
    v_mfma_f32_16x16x32_bf16 a[124:127], a[188:191], v[212:215], a[124:127]
    s_waitcnt vmcnt(32) lgkmcnt(8)
    ds_read_b64_tr_b16 a[254:255], v35 offset:24832
    s_barrier
    buffer_load_dword v42, v41, s[8:11], s35 offen sc1
    v_mfma_f32_16x16x32_bf16 a[0:3], a[192:195], v[216:219], a[0:3]
    v_add_u32 v28, s25, v16
    v_add_u32 v29, s25, v17
    v_mfma_f32_16x16x32_bf16 a[4:7], a[192:195], v[220:223], a[4:7]
    ds_read_b64_tr_b16 a[128:129], v28 offset:0
    ds_read_b64_tr_b16 a[130:131], v28 offset:8192
    v_add_u32 v30, s25, v18
    v_mfma_f32_16x16x32_bf16 a[8:11], a[196:199], v[216:219], a[8:11]
    s_add_u32 s38, s37, 8192
    buffer_load_dwordx4 v[88:91], v2, s[8:11], s38 offen offset:3072 sc1
    v_add_u32 v31, s25, v19
    v_mfma_f32_16x16x32_bf16 a[12:15], a[196:199], v[220:223], a[12:15]
    s_add_u32 s21, s21, s22
    ds_read_b64_tr_b16 a[132:133], v29 offset:0
    ds_read_b64_tr_b16 a[134:135], v29 offset:8192
    v_add_u32 v32, s25, v20
    v_mfma_f32_16x16x32_bf16 a[16:19], a[200:203], v[216:219], a[16:19]
    s_add_u32 s24, s24, 0x8000
    ds_read_b64_tr_b16 a[136:137], v30 offset:0
    v_add_u32 v33, s25, v21
    v_mfma_f32_16x16x32_bf16 a[20:23], a[200:203], v[220:223], a[20:23]
    ds_read_b64_tr_b16 a[138:139], v30 offset:8192
    ds_read_b64_tr_b16 a[140:141], v31 offset:0
    v_add_u32 v34, s25, v22
    v_mfma_f32_16x16x32_bf16 a[24:27], a[204:207], v[216:219], a[24:27]
    s_add_u32 s38, s37, 24576
    buffer_load_dwordx4 v[92:95], v2, s[8:11], s38 offen offset:1024 sc1
    v_add_u32 v35, s25, v23
    v_mfma_f32_16x16x32_bf16 a[28:31], a[204:207], v[220:223], a[28:31]
    s_cmp_ge_u32 s24, 0x28000
    ds_read_b64_tr_b16 a[142:143], v31 offset:8192
    v_mfma_f32_16x16x32_bf16 a[32:35], a[208:211], v[216:219], a[32:35]
    s_cselect_b32 s24, s49, s24
    ds_read_b64_tr_b16 a[144:145], v32 offset:0
    ds_read_b64_tr_b16 a[146:147], v32 offset:8192
    v_mfma_f32_16x16x32_bf16 a[36:39], a[208:211], v[220:223], a[36:39]
    ds_read_b64_tr_b16 a[148:149], v33 offset:0
    ds_read_b64_tr_b16 a[150:151], v33 offset:8192
    v_mfma_f32_16x16x32_bf16 a[40:43], a[212:215], v[216:219], a[40:43]
    buffer_store_dwordx4 v[116:119], v2, s[8:11], s23 offen sc1
    v_mfma_f32_16x16x32_bf16 a[44:47], a[212:215], v[220:223], a[44:47]
    s_add_u32 s23, s23, s46
    ds_read_b64_tr_b16 a[152:153], v34 offset:0
    v_mfma_f32_16x16x32_bf16 a[48:51], a[216:219], v[216:219], a[48:51]
    s_waitcnt lgkmcnt(8)
    ds_read_b64_tr_b16 a[154:155], v34 offset:8192
    ds_read_b64_tr_b16 a[156:157], v35 offset:0
    v_mfma_f32_16x16x32_bf16 a[52:55], a[216:219], v[220:223], a[52:55]
    s_add_u32 s38, s37, 12288
    buffer_load_dwordx4 v[96:99], v2, s[8:11], s38 offen offset:0 sc1
    v_mfma_f32_16x16x32_bf16 a[56:59], a[220:223], v[216:219], a[56:59]
    ds_read_b64_tr_b16 a[158:159], v35 offset:8192
    v_mfma_f32_16x16x32_bf16 a[60:63], a[220:223], v[220:223], a[60:63]
    buffer_store_dwordx4 v[120:123], v2, s[8:11], s23 offen sc1
    v_mfma_f32_16x16x32_bf16 a[64:67], a[224:227], v[216:219], a[64:67]
    s_add_u32 s23, s23, s46
    ds_read_b64_tr_b16 a[160:161], v28 offset:256
    ds_read_b64_tr_b16 a[162:163], v28 offset:8448
    v_mfma_f32_16x16x32_bf16 a[68:71], a[224:227], v[220:223], a[68:71]
    ds_read_b64_tr_b16 a[164:165], v29 offset:256
    ds_read_b64_tr_b16 a[166:167], v29 offset:8448
    v_mfma_f32_16x16x32_bf16 a[72:75], a[228:231], v[216:219], a[72:75]
    s_add_u32 s38, s37, 24576
    buffer_load_dwordx4 v[100:103], v2, s[8:11], s38 offen offset:2048 sc1
    v_mfma_f32_16x16x32_bf16 a[76:79], a[228:231], v[220:223], a[76:79]
    ds_read_b64_tr_b16 a[168:169], v30 offset:256
    v_mfma_f32_16x16x32_bf16 a[80:83], a[232:235], v[216:219], a[80:83]
    buffer_store_dwordx4 v[124:127], v2, s[8:11], s23 offen sc1
    v_mfma_f32_16x16x32_bf16 a[84:87], a[232:235], v[220:223], a[84:87]
    s_add_u32 s23, s23, s47
    ds_read_b64_tr_b16 a[170:171], v30 offset:8448
    ds_read_b64_tr_b16 a[172:173], v31 offset:256
    v_mfma_f32_16x16x32_bf16 a[88:91], a[236:239], v[216:219], a[88:91]
    ds_read_b64_tr_b16 a[174:175], v31 offset:8448
    v_mfma_f32_16x16x32_bf16 a[92:95], a[236:239], v[220:223], a[92:95]
    s_add_u32 s38, s37, 12288
    buffer_load_dwordx4 v[104:107], v2, s[8:11], s38 offen offset:1024 sc1
    v_mfma_f32_16x16x32_bf16 a[96:99], a[240:243], v[216:219], a[96:99]
    ds_read_b64_tr_b16 a[176:177], v32 offset:256
    ds_read_b64_tr_b16 a[178:179], v32 offset:8448
    v_mfma_f32_16x16x32_bf16 a[100:103], a[240:243], v[220:223], a[100:103]
    buffer_store_dwordx4 v[128:131], v2, s[8:11], s23 offen sc1
    v_mfma_f32_16x16x32_bf16 a[104:107], a[244:247], v[216:219], a[104:107]
    s_add_u32 s23, s23, s46
    ds_read_b64_tr_b16 a[180:181], v33 offset:256
    ds_read_b64_tr_b16 a[182:183], v33 offset:8448
    v_mfma_f32_16x16x32_bf16 a[108:111], a[244:247], v[220:223], a[108:111]
    ds_read_b64_tr_b16 a[184:185], v34 offset:256
    v_mfma_f32_16x16x32_bf16 a[112:115], a[248:251], v[216:219], a[112:115]
    s_add_u32 s38, s37, 24576
    buffer_load_dwordx4 v[108:111], v2, s[8:11], s38 offen offset:3072 sc1
    v_mfma_f32_16x16x32_bf16 a[116:119], a[248:251], v[220:223], a[116:119]
    s_waitcnt lgkmcnt(8)
    ds_read_b64_tr_b16 a[186:187], v34 offset:8448
    ds_read_b64_tr_b16 a[188:189], v35 offset:256
    v_mfma_f32_16x16x32_bf16 a[120:123], a[252:255], v[216:219], a[120:123]
    buffer_store_dwordx4 v[132:135], v2, s[8:11], s23 offen sc1
    v_mfma_f32_16x16x32_bf16 a[124:127], a[252:255], v[220:223], a[124:127]
    s_add_u32 s23, s23, s46
    ds_read_b64_tr_b16 a[190:191], v35 offset:8448
    v_mfma_f32_16x16x32_bf16 a[0:3], a[128:131], v[224:227], a[0:3]
    ds_read_b64_tr_b16 a[192:193], v28 offset:16384
    ds_read_b64_tr_b16 a[194:195], v28 offset:24576
    v_mfma_f32_16x16x32_bf16 a[4:7], a[128:131], v[228:231], a[4:7]
    s_add_u32 m0, s24, 0
    ds_read_b64_tr_b16 a[196:197], v29 offset:16384
    v_mfma_f32_16x16x32_bf16 a[8:11], a[132:135], v[224:227], a[8:11]
    buffer_load_dwordx4 v6, s[4:7], s21 offen sc1 lds
    v_mfma_f32_16x16x32_bf16 a[12:15], a[132:135], v[228:231], a[12:15]
    ds_read_b64_tr_b16 a[198:199], v29 offset:24576
    v_mfma_f32_16x16x32_bf16 a[16:19], a[136:139], v[224:227], a[16:19]
    ds_read_b64_tr_b16 a[200:201], v30 offset:16384
    ds_read_b64_tr_b16 a[202:203], v30 offset:24576
    v_mfma_f32_16x16x32_bf16 a[20:23], a[136:139], v[228:231], a[20:23]
    s_add_u32 m0, s24, 4096
    ds_read_b64_tr_b16 a[204:205], v31 offset:16384
    v_mfma_f32_16x16x32_bf16 a[24:27], a[140:143], v[224:227], a[24:27]
    buffer_load_dwordx4 v7, s[4:7], s21 offen sc1 lds
    v_mfma_f32_16x16x32_bf16 a[28:31], a[140:143], v[228:231], a[28:31]
    ds_read_b64_tr_b16 a[206:207], v31 offset:24576
    v_mfma_f32_16x16x32_bf16 a[32:35], a[144:147], v[224:227], a[32:35]
    ds_read_b64_tr_b16 a[208:209], v32 offset:16384
    ds_read_b64_tr_b16 a[210:211], v32 offset:24576
    v_mfma_f32_16x16x32_bf16 a[36:39], a[144:147], v[228:231], a[36:39]
    s_add_u32 m0, s24, 8192
    ds_read_b64_tr_b16 a[212:213], v33 offset:16384
    v_mfma_f32_16x16x32_bf16 a[40:43], a[148:151], v[224:227], a[40:43]
    buffer_load_dwordx4 v8, s[4:7], s21 offen sc1 lds
    v_mfma_f32_16x16x32_bf16 a[44:47], a[148:151], v[228:231], a[44:47]
    ds_read_b64_tr_b16 a[214:215], v33 offset:24576
    v_mfma_f32_16x16x32_bf16 a[48:51], a[152:155], v[224:227], a[48:51]
    s_waitcnt lgkmcnt(8)
    ds_read_b64_tr_b16 a[216:217], v34 offset:16384
    ds_read_b64_tr_b16 a[218:219], v34 offset:24576
    v_mfma_f32_16x16x32_bf16 a[52:55], a[152:155], v[228:231], a[52:55]
    s_add_u32 m0, s24, 12288
    ds_read_b64_tr_b16 a[220:221], v35 offset:16384
    v_mfma_f32_16x16x32_bf16 a[56:59], a[156:159], v[224:227], a[56:59]
    buffer_load_dwordx4 v9, s[4:7], s21 offen sc1 lds
    v_mfma_f32_16x16x32_bf16 a[60:63], a[156:159], v[228:231], a[60:63]
    ds_read_b64_tr_b16 a[222:223], v35 offset:24576
    v_mfma_f32_16x16x32_bf16 a[64:67], a[160:163], v[224:227], a[64:67]
    ds_read_b64_tr_b16 a[224:225], v28 offset:16640
    ds_read_b64_tr_b16 a[226:227], v28 offset:24832
    v_mfma_f32_16x16x32_bf16 a[68:71], a[160:163], v[228:231], a[68:71]
    s_add_u32 m0, s24, 16384
    ds_read_b64_tr_b16 a[228:229], v29 offset:16640
    v_mfma_f32_16x16x32_bf16 a[72:75], a[164:167], v[224:227], a[72:75]
    buffer_load_dwordx4 v10, s[4:7], s21 offen sc1 lds
    v_mfma_f32_16x16x32_bf16 a[76:79], a[164:167], v[228:231], a[76:79]
    ds_read_b64_tr_b16 a[230:231], v29 offset:24832
    v_mfma_f32_16x16x32_bf16 a[80:83], a[168:171], v[224:227], a[80:83]
    ds_read_b64_tr_b16 a[232:233], v30 offset:16640
    ds_read_b64_tr_b16 a[234:235], v30 offset:24832
    v_mfma_f32_16x16x32_bf16 a[84:87], a[168:171], v[228:231], a[84:87]
    s_add_u32 m0, s24, 20480
    ds_read_b64_tr_b16 a[236:237], v31 offset:16640
    v_mfma_f32_16x16x32_bf16 a[88:91], a[172:175], v[224:227], a[88:91]
    buffer_load_dwordx4 v11, s[4:7], s21 offen sc1 lds
    v_mfma_f32_16x16x32_bf16 a[92:95], a[172:175], v[228:231], a[92:95]
    ds_read_b64_tr_b16 a[238:239], v31 offset:24832
    v_mfma_f32_16x16x32_bf16 a[96:99], a[176:179], v[224:227], a[96:99]
    s_add_u32 s25, s25, 0x8000
    ds_read_b64_tr_b16 a[240:241], v32 offset:16640
    ds_read_b64_tr_b16 a[242:243], v32 offset:24832
    v_mfma_f32_16x16x32_bf16 a[100:103], a[176:179], v[228:231], a[100:103]
    s_add_u32 m0, s24, 24576
    ds_read_b64_tr_b16 a[244:245], v33 offset:16640
    v_mfma_f32_16x16x32_bf16 a[104:107], a[180:183], v[224:227], a[104:107]
    buffer_load_dwordx4 v12, s[4:7], s21 offen sc1 lds
    v_mfma_f32_16x16x32_bf16 a[108:111], a[180:183], v[228:231], a[108:111]
    s_cmp_ge_u32 s25, 0x28000
    ds_read_b64_tr_b16 a[246:247], v33 offset:24832
    v_mfma_f32_16x16x32_bf16 a[112:115], a[184:187], v[224:227], a[112:115]
    s_cselect_b32 s25, 0, s25
    ds_read_b64_tr_b16 a[248:249], v34 offset:16640
    ds_read_b64_tr_b16 a[250:251], v34 offset:24832
    v_mfma_f32_16x16x32_bf16 a[116:119], a[184:187], v[228:231], a[116:119]
    s_add_u32 m0, s24, 28672
    ds_read_b64_tr_b16 a[252:253], v35 offset:16640
    v_mfma_f32_16x16x32_bf16 a[120:123], a[188:191], v[224:227], a[120:123]
    buffer_load_dwordx4 v13, s[4:7], s21 offen sc1 lds
    v_mfma_f32_16x16x32_bf16 a[124:127], a[188:191], v[228:231], a[124:127]
    s_waitcnt vmcnt(19) lgkmcnt(8)
    ds_read_b64_tr_b16 a[254:255], v35 offset:24832
    s_barrier
    s_mov_b32 s42, 0
    s_branch AT_POLLK1_CHK
AT_POLLK1:
    buffer_load_dword v42, v41, s[8:11], s35 offen sc1
    s_waitcnt vmcnt(0)
AT_POLLK1_CHK:
    v_cmp_ne_u32 s[40:41], 0, v42
    s_nop 0
    s_and_b32 s40, s40, 0x3
    s_cmp_eq_u32 s40, 0x3
    s_cbranch_scc1 AT_POLLK1_OK
    s_sleep 1
    s_add_u32 s42, s42, 1
    s_cmp_lt_u32 s42, 0x40000
    s_cbranch_scc1 AT_POLLK1
AT_POLLK1_OK:
    v_mfma_f32_16x16x32_bf16 a[0:3], a[192:195], v[232:235], a[0:3]
    v_add_u32 v28, s25, v16
    v_add_u32 v29, s25, v17
    v_mfma_f32_16x16x32_bf16 a[4:7], a[192:195], v[236:239], a[4:7]
    ds_read_b64_tr_b16 a[128:129], v28 offset:0
    ds_read_b64_tr_b16 a[130:131], v28 offset:8192
    v_add_u32 v30, s25, v18
    v_mfma_f32_16x16x32_bf16 a[8:11], a[196:199], v[232:235], a[8:11]
    ds_read_b64_tr_b16 a[132:133], v29 offset:0
    v_add_u32 v31, s25, v19
    v_mfma_f32_16x16x32_bf16 a[12:15], a[196:199], v[236:239], a[12:15]
    s_add_u32 s21, s21, s22
    ds_read_b64_tr_b16 a[134:135], v29 offset:8192
    v_add_u32 v32, s25, v20
    v_mfma_f32_16x16x32_bf16 a[16:19], a[200:203], v[232:235], a[16:19]
    s_add_u32 s24, s24, 0x8000
    ds_read_b64_tr_b16 a[136:137], v30 offset:0
    v_add_u32 v33, s25, v21
    v_mfma_f32_16x16x32_bf16 a[20:23], a[200:203], v[236:239], a[20:23]
    ds_read_b64_tr_b16 a[138:139], v30 offset:8192
    ds_read_b64_tr_b16 a[140:141], v31 offset:0
    v_add_u32 v34, s25, v22
    v_mfma_f32_16x16x32_bf16 a[24:27], a[204:207], v[232:235], a[24:27]
    ds_read_b64_tr_b16 a[142:143], v31 offset:8192
    v_add_u32 v35, s25, v23
    v_mfma_f32_16x16x32_bf16 a[28:31], a[204:207], v[236:239], a[28:31]
    s_cmp_ge_u32 s24, 0x28000
    ds_read_b64_tr_b16 a[144:145], v32 offset:0
    v_mfma_f32_16x16x32_bf16 a[32:35], a[208:211], v[232:235], a[32:35]
    s_cselect_b32 s24, s49, s24
    ds_read_b64_tr_b16 a[146:147], v32 offset:8192
    v_mfma_f32_16x16x32_bf16 a[36:39], a[208:211], v[236:239], a[36:39]
    ds_read_b64_tr_b16 a[148:149], v33 offset:0
    ds_read_b64_tr_b16 a[150:151], v33 offset:8192
    v_mfma_f32_16x16x32_bf16 a[40:43], a[212:215], v[232:235], a[40:43]
    buffer_store_dwordx4 v[136:139], v2, s[8:11], s23 offen sc1
    v_mfma_f32_16x16x32_bf16 a[44:47], a[212:215], v[236:239], a[44:47]
    s_add_u32 s23, s23, s46
    ds_read_b64_tr_b16 a[152:153], v34 offset:0
    v_mfma_f32_16x16x32_bf16 a[48:51], a[216:219], v[232:235], a[48:51]
    s_waitcnt lgkmcnt(8)
    ds_read_b64_tr_b16 a[154:155], v34 offset:8192
    v_mfma_f32_16x16x32_bf16 a[52:55], a[216:219], v[236:239], a[52:55]
    s_mov_b32 s4, s62
    ds_read_b64_tr_b16 a[156:157], v35 offset:0
    v_mov_b32 v6, v3
    v_mfma_f32_16x16x32_bf16 a[56:59], a[220:223], v[232:235], a[56:59]
    s_and_b32 s5, s63, 0xffff
    ds_read_b64_tr_b16 a[158:159], v35 offset:8192
    v_add_u32 v7, 0x1000, v3
    v_mfma_f32_16x16x32_bf16 a[60:63], a[220:223], v[236:239], a[60:63]
    buffer_store_dwordx4 v[140:143], v2, s[8:11], s23 offen sc1
    v_mfma_f32_16x16x32_bf16 a[64:67], a[224:227], v[232:235], a[64:67]
    s_add_u32 s23, s23, s17
    ds_read_b64_tr_b16 a[160:161], v28 offset:256
    ds_read_b64_tr_b16 a[162:163], v28 offset:8448
    v_mfma_f32_16x16x32_bf16 a[68:71], a[224:227], v[236:239], a[68:71]
    s_mov_b32 s6, 0x10000000
    ds_read_b64_tr_b16 a[164:165], v29 offset:256
    v_add_u32 v8, 0x2000, v3
    v_mfma_f32_16x16x32_bf16 a[72:75], a[228:231], v[232:235], a[72:75]
    s_mov_b32 s22, 0x8000
    ds_read_b64_tr_b16 a[166:167], v29 offset:8448
    v_add_u32 v9, 0x3000, v3
    v_mfma_f32_16x16x32_bf16 a[76:79], a[228:231], v[236:239], a[76:79]
    s_lshl_b32 s21, s19, 6
    ds_read_b64_tr_b16 a[168:169], v30 offset:256
    v_add_u32 v10, 0x4000, v3
    v_mfma_f32_16x16x32_bf16 a[80:83], a[232:235], v[232:235], a[80:83]
    buffer_store_dwordx4 v[144:147], v2, s[8:11], s23 offen sc1
    v_mfma_f32_16x16x32_bf16 a[84:87], a[232:235], v[236:239], a[84:87]
    s_add_u32 s23, s23, s46
    ds_read_b64_tr_b16 a[170:171], v30 offset:8448
    ds_read_b64_tr_b16 a[172:173], v31 offset:256
    v_mfma_f32_16x16x32_bf16 a[88:91], a[236:239], v[232:235], a[88:91]
    s_add_u32 s21, s21, s27
    ds_read_b64_tr_b16 a[174:175], v31 offset:8448
    v_add_u32 v11, 0x5000, v3
    v_mfma_f32_16x16x32_bf16 a[92:95], a[236:239], v[236:239], a[92:95]
    s_lshl_b32 s21, s21, 15
    ds_read_b64_tr_b16 a[176:177], v32 offset:256
    v_add_u32 v12, 0x6000, v3
    v_mfma_f32_16x16x32_bf16 a[96:99], a[240:243], v[232:235], a[96:99]
    s_add_u32 s21, s21, 0x1ffc000
    ds_read_b64_tr_b16 a[178:179], v32 offset:8448
    v_add_u32 v13, 0x7000, v3
    v_mfma_f32_16x16x32_bf16 a[100:103], a[240:243], v[236:239], a[100:103]
    buffer_store_dwordx4 v[148:151], v2, s[8:11], s23 offen sc1
    v_mfma_f32_16x16x32_bf16 a[104:107], a[244:247], v[232:235], a[104:107]
    s_add_u32 s23, s23, s46
    ds_read_b64_tr_b16 a[180:181], v33 offset:256
    ds_read_b64_tr_b16 a[182:183], v33 offset:8448
    v_mfma_f32_16x16x32_bf16 a[108:111], a[244:247], v[236:239], a[108:111]
    ds_read_b64_tr_b16 a[184:185], v34 offset:256
    v_mfma_f32_16x16x32_bf16 a[112:115], a[248:251], v[232:235], a[112:115]
    ds_read_b64_tr_b16 a[186:187], v34 offset:8448
    v_mfma_f32_16x16x32_bf16 a[116:119], a[248:251], v[236:239], a[116:119]
    s_waitcnt lgkmcnt(8)
    ds_read_b64_tr_b16 a[188:189], v35 offset:256
    v_mfma_f32_16x16x32_bf16 a[120:123], a[252:255], v[232:235], a[120:123]
    buffer_store_dwordx4 v[152:155], v2, s[8:11], s23 offen sc1
    v_mfma_f32_16x16x32_bf16 a[124:127], a[252:255], v[236:239], a[124:127]
    s_add_u32 s23, s23, s46
    ds_read_b64_tr_b16 a[190:191], v35 offset:8448
    v_mfma_f32_16x16x32_bf16 a[0:3], a[128:131], v[64:67], a[0:3]
    ds_read_b64_tr_b16 a[192:193], v28 offset:16384
    ds_read_b64_tr_b16 a[194:195], v28 offset:24576
    v_mfma_f32_16x16x32_bf16 a[4:7], a[128:131], v[68:71], a[4:7]
    s_add_u32 m0, s24, 0
    ds_read_b64_tr_b16 a[196:197], v29 offset:16384
    v_mfma_f32_16x16x32_bf16 a[8:11], a[132:135], v[64:67], a[8:11]
    buffer_load_dwordx4 v10, s[4:7], s21 offen sc1 lds
    v_mfma_f32_16x16x32_bf16 a[12:15], a[132:135], v[68:71], a[12:15]
    ds_read_b64_tr_b16 a[198:199], v29 offset:24576
    v_mfma_f32_16x16x32_bf16 a[16:19], a[136:139], v[64:67], a[16:19]
    ds_read_b64_tr_b16 a[200:201], v30 offset:16384
    ds_read_b64_tr_b16 a[202:203], v30 offset:24576
    v_mfma_f32_16x16x32_bf16 a[20:23], a[136:139], v[68:71], a[20:23]
    s_add_u32 m0, s24, 4096
    ds_read_b64_tr_b16 a[204:205], v31 offset:16384
    v_mfma_f32_16x16x32_bf16 a[24:27], a[140:143], v[64:67], a[24:27]
    buffer_load_dwordx4 v11, s[4:7], s21 offen sc1 lds
    v_mfma_f32_16x16x32_bf16 a[28:31], a[140:143], v[68:71], a[28:31]
    ds_read_b64_tr_b16 a[206:207], v31 offset:24576
    v_mfma_f32_16x16x32_bf16 a[32:35], a[144:147], v[64:67], a[32:35]
    ds_read_b64_tr_b16 a[208:209], v32 offset:16384
    ds_read_b64_tr_b16 a[210:211], v32 offset:24576
    v_mfma_f32_16x16x32_bf16 a[36:39], a[144:147], v[68:71], a[36:39]
    s_add_u32 m0, s24, 8192
    ds_read_b64_tr_b16 a[212:213], v33 offset:16384
    v_mfma_f32_16x16x32_bf16 a[40:43], a[148:151], v[64:67], a[40:43]
    buffer_load_dwordx4 v12, s[4:7], s21 offen sc1 lds
    v_mfma_f32_16x16x32_bf16 a[44:47], a[148:151], v[68:71], a[44:47]
    ds_read_b64_tr_b16 a[214:215], v33 offset:24576
    v_mfma_f32_16x16x32_bf16 a[48:51], a[152:155], v[64:67], a[48:51]
    s_waitcnt lgkmcnt(8)
    ds_read_b64_tr_b16 a[216:217], v34 offset:16384
    ds_read_b64_tr_b16 a[218:219], v34 offset:24576
    v_mfma_f32_16x16x32_bf16 a[52:55], a[152:155], v[68:71], a[52:55]
    s_add_u32 m0, s24, 12288
    ds_read_b64_tr_b16 a[220:221], v35 offset:16384
    v_mfma_f32_16x16x32_bf16 a[56:59], a[156:159], v[64:67], a[56:59]
    buffer_load_dwordx4 v13, s[4:7], s21 offen sc1 lds
    v_mfma_f32_16x16x32_bf16 a[60:63], a[156:159], v[68:71], a[60:63]
    ds_read_b64_tr_b16 a[222:223], v35 offset:24576
    v_mfma_f32_16x16x32_bf16 a[64:67], a[160:163], v[64:67], a[64:67]
    ds_read_b64_tr_b16 a[224:225], v28 offset:16640
    ds_read_b64_tr_b16 a[226:227], v28 offset:24832
    v_mfma_f32_16x16x32_bf16 a[68:71], a[160:163], v[68:71], a[68:71]
    s_add_u32 m0, s24, 16384
    ds_read_b64_tr_b16 a[228:229], v29 offset:16640
    v_mfma_f32_16x16x32_bf16 a[72:75], a[164:167], v[64:67], a[72:75]
    buffer_load_dwordx4 v10, s[4:7], s21 offen sc1 lds
    v_mfma_f32_16x16x32_bf16 a[76:79], a[164:167], v[68:71], a[76:79]
    ds_read_b64_tr_b16 a[230:231], v29 offset:24832
    v_mfma_f32_16x16x32_bf16 a[80:83], a[168:171], v[64:67], a[80:83]
    ds_read_b64_tr_b16 a[232:233], v30 offset:16640
    ds_read_b64_tr_b16 a[234:235], v30 offset:24832
    v_mfma_f32_16x16x32_bf16 a[84:87], a[168:171], v[68:71], a[84:87]
    s_add_u32 m0, s24, 20480
    ds_read_b64_tr_b16 a[236:237], v31 offset:16640
    v_mfma_f32_16x16x32_bf16 a[88:91], a[172:175], v[64:67], a[88:91]
    buffer_load_dwordx4 v11, s[4:7], s21 offen sc1 lds
    v_mfma_f32_16x16x32_bf16 a[92:95], a[172:175], v[68:71], a[92:95]
    ds_read_b64_tr_b16 a[238:239], v31 offset:24832
    v_mfma_f32_16x16x32_bf16 a[96:99], a[176:179], v[64:67], a[96:99]
    s_add_u32 s25, s25, 0x8000
    ds_read_b64_tr_b16 a[240:241], v32 offset:16640
    ds_read_b64_tr_b16 a[242:243], v32 offset:24832
    v_mfma_f32_16x16x32_bf16 a[100:103], a[176:179], v[68:71], a[100:103]
    s_add_u32 m0, s24, 24576
    ds_read_b64_tr_b16 a[244:245], v33 offset:16640
    v_mfma_f32_16x16x32_bf16 a[104:107], a[180:183], v[64:67], a[104:107]
    buffer_load_dwordx4 v12, s[4:7], s21 offen sc1 lds
    v_mfma_f32_16x16x32_bf16 a[108:111], a[180:183], v[68:71], a[108:111]
    s_cmp_ge_u32 s25, 0x28000
    ds_read_b64_tr_b16 a[246:247], v33 offset:24832
    v_mfma_f32_16x16x32_bf16 a[112:115], a[184:187], v[64:67], a[112:115]
    s_cselect_b32 s25, 0, s25
    ds_read_b64_tr_b16 a[248:249], v34 offset:16640
    ds_read_b64_tr_b16 a[250:251], v34 offset:24832
    v_mfma_f32_16x16x32_bf16 a[116:119], a[184:187], v[68:71], a[116:119]
    s_add_u32 m0, s24, 28672
    ds_read_b64_tr_b16 a[252:253], v35 offset:16640
    v_mfma_f32_16x16x32_bf16 a[120:123], a[188:191], v[64:67], a[120:123]
    buffer_load_dwordx4 v13, s[4:7], s21 offen sc1 lds
    v_mfma_f32_16x16x32_bf16 a[124:127], a[188:191], v[68:71], a[124:127]
    s_waitcnt vmcnt(22) lgkmcnt(8)
    ds_read_b64_tr_b16 a[254:255], v35 offset:24832
    v_mfma_f32_16x16x32_bf16 a[0:3], a[192:195], v[72:75], a[0:3]
    s_barrier
    v_add_u32 v28, s25, v16
    v_add_u32 v29, s25, v17
    v_mfma_f32_16x16x32_bf16 a[4:7], a[192:195], v[76:79], a[4:7]
    ds_read_b64_tr_b16 a[128:129], v28 offset:0
    ds_read_b64_tr_b16 a[130:131], v28 offset:8192
    v_add_u32 v30, s25, v18
    v_mfma_f32_16x16x32_bf16 a[8:11], a[196:199], v[72:75], a[8:11]
    ds_read_b64_tr_b16 a[132:133], v29 offset:0
    v_add_u32 v31, s25, v19
    v_mfma_f32_16x16x32_bf16 a[12:15], a[196:199], v[76:79], a[12:15]
    s_add_u32 s21, s21, s22
    ds_read_b64_tr_b16 a[134:135], v29 offset:8192
    v_add_u32 v32, s25, v20
    v_mfma_f32_16x16x32_bf16 a[16:19], a[200:203], v[72:75], a[16:19]
    s_add_u32 s24, s24, 0x8000
    ds_read_b64_tr_b16 a[136:137], v30 offset:0
    v_add_u32 v33, s25, v21
    v_mfma_f32_16x16x32_bf16 a[20:23], a[200:203], v[76:79], a[20:23]
    ds_read_b64_tr_b16 a[138:139], v30 offset:8192
    ds_read_b64_tr_b16 a[140:141], v31 offset:0
    v_add_u32 v34, s25, v22
    v_mfma_f32_16x16x32_bf16 a[24:27], a[204:207], v[72:75], a[24:27]
    ds_read_b64_tr_b16 a[142:143], v31 offset:8192
    v_add_u32 v35, s25, v23
    v_mfma_f32_16x16x32_bf16 a[28:31], a[204:207], v[76:79], a[28:31]
    s_cmp_ge_u32 s24, 0x28000
    ds_read_b64_tr_b16 a[144:145], v32 offset:0
    v_mfma_f32_16x16x32_bf16 a[32:35], a[208:211], v[72:75], a[32:35]
    s_cselect_b32 s24, s49, s24
    ds_read_b64_tr_b16 a[146:147], v32 offset:8192
    v_mfma_f32_16x16x32_bf16 a[36:39], a[208:211], v[76:79], a[36:39]
    ds_read_b64_tr_b16 a[148:149], v33 offset:0
    ds_read_b64_tr_b16 a[150:151], v33 offset:8192
    v_mfma_f32_16x16x32_bf16 a[40:43], a[212:215], v[72:75], a[40:43]
    buffer_store_dwordx4 v[156:159], v2, s[8:11], s23 offen sc1
    v_mfma_f32_16x16x32_bf16 a[44:47], a[212:215], v[76:79], a[44:47]
    s_add_u32 s23, s23, s47
    ds_read_b64_tr_b16 a[152:153], v34 offset:0
    v_mfma_f32_16x16x32_bf16 a[48:51], a[216:219], v[72:75], a[48:51]
    s_waitcnt lgkmcnt(8)
    ds_read_b64_tr_b16 a[154:155], v34 offset:8192
    v_mfma_f32_16x16x32_bf16 a[52:55], a[216:219], v[76:79], a[52:55]
    ds_read_b64_tr_b16 a[156:157], v35 offset:0
    v_mfma_f32_16x16x32_bf16 a[56:59], a[220:223], v[72:75], a[56:59]
    ds_read_b64_tr_b16 a[158:159], v35 offset:8192
    v_mfma_f32_16x16x32_bf16 a[60:63], a[220:223], v[76:79], a[60:63]
    buffer_store_dwordx4 v[160:163], v2, s[8:11], s23 offen sc1
    v_mfma_f32_16x16x32_bf16 a[64:67], a[224:227], v[72:75], a[64:67]
    s_add_u32 s23, s23, s46
    ds_read_b64_tr_b16 a[160:161], v28 offset:256
    ds_read_b64_tr_b16 a[162:163], v28 offset:8448
    v_mfma_f32_16x16x32_bf16 a[68:71], a[224:227], v[76:79], a[68:71]
    ds_read_b64_tr_b16 a[164:165], v29 offset:256
    v_mfma_f32_16x16x32_bf16 a[72:75], a[228:231], v[72:75], a[72:75]
    ds_read_b64_tr_b16 a[166:167], v29 offset:8448
    v_mfma_f32_16x16x32_bf16 a[76:79], a[228:231], v[76:79], a[76:79]
    ds_read_b64_tr_b16 a[168:169], v30 offset:256
    v_mfma_f32_16x16x32_bf16 a[80:83], a[232:235], v[72:75], a[80:83]
    buffer_store_dwordx4 v[164:167], v2, s[8:11], s23 offen sc1
    v_mfma_f32_16x16x32_bf16 a[84:87], a[232:235], v[76:79], a[84:87]
    s_add_u32 s23, s23, s46
    ds_read_b64_tr_b16 a[170:171], v30 offset:8448
    ds_read_b64_tr_b16 a[172:173], v31 offset:256
    v_mfma_f32_16x16x32_bf16 a[88:91], a[236:239], v[72:75], a[88:91]
    ds_read_b64_tr_b16 a[174:175], v31 offset:8448
    v_mfma_f32_16x16x32_bf16 a[92:95], a[236:239], v[76:79], a[92:95]
    ds_read_b64_tr_b16 a[176:177], v32 offset:256
    v_mfma_f32_16x16x32_bf16 a[96:99], a[240:243], v[72:75], a[96:99]
    ds_read_b64_tr_b16 a[178:179], v32 offset:8448
    v_mfma_f32_16x16x32_bf16 a[100:103], a[240:243], v[76:79], a[100:103]
    buffer_store_dwordx4 v[168:171], v2, s[8:11], s23 offen sc1
    v_mfma_f32_16x16x32_bf16 a[104:107], a[244:247], v[72:75], a[104:107]
    s_add_u32 s23, s23, s46
    ds_read_b64_tr_b16 a[180:181], v33 offset:256
    ds_read_b64_tr_b16 a[182:183], v33 offset:8448
    v_mfma_f32_16x16x32_bf16 a[108:111], a[244:247], v[76:79], a[108:111]
    ds_read_b64_tr_b16 a[184:185], v34 offset:256
    v_mfma_f32_16x16x32_bf16 a[112:115], a[248:251], v[72:75], a[112:115]
    ds_read_b64_tr_b16 a[186:187], v34 offset:8448
    v_mfma_f32_16x16x32_bf16 a[116:119], a[248:251], v[76:79], a[116:119]
    s_waitcnt lgkmcnt(8)
    ds_read_b64_tr_b16 a[188:189], v35 offset:256
    v_mfma_f32_16x16x32_bf16 a[120:123], a[252:255], v[72:75], a[120:123]
    buffer_store_dwordx4 v[172:175], v2, s[8:11], s23 offen sc1
    v_mfma_f32_16x16x32_bf16 a[124:127], a[252:255], v[76:79], a[124:127]
    s_add_u32 s23, s23, s17
    ds_read_b64_tr_b16 a[190:191], v35 offset:8448
    v_mfma_f32_16x16x32_bf16 a[0:3], a[128:131], v[80:83], a[0:3]
    s_lshl_b32 s28, s26, 2
    ds_read_b64_tr_b16 a[192:193], v28 offset:16384
    ds_read_b64_tr_b16 a[194:195], v28 offset:24576
    v_mfma_f32_16x16x32_bf16 a[4:7], a[128:131], v[84:87], a[4:7]
    s_add_u32 m0, s24, 0
    ds_read_b64_tr_b16 a[196:197], v29 offset:16384
    v_lshrrev_b32 v240, 3, v0
    v_mfma_f32_16x16x32_bf16 a[8:11], a[132:135], v[80:83], a[8:11]
    s_add_u32 s28, s28, 4
    buffer_load_dwordx4 v6, s[4:7], s21 offen sc1 lds
    v_mfma_f32_16x16x32_bf16 a[12:15], a[132:135], v[84:87], a[12:15]
    ds_read_b64_tr_b16 a[198:199], v29 offset:24576
    v_bfe_u32 v241, v240, 1, 2
    v_mfma_f32_16x16x32_bf16 a[16:19], a[136:139], v[80:83], a[16:19]
    s_cmp_eq_u32 s29, 1
    s_cselect_b32 s28, 40, s28
    ds_read_b64_tr_b16 a[200:201], v30 offset:16384
    ds_read_b64_tr_b16 a[202:203], v30 offset:24576
    v_mfma_f32_16x16x32_bf16 a[20:23], a[136:139], v[84:87], a[20:23]
    s_add_u32 m0, s24, 4096
    ds_read_b64_tr_b16 a[204:205], v31 offset:16384
    v_lshlrev_b32 v241, 1, v241
    v_mfma_f32_16x16x32_bf16 a[24:27], a[140:143], v[80:83], a[24:27]
    buffer_load_dwordx4 v7, s[4:7], s21 offen sc1 lds
    v_mfma_f32_16x16x32_bf16 a[28:31], a[140:143], v[84:87], a[28:31]
    ds_read_b64_tr_b16 a[206:207], v31 offset:24576
    v_and_b32 v242, 7, v1
    v_mfma_f32_16x16x32_bf16 a[32:35], a[144:147], v[80:83], a[32:35]
    s_sub_u32 s30, 15, s26
    ds_read_b64_tr_b16 a[208:209], v32 offset:16384
    ds_read_b64_tr_b16 a[210:211], v32 offset:24576
    v_mfma_f32_16x16x32_bf16 a[36:39], a[144:147], v[84:87], a[36:39]
    s_add_u32 m0, s24, 8192
    ds_read_b64_tr_b16 a[212:213], v33 offset:16384
    v_xor_b32 v241, v241, v242
    v_mfma_f32_16x16x32_bf16 a[40:43], a[148:151], v[80:83], a[40:43]
    s_max_u32 s31, s26, s30
    buffer_load_dwordx4 v8, s[4:7], s21 offen sc1 lds
    v_mfma_f32_16x16x32_bf16 a[44:47], a[148:151], v[84:87], a[44:47]
    ds_read_b64_tr_b16 a[214:215], v33 offset:24576
    v_lshlrev_b32 v241, 4, v241
    v_mfma_f32_16x16x32_bf16 a[48:51], a[152:155], v[80:83], a[48:51]
    s_waitcnt lgkmcnt(8)
    ds_read_b64_tr_b16 a[216:217], v34 offset:16384
    ds_read_b64_tr_b16 a[218:219], v34 offset:24576
    v_mfma_f32_16x16x32_bf16 a[52:55], a[152:155], v[84:87], a[52:55]
    s_add_u32 m0, s24, 12288
    ds_read_b64_tr_b16 a[220:221], v35 offset:16384
    v_mul_u32_u24 v240, 896, v240
    v_mfma_f32_16x16x32_bf16 a[56:59], a[156:159], v[80:83], a[56:59]
    s_mul_i32 s36, s19, 6
    buffer_load_dwordx4 v9, s[4:7], s21 offen sc1 lds
    v_mfma_f32_16x16x32_bf16 a[60:63], a[156:159], v[84:87], a[60:63]
    ds_read_b64_tr_b16 a[222:223], v35 offset:24576
    v_add_u32 v5, v240, v241
    v_mfma_f32_16x16x32_bf16 a[64:67], a[160:163], v[80:83], a[64:67]
    s_add_u32 s36, s36, s31
    ds_read_b64_tr_b16 a[224:225], v28 offset:16640
    ds_read_b64_tr_b16 a[226:227], v28 offset:24832
    v_mfma_f32_16x16x32_bf16 a[68:71], a[160:163], v[84:87], a[68:71]
    s_add_u32 m0, s24, 16384
    ds_read_b64_tr_b16 a[228:229], v29 offset:16640
    v_lshrrev_b32 v240, 2, v1
    v_mfma_f32_16x16x32_bf16 a[72:75], a[164:167], v[80:83], a[72:75]
    s_sub_u32 s36, s36, 10
    buffer_load_dwordx4 v10, s[4:7], s21 offen sc1 lds
    v_mfma_f32_16x16x32_bf16 a[76:79], a[164:167], v[84:87], a[76:79]
    ds_read_b64_tr_b16 a[230:231], v29 offset:24832
    v_lshlrev_b32 v241, 7, v240
    v_mfma_f32_16x16x32_bf16 a[80:83], a[168:171], v[80:83], a[80:83]
    s_mov_b32 s48, 0x4e800000
    ds_read_b64_tr_b16 a[232:233], v30 offset:16640
    ds_read_b64_tr_b16 a[234:235], v30 offset:24832
    v_mfma_f32_16x16x32_bf16 a[84:87], a[168:171], v[84:87], a[84:87]
    s_add_u32 m0, s24, 20480
    ds_read_b64_tr_b16 a[236:237], v31 offset:16640
    v_and_b32 v242, 3, v1
    v_mfma_f32_16x16x32_bf16 a[88:91], a[172:175], v[80:83], a[88:91]
    s_sub_u32 s17, 3, s18
    buffer_load_dwordx4 v11, s[4:7], s21 offen sc1 lds
    v_mfma_f32_16x16x32_bf16 a[92:95], a[172:175], v[84:87], a[92:95]
    s_min_u32 s17, s17, 2
    ds_read_b64_tr_b16 a[238:239], v31 offset:24832
    v_mfma_f32_16x16x32_bf16 a[96:99], a[176:179], v[80:83], a[96:99]
    s_add_u32 s25, s25, 0x8000
    ds_read_b64_tr_b16 a[240:241], v32 offset:16640
    ds_read_b64_tr_b16 a[242:243], v32 offset:24832
    v_mfma_f32_16x16x32_bf16 a[100:103], a[176:179], v[84:87], a[100:103]
    s_add_u32 m0, s24, 24576
    ds_read_b64_tr_b16 a[244:245], v33 offset:16640
    v_mfma_f32_16x16x32_bf16 a[104:107], a[180:183], v[80:83], a[104:107]
    s_cmp_eq_u32 s29, 1
    s_cselect_b32 s17, 0, s17
    buffer_load_dwordx4 v12, s[4:7], s21 offen sc1 lds
    v_mfma_f32_16x16x32_bf16 a[108:111], a[180:183], v[84:87], a[108:111]
    s_cmp_ge_u32 s25, 0x28000
    ds_read_b64_tr_b16 a[246:247], v33 offset:24832
    v_mfma_f32_16x16x32_bf16 a[112:115], a[184:187], v[80:83], a[112:115]
    s_cselect_b32 s25, 0, s25
    ds_read_b64_tr_b16 a[248:249], v34 offset:16640
    ds_read_b64_tr_b16 a[250:251], v34 offset:24832
    v_mfma_f32_16x16x32_bf16 a[116:119], a[184:187], v[84:87], a[116:119]
    s_add_u32 m0, s24, 28672
    ds_read_b64_tr_b16 a[252:253], v35 offset:16640
    v_mfma_f32_16x16x32_bf16 a[120:123], a[188:191], v[80:83], a[120:123]
    s_lshl_b32 s37, s36, 2
    buffer_load_dwordx4 v13, s[4:7], s21 offen sc1 lds
    v_mfma_f32_16x16x32_bf16 a[124:127], a[188:191], v[84:87], a[124:127]
    s_waitcnt vmcnt(26) lgkmcnt(8)
    ds_read_b64_tr_b16 a[254:255], v35 offset:24832
    v_mfma_f32_16x16x32_bf16 a[0:3], a[192:195], v[88:91], a[0:3]
    s_barrier
    v_add_u32 v28, s25, v16
    v_add_u32 v29, s25, v17
    v_mfma_f32_16x16x32_bf16 a[4:7], a[192:195], v[92:95], a[4:7]
    s_add_u32 s37, s37, s18
    ds_read_b64_tr_b16 a[128:129], v28 offset:0
    ds_read_b64_tr_b16 a[130:131], v28 offset:8192
    v_add_u32 v30, s25, v18
    v_mfma_f32_16x16x32_bf16 a[8:11], a[196:199], v[88:91], a[8:11]
    s_lshl_b32 s37, s37, 14
    ds_read_b64_tr_b16 a[132:133], v29 offset:0
    v_add_u32 v31, s25, v19
    v_mfma_f32_16x16x32_bf16 a[12:15], a[196:199], v[92:95], a[12:15]
    s_add_u32 s21, s21, s22
    ds_read_b64_tr_b16 a[134:135], v29 offset:8192
    v_add_u32 v32, s25, v20
    v_mfma_f32_16x16x32_bf16 a[16:19], a[200:203], v[88:91], a[16:19]
    s_add_u32 s24, s24, 0x8000
    ds_read_b64_tr_b16 a[136:137], v30 offset:0
    v_add_u32 v33, s25, v21
    v_mfma_f32_16x16x32_bf16 a[20:23], a[200:203], v[92:95], a[20:23]
    s_add_u32 s37, s37, 0xa000000
    ds_read_b64_tr_b16 a[138:139], v30 offset:8192
    v_add_u32 v34, s25, v22
    v_mfma_f32_16x16x32_bf16 a[24:27], a[204:207], v[88:91], a[24:27]
    s_cmp_eq_u32 s29, 1
    s_cselect_b32 s37, s37, 0xf0000000
    ds_read_b64_tr_b16 a[140:141], v31 offset:0
    v_add_u32 v35, s25, v23
    v_mfma_f32_16x16x32_bf16 a[28:31], a[204:207], v[92:95], a[28:31]
    s_cmp_ge_u32 s24, 0x28000
    ds_read_b64_tr_b16 a[142:143], v31 offset:8192
    v_mfma_f32_16x16x32_bf16 a[32:35], a[208:211], v[88:91], a[32:35]
    s_cselect_b32 s24, s49, s24
    ds_read_b64_tr_b16 a[144:145], v32 offset:0
    v_mfma_f32_16x16x32_bf16 a[36:39], a[208:211], v[92:95], a[36:39]
    s_mov_b32 s16, 2
    ds_read_b64_tr_b16 a[146:147], v32 offset:8192
    v_lshl_add_u32 v241, v242, 3, v241
    v_mfma_f32_16x16x32_bf16 a[40:43], a[212:215], v[88:91], a[40:43]
    ds_read_b64_tr_b16 a[148:149], v33 offset:0
    v_bfe_u32 v242, v240, 1, 2
    v_mfma_f32_16x16x32_bf16 a[44:47], a[212:215], v[92:95], a[44:47]
    ds_read_b64_tr_b16 a[150:151], v33 offset:8192
    v_lshl_add_u32 v241, v242, 5, v241
    v_mfma_f32_16x16x32_bf16 a[48:51], a[216:219], v[88:91], a[48:51]
    s_waitcnt lgkmcnt(8)
    ds_read_b64_tr_b16 a[152:153], v34 offset:0
    v_xor_b32 v24, 0, v241
    v_mfma_f32_16x16x32_bf16 a[52:55], a[216:219], v[92:95], a[52:55]
    ds_read_b64_tr_b16 a[154:155], v34 offset:8192
    v_xor_b32 v25, 32, v241
    v_mfma_f32_16x16x32_bf16 a[56:59], a[220:223], v[88:91], a[56:59]
    ds_read_b64_tr_b16 a[156:157], v35 offset:0
    v_xor_b32 v26, 64, v241
    v_mfma_f32_16x16x32_bf16 a[60:63], a[220:223], v[92:95], a[60:63]
    ds_read_b64_tr_b16 a[158:159], v35 offset:8192
    v_xor_b32 v27, 96, v241
    v_mfma_f32_16x16x32_bf16 a[64:67], a[224:227], v[88:91], a[64:67]
    ds_read_b64_tr_b16 a[160:161], v28 offset:256
    v_and_b32 v240, 15, v1
    v_mfma_f32_16x16x32_bf16 a[68:71], a[224:227], v[92:95], a[68:71]
    ds_read_b64_tr_b16 a[162:163], v28 offset:8448
    v_lshrrev_b32 v241, 4, v1
    v_mfma_f32_16x16x32_bf16 a[72:75], a[228:231], v[88:91], a[72:75]
    ds_read_b64_tr_b16 a[164:165], v29 offset:256
    v_lshlrev_b32 v241, 2, v241
    v_mfma_f32_16x16x32_bf16 a[76:79], a[228:231], v[92:95], a[76:79]
    ds_read_b64_tr_b16 a[166:167], v29 offset:8448
    v_sub_u32 v240, v240, v241
    v_mfma_f32_16x16x32_bf16 a[80:83], a[232:235], v[88:91], a[80:83]
    ds_read_b64_tr_b16 a[168:169], v30 offset:256
    v_lshrrev_b32 v241, 6, v0
    v_mfma_f32_16x16x32_bf16 a[84:87], a[232:235], v[92:95], a[84:87]
    ds_read_b64_tr_b16 a[170:171], v30 offset:8448
    v_lshl_add_u32 v36, v241, 5, v240
    v_mfma_f32_16x16x32_bf16 a[88:91], a[236:239], v[88:91], a[88:91]
    ds_read_b64_tr_b16 a[172:173], v31 offset:256
    v_mov_b32 v15, 0xf149f2ca
    v_mfma_f32_16x16x32_bf16 a[92:95], a[236:239], v[92:95], a[92:95]
    ds_read_b64_tr_b16 a[174:175], v31 offset:8448
    v_mfma_f32_16x16x32_bf16 a[96:99], a[240:243], v[88:91], a[96:99]
    ds_read_b64_tr_b16 a[176:177], v32 offset:256
    v_mfma_f32_16x16x32_bf16 a[100:103], a[240:243], v[92:95], a[100:103]
    ds_read_b64_tr_b16 a[178:179], v32 offset:8448
    v_mfma_f32_16x16x32_bf16 a[104:107], a[244:247], v[88:91], a[104:107]
    ds_read_b64_tr_b16 a[180:181], v33 offset:256
    v_mfma_f32_16x16x32_bf16 a[108:111], a[244:247], v[92:95], a[108:111]
    ds_read_b64_tr_b16 a[182:183], v33 offset:8448
    v_mfma_f32_16x16x32_bf16 a[112:115], a[248:251], v[88:91], a[112:115]
    ds_read_b64_tr_b16 a[184:185], v34 offset:256
    v_mfma_f32_16x16x32_bf16 a[116:119], a[248:251], v[92:95], a[116:119]
    s_waitcnt lgkmcnt(8)
    ds_read_b64_tr_b16 a[186:187], v34 offset:8448
    v_mfma_f32_16x16x32_bf16 a[120:123], a[252:255], v[88:91], a[120:123]
    ds_read_b64_tr_b16 a[188:189], v35 offset:256
    v_mfma_f32_16x16x32_bf16 a[124:127], a[252:255], v[92:95], a[124:127]
    ds_read_b64_tr_b16 a[190:191], v35 offset:8448
    v_mfma_f32_16x16x32_bf16 a[0:3], a[128:131], v[96:99], a[0:3]
    ds_read_b64_tr_b16 a[192:193], v28 offset:16384
    ds_read_b64_tr_b16 a[194:195], v28 offset:24576
    v_mfma_f32_16x16x32_bf16 a[4:7], a[128:131], v[100:103], a[4:7]
    s_add_u32 m0, s24, 0
    ds_read_b64_tr_b16 a[196:197], v29 offset:16384
    v_mfma_f32_16x16x32_bf16 a[8:11], a[132:135], v[96:99], a[8:11]
    buffer_load_dwordx4 v6, s[4:7], s21 offen sc1 lds
    v_mfma_f32_16x16x32_bf16 a[12:15], a[132:135], v[100:103], a[12:15]
    ds_read_b64_tr_b16 a[198:199], v29 offset:24576
    v_mfma_f32_16x16x32_bf16 a[16:19], a[136:139], v[96:99], a[16:19]
    ds_read_b64_tr_b16 a[200:201], v30 offset:16384
    ds_read_b64_tr_b16 a[202:203], v30 offset:24576
    v_mfma_f32_16x16x32_bf16 a[20:23], a[136:139], v[100:103], a[20:23]
    s_add_u32 m0, s24, 4096
    ds_read_b64_tr_b16 a[204:205], v31 offset:16384
    v_mfma_f32_16x16x32_bf16 a[24:27], a[140:143], v[96:99], a[24:27]
    buffer_load_dwordx4 v7, s[4:7], s21 offen sc1 lds
    v_mfma_f32_16x16x32_bf16 a[28:31], a[140:143], v[100:103], a[28:31]
    ds_read_b64_tr_b16 a[206:207], v31 offset:24576
    v_mfma_f32_16x16x32_bf16 a[32:35], a[144:147], v[96:99], a[32:35]
    ds_read_b64_tr_b16 a[208:209], v32 offset:16384
    ds_read_b64_tr_b16 a[210:211], v32 offset:24576
    v_mfma_f32_16x16x32_bf16 a[36:39], a[144:147], v[100:103], a[36:39]
    s_add_u32 m0, s24, 8192
    ds_read_b64_tr_b16 a[212:213], v33 offset:16384
    v_mfma_f32_16x16x32_bf16 a[40:43], a[148:151], v[96:99], a[40:43]
    buffer_load_dwordx4 v8, s[4:7], s21 offen sc1 lds
    v_mfma_f32_16x16x32_bf16 a[44:47], a[148:151], v[100:103], a[44:47]
    ds_read_b64_tr_b16 a[214:215], v33 offset:24576
    v_mfma_f32_16x16x32_bf16 a[48:51], a[152:155], v[96:99], a[48:51]
    s_waitcnt lgkmcnt(8)
    ds_read_b64_tr_b16 a[216:217], v34 offset:16384
    ds_read_b64_tr_b16 a[218:219], v34 offset:24576
    v_mfma_f32_16x16x32_bf16 a[52:55], a[152:155], v[100:103], a[52:55]
    s_add_u32 m0, s24, 12288
    ds_read_b64_tr_b16 a[220:221], v35 offset:16384
    v_mfma_f32_16x16x32_bf16 a[56:59], a[156:159], v[96:99], a[56:59]
    buffer_load_dwordx4 v9, s[4:7], s21 offen sc1 lds
    v_mfma_f32_16x16x32_bf16 a[60:63], a[156:159], v[100:103], a[60:63]
    ds_read_b64_tr_b16 a[222:223], v35 offset:24576
    v_mfma_f32_16x16x32_bf16 a[64:67], a[160:163], v[96:99], a[64:67]
    ds_read_b64_tr_b16 a[224:225], v28 offset:16640
    ds_read_b64_tr_b16 a[226:227], v28 offset:24832
    v_mfma_f32_16x16x32_bf16 a[68:71], a[160:163], v[100:103], a[68:71]
    s_add_u32 m0, s24, 16384
    ds_read_b64_tr_b16 a[228:229], v29 offset:16640
    v_mfma_f32_16x16x32_bf16 a[72:75], a[164:167], v[96:99], a[72:75]
    buffer_load_dwordx4 v10, s[4:7], s21 offen sc1 lds
    v_mfma_f32_16x16x32_bf16 a[76:79], a[164:167], v[100:103], a[76:79]
    ds_read_b64_tr_b16 a[230:231], v29 offset:24832
    v_mfma_f32_16x16x32_bf16 a[80:83], a[168:171], v[96:99], a[80:83]
    ds_read_b64_tr_b16 a[232:233], v30 offset:16640
    ds_read_b64_tr_b16 a[234:235], v30 offset:24832
    v_mfma_f32_16x16x32_bf16 a[84:87], a[168:171], v[100:103], a[84:87]
    s_add_u32 m0, s24, 20480
    ds_read_b64_tr_b16 a[236:237], v31 offset:16640
    v_mfma_f32_16x16x32_bf16 a[88:91], a[172:175], v[96:99], a[88:91]
    buffer_load_dwordx4 v11, s[4:7], s21 offen sc1 lds
    v_mfma_f32_16x16x32_bf16 a[92:95], a[172:175], v[100:103], a[92:95]
    ds_read_b64_tr_b16 a[238:239], v31 offset:24832
    v_mfma_f32_16x16x32_bf16 a[96:99], a[176:179], v[96:99], a[96:99]
    s_add_u32 s25, s25, 0x8000
    ds_read_b64_tr_b16 a[240:241], v32 offset:16640
    ds_read_b64_tr_b16 a[242:243], v32 offset:24832
    v_mfma_f32_16x16x32_bf16 a[100:103], a[176:179], v[100:103], a[100:103]
    s_add_u32 m0, s24, 24576
    ds_read_b64_tr_b16 a[244:245], v33 offset:16640
    v_mfma_f32_16x16x32_bf16 a[104:107], a[180:183], v[96:99], a[104:107]
    buffer_load_dwordx4 v12, s[4:7], s21 offen sc1 lds
    v_mfma_f32_16x16x32_bf16 a[108:111], a[180:183], v[100:103], a[108:111]
    s_cmp_ge_u32 s25, 0x28000
    ds_read_b64_tr_b16 a[246:247], v33 offset:24832
    v_mfma_f32_16x16x32_bf16 a[112:115], a[184:187], v[96:99], a[112:115]
    s_cselect_b32 s25, 0, s25
    ds_read_b64_tr_b16 a[248:249], v34 offset:16640
    ds_read_b64_tr_b16 a[250:251], v34 offset:24832
    v_mfma_f32_16x16x32_bf16 a[116:119], a[184:187], v[100:103], a[116:119]
    s_add_u32 m0, s24, 28672
    ds_read_b64_tr_b16 a[252:253], v35 offset:16640
    v_mfma_f32_16x16x32_bf16 a[120:123], a[188:191], v[96:99], a[120:123]
    buffer_load_dwordx4 v13, s[4:7], s21 offen sc1 lds
    v_mfma_f32_16x16x32_bf16 a[124:127], a[188:191], v[100:103], a[124:127]
    s_waitcnt vmcnt(16) lgkmcnt(8)
    ds_read_b64_tr_b16 a[254:255], v35 offset:24832
    s_barrier
    s_cmp_eq_u32 s43, 0
    s_cbranch_scc1 AT_SIGKV
    s_cmp_lg_u32 s18, 0
    s_cbranch_scc1 AT_SIGKV
    v_mov_b32 v42, 1
    v_lshlrev_b32 v43, 2, s20
    s_mov_b64 exec, 1
    s_cmp_eq_u32 s96, 1
    s_cbranch_scc0 AT_SIGKV_S
    buffer_store_dword v42, v43, s[8:11], s35 offen
    s_branch AT_SIGKV_D
AT_SIGKV_S:
    buffer_store_dword v42, v43, s[8:11], s35 offen sc1
AT_SIGKV_D:
    s_mov_b64 exec, -1
AT_SIGKV:
    v_mfma_f32_16x16x32_bf16 a[0:3], a[192:195], v[104:107], a[0:3]
    v_add_u32 v14, s25, v2
    v_mfma_f32_16x16x32_bf16 a[4:7], a[192:195], v[108:111], a[4:7]
    ds_read_b128 a[128:131], v14 offset:16384
    v_mfma_f32_16x16x32_bf16 a[8:11], a[196:199], v[104:107], a[8:11]
    v_mfma_f32_16x16x32_bf16 a[12:15], a[196:199], v[108:111], a[12:15]
    s_add_u32 s21, s21, s22
    ds_read_b128 a[132:135], v14 offset:17408
    v_mfma_f32_16x16x32_bf16 a[16:19], a[200:203], v[104:107], a[16:19]
    s_add_u32 s24, s24, 0x8000
    v_mfma_f32_16x16x32_bf16 a[20:23], a[200:203], v[108:111], a[20:23]
    ds_read_b128 a[136:139], v14 offset:18432
    v_mfma_f32_16x16x32_bf16 a[24:27], a[204:207], v[104:107], a[24:27]
    v_mfma_f32_16x16x32_bf16 a[28:31], a[204:207], v[108:111], a[28:31]
    s_cmp_ge_u32 s24, 0x28000
    ds_read_b128 a[140:143], v14 offset:19456
    v_accvgpr_read_b32 v240, a0
    v_mfma_f32_16x16x32_bf16 a[32:35], a[208:211], v[104:107], a[32:35]
    s_cselect_b32 s24, s49, s24
    v_accvgpr_read_b32 v241, a1
    v_accvgpr_read_b32 v242, a2
    v_mfma_f32_16x16x32_bf16 a[36:39], a[208:211], v[108:111], a[36:39]
    ds_read_b128 a[144:147], v14 offset:20480
    v_accvgpr_read_b32 v243, a3
    v_mfma_f32_16x16x32_bf16 a[40:43], a[212:215], v[104:107], a[40:43]
    v_accvgpr_read_b32 v244, a8
    v_accvgpr_read_b32 v245, a9
    v_mfma_f32_16x16x32_bf16 a[44:47], a[212:215], v[108:111], a[44:47]
    ds_read_b128 a[148:151], v14 offset:21504
    v_accvgpr_read_b32 v246, a10
    v_mfma_f32_16x16x32_bf16 a[48:51], a[216:219], v[104:107], a[48:51]
    s_waitcnt lgkmcnt(4)
    v_accvgpr_read_b32 v247, a11
    v_cvt_pk_bf16_f32 v112, v240, v241
    v_mfma_f32_16x16x32_bf16 a[52:55], a[216:219], v[108:111], a[52:55]
    ds_read_b128 a[152:155], v14 offset:22528
    v_cvt_pk_bf16_f32 v113, v242, v243
    v_mfma_f32_16x16x32_bf16 a[56:59], a[220:223], v[104:107], a[56:59]
    v_cvt_pk_bf16_f32 v114, v244, v245
    v_cvt_pk_bf16_f32 v115, v246, v247
    v_mfma_f32_16x16x32_bf16 a[60:63], a[220:223], v[108:111], a[60:63]
    ds_read_b128 a[156:159], v14 offset:23552
    v_accvgpr_read_b32 v248, a4
    v_mfma_f32_16x16x32_bf16 a[64:67], a[224:227], v[104:107], a[64:67]
    v_accvgpr_read_b32 v249, a5
    v_accvgpr_read_b32 v250, a6
    v_mfma_f32_16x16x32_bf16 a[68:71], a[224:227], v[108:111], a[68:71]
    ds_read_b128 a[160:163], v14 offset:24576
    v_accvgpr_read_b32 v251, a7
    v_mfma_f32_16x16x32_bf16 a[72:75], a[228:231], v[104:107], a[72:75]
    v_accvgpr_read_b32 v252, a12
    v_accvgpr_read_b32 v253, a13
    v_mfma_f32_16x16x32_bf16 a[76:79], a[228:231], v[108:111], a[76:79]
    ds_read_b128 a[164:167], v14 offset:25600
    v_accvgpr_read_b32 v254, a14
    v_mfma_f32_16x16x32_bf16 a[80:83], a[232:235], v[104:107], a[80:83]
    v_accvgpr_read_b32 v255, a15
    v_cvt_pk_bf16_f32 v144, v248, v249
    v_mfma_f32_16x16x32_bf16 a[84:87], a[232:235], v[108:111], a[84:87]
    ds_read_b128 a[168:171], v14 offset:26624
    v_cvt_pk_bf16_f32 v145, v250, v251
    v_mfma_f32_16x16x32_bf16 a[88:91], a[236:239], v[104:107], a[88:91]
    v_cvt_pk_bf16_f32 v146, v252, v253
    v_cvt_pk_bf16_f32 v147, v254, v255
    v_mfma_f32_16x16x32_bf16 a[92:95], a[236:239], v[108:111], a[92:95]
    ds_read_b128 a[172:175], v14 offset:27648
    v_accvgpr_read_b32 v240, a16
    v_mfma_f32_16x16x32_bf16 a[96:99], a[240:243], v[104:107], a[96:99]
    v_accvgpr_read_b32 v241, a17
    v_accvgpr_read_b32 v242, a18
    v_mfma_f32_16x16x32_bf16 a[100:103], a[240:243], v[108:111], a[100:103]
    ds_read_b128 a[176:179], v14 offset:28672
    v_accvgpr_read_b32 v243, a19
    v_mfma_f32_16x16x32_bf16 a[104:107], a[244:247], v[104:107], a[104:107]
    v_accvgpr_read_b32 v244, a24
    v_accvgpr_read_b32 v245, a25
    v_mfma_f32_16x16x32_bf16 a[108:111], a[244:247], v[108:111], a[108:111]
    ds_read_b128 a[180:183], v14 offset:29696
    v_accvgpr_read_b32 v246, a26
    v_mfma_f32_16x16x32_bf16 a[112:115], a[248:251], v[104:107], a[112:115]
    v_accvgpr_read_b32 v247, a27
    v_cvt_pk_bf16_f32 v116, v240, v241
    v_mfma_f32_16x16x32_bf16 a[116:119], a[248:251], v[108:111], a[116:119]
    ds_read_b128 a[184:187], v14 offset:30720
    v_cvt_pk_bf16_f32 v117, v242, v243
    v_mfma_f32_16x16x32_bf16 a[120:123], a[252:255], v[104:107], a[120:123]
    ds_read_b128 a[188:191], v14 offset:31744
    v_cvt_pk_bf16_f32 v118, v244, v245
    v_mfma_f32_16x16x32_bf16 a[124:127], a[252:255], v[108:111], a[124:127]
    v_cvt_pk_bf16_f32 v119, v246, v247
    v_accvgpr_read_b32 v248, a20
    v_accvgpr_read_b32 v249, a21
    v_accvgpr_read_b32 v250, a22
    v_accvgpr_read_b32 v251, a23
    v_accvgpr_read_b32 v252, a28
    v_accvgpr_read_b32 v253, a29
    v_accvgpr_read_b32 v254, a30
    v_accvgpr_read_b32 v255, a31
    v_cvt_pk_bf16_f32 v148, v248, v249
    v_cvt_pk_bf16_f32 v149, v250, v251
    v_cvt_pk_bf16_f32 v150, v252, v253
    v_cvt_pk_bf16_f32 v151, v254, v255
    s_waitcnt lgkmcnt(0)
    v_mfma_f32_16x16x32_bf16 v[64:67], a[128:131], v[112:115], 0
    s_add_u32 m0, s24, 0
    v_accvgpr_read_b32 v240, a32
    v_accvgpr_read_b32 v241, a33
    v_accvgpr_read_b32 v242, a34
    v_accvgpr_read_b32 v243, a35
    v_accvgpr_read_b32 v244, a40
    v_accvgpr_read_b32 v245, a41
    v_mfma_f32_16x16x32_bf16 v[68:71], a[128:131], v[144:147], 0
    buffer_load_dwordx4 v6, s[4:7], s21 offen sc1 lds
    v_accvgpr_read_b32 v246, a42
    v_accvgpr_read_b32 v247, a43
    v_cvt_pk_bf16_f32 v120, v240, v241
    v_cvt_pk_bf16_f32 v121, v242, v243
    v_cvt_pk_bf16_f32 v122, v244, v245
    v_cvt_pk_bf16_f32 v123, v246, v247
    v_mfma_f32_16x16x32_bf16 v[72:75], a[160:163], v[112:115], 0
    s_add_u32 s38, s37, 0
    buffer_store_dwordx4 v[112:115], v2, s[8:11], s38 offen sc1
    s_mov_b32 s33, s27
    v_accvgpr_read_b32 v248, a36
    v_accvgpr_read_b32 v249, a37
    v_accvgpr_read_b32 v250, a38
    v_accvgpr_read_b32 v251, a39
    v_accvgpr_read_b32 v252, a44
    v_accvgpr_read_b32 v253, a45
    v_mfma_f32_16x16x32_bf16 v[76:79], a[160:163], v[144:147], 0
    s_add_u32 s38, s37, 8192
    buffer_store_dwordx4 v[144:147], v2, s[8:11], s38 offen sc1
    s_lshl_b32 s34, s26, 2
    v_accvgpr_read_b32 v254, a46
    v_accvgpr_read_b32 v255, a47
    v_cvt_pk_bf16_f32 v152, v248, v249
    v_cvt_pk_bf16_f32 v153, v250, v251
    v_cvt_pk_bf16_f32 v154, v252, v253
    v_cvt_pk_bf16_f32 v155, v254, v255
    v_mfma_f32_16x16x32_bf16 v[64:67], a[132:135], v[116:119], v[64:67]
    s_add_u32 m0, s24, 4096
    v_accvgpr_read_b32 v240, a48
    v_accvgpr_read_b32 v241, a49
    v_accvgpr_read_b32 v242, a50
    v_accvgpr_read_b32 v243, a51
    v_accvgpr_read_b32 v244, a56
    v_accvgpr_read_b32 v245, a57
    v_mfma_f32_16x16x32_bf16 v[68:71], a[132:135], v[148:151], v[68:71]
    buffer_load_dwordx4 v7, s[4:7], s21 offen sc1 lds
    v_accvgpr_read_b32 v246, a58
    v_accvgpr_read_b32 v247, a59
    v_cvt_pk_bf16_f32 v124, v240, v241
    v_cvt_pk_bf16_f32 v125, v242, v243
    v_cvt_pk_bf16_f32 v126, v244, v245
    v_cvt_pk_bf16_f32 v127, v246, v247
    v_mfma_f32_16x16x32_bf16 v[72:75], a[164:167], v[116:119], v[72:75]
    s_add_u32 s38, s37, 1024
    buffer_store_dwordx4 v[116:119], v2, s[8:11], s38 offen sc1
    s_mov_b32 s32, s28
    v_accvgpr_read_b32 v248, a52
    v_accvgpr_read_b32 v249, a53
    v_accvgpr_read_b32 v250, a54
    v_accvgpr_read_b32 v251, a55
    v_accvgpr_read_b32 v252, a60
    v_accvgpr_read_b32 v253, a61
    v_mfma_f32_16x16x32_bf16 v[76:79], a[164:167], v[148:151], v[76:79]
    s_add_u32 s38, s37, 9216
    buffer_store_dwordx4 v[148:151], v2, s[8:11], s38 offen sc1
    s_add_u32 s25, s25, 0x8000
    s_cmp_ge_u32 s25, 0x28000
    s_cselect_b32 s25, 0, s25
    v_accvgpr_read_b32 v254, a62
    v_accvgpr_read_b32 v255, a63
    v_cvt_pk_bf16_f32 v156, v248, v249
    v_cvt_pk_bf16_f32 v157, v250, v251
    v_cvt_pk_bf16_f32 v158, v252, v253
    v_cvt_pk_bf16_f32 v159, v254, v255
    v_mfma_f32_16x16x32_bf16 v[64:67], a[136:139], v[120:123], v[64:67]
    s_add_u32 m0, s24, 8192
    v_accvgpr_read_b32 v240, a64
    v_accvgpr_read_b32 v241, a65
    v_accvgpr_read_b32 v242, a66
    v_accvgpr_read_b32 v243, a67
    v_accvgpr_read_b32 v244, a72
    v_accvgpr_read_b32 v245, a73
    v_mfma_f32_16x16x32_bf16 v[68:71], a[136:139], v[152:155], v[68:71]
    buffer_load_dwordx4 v8, s[4:7], s21 offen sc1 lds
    v_accvgpr_read_b32 v246, a74
    v_accvgpr_read_b32 v247, a75
    v_cvt_pk_bf16_f32 v128, v240, v241
    v_cvt_pk_bf16_f32 v129, v242, v243
    v_cvt_pk_bf16_f32 v130, v244, v245
    v_cvt_pk_bf16_f32 v131, v246, v247
    v_mfma_f32_16x16x32_bf16 v[72:75], a[168:171], v[120:123], v[72:75]
    s_add_u32 s38, s37, 2048
    buffer_store_dwordx4 v[120:123], v2, s[8:11], s38 offen sc1
    v_accvgpr_read_b32 v248, a68
    v_accvgpr_read_b32 v249, a69
    v_accvgpr_read_b32 v250, a70
    v_accvgpr_read_b32 v251, a71
    v_accvgpr_read_b32 v252, a76
    v_accvgpr_read_b32 v253, a77
    v_mfma_f32_16x16x32_bf16 v[76:79], a[168:171], v[152:155], v[76:79]
    s_add_u32 s38, s37, 10240
    buffer_store_dwordx4 v[152:155], v2, s[8:11], s38 offen sc1
    v_accvgpr_read_b32 v254, a78
    v_accvgpr_read_b32 v255, a79
    v_cvt_pk_bf16_f32 v160, v248, v249
    v_cvt_pk_bf16_f32 v161, v250, v251
    v_cvt_pk_bf16_f32 v162, v252, v253
    v_cvt_pk_bf16_f32 v163, v254, v255
    v_mfma_f32_16x16x32_bf16 v[64:67], a[140:143], v[124:127], v[64:67]
    s_add_u32 m0, s24, 12288
    v_accvgpr_read_b32 v240, a80
    v_accvgpr_read_b32 v241, a81
    v_accvgpr_read_b32 v242, a82
    v_accvgpr_read_b32 v243, a83
    v_accvgpr_read_b32 v244, a88
    v_accvgpr_read_b32 v245, a89
    v_mfma_f32_16x16x32_bf16 v[68:71], a[140:143], v[156:159], v[68:71]
    buffer_load_dwordx4 v9, s[4:7], s21 offen sc1 lds
    v_accvgpr_read_b32 v246, a90
    v_accvgpr_read_b32 v247, a91
    v_cvt_pk_bf16_f32 v132, v240, v241
    v_cvt_pk_bf16_f32 v133, v242, v243
    v_cvt_pk_bf16_f32 v134, v244, v245
    v_cvt_pk_bf16_f32 v135, v246, v247
    v_mfma_f32_16x16x32_bf16 v[72:75], a[172:175], v[124:127], v[72:75]
    s_add_u32 s38, s37, 3072
    buffer_store_dwordx4 v[124:127], v2, s[8:11], s38 offen sc1
    v_accvgpr_read_b32 v248, a84
    v_accvgpr_read_b32 v249, a85
    v_accvgpr_read_b32 v250, a86
    v_accvgpr_read_b32 v251, a87
    v_accvgpr_read_b32 v252, a92
    v_accvgpr_read_b32 v253, a93
    v_mfma_f32_16x16x32_bf16 v[76:79], a[172:175], v[156:159], v[76:79]
    s_add_u32 s38, s37, 11264
    buffer_store_dwordx4 v[156:159], v2, s[8:11], s38 offen sc1
    v_accvgpr_read_b32 v254, a94
    v_accvgpr_read_b32 v255, a95
    v_cvt_pk_bf16_f32 v164, v248, v249
    v_cvt_pk_bf16_f32 v165, v250, v251
    v_cvt_pk_bf16_f32 v166, v252, v253
    v_cvt_pk_bf16_f32 v167, v254, v255
    v_mfma_f32_16x16x32_bf16 v[64:67], a[144:147], v[128:131], v[64:67]
    s_add_u32 m0, s24, 16384
    v_accvgpr_read_b32 v240, a96
    v_accvgpr_read_b32 v241, a97
    v_accvgpr_read_b32 v242, a98
    v_accvgpr_read_b32 v243, a99
    v_accvgpr_read_b32 v244, a104
    v_accvgpr_read_b32 v245, a105
    v_mfma_f32_16x16x32_bf16 v[68:71], a[144:147], v[160:163], v[68:71]
    buffer_load_dwordx4 v10, s[4:7], s21 offen sc1 lds
    v_accvgpr_read_b32 v246, a106
    v_accvgpr_read_b32 v247, a107
    v_cvt_pk_bf16_f32 v136, v240, v241
    v_cvt_pk_bf16_f32 v137, v242, v243
    v_cvt_pk_bf16_f32 v138, v244, v245
    v_cvt_pk_bf16_f32 v139, v246, v247
    v_mfma_f32_16x16x32_bf16 v[72:75], a[176:179], v[128:131], v[72:75]
    s_add_u32 s38, s37, 4096
    buffer_store_dwordx4 v[128:131], v2, s[8:11], s38 offen sc1
    v_accvgpr_read_b32 v248, a100
    v_accvgpr_read_b32 v249, a101
    v_accvgpr_read_b32 v250, a102
    v_accvgpr_read_b32 v251, a103
    v_accvgpr_read_b32 v252, a108
    v_accvgpr_read_b32 v253, a109
    v_mfma_f32_16x16x32_bf16 v[76:79], a[176:179], v[160:163], v[76:79]
    s_add_u32 s38, s37, 12288
    buffer_store_dwordx4 v[160:163], v2, s[8:11], s38 offen sc1
    v_accvgpr_read_b32 v254, a110
    v_accvgpr_read_b32 v255, a111
    v_cvt_pk_bf16_f32 v168, v248, v249
    v_cvt_pk_bf16_f32 v169, v250, v251
    v_cvt_pk_bf16_f32 v170, v252, v253
    v_cvt_pk_bf16_f32 v171, v254, v255
    v_mfma_f32_16x16x32_bf16 v[64:67], a[148:151], v[132:135], v[64:67]
    s_add_u32 m0, s24, 20480
    v_accvgpr_read_b32 v240, a112
    v_accvgpr_read_b32 v241, a113
    v_accvgpr_read_b32 v242, a114
    v_accvgpr_read_b32 v243, a115
    v_accvgpr_read_b32 v244, a120
    v_accvgpr_read_b32 v245, a121
    v_mfma_f32_16x16x32_bf16 v[68:71], a[148:151], v[164:167], v[68:71]
    buffer_load_dwordx4 v11, s[4:7], s21 offen sc1 lds
    v_accvgpr_read_b32 v246, a122
    v_accvgpr_read_b32 v247, a123
    v_cvt_pk_bf16_f32 v140, v240, v241
    v_cvt_pk_bf16_f32 v141, v242, v243
    v_cvt_pk_bf16_f32 v142, v244, v245
    v_cvt_pk_bf16_f32 v143, v246, v247
    v_mfma_f32_16x16x32_bf16 v[72:75], a[180:183], v[132:135], v[72:75]
    s_add_u32 s38, s37, 5120
    buffer_store_dwordx4 v[132:135], v2, s[8:11], s38 offen sc1
    v_accvgpr_read_b32 v248, a116
    v_accvgpr_read_b32 v249, a117
    v_accvgpr_read_b32 v250, a118
    v_accvgpr_read_b32 v251, a119
    v_accvgpr_read_b32 v252, a124
    v_accvgpr_read_b32 v253, a125
    v_mfma_f32_16x16x32_bf16 v[76:79], a[180:183], v[164:167], v[76:79]
    s_add_u32 s38, s37, 13312
    buffer_store_dwordx4 v[164:167], v2, s[8:11], s38 offen sc1
    v_accvgpr_read_b32 v254, a126
    v_accvgpr_read_b32 v255, a127
    v_cvt_pk_bf16_f32 v172, v248, v249
    v_cvt_pk_bf16_f32 v173, v250, v251
    v_cvt_pk_bf16_f32 v174, v252, v253
    v_cvt_pk_bf16_f32 v175, v254, v255
    v_mfma_f32_16x16x32_bf16 v[64:67], a[152:155], v[136:139], v[64:67]
    s_add_u32 m0, s24, 24576
    v_mfma_f32_16x16x32_bf16 v[68:71], a[152:155], v[168:171], v[68:71]
    buffer_load_dwordx4 v12, s[4:7], s21 offen sc1 lds
    v_add_u32 v14, s25, v2
    v_mov_b32 v37, v36
    v_mfma_f32_16x16x32_bf16 v[72:75], a[184:187], v[136:139], v[72:75]
    s_add_u32 s38, s37, 6144
    buffer_store_dwordx4 v[136:139], v2, s[8:11], s38 offen sc1
    v_mfma_f32_16x16x32_bf16 v[76:79], a[184:187], v[168:171], v[76:79]
    s_add_u32 s38, s37, 14336
    buffer_store_dwordx4 v[168:171], v2, s[8:11], s38 offen sc1
    v_mfma_f32_16x16x32_bf16 v[64:67], a[156:159], v[140:143], v[64:67]
    s_add_u32 m0, s24, 28672
    v_mfma_f32_16x16x32_bf16 v[68:71], a[156:159], v[172:175], v[68:71]
    buffer_load_dwordx4 v13, s[4:7], s21 offen sc1 lds
    v_mfma_f32_16x16x32_bf16 v[72:75], a[188:191], v[140:143], v[72:75]
    s_add_u32 s38, s37, 7168
    buffer_store_dwordx4 v[140:143], v2, s[8:11], s38 offen sc1
    v_mfma_f32_16x16x32_bf16 v[76:79], a[188:191], v[172:175], v[76:79]
    s_add_u32 s38, s37, 15360
    buffer_store_dwordx4 v[172:175], v2, s[8:11], s38 offen sc1
AT_S0B:
    s_add_u32 s21, s21, s22
    s_add_u32 s24, s24, 0x8000
    s_cmp_ge_u32 s24, 0x28000
    s_cselect_b32 s24, s49, s24
    s_waitcnt vmcnt(32)
    s_barrier
    ds_read_b128 a[128:131], v14 offset:16384
    ds_read_b128 a[132:135], v14 offset:17408
    ds_read_b128 a[136:139], v14 offset:18432
    ds_read_b128 a[140:143], v14 offset:19456
    ds_read_b128 a[144:147], v14 offset:20480
    ds_read_b128 a[148:151], v14 offset:21504
    ds_read_b128 a[152:155], v14 offset:22528
    ds_read_b128 a[156:159], v14 offset:23552
    ds_read_b128 a[160:163], v14 offset:24576
    ds_read_b128 a[164:167], v14 offset:25600
    ds_read_b128 a[168:171], v14 offset:26624
    ds_read_b128 a[172:175], v14 offset:27648
    ds_read_b128 a[176:179], v14 offset:28672
    ds_read_b128 a[180:183], v14 offset:29696
    ds_read_b128 a[184:187], v14 offset:30720
    ds_read_b128 a[188:191], v14 offset:31744
    v_mfma_f32_32x32x16_bf16 a[0:15], v[44:47], v[44:47], 0
    v_mfma_f32_32x32x16_bf16 a[16:31], v[44:47], v[44:47], 0
    v_mfma_f32_32x32x16_bf16 a[32:47], v[44:47], v[44:47], 0
    v_mfma_f32_32x32x16_bf16 a[48:63], v[44:47], v[44:47], 0
    v_mfma_f32_32x32x16_bf16 a[64:79], v[44:47], v[44:47], 0
    v_mfma_f32_32x32x16_bf16 a[80:95], v[44:47], v[44:47], 0
    v_mfma_f32_32x32x16_bf16 a[96:111], v[44:47], v[44:47], 0
    v_mfma_f32_32x32x16_bf16 a[112:127], v[44:47], v[44:47], 0
    s_cmp_lt_u32 s33, s34
    s_cbranch_scc1 AT_S0_NOMASK
    v_cmp_gt_i32 s[40:41], 0, v37
    v_cmp_gt_i32 s[42:43], 1, v37
    v_cmp_gt_i32 s[44:45], 2, v37
    v_cmp_gt_i32 s[46:47], 3, v37
    v_cndmask_b32 v64, v64, v15, s[40:41]
    v_cndmask_b32 v65, v65, v15, s[42:43]
    v_cndmask_b32 v66, v66, v15, s[44:45]
    v_cndmask_b32 v67, v67, v15, s[46:47]
    v_cmp_gt_i32 s[40:41], -16, v37
    v_cmp_gt_i32 s[42:43], -15, v37
    v_cmp_gt_i32 s[44:45], -14, v37
    v_cmp_gt_i32 s[46:47], -13, v37
    v_cndmask_b32 v68, v68, v15, s[40:41]
    v_cndmask_b32 v69, v69, v15, s[42:43]
    v_cndmask_b32 v70, v70, v15, s[44:45]
    v_cndmask_b32 v71, v71, v15, s[46:47]
    v_cmp_gt_i32 s[40:41], 16, v37
    v_cmp_gt_i32 s[42:43], 17, v37
    v_cmp_gt_i32 s[44:45], 18, v37
    v_cmp_gt_i32 s[46:47], 19, v37
    v_cndmask_b32 v72, v72, v15, s[40:41]
    v_cndmask_b32 v73, v73, v15, s[42:43]
    v_cndmask_b32 v74, v74, v15, s[44:45]
    v_cndmask_b32 v75, v75, v15, s[46:47]
    v_cmp_gt_i32 s[40:41], 0, v37
    v_cmp_gt_i32 s[42:43], 1, v37
    v_cmp_gt_i32 s[44:45], 2, v37
    v_cmp_gt_i32 s[46:47], 3, v37
    v_cndmask_b32 v76, v76, v15, s[40:41]
    v_cndmask_b32 v77, v77, v15, s[42:43]
    v_cndmask_b32 v78, v78, v15, s[44:45]
    v_cndmask_b32 v79, v79, v15, s[46:47]
    v_subrev_u32 v37, 32, v37
AT_S0_NOMASK:
    v_mov_b32 v43, 0
    v_max3_f32 v240, v64, v65, v66
    v_max3_f32 v240, v240, v67, v72
    v_max3_f32 v240, v240, v73, v74
    v_max_f32 v240, v240, v75
    v_mov_b32 v255, v240
    s_nop 1
    v_permlane16_swap_b32 v240, v255
    v_max_f32 v240, v240, v255
    v_mov_b32 v255, v240
    s_nop 1
    v_permlane32_swap_b32 v240, v255
    v_max_f32 v240, v240, v255
    v_sub_f32 v48, 0, v240
    v_sub_f32 v49, 0, v240
    v_sub_f32 v50, 0, v240
    v_sub_f32 v51, 0, v240
    v_pk_add_f32 v[64:65], v[64:65], v[48:49]
    v_pk_add_f32 v[66:67], v[66:67], v[48:49]
    v_pk_add_f32 v[72:73], v[72:73], v[48:49]
    v_pk_add_f32 v[74:75], v[74:75], v[48:49]
    v_mov_b32 v38, 0
    v_max3_f32 v242, v68, v69, v70
    v_max3_f32 v242, v242, v71, v76
    v_max3_f32 v242, v242, v77, v78
    v_max_f32 v242, v242, v79
    v_mov_b32 v255, v242
    s_nop 1
    v_permlane16_swap_b32 v242, v255
    v_max_f32 v242, v242, v255
    v_mov_b32 v255, v242
    s_nop 1
    v_permlane32_swap_b32 v242, v255
    v_max_f32 v242, v242, v255
    v_sub_f32 v52, 0, v242
    v_sub_f32 v53, 0, v242
    v_sub_f32 v54, 0, v242
    v_sub_f32 v55, 0, v242
    v_pk_add_f32 v[68:69], v[68:69], v[52:53]
    v_pk_add_f32 v[70:71], v[70:71], v[52:53]
    v_pk_add_f32 v[76:77], v[76:77], v[52:53]
    v_pk_add_f32 v[78:79], v[78:79], v[52:53]
    v_mov_b32 v39, 0
    v_exp_f32 v80, v64
    v_exp_f32 v81, v65
    v_exp_f32 v82, v66
    v_exp_f32 v83, v67
    v_exp_f32 v84, v68
    v_exp_f32 v85, v69
    v_exp_f32 v86, v70
    v_exp_f32 v87, v71
    v_exp_f32 v88, v72
    v_exp_f32 v89, v73
    v_exp_f32 v90, v74
    v_exp_f32 v91, v75
    v_exp_f32 v92, v76
    v_exp_f32 v93, v77
    v_exp_f32 v94, v78
    v_exp_f32 v95, v79
    v_add_f32 v40, v80, v81
    v_add_f32 v40, v40, v82
    v_add_f32 v40, v40, v83
    v_add_f32 v41, v84, v85
    v_add_f32 v41, v41, v86
    v_add_f32 v41, v41, v87
    v_add_f32 v40, v40, v88
    v_add_f32 v40, v40, v89
    v_add_f32 v40, v40, v90
    v_add_f32 v40, v40, v91
    v_add_f32 v41, v41, v92
    v_add_f32 v41, v41, v93
    v_add_f32 v41, v41, v94
    v_add_f32 v41, v41, v95
AT_SMDONE:
    s_add_u32 s33, s33, 1
    s_sub_u32 s32, s32, 1
    s_waitcnt lgkmcnt(0)
.p2align 6
AT_LOOP:
    v_mfma_f32_16x16x32_bf16 v[64:67], a[128:131], v[112:115], v[48:51]
    s_sub_u32 s38, s32, s17
    ds_read_b128 a[192:195], v14 offset:0
    v_cvt_pk_bf16_f32 v56, v80, v81
    v_mfma_f32_16x16x32_bf16 v[68:71], a[128:131], v[144:147], v[52:55]
    s_add_u32 m0, s24, 0
    ds_read_b128 a[196:199], v14 offset:1024
    v_cvt_pk_bf16_f32 v57, v82, v83
    v_mfma_f32_16x16x32_bf16 v[64:67], a[132:135], v[116:119], v[64:67]
    s_sub_u32 s38, s38, 1
    buffer_load_dwordx4 v6, s[4:7], s21 offen sc1 lds
    v_mfma_f32_16x16x32_bf16 v[68:71], a[132:135], v[148:151], v[68:71]
    s_min_u32 s38, s38, 1
    ds_read_b128 a[200:203], v14 offset:2048
    v_cvt_pk_bf16_f32 v60, v84, v85
    v_mfma_f32_16x16x32_bf16 v[64:67], a[136:139], v[120:123], v[64:67]
    s_lshl_b32 s38, s38, 14
    ds_read_b128 a[204:207], v14 offset:3072
    v_cvt_pk_bf16_f32 v61, v86, v87
    v_mfma_f32_16x16x32_bf16 v[68:71], a[136:139], v[152:155], v[68:71]
    s_add_u32 m0, s24, 4096
    ds_read_b128 a[208:211], v14 offset:4096
    v_cvt_pk_bf16_f32 v58, v88, v89
    v_mfma_f32_16x16x32_bf16 v[64:67], a[140:143], v[124:127], v[64:67]
    buffer_load_dwordx4 v7, s[4:7], s21 offen sc1 lds
    v_mfma_f32_16x16x32_bf16 v[68:71], a[140:143], v[156:159], v[68:71]
    ds_read_b128 a[212:215], v14 offset:5120
    v_cvt_pk_bf16_f32 v59, v90, v91
    v_mfma_f32_16x16x32_bf16 v[64:67], a[144:147], v[128:131], v[64:67]
    ds_read_b128 a[216:219], v14 offset:6144
    v_cvt_pk_bf16_f32 v62, v92, v93
    v_mfma_f32_16x16x32_bf16 v[68:71], a[144:147], v[160:163], v[68:71]
    s_add_u32 m0, s24, 8192
    ds_read_b128 a[220:223], v14 offset:7168
    v_cvt_pk_bf16_f32 v63, v94, v95
    v_mfma_f32_16x16x32_bf16 v[64:67], a[148:151], v[132:135], v[64:67]
    buffer_load_dwordx4 v8, s[4:7], s21 offen sc1 lds
    v_mfma_f32_16x16x32_bf16 v[68:71], a[148:151], v[164:167], v[68:71]
    ds_read_b128 a[224:227], v14 offset:8192
    v_add_f32 v38, v38, v40
    v_mfma_f32_16x16x32_bf16 v[64:67], a[152:155], v[136:139], v[64:67]
    ds_read_b128 a[228:231], v14 offset:9216
    v_add_f32 v39, v39, v41
    v_mfma_f32_16x16x32_bf16 v[68:71], a[152:155], v[168:171], v[68:71]
    s_add_u32 m0, s24, 12288
    ds_read_b128 a[232:235], v14 offset:10240
    v_mfma_f32_16x16x32_bf16 v[64:67], a[156:159], v[140:143], v[64:67]
    buffer_load_dwordx4 v9, s[4:7], s21 offen sc1 lds
    v_mfma_f32_16x16x32_bf16 v[68:71], a[156:159], v[172:175], v[68:71]
    ds_read_b128 a[236:239], v14 offset:11264
    v_mfma_f32_16x16x32_bf16 v[72:75], a[160:163], v[112:115], v[48:51]
    ds_read_b128 a[240:243], v14 offset:12288
    v_mfma_f32_16x16x32_bf16 v[76:79], a[160:163], v[144:147], v[52:55]
    s_add_u32 m0, s24, 16384
    ds_read_b128 a[244:247], v14 offset:13312
    v_mfma_f32_16x16x32_bf16 v[72:75], a[164:167], v[116:119], v[72:75]
    buffer_load_dwordx4 v10, s[4:7], s21 offen sc1 lds
    v_mfma_f32_16x16x32_bf16 v[76:79], a[164:167], v[148:151], v[76:79]
    s_cmp_ge_u32 s33, s34
    ds_read_b128 a[248:251], v14 offset:14336
    v_mfma_f32_16x16x32_bf16 v[72:75], a[168:171], v[120:123], v[72:75]
    s_cbranch_scc1 AT_MASK0
AT_MASK0_RET:
    ds_read_b128 a[252:255], v14 offset:15360
    v_mfma_f32_16x16x32_bf16 v[76:79], a[168:171], v[152:155], v[76:79]
    s_add_u32 m0, s24, 20480
    v_exp_f32 v80, v64
    v_mfma_f32_16x16x32_bf16 v[72:75], a[172:175], v[124:127], v[72:75]
    buffer_load_dwordx4 v11, s[4:7], s21 offen sc1 lds
    v_mfma_f32_16x16x32_bf16 v[76:79], a[172:175], v[156:159], v[76:79]
    s_add_u32 s25, s25, 0x8000
    v_exp_f32 v81, v65
    v_mfma_f32_16x16x32_bf16 v[72:75], a[176:179], v[128:131], v[72:75]
    v_exp_f32 v82, v66
    v_mfma_f32_16x16x32_bf16 v[76:79], a[176:179], v[160:163], v[76:79]
    s_add_u32 m0, s24, 24576
    v_exp_f32 v83, v67
    v_mfma_f32_16x16x32_bf16 v[72:75], a[180:183], v[132:135], v[72:75]
    buffer_load_dwordx4 v12, s[4:7], s21 offen sc1 lds
    v_mfma_f32_16x16x32_bf16 v[76:79], a[180:183], v[164:167], v[76:79]
    s_cmp_ge_u32 s25, 0x28000
    v_exp_f32 v84, v68
    v_mfma_f32_16x16x32_bf16 v[72:75], a[184:187], v[136:139], v[72:75]
    s_cselect_b32 s25, 0, s25
    v_exp_f32 v85, v69
    v_mfma_f32_16x16x32_bf16 v[76:79], a[184:187], v[168:171], v[76:79]
    s_add_u32 m0, s24, 28672
    v_exp_f32 v86, v70
    v_mfma_f32_16x16x32_bf16 v[72:75], a[188:191], v[140:143], v[72:75]
    s_add_u32 s38, s38, s25
    buffer_load_dwordx4 v13, s[4:7], s21 offen sc1 lds
    v_mfma_f32_16x16x32_bf16 v[76:79], a[188:191], v[172:175], v[76:79]
    s_waitcnt vmcnt(16) lgkmcnt(0)
    v_exp_f32 v87, v71
    v_mfma_f32_16x16x32_bf16 a[0:3], a[192:195], v[56:59], a[0:3]
    s_barrier
    v_add_u32 v35, s38, v2
    v_add_f32 v40, v80, v81
    v_mfma_f32_16x16x32_bf16 a[4:7], a[192:195], v[60:63], a[4:7]
    ds_read_b128 a[128:131], v35 offset:0
    v_add_f32 v40, v40, v82
    v_mfma_f32_16x16x32_bf16 a[8:11], a[196:199], v[56:59], a[8:11]
    s_cmp_ge_u32 s33, s34
    ds_read_b128 a[132:135], v35 offset:1024
    v_add_f32 v40, v40, v83
    v_mfma_f32_16x16x32_bf16 a[12:15], a[196:199], v[60:63], a[12:15]
    s_cbranch_scc1 AT_MASK1
AT_MASK1_RET:
    ds_read_b128 a[136:139], v35 offset:2048
    v_add_f32 v41, v84, v85
    v_mfma_f32_16x16x32_bf16 a[16:19], a[200:203], v[56:59], a[16:19]
    s_add_u32 s21, s21, s22
    v_exp_f32 v88, v72
    v_mfma_f32_16x16x32_bf16 a[20:23], a[200:203], v[60:63], a[20:23]
    s_add_u32 s24, s24, 0x8000
    ds_read_b128 a[140:143], v35 offset:3072
    v_add_f32 v41, v41, v86
    v_mfma_f32_16x16x32_bf16 a[24:27], a[204:207], v[56:59], a[24:27]
    s_cmp_ge_u32 s24, 0x28000
    v_exp_f32 v89, v73
    v_mfma_f32_16x16x32_bf16 a[28:31], a[204:207], v[60:63], a[28:31]
    s_cselect_b32 s24, s49, s24
    ds_read_b128 a[144:147], v35 offset:4096
    v_add_f32 v41, v41, v87
    v_mfma_f32_16x16x32_bf16 a[32:35], a[208:211], v[56:59], a[32:35]
    v_exp_f32 v90, v74
    v_mfma_f32_16x16x32_bf16 a[36:39], a[208:211], v[60:63], a[36:39]
    s_sub_u32 s37, s32, 2
    ds_read_b128 a[148:151], v35 offset:5120
    v_add_f32 v40, v40, v88
    v_mfma_f32_16x16x32_bf16 a[40:43], a[212:215], v[56:59], a[40:43]
    s_cmp_lt_u32 s37, 3
    v_exp_f32 v91, v75
    v_mfma_f32_16x16x32_bf16 a[44:47], a[212:215], v[60:63], a[44:47]
    s_cbranch_scc1 AT_SWITCH
AT_SWITCH_RET:
    ds_read_b128 a[152:155], v35 offset:6144
    v_add_f32 v40, v40, v89
    v_mfma_f32_16x16x32_bf16 a[48:51], a[216:219], v[56:59], a[48:51]
    v_exp_f32 v92, v76
    v_mfma_f32_16x16x32_bf16 a[52:55], a[216:219], v[60:63], a[52:55]
    s_sub_u32 s37, s33, s16
    ds_read_b128 a[156:159], v35 offset:7168
    v_add_f32 v40, v40, v90
    v_mfma_f32_16x16x32_bf16 a[56:59], a[220:223], v[56:59], a[56:59]
    s_cmp_lt_u32 s37, 2
    v_exp_f32 v93, v77
    v_mfma_f32_16x16x32_bf16 a[60:63], a[220:223], v[60:63], a[60:63]
    s_cbranch_scc1 AT_KVCHK
AT_KVCHK_RET:
    ds_read_b128 a[160:163], v35 offset:8192
    v_add_f32 v40, v40, v91
    v_mfma_f32_16x16x32_bf16 a[64:67], a[224:227], v[56:59], a[64:67]
    v_exp_f32 v94, v78
    v_mfma_f32_16x16x32_bf16 a[68:71], a[224:227], v[60:63], a[68:71]
    ds_read_b128 a[164:167], v35 offset:9216
    v_add_f32 v41, v41, v92
    v_mfma_f32_16x16x32_bf16 a[72:75], a[228:231], v[56:59], a[72:75]
    v_exp_f32 v95, v79
    v_mfma_f32_16x16x32_bf16 a[76:79], a[228:231], v[60:63], a[76:79]
    ds_read_b128 a[168:171], v35 offset:10240
    v_add_f32 v41, v41, v93
    v_mfma_f32_16x16x32_bf16 a[80:83], a[232:235], v[56:59], a[80:83]
    ds_read_b128 a[172:175], v35 offset:11264
    v_add_f32 v41, v41, v94
    v_mfma_f32_16x16x32_bf16 a[84:87], a[232:235], v[60:63], a[84:87]
    ds_read_b128 a[176:179], v35 offset:12288
    v_add_f32 v41, v41, v95
    v_mfma_f32_16x16x32_bf16 a[88:91], a[236:239], v[56:59], a[88:91]
    ds_read_b128 a[180:183], v35 offset:13312
    v_max_f32 v42, v40, v41
    v_mfma_f32_16x16x32_bf16 a[92:95], a[236:239], v[60:63], a[92:95]
    ds_read_b128 a[184:187], v35 offset:14336
    v_cmp_lt_f32 vcc, s48, v42
    v_mfma_f32_16x16x32_bf16 a[96:99], a[240:243], v[56:59], a[96:99]
    ds_read_b128 a[188:191], v35 offset:15360
    v_mfma_f32_16x16x32_bf16 a[100:103], a[240:243], v[60:63], a[100:103]
    v_add_u32 v14, s25, v2
    v_mfma_f32_16x16x32_bf16 a[104:107], a[244:247], v[56:59], a[104:107]
    s_add_u32 s33, s33, 1
    v_mfma_f32_16x16x32_bf16 a[108:111], a[244:247], v[60:63], a[108:111]
    s_sub_u32 s32, s32, 1
    v_mfma_f32_16x16x32_bf16 a[112:115], a[248:251], v[56:59], a[112:115]
    v_mfma_f32_16x16x32_bf16 a[116:119], a[248:251], v[60:63], a[116:119]
    s_waitcnt lgkmcnt(0)
    v_mfma_f32_16x16x32_bf16 a[120:123], a[252:255], v[56:59], a[120:123]
    v_mfma_f32_16x16x32_bf16 a[124:127], a[252:255], v[60:63], a[124:127]
    s_cbranch_vccnz AT_RARE
AT_RARE_RET:
    s_cmp_lt_u32 s33, 4
    s_cbranch_scc1 AT_SLOW
    s_cmp_gt_u32 s32, 4
    s_cbranch_scc1 AT_FAST
AT_SLOW:
    s_cmp_lg_u32 s32, s17
    s_cbranch_scc1 AT_LOOP
    v_cvt_pk_bf16_f32 v56, v80, v81
    v_cvt_pk_bf16_f32 v57, v82, v83
    v_cvt_pk_bf16_f32 v60, v84, v85
    v_cvt_pk_bf16_f32 v61, v86, v87
    v_cvt_pk_bf16_f32 v58, v88, v89
    v_cvt_pk_bf16_f32 v59, v90, v91
    v_cvt_pk_bf16_f32 v62, v92, v93
    v_cvt_pk_bf16_f32 v63, v94, v95
    v_add_f32 v38, v38, v40
    v_add_f32 v39, v39, v41
    s_add_u32 s25, s25, 0x8000
    s_cmp_ge_u32 s25, 0x28000
    s_cselect_b32 s25, 0, s25
    s_cmp_lg_u32 s32, 0
    s_cbranch_scc1 AT_EARLY
    s_waitcnt vmcnt(8)
    s_barrier
    s_cmp_eq_u32 s29, 3
    s_cbranch_scc1 AT_LAST_Q
    v_add_u32 v28, s25, v24
    v_add_u32 v29, s25, v25
    v_add_u32 v30, s25, v26
    v_add_u32 v31, s25, v27
    v_mfma_f32_16x16x32_bf16 a[0:3], a[128:131], v[56:59], a[0:3]
    v_lshrrev_b32 v240, 3, v0
    v_mfma_f32_16x16x32_bf16 a[4:7], a[128:131], v[60:63], a[4:7]
    s_add_u32 m0, s24, 0
    ds_read_b64_tr_b16 a[128:129], v28 offset:0
    v_mfma_f32_16x16x32_bf16 a[8:11], a[132:135], v[56:59], a[8:11]
    s_and_b32 s3, s19, 1
    buffer_load_dwordx4 v6, s[4:7], s21 offen sc1 lds
    v_mfma_f32_16x16x32_bf16 a[12:15], a[132:135], v[60:63], a[12:15]
    ds_read_b64_tr_b16 a[130:131], v28 offset:2048
    ds_read_b64_tr_b16 a[132:133], v28 offset:4096
    v_mfma_f32_16x16x32_bf16 a[16:19], a[136:139], v[56:59], a[16:19]
    ds_read_b64_tr_b16 a[134:135], v28 offset:6144
    v_bfe_u32 v241, v240, 1, 2
    v_mfma_f32_16x16x32_bf16 a[20:23], a[136:139], v[60:63], a[20:23]
    s_add_u32 m0, s24, 4096
    ds_read_b64_tr_b16 a[136:137], v28 offset:8192
    v_lshlrev_b32 v241, 1, v241
    v_mfma_f32_16x16x32_bf16 a[24:27], a[140:143], v[56:59], a[24:27]
    buffer_load_dwordx4 v7, s[4:7], s21 offen sc1 lds
    v_mfma_f32_16x16x32_bf16 a[28:31], a[140:143], v[60:63], a[28:31]
    ds_read_b64_tr_b16 a[138:139], v28 offset:10240
    ds_read_b64_tr_b16 a[140:141], v28 offset:12288
    v_mfma_f32_16x16x32_bf16 a[32:35], a[144:147], v[56:59], a[32:35]
    ds_read_b64_tr_b16 a[142:143], v28 offset:14336
    v_and_b32 v242, 7, v1
    v_mfma_f32_16x16x32_bf16 a[36:39], a[144:147], v[60:63], a[36:39]
    s_add_u32 m0, s24, 8192
    ds_read_b64_tr_b16 a[144:145], v28 offset:16384
    v_xor_b32 v241, v241, v242
    v_mfma_f32_16x16x32_bf16 a[40:43], a[148:151], v[56:59], a[40:43]
    buffer_load_dwordx4 v8, s[4:7], s21 offen sc1 lds
    v_mfma_f32_16x16x32_bf16 a[44:47], a[148:151], v[60:63], a[44:47]
    ds_read_b64_tr_b16 a[146:147], v28 offset:18432
    ds_read_b64_tr_b16 a[148:149], v28 offset:20480
    v_mfma_f32_16x16x32_bf16 a[48:51], a[152:155], v[56:59], a[48:51]
    ds_read_b64_tr_b16 a[150:151], v28 offset:22528
    v_mul_u32_u24 v240, 896, v240
    v_mfma_f32_16x16x32_bf16 a[52:55], a[152:155], v[60:63], a[52:55]
    s_add_u32 m0, s24, 12288
    ds_read_b64_tr_b16 a[152:153], v28 offset:24576
    v_and_b32 v242, 3, v241
    v_mfma_f32_16x16x32_bf16 a[56:59], a[156:159], v[56:59], a[56:59]
    buffer_load_dwordx4 v9, s[4:7], s21 offen sc1 lds
    v_mfma_f32_16x16x32_bf16 a[60:63], a[156:159], v[60:63], a[60:63]
    ds_read_b64_tr_b16 a[154:155], v28 offset:26624
    ds_read_b64_tr_b16 a[156:157], v28 offset:28672
    v_mfma_f32_16x16x32_bf16 a[64:67], a[160:163], v[56:59], a[64:67]
    ds_read_b64_tr_b16 a[158:159], v28 offset:30720
    v_lshl_add_u32 v240, v242, 4, v240
    v_mfma_f32_16x16x32_bf16 a[68:71], a[160:163], v[60:63], a[68:71]
    s_add_u32 m0, s24, 16384
    ds_read_b64_tr_b16 a[160:161], v29 offset:0
    v_lshrrev_b32 v241, 2, v241
    v_mfma_f32_16x16x32_bf16 a[72:75], a[164:167], v[56:59], a[72:75]
    buffer_load_dwordx4 v10, s[4:7], s21 offen sc1 lds
    v_mfma_f32_16x16x32_bf16 a[76:79], a[164:167], v[60:63], a[76:79]
    ds_read_b64_tr_b16 a[162:163], v29 offset:2048
    ds_read_b64_tr_b16 a[164:165], v29 offset:4096
    v_mfma_f32_16x16x32_bf16 a[80:83], a[168:171], v[56:59], a[80:83]
    ds_read_b64_tr_b16 a[166:167], v29 offset:6144
    v_xor_b32 v241, s3, v241
    v_mfma_f32_16x16x32_bf16 a[84:87], a[168:171], v[60:63], a[84:87]
    s_add_u32 m0, s24, 20480
    ds_read_b64_tr_b16 a[168:169], v29 offset:8192
    v_mfma_f32_16x16x32_bf16 a[88:91], a[172:175], v[56:59], a[88:91]
    s_lshl_b32 s3, s3, 6
    buffer_load_dwordx4 v11, s[4:7], s21 offen sc1 lds
    v_mfma_f32_16x16x32_bf16 a[92:95], a[172:175], v[60:63], a[92:95]
    ds_read_b64_tr_b16 a[170:171], v29 offset:10240
    ds_read_b64_tr_b16 a[172:173], v29 offset:12288
    v_mfma_f32_16x16x32_bf16 a[96:99], a[176:179], v[56:59], a[96:99]
    ds_read_b64_tr_b16 a[174:175], v29 offset:14336
    v_mul_u32_u24 v241, 229376, v241
    v_mfma_f32_16x16x32_bf16 a[100:103], a[176:179], v[60:63], a[100:103]
    s_add_u32 m0, s24, 24576
    ds_read_b64_tr_b16 a[176:177], v29 offset:16384
    v_mfma_f32_16x16x32_bf16 a[104:107], a[180:183], v[56:59], a[104:107]
    buffer_load_dwordx4 v12, s[4:7], s21 offen sc1 lds
    v_mfma_f32_16x16x32_bf16 a[108:111], a[180:183], v[60:63], a[108:111]
    ds_read_b64_tr_b16 a[178:179], v29 offset:18432
    ds_read_b64_tr_b16 a[180:181], v29 offset:20480
    v_mfma_f32_16x16x32_bf16 a[112:115], a[184:187], v[56:59], a[112:115]
    ds_read_b64_tr_b16 a[182:183], v29 offset:22528
    v_mfma_f32_16x16x32_bf16 a[116:119], a[184:187], v[60:63], a[116:119]
    s_add_u32 m0, s24, 28672
    ds_read_b64_tr_b16 a[184:185], v29 offset:24576
    v_mfma_f32_16x16x32_bf16 a[120:123], a[188:191], v[56:59], a[120:123]
    buffer_load_dwordx4 v13, s[4:7], s21 offen sc1 lds
    v_mfma_f32_16x16x32_bf16 a[124:127], a[188:191], v[60:63], a[124:127]
    ds_read_b64_tr_b16 a[186:187], v29 offset:26624
    ds_read_b64_tr_b16 a[188:189], v29 offset:28672
    ds_read_b64_tr_b16 a[190:191], v29 offset:30720
    s_add_u32 s21, s21, s22
    s_add_u32 s24, s24, 0x8000
    s_cmp_ge_u32 s24, 0x28000
    s_cselect_b32 s24, s49, s24
    s_and_b32 s21, s19, 14
    v_add_u32 v6, v240, v241
    s_mul_i32 s21, s21, 229376
    v_add_u32 v7, 0x7000, v6
    s_add_u32 s21, s21, s3
    v_add_u32 v8, 0xe000, v6
    s_add_u32 s21, s21, 384
    v_add_u32 v9, 0x15000, v6
    v_add_u32 v10, 0x1c000, v6
    v_add_u32 v11, 0x23000, v6
    v_add_u32 v12, 0x2a000, v6
    v_add_u32 v13, 0x31000, v6
    s_branch AT_LAST_DONE
AT_LAST_Q:
    v_add_u32 v14, s25, v2
    v_mfma_f32_16x16x32_bf16 a[0:3], a[128:131], v[56:59], a[0:3]
    v_mfma_f32_16x16x32_bf16 a[4:7], a[128:131], v[60:63], a[4:7]
    s_add_u32 m0, s24, 0
    ds_read_b128 a[128:131], v14 offset:16384
    v_mfma_f32_16x16x32_bf16 a[8:11], a[132:135], v[56:59], a[8:11]
    buffer_load_dwordx4 v6, s[4:7], s21 offen sc1 lds
    v_mfma_f32_16x16x32_bf16 a[12:15], a[132:135], v[60:63], a[12:15]
    ds_read_b128 a[132:135], v14 offset:17408
    v_mfma_f32_16x16x32_bf16 a[16:19], a[136:139], v[56:59], a[16:19]
    v_mfma_f32_16x16x32_bf16 a[20:23], a[136:139], v[60:63], a[20:23]
    s_add_u32 m0, s24, 4096
    ds_read_b128 a[136:139], v14 offset:18432
    v_mfma_f32_16x16x32_bf16 a[24:27], a[140:143], v[56:59], a[24:27]
    buffer_load_dwordx4 v7, s[4:7], s21 offen sc1 lds
    v_mfma_f32_16x16x32_bf16 a[28:31], a[140:143], v[60:63], a[28:31]
    ds_read_b128 a[140:143], v14 offset:19456
    v_mfma_f32_16x16x32_bf16 a[32:35], a[144:147], v[56:59], a[32:35]
    v_mfma_f32_16x16x32_bf16 a[36:39], a[144:147], v[60:63], a[36:39]
    s_add_u32 m0, s24, 8192
    ds_read_b128 a[144:147], v14 offset:20480
    v_mfma_f32_16x16x32_bf16 a[40:43], a[148:151], v[56:59], a[40:43]
    buffer_load_dwordx4 v8, s[4:7], s21 offen sc1 lds
    v_mfma_f32_16x16x32_bf16 a[44:47], a[148:151], v[60:63], a[44:47]
    ds_read_b128 a[148:151], v14 offset:21504
    v_mfma_f32_16x16x32_bf16 a[48:51], a[152:155], v[56:59], a[48:51]
    v_mfma_f32_16x16x32_bf16 a[52:55], a[152:155], v[60:63], a[52:55]
    s_add_u32 m0, s24, 12288
    ds_read_b128 a[152:155], v14 offset:22528
    v_mfma_f32_16x16x32_bf16 a[56:59], a[156:159], v[56:59], a[56:59]
    buffer_load_dwordx4 v9, s[4:7], s21 offen sc1 lds
    v_mfma_f32_16x16x32_bf16 a[60:63], a[156:159], v[60:63], a[60:63]
    ds_read_b128 a[156:159], v14 offset:23552
    v_mfma_f32_16x16x32_bf16 a[64:67], a[160:163], v[56:59], a[64:67]
    v_mfma_f32_16x16x32_bf16 a[68:71], a[160:163], v[60:63], a[68:71]
    s_add_u32 m0, s24, 16384
    ds_read_b128 a[160:163], v14 offset:24576
    v_mfma_f32_16x16x32_bf16 a[72:75], a[164:167], v[56:59], a[72:75]
    buffer_load_dwordx4 v10, s[4:7], s21 offen sc1 lds
    v_mfma_f32_16x16x32_bf16 a[76:79], a[164:167], v[60:63], a[76:79]
    ds_read_b128 a[164:167], v14 offset:25600
    v_mfma_f32_16x16x32_bf16 a[80:83], a[168:171], v[56:59], a[80:83]
    v_mfma_f32_16x16x32_bf16 a[84:87], a[168:171], v[60:63], a[84:87]
    s_add_u32 m0, s24, 20480
    ds_read_b128 a[168:171], v14 offset:26624
    v_mfma_f32_16x16x32_bf16 a[88:91], a[172:175], v[56:59], a[88:91]
    buffer_load_dwordx4 v11, s[4:7], s21 offen sc1 lds
    v_mfma_f32_16x16x32_bf16 a[92:95], a[172:175], v[60:63], a[92:95]
    ds_read_b128 a[172:175], v14 offset:27648
    v_mfma_f32_16x16x32_bf16 a[96:99], a[176:179], v[56:59], a[96:99]
    v_mfma_f32_16x16x32_bf16 a[100:103], a[176:179], v[60:63], a[100:103]
    s_add_u32 m0, s24, 24576
    ds_read_b128 a[176:179], v14 offset:28672
    v_mfma_f32_16x16x32_bf16 a[104:107], a[180:183], v[56:59], a[104:107]
    buffer_load_dwordx4 v12, s[4:7], s21 offen sc1 lds
    v_mfma_f32_16x16x32_bf16 a[108:111], a[180:183], v[60:63], a[108:111]
    ds_read_b128 a[180:183], v14 offset:29696
    v_mfma_f32_16x16x32_bf16 a[112:115], a[184:187], v[56:59], a[112:115]
    v_mfma_f32_16x16x32_bf16 a[116:119], a[184:187], v[60:63], a[116:119]
    s_add_u32 m0, s24, 28672
    ds_read_b128 a[184:187], v14 offset:30720
    v_mfma_f32_16x16x32_bf16 a[120:123], a[188:191], v[56:59], a[120:123]
    buffer_load_dwordx4 v13, s[4:7], s21 offen sc1 lds
    v_mfma_f32_16x16x32_bf16 a[124:127], a[188:191], v[60:63], a[124:127]
    ds_read_b128 a[188:191], v14 offset:31744
    s_add_u32 s21, s21, s22
    s_add_u32 s24, s24, 0x8000
    s_cmp_ge_u32 s24, 0x28000
    s_cselect_b32 s24, s49, s24
AT_LAST_DONE:
    v_mov_b32 v255, v38
    s_nop 1
    v_permlane16_swap_b32 v38, v255
    v_add_f32 v38, v38, v255
    v_mov_b32 v255, v38
    s_nop 1
    v_permlane32_swap_b32 v38, v255
    v_add_f32 v38, v38, v255
    v_mov_b32 v255, v39
    s_nop 1
    v_permlane16_swap_b32 v39, v255
    v_add_f32 v39, v39, v255
    v_mov_b32 v255, v39
    s_nop 1
    v_permlane32_swap_b32 v39, v255
    v_add_f32 v39, v39, v255
    s_mul_i32 s37, s36, 0x12000
    s_mul_i32 s38, s18, 17408
    s_add_u32 s37, s37, s38
    s_add_u32 s37, s37, 0x8000000
    s_lshl_b32 s39, s2, 2
    s_add_u32 s39, s39, s18
    s_lshl_b32 s39, s39, 14
    s_add_u32 s39, s39, 0x9000000
    s_cmp_eq_u32 s29, 2
    s_cselect_b32 s37, s37, s39
    s_waitcnt vmcnt(8)
    s_cmp_eq_u32 s29, 1
    s_cbranch_scc1 AT_MERGE
    v_rcp_f32 v40, v38
    v_rcp_f32 v41, v39
    v_accvgpr_read_b32 v240, a0
    v_accvgpr_read_b32 v241, a1
    v_accvgpr_read_b32 v242, a2
    v_accvgpr_read_b32 v243, a3
    v_accvgpr_read_b32 v244, a8
    v_accvgpr_read_b32 v245, a9
    v_accvgpr_read_b32 v246, a10
    v_accvgpr_read_b32 v247, a11
    v_pk_mul_f32 v[240:241], v[240:241], v[40:41] op_sel:[0,0] op_sel_hi:[1,0]
    v_pk_mul_f32 v[242:243], v[242:243], v[40:41] op_sel:[0,0] op_sel_hi:[1,0]
    v_pk_mul_f32 v[244:245], v[244:245], v[40:41] op_sel:[0,0] op_sel_hi:[1,0]
    v_pk_mul_f32 v[246:247], v[246:247], v[40:41] op_sel:[0,0] op_sel_hi:[1,0]
    v_cvt_pk_bf16_f32 v112, v240, v241
    v_cvt_pk_bf16_f32 v113, v242, v243
    v_cvt_pk_bf16_f32 v114, v244, v245
    v_cvt_pk_bf16_f32 v115, v246, v247
    s_add_u32 s38, s37, 0
    buffer_store_dwordx4 v[112:115], v2, s[8:11], s38 offen sc1
    v_accvgpr_read_b32 v248, a4
    v_accvgpr_read_b32 v249, a5
    v_accvgpr_read_b32 v250, a6
    v_accvgpr_read_b32 v251, a7
    v_accvgpr_read_b32 v252, a12
    v_accvgpr_read_b32 v253, a13
    v_accvgpr_read_b32 v254, a14
    v_accvgpr_read_b32 v255, a15
    v_pk_mul_f32 v[248:249], v[248:249], v[40:41] op_sel:[0,1] op_sel_hi:[1,1]
    v_pk_mul_f32 v[250:251], v[250:251], v[40:41] op_sel:[0,1] op_sel_hi:[1,1]
    v_pk_mul_f32 v[252:253], v[252:253], v[40:41] op_sel:[0,1] op_sel_hi:[1,1]
    v_pk_mul_f32 v[254:255], v[254:255], v[40:41] op_sel:[0,1] op_sel_hi:[1,1]
    v_cvt_pk_bf16_f32 v144, v248, v249
    v_cvt_pk_bf16_f32 v145, v250, v251
    v_cvt_pk_bf16_f32 v146, v252, v253
    v_cvt_pk_bf16_f32 v147, v254, v255
    s_add_u32 s38, s37, 8192
    buffer_store_dwordx4 v[144:147], v2, s[8:11], s38 offen sc1
    v_accvgpr_read_b32 v240, a16
    v_accvgpr_read_b32 v241, a17
    v_accvgpr_read_b32 v242, a18
    v_accvgpr_read_b32 v243, a19
    v_accvgpr_read_b32 v244, a24
    v_accvgpr_read_b32 v245, a25
    v_accvgpr_read_b32 v246, a26
    v_accvgpr_read_b32 v247, a27
    v_pk_mul_f32 v[240:241], v[240:241], v[40:41] op_sel:[0,0] op_sel_hi:[1,0]
    v_pk_mul_f32 v[242:243], v[242:243], v[40:41] op_sel:[0,0] op_sel_hi:[1,0]
    v_pk_mul_f32 v[244:245], v[244:245], v[40:41] op_sel:[0,0] op_sel_hi:[1,0]
    v_pk_mul_f32 v[246:247], v[246:247], v[40:41] op_sel:[0,0] op_sel_hi:[1,0]
    v_cvt_pk_bf16_f32 v116, v240, v241
    v_cvt_pk_bf16_f32 v117, v242, v243
    v_cvt_pk_bf16_f32 v118, v244, v245
    v_cvt_pk_bf16_f32 v119, v246, v247
    s_add_u32 s38, s37, 1024
    buffer_store_dwordx4 v[116:119], v2, s[8:11], s38 offen sc1
    v_accvgpr_read_b32 v248, a20
    v_accvgpr_read_b32 v249, a21
    v_accvgpr_read_b32 v250, a22
    v_accvgpr_read_b32 v251, a23
    v_accvgpr_read_b32 v252, a28
    v_accvgpr_read_b32 v253, a29
    v_accvgpr_read_b32 v254, a30
    v_accvgpr_read_b32 v255, a31
    v_pk_mul_f32 v[248:249], v[248:249], v[40:41] op_sel:[0,1] op_sel_hi:[1,1]
    v_pk_mul_f32 v[250:251], v[250:251], v[40:41] op_sel:[0,1] op_sel_hi:[1,1]
    v_pk_mul_f32 v[252:253], v[252:253], v[40:41] op_sel:[0,1] op_sel_hi:[1,1]
    v_pk_mul_f32 v[254:255], v[254:255], v[40:41] op_sel:[0,1] op_sel_hi:[1,1]
    v_cvt_pk_bf16_f32 v148, v248, v249
    v_cvt_pk_bf16_f32 v149, v250, v251
    v_cvt_pk_bf16_f32 v150, v252, v253
    v_cvt_pk_bf16_f32 v151, v254, v255
    s_add_u32 s38, s37, 9216
    buffer_store_dwordx4 v[148:151], v2, s[8:11], s38 offen sc1
    v_accvgpr_read_b32 v240, a32
    v_accvgpr_read_b32 v241, a33
    v_accvgpr_read_b32 v242, a34
    v_accvgpr_read_b32 v243, a35
    v_accvgpr_read_b32 v244, a40
    v_accvgpr_read_b32 v245, a41
    v_accvgpr_read_b32 v246, a42
    v_accvgpr_read_b32 v247, a43
    v_pk_mul_f32 v[240:241], v[240:241], v[40:41] op_sel:[0,0] op_sel_hi:[1,0]
    v_pk_mul_f32 v[242:243], v[242:243], v[40:41] op_sel:[0,0] op_sel_hi:[1,0]
    v_pk_mul_f32 v[244:245], v[244:245], v[40:41] op_sel:[0,0] op_sel_hi:[1,0]
    v_pk_mul_f32 v[246:247], v[246:247], v[40:41] op_sel:[0,0] op_sel_hi:[1,0]
    v_cvt_pk_bf16_f32 v120, v240, v241
    v_cvt_pk_bf16_f32 v121, v242, v243
    v_cvt_pk_bf16_f32 v122, v244, v245
    v_cvt_pk_bf16_f32 v123, v246, v247
    s_add_u32 s38, s37, 2048
    buffer_store_dwordx4 v[120:123], v2, s[8:11], s38 offen sc1
    v_accvgpr_read_b32 v248, a36
    v_accvgpr_read_b32 v249, a37
    v_accvgpr_read_b32 v250, a38
    v_accvgpr_read_b32 v251, a39
    v_accvgpr_read_b32 v252, a44
    v_accvgpr_read_b32 v253, a45
    v_accvgpr_read_b32 v254, a46
    v_accvgpr_read_b32 v255, a47
    v_pk_mul_f32 v[248:249], v[248:249], v[40:41] op_sel:[0,1] op_sel_hi:[1,1]
    v_pk_mul_f32 v[250:251], v[250:251], v[40:41] op_sel:[0,1] op_sel_hi:[1,1]
    v_pk_mul_f32 v[252:253], v[252:253], v[40:41] op_sel:[0,1] op_sel_hi:[1,1]
    v_pk_mul_f32 v[254:255], v[254:255], v[40:41] op_sel:[0,1] op_sel_hi:[1,1]
    v_cvt_pk_bf16_f32 v152, v248, v249
    v_cvt_pk_bf16_f32 v153, v250, v251
    v_cvt_pk_bf16_f32 v154, v252, v253
    v_cvt_pk_bf16_f32 v155, v254, v255
    s_add_u32 s38, s37, 10240
    buffer_store_dwordx4 v[152:155], v2, s[8:11], s38 offen sc1
    v_accvgpr_read_b32 v240, a48
    v_accvgpr_read_b32 v241, a49
    v_accvgpr_read_b32 v242, a50
    v_accvgpr_read_b32 v243, a51
    v_accvgpr_read_b32 v244, a56
    v_accvgpr_read_b32 v245, a57
    v_accvgpr_read_b32 v246, a58
    v_accvgpr_read_b32 v247, a59
    v_pk_mul_f32 v[240:241], v[240:241], v[40:41] op_sel:[0,0] op_sel_hi:[1,0]
    v_pk_mul_f32 v[242:243], v[242:243], v[40:41] op_sel:[0,0] op_sel_hi:[1,0]
    v_pk_mul_f32 v[244:245], v[244:245], v[40:41] op_sel:[0,0] op_sel_hi:[1,0]
    v_pk_mul_f32 v[246:247], v[246:247], v[40:41] op_sel:[0,0] op_sel_hi:[1,0]
    v_cvt_pk_bf16_f32 v124, v240, v241
    v_cvt_pk_bf16_f32 v125, v242, v243
    v_cvt_pk_bf16_f32 v126, v244, v245
    v_cvt_pk_bf16_f32 v127, v246, v247
    s_add_u32 s38, s37, 3072
    buffer_store_dwordx4 v[124:127], v2, s[8:11], s38 offen sc1
    v_accvgpr_read_b32 v248, a52
    v_accvgpr_read_b32 v249, a53
    v_accvgpr_read_b32 v250, a54
    v_accvgpr_read_b32 v251, a55
    v_accvgpr_read_b32 v252, a60
    v_accvgpr_read_b32 v253, a61
    v_accvgpr_read_b32 v254, a62
    v_accvgpr_read_b32 v255, a63
    v_pk_mul_f32 v[248:249], v[248:249], v[40:41] op_sel:[0,1] op_sel_hi:[1,1]
    v_pk_mul_f32 v[250:251], v[250:251], v[40:41] op_sel:[0,1] op_sel_hi:[1,1]
    v_pk_mul_f32 v[252:253], v[252:253], v[40:41] op_sel:[0,1] op_sel_hi:[1,1]
    v_pk_mul_f32 v[254:255], v[254:255], v[40:41] op_sel:[0,1] op_sel_hi:[1,1]
    v_cvt_pk_bf16_f32 v156, v248, v249
    v_cvt_pk_bf16_f32 v157, v250, v251
    v_cvt_pk_bf16_f32 v158, v252, v253
    v_cvt_pk_bf16_f32 v159, v254, v255
    s_add_u32 s38, s37, 11264
    buffer_store_dwordx4 v[156:159], v2, s[8:11], s38 offen sc1
    v_accvgpr_read_b32 v240, a64
    v_accvgpr_read_b32 v241, a65
    v_accvgpr_read_b32 v242, a66
    v_accvgpr_read_b32 v243, a67
    v_accvgpr_read_b32 v244, a72
    v_accvgpr_read_b32 v245, a73
    v_accvgpr_read_b32 v246, a74
    v_accvgpr_read_b32 v247, a75
    v_pk_mul_f32 v[240:241], v[240:241], v[40:41] op_sel:[0,0] op_sel_hi:[1,0]
    v_pk_mul_f32 v[242:243], v[242:243], v[40:41] op_sel:[0,0] op_sel_hi:[1,0]
    v_pk_mul_f32 v[244:245], v[244:245], v[40:41] op_sel:[0,0] op_sel_hi:[1,0]
    v_pk_mul_f32 v[246:247], v[246:247], v[40:41] op_sel:[0,0] op_sel_hi:[1,0]
    v_cvt_pk_bf16_f32 v128, v240, v241
    v_cvt_pk_bf16_f32 v129, v242, v243
    v_cvt_pk_bf16_f32 v130, v244, v245
    v_cvt_pk_bf16_f32 v131, v246, v247
    s_add_u32 s38, s37, 4096
    buffer_store_dwordx4 v[128:131], v2, s[8:11], s38 offen sc1
    v_accvgpr_read_b32 v248, a68
    v_accvgpr_read_b32 v249, a69
    v_accvgpr_read_b32 v250, a70
    v_accvgpr_read_b32 v251, a71
    v_accvgpr_read_b32 v252, a76
    v_accvgpr_read_b32 v253, a77
    v_accvgpr_read_b32 v254, a78
    v_accvgpr_read_b32 v255, a79
    v_pk_mul_f32 v[248:249], v[248:249], v[40:41] op_sel:[0,1] op_sel_hi:[1,1]
    v_pk_mul_f32 v[250:251], v[250:251], v[40:41] op_sel:[0,1] op_sel_hi:[1,1]
    v_pk_mul_f32 v[252:253], v[252:253], v[40:41] op_sel:[0,1] op_sel_hi:[1,1]
    v_pk_mul_f32 v[254:255], v[254:255], v[40:41] op_sel:[0,1] op_sel_hi:[1,1]
    v_cvt_pk_bf16_f32 v160, v248, v249
    v_cvt_pk_bf16_f32 v161, v250, v251
    v_cvt_pk_bf16_f32 v162, v252, v253
    v_cvt_pk_bf16_f32 v163, v254, v255
    s_add_u32 s38, s37, 12288
    buffer_store_dwordx4 v[160:163], v2, s[8:11], s38 offen sc1
    v_accvgpr_read_b32 v240, a80
    v_accvgpr_read_b32 v241, a81
    v_accvgpr_read_b32 v242, a82
    v_accvgpr_read_b32 v243, a83
    v_accvgpr_read_b32 v244, a88
    v_accvgpr_read_b32 v245, a89
    v_accvgpr_read_b32 v246, a90
    v_accvgpr_read_b32 v247, a91
    v_pk_mul_f32 v[240:241], v[240:241], v[40:41] op_sel:[0,0] op_sel_hi:[1,0]
    v_pk_mul_f32 v[242:243], v[242:243], v[40:41] op_sel:[0,0] op_sel_hi:[1,0]
    v_pk_mul_f32 v[244:245], v[244:245], v[40:41] op_sel:[0,0] op_sel_hi:[1,0]
    v_pk_mul_f32 v[246:247], v[246:247], v[40:41] op_sel:[0,0] op_sel_hi:[1,0]
    v_cvt_pk_bf16_f32 v132, v240, v241
    v_cvt_pk_bf16_f32 v133, v242, v243
    v_cvt_pk_bf16_f32 v134, v244, v245
    v_cvt_pk_bf16_f32 v135, v246, v247
    s_add_u32 s38, s37, 5120
    buffer_store_dwordx4 v[132:135], v2, s[8:11], s38 offen sc1
    v_accvgpr_read_b32 v248, a84
    v_accvgpr_read_b32 v249, a85
    v_accvgpr_read_b32 v250, a86
    v_accvgpr_read_b32 v251, a87
    v_accvgpr_read_b32 v252, a92
    v_accvgpr_read_b32 v253, a93
    v_accvgpr_read_b32 v254, a94
    v_accvgpr_read_b32 v255, a95
    v_pk_mul_f32 v[248:249], v[248:249], v[40:41] op_sel:[0,1] op_sel_hi:[1,1]
    v_pk_mul_f32 v[250:251], v[250:251], v[40:41] op_sel:[0,1] op_sel_hi:[1,1]
    v_pk_mul_f32 v[252:253], v[252:253], v[40:41] op_sel:[0,1] op_sel_hi:[1,1]
    v_pk_mul_f32 v[254:255], v[254:255], v[40:41] op_sel:[0,1] op_sel_hi:[1,1]
    v_cvt_pk_bf16_f32 v164, v248, v249
    v_cvt_pk_bf16_f32 v165, v250, v251
    v_cvt_pk_bf16_f32 v166, v252, v253
    v_cvt_pk_bf16_f32 v167, v254, v255
    s_add_u32 s38, s37, 13312
    buffer_store_dwordx4 v[164:167], v2, s[8:11], s38 offen sc1
    v_accvgpr_read_b32 v240, a96
    v_accvgpr_read_b32 v241, a97
    v_accvgpr_read_b32 v242, a98
    v_accvgpr_read_b32 v243, a99
    v_accvgpr_read_b32 v244, a104
    v_accvgpr_read_b32 v245, a105
    v_accvgpr_read_b32 v246, a106
    v_accvgpr_read_b32 v247, a107
    v_pk_mul_f32 v[240:241], v[240:241], v[40:41] op_sel:[0,0] op_sel_hi:[1,0]
    v_pk_mul_f32 v[242:243], v[242:243], v[40:41] op_sel:[0,0] op_sel_hi:[1,0]
    v_pk_mul_f32 v[244:245], v[244:245], v[40:41] op_sel:[0,0] op_sel_hi:[1,0]
    v_pk_mul_f32 v[246:247], v[246:247], v[40:41] op_sel:[0,0] op_sel_hi:[1,0]
    v_cvt_pk_bf16_f32 v136, v240, v241
    v_cvt_pk_bf16_f32 v137, v242, v243
    v_cvt_pk_bf16_f32 v138, v244, v245
    v_cvt_pk_bf16_f32 v139, v246, v247
    s_add_u32 s38, s37, 6144
    buffer_store_dwordx4 v[136:139], v2, s[8:11], s38 offen sc1
    v_accvgpr_read_b32 v248, a100
    v_accvgpr_read_b32 v249, a101
    v_accvgpr_read_b32 v250, a102
    v_accvgpr_read_b32 v251, a103
    v_accvgpr_read_b32 v252, a108
    v_accvgpr_read_b32 v253, a109
    v_accvgpr_read_b32 v254, a110
    v_accvgpr_read_b32 v255, a111
    v_pk_mul_f32 v[248:249], v[248:249], v[40:41] op_sel:[0,1] op_sel_hi:[1,1]
    v_pk_mul_f32 v[250:251], v[250:251], v[40:41] op_sel:[0,1] op_sel_hi:[1,1]
    v_pk_mul_f32 v[252:253], v[252:253], v[40:41] op_sel:[0,1] op_sel_hi:[1,1]
    v_pk_mul_f32 v[254:255], v[254:255], v[40:41] op_sel:[0,1] op_sel_hi:[1,1]
    v_cvt_pk_bf16_f32 v168, v248, v249
    v_cvt_pk_bf16_f32 v169, v250, v251
    v_cvt_pk_bf16_f32 v170, v252, v253
    v_cvt_pk_bf16_f32 v171, v254, v255
    s_add_u32 s38, s37, 14336
    buffer_store_dwordx4 v[168:171], v2, s[8:11], s38 offen sc1
    v_accvgpr_read_b32 v240, a112
    v_accvgpr_read_b32 v241, a113
    v_accvgpr_read_b32 v242, a114
    v_accvgpr_read_b32 v243, a115
    v_accvgpr_read_b32 v244, a120
    v_accvgpr_read_b32 v245, a121
    v_accvgpr_read_b32 v246, a122
    v_accvgpr_read_b32 v247, a123
    v_pk_mul_f32 v[240:241], v[240:241], v[40:41] op_sel:[0,0] op_sel_hi:[1,0]
    v_pk_mul_f32 v[242:243], v[242:243], v[40:41] op_sel:[0,0] op_sel_hi:[1,0]
    v_pk_mul_f32 v[244:245], v[244:245], v[40:41] op_sel:[0,0] op_sel_hi:[1,0]
    v_pk_mul_f32 v[246:247], v[246:247], v[40:41] op_sel:[0,0] op_sel_hi:[1,0]
    v_cvt_pk_bf16_f32 v140, v240, v241
    v_cvt_pk_bf16_f32 v141, v242, v243
    v_cvt_pk_bf16_f32 v142, v244, v245
    v_cvt_pk_bf16_f32 v143, v246, v247
    s_add_u32 s38, s37, 7168
    buffer_store_dwordx4 v[140:143], v2, s[8:11], s38 offen sc1
    v_accvgpr_read_b32 v248, a116
    v_accvgpr_read_b32 v249, a117
    v_accvgpr_read_b32 v250, a118
    v_accvgpr_read_b32 v251, a119
    v_accvgpr_read_b32 v252, a124
    v_accvgpr_read_b32 v253, a125
    v_accvgpr_read_b32 v254, a126
    v_accvgpr_read_b32 v255, a127
    v_pk_mul_f32 v[248:249], v[248:249], v[40:41] op_sel:[0,1] op_sel_hi:[1,1]
    v_pk_mul_f32 v[250:251], v[250:251], v[40:41] op_sel:[0,1] op_sel_hi:[1,1]
    v_pk_mul_f32 v[252:253], v[252:253], v[40:41] op_sel:[0,1] op_sel_hi:[1,1]
    v_pk_mul_f32 v[254:255], v[254:255], v[40:41] op_sel:[0,1] op_sel_hi:[1,1]
    v_cvt_pk_bf16_f32 v172, v248, v249
    v_cvt_pk_bf16_f32 v173, v250, v251
    v_cvt_pk_bf16_f32 v174, v252, v253
    v_cvt_pk_bf16_f32 v175, v254, v255
    s_add_u32 s38, s37, 15360
    buffer_store_dwordx4 v[172:175], v2, s[8:11], s38 offen sc1
    s_cmp_eq_u32 s29, 0
    s_cbranch_scc1 AT_OPROJ
    s_add_u32 s37, s37, 16384
    s_cmp_eq_u32 s29, 2
    s_cselect_b32 s37, s37, 0xf0000000
    v_mov_b32 v240, v48
    v_mov_b32 v241, v38
    v_mov_b32 v242, v52
    v_mov_b32 v243, v39
    buffer_store_dwordx4 v[240:243], v2, s[8:11], s37 offen sc1
    v_swap_b32 v112, v176
    v_swap_b32 v113, v177
    v_swap_b32 v114, v178
    v_swap_b32 v115, v179
    v_swap_b32 v116, v180
    v_swap_b32 v117, v181
    v_swap_b32 v118, v182
    v_swap_b32 v119, v183
    v_swap_b32 v120, v184
    v_swap_b32 v121, v185
    v_swap_b32 v122, v186
    v_swap_b32 v123, v187
    v_swap_b32 v124, v188
    v_swap_b32 v125, v189
    v_swap_b32 v126, v190
    v_swap_b32 v127, v191
    v_swap_b32 v128, v192
    v_swap_b32 v129, v193
    v_swap_b32 v130, v194
    v_swap_b32 v131, v195
    v_swap_b32 v132, v196
    v_swap_b32 v133, v197
    v_swap_b32 v134, v198
    v_swap_b32 v135, v199
    v_swap_b32 v136, v200
    v_swap_b32 v137, v201
    v_swap_b32 v138, v202
    v_swap_b32 v139, v203
    v_swap_b32 v140, v204
    v_swap_b32 v141, v205
    v_swap_b32 v142, v206
    v_swap_b32 v143, v207
    v_swap_b32 v144, v208
    v_swap_b32 v145, v209
    v_swap_b32 v146, v210
    v_swap_b32 v147, v211
    v_swap_b32 v148, v212
    v_swap_b32 v149, v213
    v_swap_b32 v150, v214
    v_swap_b32 v151, v215
    v_swap_b32 v152, v216
    v_swap_b32 v153, v217
    v_swap_b32 v154, v218
    v_swap_b32 v155, v219
    v_swap_b32 v156, v220
    v_swap_b32 v157, v221
    v_swap_b32 v158, v222
    v_swap_b32 v159, v223
    v_swap_b32 v160, v224
    v_swap_b32 v161, v225
    v_swap_b32 v162, v226
    v_swap_b32 v163, v227
    v_swap_b32 v164, v228
    v_swap_b32 v165, v229
    v_swap_b32 v166, v230
    v_swap_b32 v167, v231
    v_swap_b32 v168, v232
    v_swap_b32 v169, v233
    v_swap_b32 v170, v234
    v_swap_b32 v171, v235
    v_swap_b32 v172, v236
    v_swap_b32 v173, v237
    v_swap_b32 v174, v238
    v_swap_b32 v175, v239
    s_sub_u32 s26, 15, s26
    s_cmp_eq_u32 s29, 3
    s_cbranch_scc1 AT_JOB2
    s_mov_b32 s37, s39
    s_lshl_b32 s3, s19, 6
    s_add_u32 s3, s3, 0x5400
    s_waitcnt vmcnt(0)
    s_barrier
    s_cmp_lg_u32 s18, 0
    s_cbranch_scc1 AT_SIGP
    v_mov_b32 v42, 1
    v_lshlrev_b32 v43, 2, s20
    s_mov_b64 exec, 1
    s_cmp_eq_u32 s96, 1
    s_cbranch_scc0 AT_SIGP_S
    buffer_store_dword v42, v43, s[8:11], s3 offen
    s_branch AT_SIGP_D
AT_SIGP_S:
    buffer_store_dword v42, v43, s[8:11], s3 offen sc1
AT_SIGP_D:
    s_mov_b64 exec, -1
AT_SIGP:
    s_branch AT_OPROJ
AT_JOB2:
    s_mov_b32 s29, 2
    s_mov_b32 s16, 0x1000
    s_mov_b32 s33, 40
    s_lshl_b32 s34, s26, 2
    s_sub_u32 s32, s34, 36
    v_mov_b32 v37, v36
    s_waitcnt lgkmcnt(0)
    v_mfma_f32_16x16x32_bf16 v[64:67], a[128:131], v[112:115], 0
    v_mfma_f32_16x16x32_bf16 v[68:71], a[128:131], v[144:147], 0
    s_add_u32 m0, s24, 0
    v_mfma_f32_16x16x32_bf16 v[64:67], a[132:135], v[116:119], v[64:67]
    buffer_load_dwordx4 v6, s[4:7], s21 offen sc1 lds
    v_mfma_f32_16x16x32_bf16 v[68:71], a[132:135], v[148:151], v[68:71]
    v_mfma_f32_16x16x32_bf16 v[64:67], a[136:139], v[120:123], v[64:67]
    v_mfma_f32_16x16x32_bf16 v[68:71], a[136:139], v[152:155], v[68:71]
    s_add_u32 m0, s24, 4096
    v_mfma_f32_16x16x32_bf16 v[64:67], a[140:143], v[124:127], v[64:67]
    buffer_load_dwordx4 v7, s[4:7], s21 offen sc1 lds
    v_mfma_f32_16x16x32_bf16 v[68:71], a[140:143], v[156:159], v[68:71]
    v_mfma_f32_16x16x32_bf16 v[64:67], a[144:147], v[128:131], v[64:67]
    v_mfma_f32_16x16x32_bf16 v[68:71], a[144:147], v[160:163], v[68:71]
    s_add_u32 m0, s24, 8192
    v_mfma_f32_16x16x32_bf16 v[64:67], a[148:151], v[132:135], v[64:67]
    buffer_load_dwordx4 v8, s[4:7], s21 offen sc1 lds
    v_mfma_f32_16x16x32_bf16 v[68:71], a[148:151], v[164:167], v[68:71]
    v_mfma_f32_16x16x32_bf16 v[64:67], a[152:155], v[136:139], v[64:67]
    v_mfma_f32_16x16x32_bf16 v[68:71], a[152:155], v[168:171], v[68:71]
    s_add_u32 m0, s24, 12288
    v_mfma_f32_16x16x32_bf16 v[64:67], a[156:159], v[140:143], v[64:67]
    buffer_load_dwordx4 v9, s[4:7], s21 offen sc1 lds
    v_mfma_f32_16x16x32_bf16 v[68:71], a[156:159], v[172:175], v[68:71]
    v_mfma_f32_16x16x32_bf16 v[72:75], a[160:163], v[112:115], 0
    v_mfma_f32_16x16x32_bf16 v[76:79], a[160:163], v[144:147], 0
    s_add_u32 m0, s24, 16384
    v_mfma_f32_16x16x32_bf16 v[72:75], a[164:167], v[116:119], v[72:75]
    buffer_load_dwordx4 v10, s[4:7], s21 offen sc1 lds
    v_mfma_f32_16x16x32_bf16 v[76:79], a[164:167], v[148:151], v[76:79]
    v_mfma_f32_16x16x32_bf16 v[72:75], a[168:171], v[120:123], v[72:75]
    v_mfma_f32_16x16x32_bf16 v[76:79], a[168:171], v[152:155], v[76:79]
    s_add_u32 m0, s24, 20480
    v_mfma_f32_16x16x32_bf16 v[72:75], a[172:175], v[124:127], v[72:75]
    buffer_load_dwordx4 v11, s[4:7], s21 offen sc1 lds
    v_mfma_f32_16x16x32_bf16 v[76:79], a[172:175], v[156:159], v[76:79]
    v_mfma_f32_16x16x32_bf16 v[72:75], a[176:179], v[128:131], v[72:75]
    s_add_u32 s25, s25, 0x8000
    v_mfma_f32_16x16x32_bf16 v[76:79], a[176:179], v[160:163], v[76:79]
    s_add_u32 m0, s24, 24576
    v_mfma_f32_16x16x32_bf16 v[72:75], a[180:183], v[132:135], v[72:75]
    buffer_load_dwordx4 v12, s[4:7], s21 offen sc1 lds
    v_mfma_f32_16x16x32_bf16 v[76:79], a[180:183], v[164:167], v[76:79]
    s_cmp_ge_u32 s25, 0x28000
    v_mfma_f32_16x16x32_bf16 v[72:75], a[184:187], v[136:139], v[72:75]
    s_cselect_b32 s25, 0, s25
    v_mfma_f32_16x16x32_bf16 v[76:79], a[184:187], v[168:171], v[76:79]
    s_add_u32 m0, s24, 28672
    v_mfma_f32_16x16x32_bf16 v[72:75], a[188:191], v[140:143], v[72:75]
    buffer_load_dwordx4 v13, s[4:7], s21 offen sc1 lds
    v_mfma_f32_16x16x32_bf16 v[76:79], a[188:191], v[172:175], v[76:79]
    v_add_u32 v14, s25, v2
    s_branch AT_S0B
AT_MERGE:
    v_min_f32 v42, v48, v96
    v_sub_f32 v43, v42, v48
    v_sub_f32 v42, v42, v96
    v_exp_f32 v43, v43
    v_exp_f32 v42, v42
    s_nop 0
    v_mul_f32 v97, v97, v42
    v_fma_f32 v42, v38, v43, v97
    v_rcp_f32 v42, v42
    s_nop 0
    v_mul_f32 v40, v43, v42
    v_mul_f32 v38, v97, v42
    v_min_f32 v42, v52, v98
    v_sub_f32 v43, v42, v52
    v_sub_f32 v42, v42, v98
    v_exp_f32 v43, v43
    v_exp_f32 v42, v42
    s_nop 0
    v_mul_f32 v99, v99, v42
    v_fma_f32 v42, v39, v43, v99
    v_rcp_f32 v42, v42
    s_nop 0
    v_mul_f32 v41, v43, v42
    v_mul_f32 v39, v99, v42
    v_accvgpr_read_b32 v240, a0
    v_accvgpr_read_b32 v241, a1
    v_accvgpr_read_b32 v242, a2
    v_accvgpr_read_b32 v243, a3
    v_accvgpr_read_b32 v244, a8
    v_accvgpr_read_b32 v245, a9
    v_accvgpr_read_b32 v246, a10
    v_accvgpr_read_b32 v247, a11
    v_pk_mul_f32 v[240:241], v[240:241], v[40:41] op_sel:[0,0] op_sel_hi:[1,0]
    v_pk_mul_f32 v[242:243], v[242:243], v[40:41] op_sel:[0,0] op_sel_hi:[1,0]
    v_pk_mul_f32 v[244:245], v[244:245], v[40:41] op_sel:[0,0] op_sel_hi:[1,0]
    v_pk_mul_f32 v[246:247], v[246:247], v[40:41] op_sel:[0,0] op_sel_hi:[1,0]
    v_lshlrev_b32 v42, 16, v176
    v_and_b32 v43, 0xffff0000, v176
    v_pk_fma_f32 v[240:241], v[42:43], v[38:39], v[240:241] op_sel:[0,0,0] op_sel_hi:[1,0,1]
    v_lshlrev_b32 v42, 16, v177
    v_and_b32 v43, 0xffff0000, v177
    v_pk_fma_f32 v[242:243], v[42:43], v[38:39], v[242:243] op_sel:[0,0,0] op_sel_hi:[1,0,1]
    v_lshlrev_b32 v42, 16, v178
    v_and_b32 v43, 0xffff0000, v178
    v_pk_fma_f32 v[244:245], v[42:43], v[38:39], v[244:245] op_sel:[0,0,0] op_sel_hi:[1,0,1]
    v_lshlrev_b32 v42, 16, v179
    v_and_b32 v43, 0xffff0000, v179
    v_pk_fma_f32 v[246:247], v[42:43], v[38:39], v[246:247] op_sel:[0,0,0] op_sel_hi:[1,0,1]
    v_cvt_pk_bf16_f32 v112, v240, v241
    v_cvt_pk_bf16_f32 v113, v242, v243
    v_cvt_pk_bf16_f32 v114, v244, v245
    v_cvt_pk_bf16_f32 v115, v246, v247
    s_add_u32 s38, s37, 0
    buffer_store_dwordx4 v[112:115], v2, s[8:11], s38 offen sc1
    v_accvgpr_read_b32 v248, a4
    v_accvgpr_read_b32 v249, a5
    v_accvgpr_read_b32 v250, a6
    v_accvgpr_read_b32 v251, a7
    v_accvgpr_read_b32 v252, a12
    v_accvgpr_read_b32 v253, a13
    v_accvgpr_read_b32 v254, a14
    v_accvgpr_read_b32 v255, a15
    v_pk_mul_f32 v[248:249], v[248:249], v[40:41] op_sel:[0,1] op_sel_hi:[1,1]
    v_pk_mul_f32 v[250:251], v[250:251], v[40:41] op_sel:[0,1] op_sel_hi:[1,1]
    v_pk_mul_f32 v[252:253], v[252:253], v[40:41] op_sel:[0,1] op_sel_hi:[1,1]
    v_pk_mul_f32 v[254:255], v[254:255], v[40:41] op_sel:[0,1] op_sel_hi:[1,1]
    v_lshlrev_b32 v42, 16, v208
    v_and_b32 v43, 0xffff0000, v208
    v_pk_fma_f32 v[248:249], v[42:43], v[38:39], v[248:249] op_sel:[0,1,0] op_sel_hi:[1,1,1]
    v_lshlrev_b32 v42, 16, v209
    v_and_b32 v43, 0xffff0000, v209
    v_pk_fma_f32 v[250:251], v[42:43], v[38:39], v[250:251] op_sel:[0,1,0] op_sel_hi:[1,1,1]
    v_lshlrev_b32 v42, 16, v210
    v_and_b32 v43, 0xffff0000, v210
    v_pk_fma_f32 v[252:253], v[42:43], v[38:39], v[252:253] op_sel:[0,1,0] op_sel_hi:[1,1,1]
    v_lshlrev_b32 v42, 16, v211
    v_and_b32 v43, 0xffff0000, v211
    v_pk_fma_f32 v[254:255], v[42:43], v[38:39], v[254:255] op_sel:[0,1,0] op_sel_hi:[1,1,1]
    v_cvt_pk_bf16_f32 v144, v248, v249
    v_cvt_pk_bf16_f32 v145, v250, v251
    v_cvt_pk_bf16_f32 v146, v252, v253
    v_cvt_pk_bf16_f32 v147, v254, v255
    s_add_u32 s38, s37, 8192
    buffer_store_dwordx4 v[144:147], v2, s[8:11], s38 offen sc1
    v_accvgpr_read_b32 v240, a16
    v_accvgpr_read_b32 v241, a17
    v_accvgpr_read_b32 v242, a18
    v_accvgpr_read_b32 v243, a19
    v_accvgpr_read_b32 v244, a24
    v_accvgpr_read_b32 v245, a25
    v_accvgpr_read_b32 v246, a26
    v_accvgpr_read_b32 v247, a27
    v_pk_mul_f32 v[240:241], v[240:241], v[40:41] op_sel:[0,0] op_sel_hi:[1,0]
    v_pk_mul_f32 v[242:243], v[242:243], v[40:41] op_sel:[0,0] op_sel_hi:[1,0]
    v_pk_mul_f32 v[244:245], v[244:245], v[40:41] op_sel:[0,0] op_sel_hi:[1,0]
    v_pk_mul_f32 v[246:247], v[246:247], v[40:41] op_sel:[0,0] op_sel_hi:[1,0]
    v_lshlrev_b32 v42, 16, v180
    v_and_b32 v43, 0xffff0000, v180
    v_pk_fma_f32 v[240:241], v[42:43], v[38:39], v[240:241] op_sel:[0,0,0] op_sel_hi:[1,0,1]
    v_lshlrev_b32 v42, 16, v181
    v_and_b32 v43, 0xffff0000, v181
    v_pk_fma_f32 v[242:243], v[42:43], v[38:39], v[242:243] op_sel:[0,0,0] op_sel_hi:[1,0,1]
    v_lshlrev_b32 v42, 16, v182
    v_and_b32 v43, 0xffff0000, v182
    v_pk_fma_f32 v[244:245], v[42:43], v[38:39], v[244:245] op_sel:[0,0,0] op_sel_hi:[1,0,1]
    v_lshlrev_b32 v42, 16, v183
    v_and_b32 v43, 0xffff0000, v183
    v_pk_fma_f32 v[246:247], v[42:43], v[38:39], v[246:247] op_sel:[0,0,0] op_sel_hi:[1,0,1]
    v_cvt_pk_bf16_f32 v116, v240, v241
    v_cvt_pk_bf16_f32 v117, v242, v243
    v_cvt_pk_bf16_f32 v118, v244, v245
    v_cvt_pk_bf16_f32 v119, v246, v247
    s_add_u32 s38, s37, 1024
    buffer_store_dwordx4 v[116:119], v2, s[8:11], s38 offen sc1
    v_accvgpr_read_b32 v248, a20
    v_accvgpr_read_b32 v249, a21
    v_accvgpr_read_b32 v250, a22
    v_accvgpr_read_b32 v251, a23
    v_accvgpr_read_b32 v252, a28
    v_accvgpr_read_b32 v253, a29
    v_accvgpr_read_b32 v254, a30
    v_accvgpr_read_b32 v255, a31
    v_pk_mul_f32 v[248:249], v[248:249], v[40:41] op_sel:[0,1] op_sel_hi:[1,1]
    v_pk_mul_f32 v[250:251], v[250:251], v[40:41] op_sel:[0,1] op_sel_hi:[1,1]
    v_pk_mul_f32 v[252:253], v[252:253], v[40:41] op_sel:[0,1] op_sel_hi:[1,1]
    v_pk_mul_f32 v[254:255], v[254:255], v[40:41] op_sel:[0,1] op_sel_hi:[1,1]
    v_lshlrev_b32 v42, 16, v212
    v_and_b32 v43, 0xffff0000, v212
    v_pk_fma_f32 v[248:249], v[42:43], v[38:39], v[248:249] op_sel:[0,1,0] op_sel_hi:[1,1,1]
    v_lshlrev_b32 v42, 16, v213
    v_and_b32 v43, 0xffff0000, v213
    v_pk_fma_f32 v[250:251], v[42:43], v[38:39], v[250:251] op_sel:[0,1,0] op_sel_hi:[1,1,1]
    v_lshlrev_b32 v42, 16, v214
    v_and_b32 v43, 0xffff0000, v214
    v_pk_fma_f32 v[252:253], v[42:43], v[38:39], v[252:253] op_sel:[0,1,0] op_sel_hi:[1,1,1]
    v_lshlrev_b32 v42, 16, v215
    v_and_b32 v43, 0xffff0000, v215
    v_pk_fma_f32 v[254:255], v[42:43], v[38:39], v[254:255] op_sel:[0,1,0] op_sel_hi:[1,1,1]
    v_cvt_pk_bf16_f32 v148, v248, v249
    v_cvt_pk_bf16_f32 v149, v250, v251
    v_cvt_pk_bf16_f32 v150, v252, v253
    v_cvt_pk_bf16_f32 v151, v254, v255
    s_add_u32 s38, s37, 9216
    buffer_store_dwordx4 v[148:151], v2, s[8:11], s38 offen sc1
    v_accvgpr_read_b32 v240, a32
    v_accvgpr_read_b32 v241, a33
    v_accvgpr_read_b32 v242, a34
    v_accvgpr_read_b32 v243, a35
    v_accvgpr_read_b32 v244, a40
    v_accvgpr_read_b32 v245, a41
    v_accvgpr_read_b32 v246, a42
    v_accvgpr_read_b32 v247, a43
    v_pk_mul_f32 v[240:241], v[240:241], v[40:41] op_sel:[0,0] op_sel_hi:[1,0]
    v_pk_mul_f32 v[242:243], v[242:243], v[40:41] op_sel:[0,0] op_sel_hi:[1,0]
    v_pk_mul_f32 v[244:245], v[244:245], v[40:41] op_sel:[0,0] op_sel_hi:[1,0]
    v_pk_mul_f32 v[246:247], v[246:247], v[40:41] op_sel:[0,0] op_sel_hi:[1,0]
    v_lshlrev_b32 v42, 16, v184
    v_and_b32 v43, 0xffff0000, v184
    v_pk_fma_f32 v[240:241], v[42:43], v[38:39], v[240:241] op_sel:[0,0,0] op_sel_hi:[1,0,1]
    v_lshlrev_b32 v42, 16, v185
    v_and_b32 v43, 0xffff0000, v185
    v_pk_fma_f32 v[242:243], v[42:43], v[38:39], v[242:243] op_sel:[0,0,0] op_sel_hi:[1,0,1]
    v_lshlrev_b32 v42, 16, v186
    v_and_b32 v43, 0xffff0000, v186
    v_pk_fma_f32 v[244:245], v[42:43], v[38:39], v[244:245] op_sel:[0,0,0] op_sel_hi:[1,0,1]
    v_lshlrev_b32 v42, 16, v187
    v_and_b32 v43, 0xffff0000, v187
    v_pk_fma_f32 v[246:247], v[42:43], v[38:39], v[246:247] op_sel:[0,0,0] op_sel_hi:[1,0,1]
    v_cvt_pk_bf16_f32 v120, v240, v241
    v_cvt_pk_bf16_f32 v121, v242, v243
    v_cvt_pk_bf16_f32 v122, v244, v245
    v_cvt_pk_bf16_f32 v123, v246, v247
    s_add_u32 s38, s37, 2048
    buffer_store_dwordx4 v[120:123], v2, s[8:11], s38 offen sc1
    v_accvgpr_read_b32 v248, a36
    v_accvgpr_read_b32 v249, a37
    v_accvgpr_read_b32 v250, a38
    v_accvgpr_read_b32 v251, a39
    v_accvgpr_read_b32 v252, a44
    v_accvgpr_read_b32 v253, a45
    v_accvgpr_read_b32 v254, a46
    v_accvgpr_read_b32 v255, a47
    v_pk_mul_f32 v[248:249], v[248:249], v[40:41] op_sel:[0,1] op_sel_hi:[1,1]
    v_pk_mul_f32 v[250:251], v[250:251], v[40:41] op_sel:[0,1] op_sel_hi:[1,1]
    v_pk_mul_f32 v[252:253], v[252:253], v[40:41] op_sel:[0,1] op_sel_hi:[1,1]
    v_pk_mul_f32 v[254:255], v[254:255], v[40:41] op_sel:[0,1] op_sel_hi:[1,1]
    v_lshlrev_b32 v42, 16, v216
    v_and_b32 v43, 0xffff0000, v216
    v_pk_fma_f32 v[248:249], v[42:43], v[38:39], v[248:249] op_sel:[0,1,0] op_sel_hi:[1,1,1]
    v_lshlrev_b32 v42, 16, v217
    v_and_b32 v43, 0xffff0000, v217
    v_pk_fma_f32 v[250:251], v[42:43], v[38:39], v[250:251] op_sel:[0,1,0] op_sel_hi:[1,1,1]
    v_lshlrev_b32 v42, 16, v218
    v_and_b32 v43, 0xffff0000, v218
    v_pk_fma_f32 v[252:253], v[42:43], v[38:39], v[252:253] op_sel:[0,1,0] op_sel_hi:[1,1,1]
    v_lshlrev_b32 v42, 16, v219
    v_and_b32 v43, 0xffff0000, v219
    v_pk_fma_f32 v[254:255], v[42:43], v[38:39], v[254:255] op_sel:[0,1,0] op_sel_hi:[1,1,1]
    v_cvt_pk_bf16_f32 v152, v248, v249
    v_cvt_pk_bf16_f32 v153, v250, v251
    v_cvt_pk_bf16_f32 v154, v252, v253
    v_cvt_pk_bf16_f32 v155, v254, v255
    s_add_u32 s38, s37, 10240
    buffer_store_dwordx4 v[152:155], v2, s[8:11], s38 offen sc1
    v_accvgpr_read_b32 v240, a48
    v_accvgpr_read_b32 v241, a49
    v_accvgpr_read_b32 v242, a50
    v_accvgpr_read_b32 v243, a51
    v_accvgpr_read_b32 v244, a56
    v_accvgpr_read_b32 v245, a57
    v_accvgpr_read_b32 v246, a58
    v_accvgpr_read_b32 v247, a59
    v_pk_mul_f32 v[240:241], v[240:241], v[40:41] op_sel:[0,0] op_sel_hi:[1,0]
    v_pk_mul_f32 v[242:243], v[242:243], v[40:41] op_sel:[0,0] op_sel_hi:[1,0]
    v_pk_mul_f32 v[244:245], v[244:245], v[40:41] op_sel:[0,0] op_sel_hi:[1,0]
    v_pk_mul_f32 v[246:247], v[246:247], v[40:41] op_sel:[0,0] op_sel_hi:[1,0]
    v_lshlrev_b32 v42, 16, v188
    v_and_b32 v43, 0xffff0000, v188
    v_pk_fma_f32 v[240:241], v[42:43], v[38:39], v[240:241] op_sel:[0,0,0] op_sel_hi:[1,0,1]
    v_lshlrev_b32 v42, 16, v189
    v_and_b32 v43, 0xffff0000, v189
    v_pk_fma_f32 v[242:243], v[42:43], v[38:39], v[242:243] op_sel:[0,0,0] op_sel_hi:[1,0,1]
    v_lshlrev_b32 v42, 16, v190
    v_and_b32 v43, 0xffff0000, v190
    v_pk_fma_f32 v[244:245], v[42:43], v[38:39], v[244:245] op_sel:[0,0,0] op_sel_hi:[1,0,1]
    v_lshlrev_b32 v42, 16, v191
    v_and_b32 v43, 0xffff0000, v191
    v_pk_fma_f32 v[246:247], v[42:43], v[38:39], v[246:247] op_sel:[0,0,0] op_sel_hi:[1,0,1]
    v_cvt_pk_bf16_f32 v124, v240, v241
    v_cvt_pk_bf16_f32 v125, v242, v243
    v_cvt_pk_bf16_f32 v126, v244, v245
    v_cvt_pk_bf16_f32 v127, v246, v247
    s_add_u32 s38, s37, 3072
    buffer_store_dwordx4 v[124:127], v2, s[8:11], s38 offen sc1
    v_accvgpr_read_b32 v248, a52
    v_accvgpr_read_b32 v249, a53
    v_accvgpr_read_b32 v250, a54
    v_accvgpr_read_b32 v251, a55
    v_accvgpr_read_b32 v252, a60
    v_accvgpr_read_b32 v253, a61
    v_accvgpr_read_b32 v254, a62
    v_accvgpr_read_b32 v255, a63
    v_pk_mul_f32 v[248:249], v[248:249], v[40:41] op_sel:[0,1] op_sel_hi:[1,1]
    v_pk_mul_f32 v[250:251], v[250:251], v[40:41] op_sel:[0,1] op_sel_hi:[1,1]
    v_pk_mul_f32 v[252:253], v[252:253], v[40:41] op_sel:[0,1] op_sel_hi:[1,1]
    v_pk_mul_f32 v[254:255], v[254:255], v[40:41] op_sel:[0,1] op_sel_hi:[1,1]
    v_lshlrev_b32 v42, 16, v220
    v_and_b32 v43, 0xffff0000, v220
    v_pk_fma_f32 v[248:249], v[42:43], v[38:39], v[248:249] op_sel:[0,1,0] op_sel_hi:[1,1,1]
    v_lshlrev_b32 v42, 16, v221
    v_and_b32 v43, 0xffff0000, v221
    v_pk_fma_f32 v[250:251], v[42:43], v[38:39], v[250:251] op_sel:[0,1,0] op_sel_hi:[1,1,1]
    v_lshlrev_b32 v42, 16, v222
    v_and_b32 v43, 0xffff0000, v222
    v_pk_fma_f32 v[252:253], v[42:43], v[38:39], v[252:253] op_sel:[0,1,0] op_sel_hi:[1,1,1]
    v_lshlrev_b32 v42, 16, v223
    v_and_b32 v43, 0xffff0000, v223
    v_pk_fma_f32 v[254:255], v[42:43], v[38:39], v[254:255] op_sel:[0,1,0] op_sel_hi:[1,1,1]
    v_cvt_pk_bf16_f32 v156, v248, v249
    v_cvt_pk_bf16_f32 v157, v250, v251
    v_cvt_pk_bf16_f32 v158, v252, v253
    v_cvt_pk_bf16_f32 v159, v254, v255
    s_add_u32 s38, s37, 11264
    buffer_store_dwordx4 v[156:159], v2, s[8:11], s38 offen sc1
    v_accvgpr_read_b32 v240, a64
    v_accvgpr_read_b32 v241, a65
    v_accvgpr_read_b32 v242, a66
    v_accvgpr_read_b32 v243, a67
    v_accvgpr_read_b32 v244, a72
    v_accvgpr_read_b32 v245, a73
    v_accvgpr_read_b32 v246, a74
    v_accvgpr_read_b32 v247, a75
    v_pk_mul_f32 v[240:241], v[240:241], v[40:41] op_sel:[0,0] op_sel_hi:[1,0]
    v_pk_mul_f32 v[242:243], v[242:243], v[40:41] op_sel:[0,0] op_sel_hi:[1,0]
    v_pk_mul_f32 v[244:245], v[244:245], v[40:41] op_sel:[0,0] op_sel_hi:[1,0]
    v_pk_mul_f32 v[246:247], v[246:247], v[40:41] op_sel:[0,0] op_sel_hi:[1,0]
    v_lshlrev_b32 v42, 16, v192
    v_and_b32 v43, 0xffff0000, v192
    v_pk_fma_f32 v[240:241], v[42:43], v[38:39], v[240:241] op_sel:[0,0,0] op_sel_hi:[1,0,1]
    v_lshlrev_b32 v42, 16, v193
    v_and_b32 v43, 0xffff0000, v193
    v_pk_fma_f32 v[242:243], v[42:43], v[38:39], v[242:243] op_sel:[0,0,0] op_sel_hi:[1,0,1]
    v_lshlrev_b32 v42, 16, v194
    v_and_b32 v43, 0xffff0000, v194
    v_pk_fma_f32 v[244:245], v[42:43], v[38:39], v[244:245] op_sel:[0,0,0] op_sel_hi:[1,0,1]
    v_lshlrev_b32 v42, 16, v195
    v_and_b32 v43, 0xffff0000, v195
    v_pk_fma_f32 v[246:247], v[42:43], v[38:39], v[246:247] op_sel:[0,0,0] op_sel_hi:[1,0,1]
    v_cvt_pk_bf16_f32 v128, v240, v241
    v_cvt_pk_bf16_f32 v129, v242, v243
    v_cvt_pk_bf16_f32 v130, v244, v245
    v_cvt_pk_bf16_f32 v131, v246, v247
    s_add_u32 s38, s37, 4096
    buffer_store_dwordx4 v[128:131], v2, s[8:11], s38 offen sc1
    v_accvgpr_read_b32 v248, a68
    v_accvgpr_read_b32 v249, a69
    v_accvgpr_read_b32 v250, a70
    v_accvgpr_read_b32 v251, a71
    v_accvgpr_read_b32 v252, a76
    v_accvgpr_read_b32 v253, a77
    v_accvgpr_read_b32 v254, a78
    v_accvgpr_read_b32 v255, a79
    v_pk_mul_f32 v[248:249], v[248:249], v[40:41] op_sel:[0,1] op_sel_hi:[1,1]
    v_pk_mul_f32 v[250:251], v[250:251], v[40:41] op_sel:[0,1] op_sel_hi:[1,1]
    v_pk_mul_f32 v[252:253], v[252:253], v[40:41] op_sel:[0,1] op_sel_hi:[1,1]
    v_pk_mul_f32 v[254:255], v[254:255], v[40:41] op_sel:[0,1] op_sel_hi:[1,1]
    v_lshlrev_b32 v42, 16, v224
    v_and_b32 v43, 0xffff0000, v224
    v_pk_fma_f32 v[248:249], v[42:43], v[38:39], v[248:249] op_sel:[0,1,0] op_sel_hi:[1,1,1]
    v_lshlrev_b32 v42, 16, v225
    v_and_b32 v43, 0xffff0000, v225
    v_pk_fma_f32 v[250:251], v[42:43], v[38:39], v[250:251] op_sel:[0,1,0] op_sel_hi:[1,1,1]
    v_lshlrev_b32 v42, 16, v226
    v_and_b32 v43, 0xffff0000, v226
    v_pk_fma_f32 v[252:253], v[42:43], v[38:39], v[252:253] op_sel:[0,1,0] op_sel_hi:[1,1,1]
    v_lshlrev_b32 v42, 16, v227
    v_and_b32 v43, 0xffff0000, v227
    v_pk_fma_f32 v[254:255], v[42:43], v[38:39], v[254:255] op_sel:[0,1,0] op_sel_hi:[1,1,1]
    v_cvt_pk_bf16_f32 v160, v248, v249
    v_cvt_pk_bf16_f32 v161, v250, v251
    v_cvt_pk_bf16_f32 v162, v252, v253
    v_cvt_pk_bf16_f32 v163, v254, v255
    s_add_u32 s38, s37, 12288
    buffer_store_dwordx4 v[160:163], v2, s[8:11], s38 offen sc1
    v_accvgpr_read_b32 v240, a80
    v_accvgpr_read_b32 v241, a81
    v_accvgpr_read_b32 v242, a82
    v_accvgpr_read_b32 v243, a83
    v_accvgpr_read_b32 v244, a88
    v_accvgpr_read_b32 v245, a89
    v_accvgpr_read_b32 v246, a90
    v_accvgpr_read_b32 v247, a91
    v_pk_mul_f32 v[240:241], v[240:241], v[40:41] op_sel:[0,0] op_sel_hi:[1,0]
    v_pk_mul_f32 v[242:243], v[242:243], v[40:41] op_sel:[0,0] op_sel_hi:[1,0]
    v_pk_mul_f32 v[244:245], v[244:245], v[40:41] op_sel:[0,0] op_sel_hi:[1,0]
    v_pk_mul_f32 v[246:247], v[246:247], v[40:41] op_sel:[0,0] op_sel_hi:[1,0]
    v_lshlrev_b32 v42, 16, v196
    v_and_b32 v43, 0xffff0000, v196
    v_pk_fma_f32 v[240:241], v[42:43], v[38:39], v[240:241] op_sel:[0,0,0] op_sel_hi:[1,0,1]
    v_lshlrev_b32 v42, 16, v197
    v_and_b32 v43, 0xffff0000, v197
    v_pk_fma_f32 v[242:243], v[42:43], v[38:39], v[242:243] op_sel:[0,0,0] op_sel_hi:[1,0,1]
    v_lshlrev_b32 v42, 16, v198
    v_and_b32 v43, 0xffff0000, v198
    v_pk_fma_f32 v[244:245], v[42:43], v[38:39], v[244:245] op_sel:[0,0,0] op_sel_hi:[1,0,1]
    v_lshlrev_b32 v42, 16, v199
    v_and_b32 v43, 0xffff0000, v199
    v_pk_fma_f32 v[246:247], v[42:43], v[38:39], v[246:247] op_sel:[0,0,0] op_sel_hi:[1,0,1]
    v_cvt_pk_bf16_f32 v132, v240, v241
    v_cvt_pk_bf16_f32 v133, v242, v243
    v_cvt_pk_bf16_f32 v134, v244, v245
    v_cvt_pk_bf16_f32 v135, v246, v247
    s_add_u32 s38, s37, 5120
    buffer_store_dwordx4 v[132:135], v2, s[8:11], s38 offen sc1
    v_accvgpr_read_b32 v248, a84
    v_accvgpr_read_b32 v249, a85
    v_accvgpr_read_b32 v250, a86
    v_accvgpr_read_b32 v251, a87
    v_accvgpr_read_b32 v252, a92
    v_accvgpr_read_b32 v253, a93
    v_accvgpr_read_b32 v254, a94
    v_accvgpr_read_b32 v255, a95
    v_pk_mul_f32 v[248:249], v[248:249], v[40:41] op_sel:[0,1] op_sel_hi:[1,1]
    v_pk_mul_f32 v[250:251], v[250:251], v[40:41] op_sel:[0,1] op_sel_hi:[1,1]
    v_pk_mul_f32 v[252:253], v[252:253], v[40:41] op_sel:[0,1] op_sel_hi:[1,1]
    v_pk_mul_f32 v[254:255], v[254:255], v[40:41] op_sel:[0,1] op_sel_hi:[1,1]
    v_lshlrev_b32 v42, 16, v228
    v_and_b32 v43, 0xffff0000, v228
    v_pk_fma_f32 v[248:249], v[42:43], v[38:39], v[248:249] op_sel:[0,1,0] op_sel_hi:[1,1,1]
    v_lshlrev_b32 v42, 16, v229
    v_and_b32 v43, 0xffff0000, v229
    v_pk_fma_f32 v[250:251], v[42:43], v[38:39], v[250:251] op_sel:[0,1,0] op_sel_hi:[1,1,1]
    v_lshlrev_b32 v42, 16, v230
    v_and_b32 v43, 0xffff0000, v230
    v_pk_fma_f32 v[252:253], v[42:43], v[38:39], v[252:253] op_sel:[0,1,0] op_sel_hi:[1,1,1]
    v_lshlrev_b32 v42, 16, v231
    v_and_b32 v43, 0xffff0000, v231
    v_pk_fma_f32 v[254:255], v[42:43], v[38:39], v[254:255] op_sel:[0,1,0] op_sel_hi:[1,1,1]
    v_cvt_pk_bf16_f32 v164, v248, v249
    v_cvt_pk_bf16_f32 v165, v250, v251
    v_cvt_pk_bf16_f32 v166, v252, v253
    v_cvt_pk_bf16_f32 v167, v254, v255
    s_add_u32 s38, s37, 13312
    buffer_store_dwordx4 v[164:167], v2, s[8:11], s38 offen sc1
    v_accvgpr_read_b32 v240, a96
    v_accvgpr_read_b32 v241, a97
    v_accvgpr_read_b32 v242, a98
    v_accvgpr_read_b32 v243, a99
    v_accvgpr_read_b32 v244, a104
    v_accvgpr_read_b32 v245, a105
    v_accvgpr_read_b32 v246, a106
    v_accvgpr_read_b32 v247, a107
    v_pk_mul_f32 v[240:241], v[240:241], v[40:41] op_sel:[0,0] op_sel_hi:[1,0]
    v_pk_mul_f32 v[242:243], v[242:243], v[40:41] op_sel:[0,0] op_sel_hi:[1,0]
    v_pk_mul_f32 v[244:245], v[244:245], v[40:41] op_sel:[0,0] op_sel_hi:[1,0]
    v_pk_mul_f32 v[246:247], v[246:247], v[40:41] op_sel:[0,0] op_sel_hi:[1,0]
    v_lshlrev_b32 v42, 16, v200
    v_and_b32 v43, 0xffff0000, v200
    v_pk_fma_f32 v[240:241], v[42:43], v[38:39], v[240:241] op_sel:[0,0,0] op_sel_hi:[1,0,1]
    v_lshlrev_b32 v42, 16, v201
    v_and_b32 v43, 0xffff0000, v201
    v_pk_fma_f32 v[242:243], v[42:43], v[38:39], v[242:243] op_sel:[0,0,0] op_sel_hi:[1,0,1]
    v_lshlrev_b32 v42, 16, v202
    v_and_b32 v43, 0xffff0000, v202
    v_pk_fma_f32 v[244:245], v[42:43], v[38:39], v[244:245] op_sel:[0,0,0] op_sel_hi:[1,0,1]
    v_lshlrev_b32 v42, 16, v203
    v_and_b32 v43, 0xffff0000, v203
    v_pk_fma_f32 v[246:247], v[42:43], v[38:39], v[246:247] op_sel:[0,0,0] op_sel_hi:[1,0,1]
    v_cvt_pk_bf16_f32 v136, v240, v241
    v_cvt_pk_bf16_f32 v137, v242, v243
    v_cvt_pk_bf16_f32 v138, v244, v245
    v_cvt_pk_bf16_f32 v139, v246, v247
    s_add_u32 s38, s37, 6144
    buffer_store_dwordx4 v[136:139], v2, s[8:11], s38 offen sc1
    v_accvgpr_read_b32 v248, a100
    v_accvgpr_read_b32 v249, a101
    v_accvgpr_read_b32 v250, a102
    v_accvgpr_read_b32 v251, a103
    v_accvgpr_read_b32 v252, a108
    v_accvgpr_read_b32 v253, a109
    v_accvgpr_read_b32 v254, a110
    v_accvgpr_read_b32 v255, a111
    v_pk_mul_f32 v[248:249], v[248:249], v[40:41] op_sel:[0,1] op_sel_hi:[1,1]
    v_pk_mul_f32 v[250:251], v[250:251], v[40:41] op_sel:[0,1] op_sel_hi:[1,1]
    v_pk_mul_f32 v[252:253], v[252:253], v[40:41] op_sel:[0,1] op_sel_hi:[1,1]
    v_pk_mul_f32 v[254:255], v[254:255], v[40:41] op_sel:[0,1] op_sel_hi:[1,1]
    v_lshlrev_b32 v42, 16, v232
    v_and_b32 v43, 0xffff0000, v232
    v_pk_fma_f32 v[248:249], v[42:43], v[38:39], v[248:249] op_sel:[0,1,0] op_sel_hi:[1,1,1]
    v_lshlrev_b32 v42, 16, v233
    v_and_b32 v43, 0xffff0000, v233
    v_pk_fma_f32 v[250:251], v[42:43], v[38:39], v[250:251] op_sel:[0,1,0] op_sel_hi:[1,1,1]
    v_lshlrev_b32 v42, 16, v234
    v_and_b32 v43, 0xffff0000, v234
    v_pk_fma_f32 v[252:253], v[42:43], v[38:39], v[252:253] op_sel:[0,1,0] op_sel_hi:[1,1,1]
    v_lshlrev_b32 v42, 16, v235
    v_and_b32 v43, 0xffff0000, v235
    v_pk_fma_f32 v[254:255], v[42:43], v[38:39], v[254:255] op_sel:[0,1,0] op_sel_hi:[1,1,1]
    v_cvt_pk_bf16_f32 v168, v248, v249
    v_cvt_pk_bf16_f32 v169, v250, v251
    v_cvt_pk_bf16_f32 v170, v252, v253
    v_cvt_pk_bf16_f32 v171, v254, v255
    s_add_u32 s38, s37, 14336
    buffer_store_dwordx4 v[168:171], v2, s[8:11], s38 offen sc1
    v_accvgpr_read_b32 v240, a112
    v_accvgpr_read_b32 v241, a113
    v_accvgpr_read_b32 v242, a114
    v_accvgpr_read_b32 v243, a115
    v_accvgpr_read_b32 v244, a120
    v_accvgpr_read_b32 v245, a121
    v_accvgpr_read_b32 v246, a122
    v_accvgpr_read_b32 v247, a123
    v_pk_mul_f32 v[240:241], v[240:241], v[40:41] op_sel:[0,0] op_sel_hi:[1,0]
    v_pk_mul_f32 v[242:243], v[242:243], v[40:41] op_sel:[0,0] op_sel_hi:[1,0]
    v_pk_mul_f32 v[244:245], v[244:245], v[40:41] op_sel:[0,0] op_sel_hi:[1,0]
    v_pk_mul_f32 v[246:247], v[246:247], v[40:41] op_sel:[0,0] op_sel_hi:[1,0]
    v_lshlrev_b32 v42, 16, v204
    v_and_b32 v43, 0xffff0000, v204
    v_pk_fma_f32 v[240:241], v[42:43], v[38:39], v[240:241] op_sel:[0,0,0] op_sel_hi:[1,0,1]
    v_lshlrev_b32 v42, 16, v205
    v_and_b32 v43, 0xffff0000, v205
    v_pk_fma_f32 v[242:243], v[42:43], v[38:39], v[242:243] op_sel:[0,0,0] op_sel_hi:[1,0,1]
    v_lshlrev_b32 v42, 16, v206
    v_and_b32 v43, 0xffff0000, v206
    v_pk_fma_f32 v[244:245], v[42:43], v[38:39], v[244:245] op_sel:[0,0,0] op_sel_hi:[1,0,1]
    v_lshlrev_b32 v42, 16, v207
    v_and_b32 v43, 0xffff0000, v207
    v_pk_fma_f32 v[246:247], v[42:43], v[38:39], v[246:247] op_sel:[0,0,0] op_sel_hi:[1,0,1]
    v_cvt_pk_bf16_f32 v140, v240, v241
    v_cvt_pk_bf16_f32 v141, v242, v243
    v_cvt_pk_bf16_f32 v142, v244, v245
    v_cvt_pk_bf16_f32 v143, v246, v247
    s_add_u32 s38, s37, 7168
    buffer_store_dwordx4 v[140:143], v2, s[8:11], s38 offen sc1
    v_accvgpr_read_b32 v248, a116
    v_accvgpr_read_b32 v249, a117
    v_accvgpr_read_b32 v250, a118
    v_accvgpr_read_b32 v251, a119
    v_accvgpr_read_b32 v252, a124
    v_accvgpr_read_b32 v253, a125
    v_accvgpr_read_b32 v254, a126
    v_accvgpr_read_b32 v255, a127
    v_pk_mul_f32 v[248:249], v[248:249], v[40:41] op_sel:[0,1] op_sel_hi:[1,1]
    v_pk_mul_f32 v[250:251], v[250:251], v[40:41] op_sel:[0,1] op_sel_hi:[1,1]
    v_pk_mul_f32 v[252:253], v[252:253], v[40:41] op_sel:[0,1] op_sel_hi:[1,1]
    v_pk_mul_f32 v[254:255], v[254:255], v[40:41] op_sel:[0,1] op_sel_hi:[1,1]
    v_lshlrev_b32 v42, 16, v236
    v_and_b32 v43, 0xffff0000, v236
    v_pk_fma_f32 v[248:249], v[42:43], v[38:39], v[248:249] op_sel:[0,1,0] op_sel_hi:[1,1,1]
    v_lshlrev_b32 v42, 16, v237
    v_and_b32 v43, 0xffff0000, v237
    v_pk_fma_f32 v[250:251], v[42:43], v[38:39], v[250:251] op_sel:[0,1,0] op_sel_hi:[1,1,1]
    v_lshlrev_b32 v42, 16, v238
    v_and_b32 v43, 0xffff0000, v238
    v_pk_fma_f32 v[252:253], v[42:43], v[38:39], v[252:253] op_sel:[0,1,0] op_sel_hi:[1,1,1]
    v_lshlrev_b32 v42, 16, v239
    v_and_b32 v43, 0xffff0000, v239
    v_pk_fma_f32 v[254:255], v[42:43], v[38:39], v[254:255] op_sel:[0,1,0] op_sel_hi:[1,1,1]
    v_cvt_pk_bf16_f32 v172, v248, v249
    v_cvt_pk_bf16_f32 v173, v250, v251
    v_cvt_pk_bf16_f32 v174, v252, v253
    v_cvt_pk_bf16_f32 v175, v254, v255
    s_add_u32 s38, s37, 15360
    buffer_store_dwordx4 v[172:175], v2, s[8:11], s38 offen sc1
AT_OPROJ:
    s_sub_u32 s3, s20, 8
    s_cmp_lt_u32 s20, 6
    s_cselect_b32 s3, s20, s3
    s_sub_u32 s48, s20, 6
    s_cmp_lt_u32 s48, 8
    s_cselect_b32 s48, s48, s3
    s_cselect_b32 s3, 0, 8
    s_lshr_b32 s97, s19, 1
    s_add_u32 s97, s97, s3
    s_lshl_b32 s48, s48, 1
    s_and_b32 s3, s19, 1
    s_add_u32 s48, s48, s3
    s_lshl_b32 s35, s19, 6
    s_add_u32 s35, s35, 0x5800
    s_xor_b32 s39, s35, 64
    s_lshl_b32 s3, s20, 2
    s_add_u32 s39, s39, s3
    s_xor_b32 s37, s37, 0x80000
    s_waitcnt lgkmcnt(0)
    v_mfma_f32_16x16x32_bf16 a[0:3], a[128:131], v[112:115], 0
    ds_read_b64_tr_b16 a[192:193], v30 offset:0
    ds_read_b64_tr_b16 a[194:195], v30 offset:2048
    v_mfma_f32_16x16x32_bf16 a[8:11], a[128:131], v[144:147], 0
    s_add_u32 m0, s24, 0
    ds_read_b64_tr_b16 a[196:197], v30 offset:4096
    v_mfma_f32_16x16x32_bf16 a[0:3], a[132:135], v[116:119], a[0:3]
    buffer_load_dwordx4 v6, s[4:7], s21 offen sc1 lds
    v_mfma_f32_16x16x32_bf16 a[8:11], a[132:135], v[148:151], a[8:11]
    ds_read_b64_tr_b16 a[198:199], v30 offset:6144
    v_mfma_f32_16x16x32_bf16 a[0:3], a[136:139], v[120:123], a[0:3]
    ds_read_b64_tr_b16 a[200:201], v30 offset:8192
    ds_read_b64_tr_b16 a[202:203], v30 offset:10240
    v_mfma_f32_16x16x32_bf16 a[8:11], a[136:139], v[152:155], a[8:11]
    s_add_u32 m0, s24, 4096
    ds_read_b64_tr_b16 a[204:205], v30 offset:12288
    v_mfma_f32_16x16x32_bf16 a[0:3], a[140:143], v[124:127], a[0:3]
    buffer_load_dwordx4 v7, s[4:7], s21 offen sc1 lds
    v_mfma_f32_16x16x32_bf16 a[8:11], a[140:143], v[156:159], a[8:11]
    ds_read_b64_tr_b16 a[206:207], v30 offset:14336
    v_mfma_f32_16x16x32_bf16 a[0:3], a[144:147], v[128:131], a[0:3]
    ds_read_b64_tr_b16 a[208:209], v30 offset:16384
    ds_read_b64_tr_b16 a[210:211], v30 offset:18432
    v_mfma_f32_16x16x32_bf16 a[8:11], a[144:147], v[160:163], a[8:11]
    s_add_u32 m0, s24, 8192
    ds_read_b64_tr_b16 a[212:213], v30 offset:20480
    v_mfma_f32_16x16x32_bf16 a[0:3], a[148:151], v[132:135], a[0:3]
    buffer_load_dwordx4 v8, s[4:7], s21 offen sc1 lds
    v_mfma_f32_16x16x32_bf16 a[8:11], a[148:151], v[164:167], a[8:11]
    ds_read_b64_tr_b16 a[214:215], v30 offset:22528
    v_mfma_f32_16x16x32_bf16 a[0:3], a[152:155], v[136:139], a[0:3]
    s_waitcnt lgkmcnt(8)
    ds_read_b64_tr_b16 a[216:217], v30 offset:24576
    ds_read_b64_tr_b16 a[218:219], v30 offset:26624
    v_mfma_f32_16x16x32_bf16 a[8:11], a[152:155], v[168:171], a[8:11]
    s_add_u32 m0, s24, 12288
    ds_read_b64_tr_b16 a[220:221], v30 offset:28672
    v_mfma_f32_16x16x32_bf16 a[0:3], a[156:159], v[140:143], a[0:3]
    buffer_load_dwordx4 v9, s[4:7], s21 offen sc1 lds
    v_mfma_f32_16x16x32_bf16 a[8:11], a[156:159], v[172:175], a[8:11]
    ds_read_b64_tr_b16 a[222:223], v30 offset:30720
    v_mfma_f32_16x16x32_bf16 a[4:7], a[160:163], v[112:115], 0
    ds_read_b64_tr_b16 a[224:225], v31 offset:0
    ds_read_b64_tr_b16 a[226:227], v31 offset:2048
    v_mfma_f32_16x16x32_bf16 a[12:15], a[160:163], v[144:147], 0
    s_add_u32 m0, s24, 16384
    ds_read_b64_tr_b16 a[228:229], v31 offset:4096
    v_mfma_f32_16x16x32_bf16 a[4:7], a[164:167], v[116:119], a[4:7]
    buffer_load_dwordx4 v10, s[4:7], s21 offen sc1 lds
    v_mfma_f32_16x16x32_bf16 a[12:15], a[164:167], v[148:151], a[12:15]
    ds_read_b64_tr_b16 a[230:231], v31 offset:6144
    v_mfma_f32_16x16x32_bf16 a[4:7], a[168:171], v[120:123], a[4:7]
    ds_read_b64_tr_b16 a[232:233], v31 offset:8192
    ds_read_b64_tr_b16 a[234:235], v31 offset:10240
    v_mfma_f32_16x16x32_bf16 a[12:15], a[168:171], v[152:155], a[12:15]
    s_add_u32 m0, s24, 20480
    ds_read_b64_tr_b16 a[236:237], v31 offset:12288
    v_mfma_f32_16x16x32_bf16 a[4:7], a[172:175], v[124:127], a[4:7]
    buffer_load_dwordx4 v11, s[4:7], s21 offen sc1 lds
    v_mfma_f32_16x16x32_bf16 a[12:15], a[172:175], v[156:159], a[12:15]
    ds_read_b64_tr_b16 a[238:239], v31 offset:14336
    v_mfma_f32_16x16x32_bf16 a[4:7], a[176:179], v[128:131], a[4:7]
    s_add_u32 s25, s25, 0x8000
    ds_read_b64_tr_b16 a[240:241], v31 offset:16384
    ds_read_b64_tr_b16 a[242:243], v31 offset:18432
    v_mfma_f32_16x16x32_bf16 a[12:15], a[176:179], v[160:163], a[12:15]
    s_add_u32 m0, s24, 24576
    ds_read_b64_tr_b16 a[244:245], v31 offset:20480
    v_mfma_f32_16x16x32_bf16 a[4:7], a[180:183], v[132:135], a[4:7]
    buffer_load_dwordx4 v12, s[4:7], s21 offen sc1 lds
    v_mfma_f32_16x16x32_bf16 a[12:15], a[180:183], v[164:167], a[12:15]
    s_cmp_ge_u32 s25, 0x28000
    ds_read_b64_tr_b16 a[246:247], v31 offset:22528
    v_mfma_f32_16x16x32_bf16 a[4:7], a[184:187], v[136:139], a[4:7]
    s_cselect_b32 s25, 0, s25
    ds_read_b64_tr_b16 a[248:249], v31 offset:24576
    ds_read_b64_tr_b16 a[250:251], v31 offset:26624
    v_mfma_f32_16x16x32_bf16 a[12:15], a[184:187], v[168:171], a[12:15]
    s_add_u32 m0, s24, 28672
    ds_read_b64_tr_b16 a[252:253], v31 offset:28672
    v_mfma_f32_16x16x32_bf16 a[4:7], a[188:191], v[140:143], a[4:7]
    buffer_load_dwordx4 v13, s[4:7], s21 offen sc1 lds
    v_mfma_f32_16x16x32_bf16 a[12:15], a[188:191], v[172:175], a[12:15]
    ds_read_b64_tr_b16 a[254:255], v31 offset:30720
    s_waitcnt vmcnt(8) lgkmcnt(8)
    s_barrier
    s_cmp_lg_u32 s18, 0
    s_cbranch_scc1 AT_SIGCX
    v_mov_b32 v42, 1
    v_lshlrev_b32 v43, 2, s20
    s_mov_b64 exec, 1
    s_cmp_eq_u32 s96, 1
    s_cbranch_scc0 AT_SIGCX_S
    buffer_store_dword v42, v43, s[8:11], s35 offen
    s_branch AT_SIGCX_D
AT_SIGCX_S:
    buffer_store_dword v42, v43, s[8:11], s35 offen sc1
AT_SIGCX_D:
    s_mov_b64 exec, -1
AT_SIGCX:
    v_mfma_f32_16x16x32_bf16 a[16:19], a[192:195], v[112:115], 0
    v_add_u32 v28, s25, v24
    v_add_u32 v29, s25, v25
    v_mfma_f32_16x16x32_bf16 a[24:27], a[192:195], v[144:147], 0
    ds_read_b64_tr_b16 a[128:129], v28 offset:0
    ds_read_b64_tr_b16 a[130:131], v28 offset:2048
    v_add_u32 v30, s25, v26
    v_mfma_f32_16x16x32_bf16 a[16:19], a[196:199], v[116:119], a[16:19]
    ds_read_b64_tr_b16 a[132:133], v28 offset:4096
    v_add_u32 v31, s25, v27
    v_mfma_f32_16x16x32_bf16 a[24:27], a[196:199], v[148:151], a[24:27]
    s_add_u32 s21, s21, s22
    ds_read_b64_tr_b16 a[134:135], v28 offset:6144
    v_mfma_f32_16x16x32_bf16 a[16:19], a[200:203], v[120:123], a[16:19]
    s_add_u32 s24, s24, 0x8000
    ds_read_b64_tr_b16 a[136:137], v28 offset:8192
    v_mfma_f32_16x16x32_bf16 a[24:27], a[200:203], v[152:155], a[24:27]
    ds_read_b64_tr_b16 a[138:139], v28 offset:10240
    v_mfma_f32_16x16x32_bf16 a[16:19], a[204:207], v[124:127], a[16:19]
    ds_read_b64_tr_b16 a[140:141], v28 offset:12288
    v_mfma_f32_16x16x32_bf16 a[24:27], a[204:207], v[156:159], a[24:27]
    s_cmp_ge_u32 s24, 0x28000
    ds_read_b64_tr_b16 a[142:143], v28 offset:14336
    v_mfma_f32_16x16x32_bf16 a[16:19], a[208:211], v[128:131], a[16:19]
    s_cselect_b32 s24, s49, s24
    ds_read_b64_tr_b16 a[144:145], v28 offset:16384
    v_mfma_f32_16x16x32_bf16 a[24:27], a[208:211], v[160:163], a[24:27]
    s_xor_b32 s21, s19, 1
    ds_read_b64_tr_b16 a[146:147], v28 offset:18432
    v_mov_b32 v6, v5
    v_mfma_f32_16x16x32_bf16 a[16:19], a[212:215], v[132:135], a[16:19]
    s_mul_i32 s21, s21, 229376
    ds_read_b64_tr_b16 a[148:149], v28 offset:20480
    v_add_u32 v7, 0x7000, v5
    v_mfma_f32_16x16x32_bf16 a[24:27], a[212:215], v[164:167], a[24:27]
    s_and_b32 s3, s19, 1
    ds_read_b64_tr_b16 a[150:151], v28 offset:22528
    v_add_u32 v8, 0xe000, v5
    v_mfma_f32_16x16x32_bf16 a[16:19], a[216:219], v[136:139], a[16:19]
    s_waitcnt lgkmcnt(8)
    ds_read_b64_tr_b16 a[152:153], v28 offset:24576
    v_mfma_f32_16x16x32_bf16 a[24:27], a[216:219], v[168:171], a[24:27]
    s_lshl_b32 s3, s3, 9
    ds_read_b64_tr_b16 a[154:155], v28 offset:26624
    v_add_u32 v9, 0x15000, v5
    v_mfma_f32_16x16x32_bf16 a[16:19], a[220:223], v[140:143], a[16:19]
    s_add_u32 s21, s21, s3
    ds_read_b64_tr_b16 a[156:157], v28 offset:28672
    v_add_u32 v10, 0x1c000, v5
    v_mfma_f32_16x16x32_bf16 a[24:27], a[220:223], v[172:175], a[24:27]
    ds_read_b64_tr_b16 a[158:159], v28 offset:30720
    v_add_u32 v11, 0x23000, v5
    v_mfma_f32_16x16x32_bf16 a[20:23], a[224:227], v[112:115], 0
    ds_read_b64_tr_b16 a[160:161], v29 offset:0
    ds_read_b64_tr_b16 a[162:163], v29 offset:2048
    v_mfma_f32_16x16x32_bf16 a[28:31], a[224:227], v[144:147], 0
    ds_read_b64_tr_b16 a[164:165], v29 offset:4096
    v_add_u32 v12, 0x2a000, v5
    v_mfma_f32_16x16x32_bf16 a[20:23], a[228:231], v[116:119], a[20:23]
    ds_read_b64_tr_b16 a[166:167], v29 offset:6144
    v_add_u32 v13, 0x31000, v5
    v_mfma_f32_16x16x32_bf16 a[28:31], a[228:231], v[148:151], a[28:31]
    s_lshl_b32 s30, s26, 11
    ds_read_b64_tr_b16 a[168:169], v29 offset:8192
    v_mfma_f32_16x16x32_bf16 a[20:23], a[232:235], v[120:123], a[20:23]
    s_add_u32 s30, s30, 0x8000
    buffer_load_dword v42, v44, s[8:11], s39 offen sc1
    v_mfma_f32_16x16x32_bf16 a[28:31], a[232:235], v[152:155], a[28:31]
    s_lshl_b32 s31, s97, 11
    ds_read_b64_tr_b16 a[170:171], v29 offset:10240
    v_mfma_f32_16x16x32_bf16 a[20:23], a[236:239], v[124:127], a[20:23]
    s_add_u32 s31, s31, 0x8000
    ds_read_b64_tr_b16 a[172:173], v29 offset:12288
    v_and_b32 v16, 7, v1
    v_mfma_f32_16x16x32_bf16 a[28:31], a[236:239], v[156:159], a[28:31]
    s_lshl_b32 s28, s97, 4
    ds_read_b64_tr_b16 a[174:175], v29 offset:14336
    v_lshrrev_b32 v17, 5, v1
    v_mfma_f32_16x16x32_bf16 a[20:23], a[240:243], v[128:131], a[20:23]
    s_add_u32 s28, s28, s48
    ds_read_b64_tr_b16 a[176:177], v29 offset:16384
    v_bfe_u32 v18, v1, 3, 2
    v_mfma_f32_16x16x32_bf16 a[28:31], a[240:243], v[160:163], a[28:31]
    s_lshr_b32 s3, s28, 1
    ds_read_b64_tr_b16 a[178:179], v29 offset:18432
    v_lshlrev_b32 v19, 10, v17
    v_mfma_f32_16x16x32_bf16 a[20:23], a[244:247], v[132:135], a[20:23]
    s_waitcnt lgkmcnt(8)
    ds_read_b64_tr_b16 a[180:181], v29 offset:20480
    v_mfma_f32_16x16x32_bf16 a[28:31], a[244:247], v[164:167], a[28:31]
    s_mul_i32 s3, s3, 14336
    ds_read_b64_tr_b16 a[182:183], v29 offset:22528
    v_lshl_add_u32 v19, v18, 8, v19
    v_mfma_f32_16x16x32_bf16 a[20:23], a[248:251], v[136:139], a[20:23]
    s_and_b32 s27, s28, 1
    ds_read_b64_tr_b16 a[184:185], v29 offset:24576
    v_lshl_add_u32 v19, v16, 4, v19
    v_mfma_f32_16x16x32_bf16 a[28:31], a[248:251], v[168:171], a[28:31]
    s_lshl_b32 s27, s27, 7
    ds_read_b64_tr_b16 a[186:187], v29 offset:26624
    v_lshlrev_b32 v21, 7, v17
    v_mfma_f32_16x16x32_bf16 a[20:23], a[252:255], v[140:143], a[20:23]
    s_add_u32 s3, s3, s27
    ds_read_b64_tr_b16 a[188:189], v29 offset:28672
    v_lshl_add_u32 v21, v18, 4, v21
    v_mfma_f32_16x16x32_bf16 a[28:31], a[252:255], v[172:175], a[28:31]
    s_lshl_b32 s27, s18, 11
    ds_read_b64_tr_b16 a[190:191], v29 offset:30720
    s_waitcnt vmcnt(0)
    s_mov_b32 s41, 0
    s_branch AT_POLLCX_CHK
AT_POLLCX:
    buffer_load_dword v42, v44, s[8:11], s39 offen sc1
    s_waitcnt vmcnt(0)
AT_POLLCX_CHK:
    v_readfirstlane_b32 s40, v42
    s_nop 0
    s_cmp_ge_u32 s40, 1
    s_cbranch_scc1 AT_POLLCX_OK
    s_add_u32 s41, s41, 1
    s_cmp_ge_u32 s41, 0x40000
    s_cbranch_scc1 AT_POLLCX_OK
    s_sleep 2
    s_branch AT_POLLCX
AT_POLLCX_OK:
    v_mfma_f32_16x16x32_bf16 a[32:35], a[128:131], v[112:115], 0
    s_add_u32 s38, s37, 0
    buffer_load_dwordx4 v[48:51], v2, s[8:11], s38 offen sc1
    v_mfma_f32_16x16x32_bf16 a[40:43], a[128:131], v[144:147], 0
    ds_read_b64_tr_b16 a[192:193], v30 offset:0
    ds_read_b64_tr_b16 a[194:195], v30 offset:2048
    v_mfma_f32_16x16x32_bf16 a[32:35], a[132:135], v[116:119], a[32:35]
    s_add_u32 s38, s37, 8192
    buffer_load_dwordx4 v[80:83], v2, s[8:11], s38 offen sc1
    v_mfma_f32_16x16x32_bf16 a[40:43], a[132:135], v[148:151], a[40:43]
    ds_read_b64_tr_b16 a[196:197], v30 offset:4096
    ds_read_b64_tr_b16 a[198:199], v30 offset:6144
    v_mfma_f32_16x16x32_bf16 a[32:35], a[136:139], v[120:123], a[32:35]
    s_add_u32 s38, s37, 1024
    buffer_load_dwordx4 v[52:55], v2, s[8:11], s38 offen sc1
    v_mfma_f32_16x16x32_bf16 a[40:43], a[136:139], v[152:155], a[40:43]
    ds_read_b64_tr_b16 a[200:201], v30 offset:8192
    ds_read_b64_tr_b16 a[202:203], v30 offset:10240
    v_mfma_f32_16x16x32_bf16 a[32:35], a[140:143], v[124:127], a[32:35]
    s_add_u32 s38, s37, 9216
    buffer_load_dwordx4 v[84:87], v2, s[8:11], s38 offen sc1
    v_mfma_f32_16x16x32_bf16 a[40:43], a[140:143], v[156:159], a[40:43]
    ds_read_b64_tr_b16 a[204:205], v30 offset:12288
    ds_read_b64_tr_b16 a[206:207], v30 offset:14336
    v_mfma_f32_16x16x32_bf16 a[32:35], a[144:147], v[128:131], a[32:35]
    s_add_u32 s38, s37, 2048
    buffer_load_dwordx4 v[56:59], v2, s[8:11], s38 offen sc1
    v_mfma_f32_16x16x32_bf16 a[40:43], a[144:147], v[160:163], a[40:43]
    ds_read_b64_tr_b16 a[208:209], v30 offset:16384
    ds_read_b64_tr_b16 a[210:211], v30 offset:18432
    v_mfma_f32_16x16x32_bf16 a[32:35], a[148:151], v[132:135], a[32:35]
    s_add_u32 s38, s37, 10240
    buffer_load_dwordx4 v[88:91], v2, s[8:11], s38 offen sc1
    v_mfma_f32_16x16x32_bf16 a[40:43], a[148:151], v[164:167], a[40:43]
    ds_read_b64_tr_b16 a[212:213], v30 offset:20480
    ds_read_b64_tr_b16 a[214:215], v30 offset:22528
    v_mfma_f32_16x16x32_bf16 a[32:35], a[152:155], v[136:139], a[32:35]
    s_waitcnt lgkmcnt(8)
    ds_read_b64_tr_b16 a[216:217], v30 offset:24576
    ds_read_b64_tr_b16 a[218:219], v30 offset:26624
    v_mfma_f32_16x16x32_bf16 a[40:43], a[152:155], v[168:171], a[40:43]
    s_add_u32 s38, s37, 3072
    buffer_load_dwordx4 v[60:63], v2, s[8:11], s38 offen sc1
    v_mfma_f32_16x16x32_bf16 a[32:35], a[156:159], v[140:143], a[32:35]
    ds_read_b64_tr_b16 a[220:221], v30 offset:28672
    ds_read_b64_tr_b16 a[222:223], v30 offset:30720
    v_mfma_f32_16x16x32_bf16 a[40:43], a[156:159], v[172:175], a[40:43]
    s_add_u32 s38, s37, 11264
    buffer_load_dwordx4 v[92:95], v2, s[8:11], s38 offen sc1
    v_mfma_f32_16x16x32_bf16 a[36:39], a[160:163], v[112:115], 0
    ds_read_b64_tr_b16 a[224:225], v31 offset:0
    ds_read_b64_tr_b16 a[226:227], v31 offset:2048
    v_mfma_f32_16x16x32_bf16 a[44:47], a[160:163], v[144:147], 0
    s_add_u32 s38, s37, 4096
    buffer_load_dwordx4 v[64:67], v2, s[8:11], s38 offen sc1
    v_mfma_f32_16x16x32_bf16 a[36:39], a[164:167], v[116:119], a[36:39]
    ds_read_b64_tr_b16 a[228:229], v31 offset:4096
    ds_read_b64_tr_b16 a[230:231], v31 offset:6144
    v_mfma_f32_16x16x32_bf16 a[44:47], a[164:167], v[148:151], a[44:47]
    s_add_u32 s38, s37, 12288
    buffer_load_dwordx4 v[96:99], v2, s[8:11], s38 offen sc1
    v_mfma_f32_16x16x32_bf16 a[36:39], a[168:171], v[120:123], a[36:39]
    ds_read_b64_tr_b16 a[232:233], v31 offset:8192
    ds_read_b64_tr_b16 a[234:235], v31 offset:10240
    v_mfma_f32_16x16x32_bf16 a[44:47], a[168:171], v[152:155], a[44:47]
    s_add_u32 s38, s37, 5120
    buffer_load_dwordx4 v[68:71], v2, s[8:11], s38 offen sc1
    v_mfma_f32_16x16x32_bf16 a[36:39], a[172:175], v[124:127], a[36:39]
    ds_read_b64_tr_b16 a[236:237], v31 offset:12288
    ds_read_b64_tr_b16 a[238:239], v31 offset:14336
    v_mfma_f32_16x16x32_bf16 a[44:47], a[172:175], v[156:159], a[44:47]
    s_add_u32 s38, s37, 13312
    buffer_load_dwordx4 v[100:103], v2, s[8:11], s38 offen sc1
    v_mfma_f32_16x16x32_bf16 a[36:39], a[176:179], v[128:131], a[36:39]
    s_add_u32 s25, s25, 0x8000
    ds_read_b64_tr_b16 a[240:241], v31 offset:16384
    ds_read_b64_tr_b16 a[242:243], v31 offset:18432
    v_mfma_f32_16x16x32_bf16 a[44:47], a[176:179], v[160:163], a[44:47]
    s_add_u32 s38, s37, 6144
    buffer_load_dwordx4 v[72:75], v2, s[8:11], s38 offen sc1
    v_mfma_f32_16x16x32_bf16 a[36:39], a[180:183], v[132:135], a[36:39]
    s_add_u32 s38, s37, 14336
    buffer_load_dwordx4 v[104:107], v2, s[8:11], s38 offen sc1
    v_mfma_f32_16x16x32_bf16 a[44:47], a[180:183], v[164:167], a[44:47]
    s_cmp_ge_u32 s25, 0x28000
    ds_read_b64_tr_b16 a[244:245], v31 offset:20480
    ds_read_b64_tr_b16 a[246:247], v31 offset:22528
    v_mfma_f32_16x16x32_bf16 a[36:39], a[184:187], v[136:139], a[36:39]
    s_cselect_b32 s25, 0, s25
    ds_read_b64_tr_b16 a[248:249], v31 offset:24576
    ds_read_b64_tr_b16 a[250:251], v31 offset:26624
    v_mfma_f32_16x16x32_bf16 a[44:47], a[184:187], v[168:171], a[44:47]
    s_add_u32 s38, s37, 7168
    buffer_load_dwordx4 v[76:79], v2, s[8:11], s38 offen sc1
    v_mfma_f32_16x16x32_bf16 a[36:39], a[188:191], v[140:143], a[36:39]
    s_add_u32 s38, s37, 15360
    buffer_load_dwordx4 v[108:111], v2, s[8:11], s38 offen sc1
    v_mfma_f32_16x16x32_bf16 a[44:47], a[188:191], v[172:175], a[44:47]
    ds_read_b64_tr_b16 a[252:253], v31 offset:28672
    ds_read_b64_tr_b16 a[254:255], v31 offset:30720
    s_waitcnt lgkmcnt(8)
    s_barrier
    v_mfma_f32_16x16x32_bf16 a[48:51], a[192:195], v[112:115], 0
    v_add_u32 v28, s25, v24
    v_add_u32 v29, s25, v25
    v_mfma_f32_16x16x32_bf16 a[56:59], a[192:195], v[144:147], 0
    s_add_u32 m0, s24, 0
    ds_read_b64_tr_b16 a[128:129], v28 offset:0
    ds_read_b64_tr_b16 a[130:131], v28 offset:2048
    v_add_u32 v30, s25, v26
    v_mfma_f32_16x16x32_bf16 a[48:51], a[196:199], v[116:119], a[48:51]
    buffer_load_dwordx4 v6, s[4:7], s21 offen sc1 lds
    v_add_u32 v31, s25, v27
    v_mfma_f32_16x16x32_bf16 a[56:59], a[196:199], v[148:151], a[56:59]
    ds_read_b64_tr_b16 a[132:133], v28 offset:4096
    v_mfma_f32_16x16x32_bf16 a[48:51], a[200:203], v[120:123], a[48:51]
    ds_read_b64_tr_b16 a[134:135], v28 offset:6144
    ds_read_b64_tr_b16 a[136:137], v28 offset:8192
    v_mfma_f32_16x16x32_bf16 a[56:59], a[200:203], v[152:155], a[56:59]
    s_add_u32 m0, s24, 4096
    ds_read_b64_tr_b16 a[138:139], v28 offset:10240
    v_mfma_f32_16x16x32_bf16 a[48:51], a[204:207], v[124:127], a[48:51]
    buffer_load_dwordx4 v7, s[4:7], s21 offen sc1 lds
    v_mfma_f32_16x16x32_bf16 a[56:59], a[204:207], v[156:159], a[56:59]
    ds_read_b64_tr_b16 a[140:141], v28 offset:12288
    v_mfma_f32_16x16x32_bf16 a[48:51], a[208:211], v[128:131], a[48:51]
    ds_read_b64_tr_b16 a[142:143], v28 offset:14336
    ds_read_b64_tr_b16 a[144:145], v28 offset:16384
    v_mfma_f32_16x16x32_bf16 a[56:59], a[208:211], v[160:163], a[56:59]
    s_add_u32 m0, s24, 8192
    ds_read_b64_tr_b16 a[146:147], v28 offset:18432
    v_mfma_f32_16x16x32_bf16 a[48:51], a[212:215], v[132:135], a[48:51]
    buffer_load_dwordx4 v8, s[4:7], s21 offen sc1 lds
    v_mfma_f32_16x16x32_bf16 a[56:59], a[212:215], v[164:167], a[56:59]
    ds_read_b64_tr_b16 a[148:149], v28 offset:20480
    ds_read_b64_tr_b16 a[150:151], v28 offset:22528
    v_mfma_f32_16x16x32_bf16 a[48:51], a[216:219], v[136:139], a[48:51]
    s_waitcnt lgkmcnt(8)
    ds_read_b64_tr_b16 a[152:153], v28 offset:24576
    v_mfma_f32_16x16x32_bf16 a[56:59], a[216:219], v[168:171], a[56:59]
    s_add_u32 m0, s24, 12288
    ds_read_b64_tr_b16 a[154:155], v28 offset:26624
    v_mfma_f32_16x16x32_bf16 a[48:51], a[220:223], v[140:143], a[48:51]
    buffer_load_dwordx4 v9, s[4:7], s21 offen sc1 lds
    v_mfma_f32_16x16x32_bf16 a[56:59], a[220:223], v[172:175], a[56:59]
    ds_read_b64_tr_b16 a[156:157], v28 offset:28672
    ds_read_b64_tr_b16 a[158:159], v28 offset:30720
    v_mfma_f32_16x16x32_bf16 a[52:55], a[224:227], v[112:115], 0
    ds_read_b64_tr_b16 a[160:161], v29 offset:0
    v_mfma_f32_16x16x32_bf16 a[60:63], a[224:227], v[144:147], 0
    s_add_u32 m0, s24, 16384
    ds_read_b64_tr_b16 a[162:163], v29 offset:2048
    ds_read_b64_tr_b16 a[164:165], v29 offset:4096
    v_mfma_f32_16x16x32_bf16 a[52:55], a[228:231], v[116:119], a[52:55]
    buffer_load_dwordx4 v10, s[4:7], s21 offen sc1 lds
    v_mfma_f32_16x16x32_bf16 a[60:63], a[228:231], v[148:151], a[60:63]
    ds_read_b64_tr_b16 a[166:167], v29 offset:6144
    v_mfma_f32_16x16x32_bf16 a[52:55], a[232:235], v[120:123], a[52:55]
    ds_read_b64_tr_b16 a[168:169], v29 offset:8192
    v_mfma_f32_16x16x32_bf16 a[60:63], a[232:235], v[152:155], a[60:63]
    s_add_u32 m0, s24, 20480
    ds_read_b64_tr_b16 a[170:171], v29 offset:10240
    ds_read_b64_tr_b16 a[172:173], v29 offset:12288
    v_mfma_f32_16x16x32_bf16 a[52:55], a[236:239], v[124:127], a[52:55]
    buffer_load_dwordx4 v11, s[4:7], s21 offen sc1 lds
    v_mfma_f32_16x16x32_bf16 a[60:63], a[236:239], v[156:159], a[60:63]
    ds_read_b64_tr_b16 a[174:175], v29 offset:14336
    v_mfma_f32_16x16x32_bf16 a[52:55], a[240:243], v[128:131], a[52:55]
    ds_read_b64_tr_b16 a[176:177], v29 offset:16384
    ds_read_b64_tr_b16 a[178:179], v29 offset:18432
    v_mfma_f32_16x16x32_bf16 a[60:63], a[240:243], v[160:163], a[60:63]
    s_add_u32 m0, s24, 24576
    ds_read_b64_tr_b16 a[180:181], v29 offset:20480
    v_mfma_f32_16x16x32_bf16 a[52:55], a[244:247], v[132:135], a[52:55]
    s_waitcnt lgkmcnt(8)
    buffer_load_dwordx4 v12, s[4:7], s21 offen sc1 lds
    v_mfma_f32_16x16x32_bf16 a[60:63], a[244:247], v[164:167], a[60:63]
    ds_read_b64_tr_b16 a[182:183], v29 offset:22528
    v_mfma_f32_16x16x32_bf16 a[52:55], a[248:251], v[136:139], a[52:55]
    ds_read_b64_tr_b16 a[184:185], v29 offset:24576
    ds_read_b64_tr_b16 a[186:187], v29 offset:26624
    v_mfma_f32_16x16x32_bf16 a[60:63], a[248:251], v[168:171], a[60:63]
    s_add_u32 m0, s24, 28672
    ds_read_b64_tr_b16 a[188:189], v29 offset:28672
    v_mfma_f32_16x16x32_bf16 a[52:55], a[252:255], v[140:143], a[52:55]
    buffer_load_dwordx4 v13, s[4:7], s21 offen sc1 lds
    v_mfma_f32_16x16x32_bf16 a[60:63], a[252:255], v[172:175], a[60:63]
    s_add_u32 s21, s21, s22
    s_add_u32 s24, s24, 0x8000
    s_cmp_ge_u32 s24, 0x28000
    s_cselect_b32 s24, s49, s24
    ds_read_b64_tr_b16 a[190:191], v29 offset:30720
    v_mfma_f32_16x16x32_bf16 a[64:67], a[128:131], v[112:115], 0
    s_add_u32 s3, s3, s27
    ds_read_b64_tr_b16 a[192:193], v30 offset:0
    ds_read_b64_tr_b16 a[194:195], v30 offset:2048
    v_mfma_f32_16x16x32_bf16 a[72:75], a[128:131], v[144:147], 0
    s_add_u32 m0, s24, 0
    ds_read_b64_tr_b16 a[196:197], v30 offset:4096
    v_add_u32 v19, s3, v19
    v_mfma_f32_16x16x32_bf16 a[64:67], a[132:135], v[116:119], a[64:67]
    s_lshl_b32 s3, s18, 8
    buffer_load_dwordx4 v6, s[4:7], s21 offen sc1 lds
    v_mfma_f32_16x16x32_bf16 a[72:75], a[132:135], v[148:151], a[72:75]
    ds_read_b64_tr_b16 a[198:199], v30 offset:6144
    v_add_u32 v21, s3, v21
    v_mfma_f32_16x16x32_bf16 a[64:67], a[136:139], v[120:123], a[64:67]
    s_lshl_b32 s3, s28, 3
    ds_read_b64_tr_b16 a[200:201], v30 offset:8192
    ds_read_b64_tr_b16 a[202:203], v30 offset:10240
    v_mfma_f32_16x16x32_bf16 a[72:75], a[136:139], v[152:155], a[72:75]
    s_add_u32 m0, s24, 4096
    ds_read_b64_tr_b16 a[204:205], v30 offset:12288
    v_add_u32 v20, s3, v16
    v_mfma_f32_16x16x32_bf16 a[64:67], a[140:143], v[124:127], a[64:67]
    s_add_u32 s28, s18, 1
    buffer_load_dwordx4 v7, s[4:7], s21 offen sc1 lds
    v_mfma_f32_16x16x32_bf16 a[72:75], a[140:143], v[156:159], a[72:75]
    ds_read_b64_tr_b16 a[206:207], v30 offset:14336
    v_mul_u32_u24 v20, 896, v20
    v_mfma_f32_16x16x32_bf16 a[64:67], a[144:147], v[128:131], a[64:67]
    s_lshr_b32 s28, s28, 2
    ds_read_b64_tr_b16 a[208:209], v30 offset:16384
    ds_read_b64_tr_b16 a[210:211], v30 offset:18432
    v_mfma_f32_16x16x32_bf16 a[72:75], a[144:147], v[160:163], a[72:75]
    s_add_u32 m0, s24, 8192
    ds_read_b64_tr_b16 a[212:213], v30 offset:20480
    v_lshrrev_b32 v23, 1, v21
    v_mfma_f32_16x16x32_bf16 a[64:67], a[148:151], v[132:135], a[64:67]
    s_sub_u32 s29, s28, 1
    buffer_load_dwordx4 v8, s[4:7], s21 offen sc1 lds
    v_mfma_f32_16x16x32_bf16 a[72:75], a[148:151], v[164:167], a[72:75]
    ds_read_b64_tr_b16 a[214:215], v30 offset:22528
    v_add_u32 v20, v20, v23
    v_mfma_f32_16x16x32_bf16 a[64:67], a[152:155], v[136:139], a[64:67]
    s_waitcnt lgkmcnt(8)
    ds_read_b64_tr_b16 a[216:217], v30 offset:24576
    ds_read_b64_tr_b16 a[218:219], v30 offset:26624
    v_mfma_f32_16x16x32_bf16 a[72:75], a[152:155], v[168:171], a[72:75]
    s_add_u32 m0, s24, 12288
    ds_read_b64_tr_b16 a[220:221], v30 offset:28672
    v_mfma_f32_16x16x32_bf16 a[64:67], a[156:159], v[140:143], a[64:67]
    s_and_b32 s29, s29, 0x3f800000
    buffer_load_dwordx4 v9, s[4:7], s21 offen sc1 lds
    v_mfma_f32_16x16x32_bf16 a[72:75], a[156:159], v[172:175], a[72:75]
    s_mul_i32 s28, s28, 0x70000000
    ds_read_b64_tr_b16 a[222:223], v30 offset:30720
    v_add_u32 v22, s28, v19
    v_mfma_f32_16x16x32_bf16 a[68:71], a[160:163], v[112:115], 0
    s_mov_b32 s12, s50
    ds_read_b64_tr_b16 a[224:225], v31 offset:0
    ds_read_b64_tr_b16 a[226:227], v31 offset:2048
    v_mfma_f32_16x16x32_bf16 a[76:79], a[160:163], v[144:147], 0
    s_add_u32 m0, s24, 16384
    ds_read_b64_tr_b16 a[228:229], v31 offset:4096
    v_add_u32 v22, 8192, v22
    v_mfma_f32_16x16x32_bf16 a[68:71], a[164:167], v[116:119], a[68:71]
    s_and_b32 s13, s51, 0xffff
    buffer_load_dwordx4 v10, s[4:7], s21 offen sc1 lds
    v_mfma_f32_16x16x32_bf16 a[76:79], a[164:167], v[148:151], a[76:79]
    ds_read_b64_tr_b16 a[230:231], v31 offset:6144
    v_add_u32 v23, s28, v20
    v_mfma_f32_16x16x32_bf16 a[68:71], a[168:171], v[120:123], a[68:71]
    s_mov_b32 s14, 0x1c0000
    ds_read_b64_tr_b16 a[232:233], v31 offset:8192
    ds_read_b64_tr_b16 a[234:235], v31 offset:10240
    v_mfma_f32_16x16x32_bf16 a[76:79], a[168:171], v[152:155], a[76:79]
    s_add_u32 m0, s24, 20480
    ds_read_b64_tr_b16 a[236:237], v31 offset:12288
    v_mfma_f32_16x16x32_bf16 a[68:71], a[172:175], v[124:127], a[68:71]
    buffer_load_dwordx4 v11, s[4:7], s21 offen sc1 lds
    v_mfma_f32_16x16x32_bf16 a[76:79], a[172:175], v[156:159], a[76:79]
    ds_read_b64_tr_b16 a[238:239], v31 offset:14336
    v_mfma_f32_16x16x32_bf16 a[68:71], a[176:179], v[128:131], a[68:71]
    s_add_u32 s25, s25, 0x8000
    ds_read_b64_tr_b16 a[240:241], v31 offset:16384
    ds_read_b64_tr_b16 a[242:243], v31 offset:18432
    v_mfma_f32_16x16x32_bf16 a[76:79], a[176:179], v[160:163], a[76:79]
    s_add_u32 m0, s24, 24576
    ds_read_b64_tr_b16 a[244:245], v31 offset:20480
    v_mfma_f32_16x16x32_bf16 a[68:71], a[180:183], v[132:135], a[68:71]
    buffer_load_dwordx4 v12, s[4:7], s21 offen sc1 lds
    v_mfma_f32_16x16x32_bf16 a[76:79], a[180:183], v[164:167], a[76:79]
    s_cmp_ge_u32 s25, 0x28000
    ds_read_b64_tr_b16 a[246:247], v31 offset:22528
    v_mfma_f32_16x16x32_bf16 a[68:71], a[184:187], v[136:139], a[68:71]
    s_cselect_b32 s25, 0, s25
    ds_read_b64_tr_b16 a[248:249], v31 offset:24576
    ds_read_b64_tr_b16 a[250:251], v31 offset:26624
    v_mfma_f32_16x16x32_bf16 a[76:79], a[184:187], v[168:171], a[76:79]
    s_add_u32 m0, s24, 28672
    ds_read_b64_tr_b16 a[252:253], v31 offset:28672
    v_mfma_f32_16x16x32_bf16 a[68:71], a[188:191], v[140:143], a[68:71]
    buffer_load_dwordx4 v13, s[4:7], s21 offen sc1 lds
    v_mfma_f32_16x16x32_bf16 a[76:79], a[188:191], v[172:175], a[76:79]
    ds_read_b64_tr_b16 a[254:255], v31 offset:30720
    s_waitcnt lgkmcnt(8)
    s_barrier
    v_mfma_f32_16x16x32_bf16 a[80:83], a[192:195], v[112:115], 0
    v_add_u32 v28, s25, v24
    v_add_u32 v29, s25, v25
    v_mfma_f32_16x16x32_bf16 a[88:91], a[192:195], v[144:147], 0
    ds_read_b64_tr_b16 a[128:129], v28 offset:0
    ds_read_b64_tr_b16 a[130:131], v28 offset:2048
    v_add_u32 v30, s25, v26
    v_mfma_f32_16x16x32_bf16 a[80:83], a[196:199], v[116:119], a[80:83]
    ds_read_b64_tr_b16 a[132:133], v28 offset:4096
    v_add_u32 v31, s25, v27
    v_mfma_f32_16x16x32_bf16 a[88:91], a[196:199], v[148:151], a[88:91]
    s_add_u32 s21, s21, s22
    ds_read_b64_tr_b16 a[134:135], v28 offset:6144
    v_mfma_f32_16x16x32_bf16 a[80:83], a[200:203], v[120:123], a[80:83]
    s_add_u32 s24, s24, 0x8000
    ds_read_b64_tr_b16 a[136:137], v28 offset:8192
    v_mfma_f32_16x16x32_bf16 a[88:91], a[200:203], v[152:155], a[88:91]
    ds_read_b64_tr_b16 a[138:139], v28 offset:10240
    v_mfma_f32_16x16x32_bf16 a[80:83], a[204:207], v[124:127], a[80:83]
    ds_read_b64_tr_b16 a[140:141], v28 offset:12288
    v_mfma_f32_16x16x32_bf16 a[88:91], a[204:207], v[156:159], a[88:91]
    s_cmp_ge_u32 s24, 0x28000
    ds_read_b64_tr_b16 a[142:143], v28 offset:14336
    v_mfma_f32_16x16x32_bf16 a[80:83], a[208:211], v[128:131], a[80:83]
    s_cselect_b32 s24, s49, s24
    ds_read_b64_tr_b16 a[144:145], v28 offset:16384
    v_mfma_f32_16x16x32_bf16 a[88:91], a[208:211], v[160:163], a[88:91]
    s_lshl_b32 s16, s26, 3
    ds_read_b64_tr_b16 a[146:147], v28 offset:18432
    v_lshrrev_b32 v240, 4, v0
    v_mfma_f32_16x16x32_bf16 a[80:83], a[212:215], v[132:135], a[80:83]
    s_lshl_b32 s3, s18, 1
    ds_read_b64_tr_b16 a[148:149], v28 offset:20480
    v_and_b32 v241, 7, v240
    v_mfma_f32_16x16x32_bf16 a[88:91], a[212:215], v[164:167], a[88:91]
    s_add_u32 s16, s16, s3
    ds_read_b64_tr_b16 a[150:151], v28 offset:22528
    v_lshlrev_b32 v241, 1, v241
    v_mfma_f32_16x16x32_bf16 a[80:83], a[216:219], v[136:139], a[80:83]
    s_waitcnt lgkmcnt(8)
    ds_read_b64_tr_b16 a[152:153], v28 offset:24576
    v_mfma_f32_16x16x32_bf16 a[88:91], a[216:219], v[168:171], a[88:91]
    s_mul_i32 s16, s16, 14336
    ds_read_b64_tr_b16 a[154:155], v28 offset:26624
    v_and_b32 v242, 15, v1
    v_mfma_f32_16x16x32_bf16 a[80:83], a[220:223], v[140:143], a[80:83]
    s_lshr_b32 s3, s19, 1
    ds_read_b64_tr_b16 a[156:157], v28 offset:28672
    v_xor_b32 v241, v241, v242
    v_mfma_f32_16x16x32_bf16 a[88:91], a[220:223], v[172:175], a[88:91]
    s_mul_i32 s3, s3, 0x1c0000
    ds_read_b64_tr_b16 a[158:159], v28 offset:30720
    v_lshlrev_b32 v241, 4, v241
    v_mfma_f32_16x16x32_bf16 a[84:87], a[224:227], v[112:115], 0
    s_add_u32 s16, s16, s3
    ds_read_b64_tr_b16 a[160:161], v29 offset:0
    v_mul_u32_u24 v240, 3584, v240
    v_mfma_f32_16x16x32_bf16 a[92:95], a[224:227], v[144:147], 0
    s_add_u32 s16, s16, 0x5000000
    ds_read_b64_tr_b16 a[162:163], v29 offset:2048
    v_add_u32 v4, v240, v241
    v_mfma_f32_16x16x32_bf16 a[84:87], a[228:231], v[116:119], a[84:87]
    s_and_b32 s3, s19, 1
    ds_read_b64_tr_b16 a[164:165], v29 offset:4096
    v_mfma_f32_16x16x32_bf16 a[92:95], a[228:231], v[148:151], a[92:95]
    s_lshl_b32 s3, s3, 10
    ds_read_b64_tr_b16 a[166:167], v29 offset:6144
    v_mfma_f32_16x16x32_bf16 a[84:87], a[232:235], v[120:123], a[84:87]
    s_add_u32 s17, s16, s3
    ds_read_b64_tr_b16 a[168:169], v29 offset:8192
    v_mfma_f32_16x16x32_bf16 a[92:95], a[232:235], v[152:155], a[92:95]
    s_add_u32 s17, s17, 6144
    ds_read_b64_tr_b16 a[170:171], v29 offset:10240
    v_mfma_f32_16x16x32_bf16 a[84:87], a[236:239], v[124:127], a[84:87]
    s_lshl_b32 s3, s3, 3
    ds_read_b64_tr_b16 a[172:173], v29 offset:12288
    v_mfma_f32_16x16x32_bf16 a[92:95], a[236:239], v[156:159], a[92:95]
    s_add_u32 s16, s16, s3
    ds_read_b64_tr_b16 a[174:175], v29 offset:14336
    v_mfma_f32_16x16x32_bf16 a[84:87], a[240:243], v[128:131], a[84:87]
    ds_read_b64_tr_b16 a[176:177], v29 offset:16384
    v_mfma_f32_16x16x32_bf16 a[92:95], a[240:243], v[160:163], a[92:95]
    ds_read_b64_tr_b16 a[178:179], v29 offset:18432
    v_mfma_f32_16x16x32_bf16 a[84:87], a[244:247], v[132:135], a[84:87]
    s_waitcnt lgkmcnt(8)
    ds_read_b64_tr_b16 a[180:181], v29 offset:20480
    v_mfma_f32_16x16x32_bf16 a[92:95], a[244:247], v[164:167], a[92:95]
    ds_read_b64_tr_b16 a[182:183], v29 offset:22528
    v_mfma_f32_16x16x32_bf16 a[84:87], a[248:251], v[136:139], a[84:87]
    ds_read_b64_tr_b16 a[184:185], v29 offset:24576
    v_mfma_f32_16x16x32_bf16 a[92:95], a[248:251], v[168:171], a[92:95]
    ds_read_b64_tr_b16 a[186:187], v29 offset:26624
    v_mfma_f32_16x16x32_bf16 a[84:87], a[252:255], v[140:143], a[84:87]
    ds_read_b64_tr_b16 a[188:189], v29 offset:28672
    v_mfma_f32_16x16x32_bf16 a[92:95], a[252:255], v[172:175], a[92:95]
    ds_read_b64_tr_b16 a[190:191], v29 offset:30720
    v_mfma_f32_16x16x32_bf16 a[96:99], a[128:131], v[112:115], 0
    ds_read_b64_tr_b16 a[192:193], v30 offset:0
    ds_read_b64_tr_b16 a[194:195], v30 offset:2048
    v_mfma_f32_16x16x32_bf16 a[104:107], a[128:131], v[144:147], 0
    s_add_u32 m0, s24, 0
    ds_read_b64_tr_b16 a[196:197], v30 offset:4096
    v_mfma_f32_16x16x32_bf16 a[96:99], a[132:135], v[116:119], a[96:99]
    buffer_load_dwordx4 v6, s[4:7], s21 offen sc1 lds
    v_mfma_f32_16x16x32_bf16 a[104:107], a[132:135], v[148:151], a[104:107]
    ds_read_b64_tr_b16 a[198:199], v30 offset:6144
    v_mfma_f32_16x16x32_bf16 a[96:99], a[136:139], v[120:123], a[96:99]
    ds_read_b64_tr_b16 a[200:201], v30 offset:8192
    ds_read_b64_tr_b16 a[202:203], v30 offset:10240
    v_mfma_f32_16x16x32_bf16 a[104:107], a[136:139], v[152:155], a[104:107]
    s_add_u32 m0, s24, 4096
    ds_read_b64_tr_b16 a[204:205], v30 offset:12288
    v_mfma_f32_16x16x32_bf16 a[96:99], a[140:143], v[124:127], a[96:99]
    buffer_load_dwordx4 v7, s[4:7], s21 offen sc1 lds
    v_mfma_f32_16x16x32_bf16 a[104:107], a[140:143], v[156:159], a[104:107]
    ds_read_b64_tr_b16 a[206:207], v30 offset:14336
    v_mfma_f32_16x16x32_bf16 a[96:99], a[144:147], v[128:131], a[96:99]
    ds_read_b64_tr_b16 a[208:209], v30 offset:16384
    ds_read_b64_tr_b16 a[210:211], v30 offset:18432
    v_mfma_f32_16x16x32_bf16 a[104:107], a[144:147], v[160:163], a[104:107]
    s_add_u32 m0, s24, 8192
    ds_read_b64_tr_b16 a[212:213], v30 offset:20480
    v_mfma_f32_16x16x32_bf16 a[96:99], a[148:151], v[132:135], a[96:99]
    buffer_load_dwordx4 v8, s[4:7], s21 offen sc1 lds
    v_mfma_f32_16x16x32_bf16 a[104:107], a[148:151], v[164:167], a[104:107]
    ds_read_b64_tr_b16 a[214:215], v30 offset:22528
    v_mfma_f32_16x16x32_bf16 a[96:99], a[152:155], v[136:139], a[96:99]
    s_waitcnt lgkmcnt(8)
    ds_read_b64_tr_b16 a[216:217], v30 offset:24576
    ds_read_b64_tr_b16 a[218:219], v30 offset:26624
    v_mfma_f32_16x16x32_bf16 a[104:107], a[152:155], v[168:171], a[104:107]
    s_add_u32 m0, s24, 12288
    ds_read_b64_tr_b16 a[220:221], v30 offset:28672
    v_mfma_f32_16x16x32_bf16 a[96:99], a[156:159], v[140:143], a[96:99]
    buffer_load_dwordx4 v9, s[4:7], s21 offen sc1 lds
    v_mfma_f32_16x16x32_bf16 a[104:107], a[156:159], v[172:175], a[104:107]
    ds_read_b64_tr_b16 a[222:223], v30 offset:30720
    v_mfma_f32_16x16x32_bf16 a[100:103], a[160:163], v[112:115], 0
    ds_read_b64_tr_b16 a[224:225], v31 offset:0
    ds_read_b64_tr_b16 a[226:227], v31 offset:2048
    v_mfma_f32_16x16x32_bf16 a[108:111], a[160:163], v[144:147], 0
    s_add_u32 m0, s24, 16384
    ds_read_b64_tr_b16 a[228:229], v31 offset:4096
    v_mfma_f32_16x16x32_bf16 a[100:103], a[164:167], v[116:119], a[100:103]
    buffer_load_dwordx4 v10, s[4:7], s21 offen sc1 lds
    v_mfma_f32_16x16x32_bf16 a[108:111], a[164:167], v[148:151], a[108:111]
    ds_read_b64_tr_b16 a[230:231], v31 offset:6144
    v_mfma_f32_16x16x32_bf16 a[100:103], a[168:171], v[120:123], a[100:103]
    ds_read_b64_tr_b16 a[232:233], v31 offset:8192
    ds_read_b64_tr_b16 a[234:235], v31 offset:10240
    v_mfma_f32_16x16x32_bf16 a[108:111], a[168:171], v[152:155], a[108:111]
    s_add_u32 m0, s24, 20480
    ds_read_b64_tr_b16 a[236:237], v31 offset:12288
    v_mfma_f32_16x16x32_bf16 a[100:103], a[172:175], v[124:127], a[100:103]
    buffer_load_dwordx4 v11, s[4:7], s21 offen sc1 lds
    v_mfma_f32_16x16x32_bf16 a[108:111], a[172:175], v[156:159], a[108:111]
    ds_read_b64_tr_b16 a[238:239], v31 offset:14336
    v_mfma_f32_16x16x32_bf16 a[100:103], a[176:179], v[128:131], a[100:103]
    s_add_u32 s25, s25, 0x8000
    ds_read_b64_tr_b16 a[240:241], v31 offset:16384
    ds_read_b64_tr_b16 a[242:243], v31 offset:18432
    v_mfma_f32_16x16x32_bf16 a[108:111], a[176:179], v[160:163], a[108:111]
    s_add_u32 m0, s24, 24576
    ds_read_b64_tr_b16 a[244:245], v31 offset:20480
    v_mfma_f32_16x16x32_bf16 a[100:103], a[180:183], v[132:135], a[100:103]
    buffer_load_dwordx4 v12, s[4:7], s21 offen sc1 lds
    v_mfma_f32_16x16x32_bf16 a[108:111], a[180:183], v[164:167], a[108:111]
    s_cmp_ge_u32 s25, 0x28000
    ds_read_b64_tr_b16 a[246:247], v31 offset:22528
    v_mfma_f32_16x16x32_bf16 a[100:103], a[184:187], v[136:139], a[100:103]
    s_cselect_b32 s25, 0, s25
    ds_read_b64_tr_b16 a[248:249], v31 offset:24576
    ds_read_b64_tr_b16 a[250:251], v31 offset:26624
    v_mfma_f32_16x16x32_bf16 a[108:111], a[184:187], v[168:171], a[108:111]
    s_add_u32 m0, s24, 28672
    ds_read_b64_tr_b16 a[252:253], v31 offset:28672
    v_mfma_f32_16x16x32_bf16 a[100:103], a[188:191], v[140:143], a[100:103]
    buffer_load_dwordx4 v13, s[4:7], s21 offen sc1 lds
    v_mfma_f32_16x16x32_bf16 a[108:111], a[188:191], v[172:175], a[108:111]
    ds_read_b64_tr_b16 a[254:255], v31 offset:30720
    s_waitcnt vmcnt(16) lgkmcnt(8)
    s_barrier
    v_mfma_f32_16x16x32_bf16 a[96:99], a[192:195], v[48:51], a[96:99]
    v_add_u32 v28, s25, v24
    v_add_u32 v29, s25, v25
    v_mfma_f32_16x16x32_bf16 a[104:107], a[192:195], v[80:83], a[104:107]
    ds_read_b64_tr_b16 a[128:129], v28 offset:0
    ds_read_b64_tr_b16 a[130:131], v28 offset:2048
    v_add_u32 v30, s25, v26
    v_mfma_f32_16x16x32_bf16 a[96:99], a[196:199], v[52:55], a[96:99]
    ds_read_b64_tr_b16 a[132:133], v28 offset:4096
    v_add_u32 v31, s25, v27
    v_mfma_f32_16x16x32_bf16 a[104:107], a[196:199], v[84:87], a[104:107]
    s_add_u32 s21, s21, s22
    ds_read_b64_tr_b16 a[134:135], v28 offset:6144
    ds_read_b64_tr_b16 a[136:137], v28 offset:8192
    v_mfma_f32_16x16x32_bf16 a[96:99], a[200:203], v[56:59], a[96:99]
    s_add_u32 s24, s24, 0x8000
    ds_read_b64_tr_b16 a[138:139], v28 offset:10240
    v_mfma_f32_16x16x32_bf16 a[104:107], a[200:203], v[88:91], a[104:107]
    buffer_load_dwordx2 v[176:177], v20, s[12:15], 0 offen offset:0
    v_mfma_f32_16x16x32_bf16 a[96:99], a[204:207], v[60:63], a[96:99]
    ds_read_b64_tr_b16 a[140:141], v28 offset:12288
    v_mfma_f32_16x16x32_bf16 a[104:107], a[204:207], v[92:95], a[104:107]
    s_cmp_ge_u32 s24, 0x28000
    ds_read_b64_tr_b16 a[142:143], v28 offset:14336
    ds_read_b64_tr_b16 a[144:145], v28 offset:16384
    v_mfma_f32_16x16x32_bf16 a[96:99], a[208:211], v[64:67], a[96:99]
    s_cselect_b32 s24, s49, s24
    ds_read_b64_tr_b16 a[146:147], v28 offset:18432
    v_mfma_f32_16x16x32_bf16 a[104:107], a[208:211], v[96:99], a[104:107]
    buffer_load_dwordx2 v[178:179], v20, s[12:15], 0 offen offset:32
    v_mfma_f32_16x16x32_bf16 a[96:99], a[212:215], v[68:71], a[96:99]
    s_mov_b32 s4, s56
    ds_read_b64_tr_b16 a[148:149], v28 offset:20480
    ds_read_b64_tr_b16 a[150:151], v28 offset:22528
    v_mov_b32 v6, v4
    v_mfma_f32_16x16x32_bf16 a[104:107], a[212:215], v[100:103], a[104:107]
    s_and_b32 s5, s57, 0xffff
    ds_read_b64_tr_b16 a[152:153], v28 offset:24576
    v_add_u32 v7, 0xe000, v4
    v_mfma_f32_16x16x32_bf16 a[96:99], a[216:219], v[72:75], a[96:99]
    s_waitcnt lgkmcnt(8)
    ds_read_b64_tr_b16 a[154:155], v28 offset:26624
    v_mfma_f32_16x16x32_bf16 a[104:107], a[216:219], v[104:107], a[104:107]
    buffer_load_dwordx2 v[180:181], v23, s[12:15], 0 offen offset:512
    v_mfma_f32_16x16x32_bf16 a[96:99], a[220:223], v[76:79], a[96:99]
    s_mov_b32 s6, 0x188000
    ds_read_b64_tr_b16 a[156:157], v28 offset:28672
    ds_read_b64_tr_b16 a[158:159], v28 offset:30720
    v_add_u32 v8, 0x1c000, v4
    v_mfma_f32_16x16x32_bf16 a[104:107], a[220:223], v[108:111], a[104:107]
    s_mov_b32 s22, 0x70000
    ds_read_b64_tr_b16 a[160:161], v29 offset:0
    v_add_u32 v9, 0x2a000, v4
    v_mfma_f32_16x16x32_bf16 a[100:103], a[224:227], v[48:51], a[100:103]
    buffer_load_dwordx2 v[182:183], v23, s[12:15], 0 offen offset:544
    v_mfma_f32_16x16x32_bf16 a[108:111], a[224:227], v[80:83], a[108:111]
    s_lshl_b32 s21, s48, 8
    ds_read_b64_tr_b16 a[162:163], v29 offset:2048
    ds_read_b64_tr_b16 a[164:165], v29 offset:4096
    v_add_u32 v10, 0x38000, v4
    v_mfma_f32_16x16x32_bf16 a[100:103], a[228:231], v[52:55], a[100:103]
    ds_read_b64_tr_b16 a[166:167], v29 offset:6144
    v_mfma_f32_16x16x32_bf16 a[108:111], a[228:231], v[84:87], a[108:111]
    s_mov_b32 s3, 3584
    buffer_load_dwordx4 v[184:187], v21, s[8:11], s3 offen offset:0 sc1
    v_mfma_f32_16x16x32_bf16 a[100:103], a[232:235], v[56:59], a[100:103]
    s_cmp_lt_u32 s48, 14
    ds_read_b64_tr_b16 a[168:169], v29 offset:8192
    v_add_u32 v11, 0x46000, v4
    v_mfma_f32_16x16x32_bf16 a[108:111], a[232:235], v[88:91], a[108:111]
    s_cselect_b32 s6, s6, 0
    ds_read_b64_tr_b16 a[170:171], v29 offset:10240
    ds_read_b64_tr_b16 a[172:173], v29 offset:12288
    v_add_u32 v12, 0x54000, v4
    v_mfma_f32_16x16x32_bf16 a[100:103], a[236:239], v[60:63], a[100:103]
    s_mov_b32 s3, 3584
    buffer_load_dwordx4 v[188:191], v21, s[8:11], s3 offen offset:64 sc1
    v_mfma_f32_16x16x32_bf16 a[108:111], a[236:239], v[92:95], a[108:111]
    ds_read_b64_tr_b16 a[174:175], v29 offset:14336
    v_add_u32 v13, 0x62000, v4
    v_mfma_f32_16x16x32_bf16 a[100:103], a[240:243], v[64:67], a[100:103]
    ds_read_b64_tr_b16 a[176:177], v29 offset:16384
    ds_read_b64_tr_b16 a[178:179], v29 offset:18432
    v_mfma_f32_16x16x32_bf16 a[108:111], a[240:243], v[96:99], a[108:111]
    s_mov_b32 s3, 3584
    buffer_load_dwordx4 v[192:195], v21, s[8:11], s3 offen offset:1024 sc1
    v_mfma_f32_16x16x32_bf16 a[100:103], a[244:247], v[68:71], a[100:103]
    s_waitcnt lgkmcnt(8)
    ds_read_b64_tr_b16 a[180:181], v29 offset:20480
    v_mfma_f32_16x16x32_bf16 a[108:111], a[244:247], v[100:103], a[108:111]
    ds_read_b64_tr_b16 a[182:183], v29 offset:22528
    v_mfma_f32_16x16x32_bf16 a[100:103], a[248:251], v[72:75], a[100:103]
    s_mov_b32 s3, 3584
    buffer_load_dwordx4 v[196:199], v21, s[8:11], s3 offen offset:1088 sc1
    v_mfma_f32_16x16x32_bf16 a[108:111], a[248:251], v[104:107], a[108:111]
    ds_read_b64_tr_b16 a[184:185], v29 offset:24576
    ds_read_b64_tr_b16 a[186:187], v29 offset:26624
    v_mfma_f32_16x16x32_bf16 a[100:103], a[252:255], v[76:79], a[100:103]
    ds_read_b64_tr_b16 a[188:189], v29 offset:28672
    v_mfma_f32_16x16x32_bf16 a[108:111], a[252:255], v[108:111], a[108:111]
    ds_read_b64_tr_b16 a[190:191], v29 offset:30720
    v_mfma_f32_16x16x32_bf16 a[0:3], a[128:131], v[48:51], a[0:3]
    s_mov_b32 s40, s58
    s_and_b32 s41, s59, 0xffff
    s_mov_b32 s43, 0x20000
    ds_read_b64_tr_b16 a[192:193], v30 offset:0
    ds_read_b64_tr_b16 a[194:195], v30 offset:2048
    v_mfma_f32_16x16x32_bf16 a[8:11], a[128:131], v[80:83], a[8:11]
    s_sub_u32 s42, s20, 6
    s_cmp_lt_u32 s42, 6
    s_cselect_b32 s42, 0x188000, 0
    ds_read_b64_tr_b16 a[196:197], v30 offset:4096
    v_mfma_f32_16x16x32_bf16 a[0:3], a[132:135], v[52:55], a[0:3]
    s_lshl_b32 s44, s36, 2
    s_add_u32 s44, s44, s18
    s_mul_i32 s44, s44, 4224
    v_min_u32 v43, 32, v1
    v_lshlrev_b32 v43, 7, v43
    v_mfma_f32_16x16x32_bf16 a[8:11], a[132:135], v[84:87], a[8:11]
    ds_read_b64_tr_b16 a[198:199], v30 offset:6144
    v_accvgpr_read_b32 v240, a96
    v_mfma_f32_16x16x32_bf16 a[0:3], a[136:139], v[56:59], a[0:3]
    ds_read_b64_tr_b16 a[200:201], v30 offset:8192
    v_accvgpr_read_b32 v241, a97
    v_mfma_f32_16x16x32_bf16 a[8:11], a[136:139], v[88:91], a[8:11]
    ds_read_b64_tr_b16 a[202:203], v30 offset:10240
    v_accvgpr_read_b32 v242, a98
    v_mfma_f32_16x16x32_bf16 a[0:3], a[140:143], v[60:63], a[0:3]
    buffer_load_dword v37, v43, s[40:43], s44 offen
    v_mfma_f32_16x16x32_bf16 a[8:11], a[140:143], v[92:95], a[8:11]
    ds_read_b64_tr_b16 a[204:205], v30 offset:12288
    v_accvgpr_read_b32 v243, a99
    v_mfma_f32_16x16x32_bf16 a[0:3], a[144:147], v[64:67], a[0:3]
    ds_read_b64_tr_b16 a[206:207], v30 offset:14336
    v_accvgpr_read_b32 v244, a100
    v_mfma_f32_16x16x32_bf16 a[8:11], a[144:147], v[96:99], a[8:11]
    ds_read_b64_tr_b16 a[208:209], v30 offset:16384
    ds_read_b64_tr_b16 a[210:211], v30 offset:18432
    v_accvgpr_read_b32 v245, a101
    v_mfma_f32_16x16x32_bf16 a[0:3], a[148:151], v[68:71], a[0:3]
    ds_read_b64_tr_b16 a[212:213], v30 offset:20480
    v_mfma_f32_16x16x32_bf16 a[8:11], a[148:151], v[100:103], a[8:11]
    ds_read_b64_tr_b16 a[214:215], v30 offset:22528
    v_accvgpr_read_b32 v246, a102
    v_mfma_f32_16x16x32_bf16 a[0:3], a[152:155], v[72:75], a[0:3]
    s_waitcnt lgkmcnt(8)
    ds_read_b64_tr_b16 a[216:217], v30 offset:24576
    v_accvgpr_read_b32 v247, a103
    v_mfma_f32_16x16x32_bf16 a[8:11], a[152:155], v[104:107], a[8:11]
    ds_read_b64_tr_b16 a[218:219], v30 offset:26624
    v_cvt_pk_bf16_f32 v248, v240, v241
    v_mfma_f32_16x16x32_bf16 a[0:3], a[156:159], v[76:79], a[0:3]
    ds_read_b64_tr_b16 a[220:221], v30 offset:28672
    v_mfma_f32_16x16x32_bf16 a[8:11], a[156:159], v[108:111], a[8:11]
    ds_read_b64_tr_b16 a[222:223], v30 offset:30720
    v_cvt_pk_bf16_f32 v249, v242, v243
    v_mfma_f32_16x16x32_bf16 a[4:7], a[160:163], v[48:51], a[4:7]
    ds_read_b64_tr_b16 a[224:225], v31 offset:0
    ds_read_b64_tr_b16 a[226:227], v31 offset:2048
    v_cvt_pk_bf16_f32 v250, v244, v245
    v_accvgpr_read_b32 v240, a104
    v_mfma_f32_16x16x32_bf16 a[12:15], a[160:163], v[80:83], a[12:15]
    ds_read_b64_tr_b16 a[228:229], v31 offset:4096
    v_cvt_pk_bf16_f32 v251, v246, v247
    v_accvgpr_read_b32 v241, a105
    v_mfma_f32_16x16x32_bf16 a[4:7], a[164:167], v[52:55], a[4:7]
    ds_read_b64_tr_b16 a[230:231], v31 offset:6144
    v_mfma_f32_16x16x32_bf16 a[12:15], a[164:167], v[84:87], a[12:15]
    ds_read_b64_tr_b16 a[232:233], v31 offset:8192
    v_accvgpr_read_b32 v242, a106
    v_accvgpr_read_b32 v243, a107
    v_mfma_f32_16x16x32_bf16 a[4:7], a[168:171], v[56:59], a[4:7]
    s_add_u32 s38, s17, 0
    buffer_store_dwordx4 v[248:251], v2, s[8:11], s38 offen sc1
    v_mfma_f32_16x16x32_bf16 a[12:15], a[168:171], v[88:91], a[12:15]
    ds_read_b64_tr_b16 a[234:235], v31 offset:10240
    v_accvgpr_read_b32 v244, a108
    v_accvgpr_read_b32 v245, a109
    v_mfma_f32_16x16x32_bf16 a[4:7], a[172:175], v[60:63], a[4:7]
    ds_read_b64_tr_b16 a[236:237], v31 offset:12288
    v_mfma_f32_16x16x32_bf16 a[12:15], a[172:175], v[92:95], a[12:15]
    ds_read_b64_tr_b16 a[238:239], v31 offset:14336
    v_accvgpr_read_b32 v246, a110
    v_mfma_f32_16x16x32_bf16 a[4:7], a[176:179], v[64:67], a[4:7]
    s_add_u32 s25, s25, 0x8000
    ds_read_b64_tr_b16 a[240:241], v31 offset:16384
    ds_read_b64_tr_b16 a[242:243], v31 offset:18432
    v_accvgpr_read_b32 v247, a111
    v_mfma_f32_16x16x32_bf16 a[12:15], a[176:179], v[96:99], a[12:15]
    ds_read_b64_tr_b16 a[244:245], v31 offset:20480
    v_cvt_pk_bf16_f32 v252, v240, v241
    v_mfma_f32_16x16x32_bf16 a[4:7], a[180:183], v[68:71], a[4:7]
    ds_read_b64_tr_b16 a[246:247], v31 offset:22528
    v_mfma_f32_16x16x32_bf16 a[12:15], a[180:183], v[100:103], a[12:15]
    s_cmp_ge_u32 s25, 0x28000
    ds_read_b64_tr_b16 a[248:249], v31 offset:24576
    v_cvt_pk_bf16_f32 v253, v242, v243
    v_mfma_f32_16x16x32_bf16 a[4:7], a[184:187], v[72:75], a[4:7]
    s_cselect_b32 s25, 0, s25
    ds_read_b64_tr_b16 a[250:251], v31 offset:26624
    v_cvt_pk_bf16_f32 v254, v244, v245
    v_mfma_f32_16x16x32_bf16 a[12:15], a[184:187], v[104:107], a[12:15]
    ds_read_b64_tr_b16 a[252:253], v31 offset:28672
    v_cvt_pk_bf16_f32 v255, v246, v247
    v_mfma_f32_16x16x32_bf16 a[4:7], a[188:191], v[76:79], a[4:7]
    ds_read_b64_tr_b16 a[254:255], v31 offset:30720
    v_mfma_f32_16x16x32_bf16 a[12:15], a[188:191], v[108:111], a[12:15]
    s_add_u32 s38, s17, 14336
    buffer_store_dwordx4 v[252:255], v2, s[8:11], s38 offen sc1
    s_waitcnt vmcnt(19) lgkmcnt(8)
    s_barrier
    v_mfma_f32_16x16x32_bf16 a[16:19], a[192:195], v[48:51], a[16:19]
    v_add_u32 v28, s25, v24
    v_add_u32 v29, s25, v25
    v_mfma_f32_16x16x32_bf16 a[24:27], a[192:195], v[80:83], a[24:27]
    s_mov_b32 s3, 7168
    buffer_load_dwordx4 v[200:203], v21, s[8:11], s3 offen offset:0 sc1
    v_add_u32 v30, s25, v26
    v_mfma_f32_16x16x32_bf16 a[16:19], a[196:199], v[52:55], a[16:19]
    s_mov_b32 s3, 7168
    buffer_load_dwordx4 v[204:207], v21, s[8:11], s3 offen offset:64 sc1
    v_add_u32 v31, s25, v27
    v_mfma_f32_16x16x32_bf16 a[24:27], a[196:199], v[84:87], a[24:27]
    ds_read_b64_tr_b16 a[128:129], v28 offset:0
    ds_read_b64_tr_b16 a[130:131], v28 offset:2048
    v_mfma_f32_16x16x32_bf16 a[16:19], a[200:203], v[56:59], a[16:19]
    s_mov_b32 s3, 7168
    buffer_load_dwordx4 v[208:211], v21, s[8:11], s3 offen offset:1024 sc1
    v_mfma_f32_16x16x32_bf16 a[24:27], a[200:203], v[88:91], a[24:27]
    ds_read_b64_tr_b16 a[132:133], v28 offset:4096
    v_accvgpr_read_b32 v240, a0
    v_mfma_f32_16x16x32_bf16 a[16:19], a[204:207], v[60:63], a[16:19]
    ds_read_b64_tr_b16 a[134:135], v28 offset:6144
    v_accvgpr_read_b32 v241, a1
    v_mfma_f32_16x16x32_bf16 a[24:27], a[204:207], v[92:95], a[24:27]
    ds_read_b64_tr_b16 a[136:137], v28 offset:8192
    ds_read_b64_tr_b16 a[138:139], v28 offset:10240
    v_accvgpr_read_b32 v242, a2
    v_mfma_f32_16x16x32_bf16 a[16:19], a[208:211], v[64:67], a[16:19]
    ds_read_b64_tr_b16 a[140:141], v28 offset:12288
    v_accvgpr_read_b32 v243, a3
    v_mfma_f32_16x16x32_bf16 a[24:27], a[208:211], v[96:99], a[24:27]
    ds_read_b64_tr_b16 a[142:143], v28 offset:14336
    v_accvgpr_read_b32 v244, a4
    v_mfma_f32_16x16x32_bf16 a[16:19], a[212:215], v[68:71], a[16:19]
    ds_read_b64_tr_b16 a[144:145], v28 offset:16384
    v_accvgpr_read_b32 v245, a5
    v_mfma_f32_16x16x32_bf16 a[24:27], a[212:215], v[100:103], a[24:27]
    ds_read_b64_tr_b16 a[146:147], v28 offset:18432
    ds_read_b64_tr_b16 a[148:149], v28 offset:20480
    v_accvgpr_read_b32 v246, a6
    v_mfma_f32_16x16x32_bf16 a[16:19], a[216:219], v[72:75], a[16:19]
    s_waitcnt lgkmcnt(8)
    ds_read_b64_tr_b16 a[150:151], v28 offset:22528
    v_accvgpr_read_b32 v247, a7
    v_mfma_f32_16x16x32_bf16 a[24:27], a[216:219], v[104:107], a[24:27]
    ds_read_b64_tr_b16 a[152:153], v28 offset:24576
    v_cvt_pk_bf16_f32 v248, v240, v241
    v_mfma_f32_16x16x32_bf16 a[16:19], a[220:223], v[76:79], a[16:19]
    ds_read_b64_tr_b16 a[154:155], v28 offset:26624
    ds_read_b64_tr_b16 a[156:157], v28 offset:28672
    v_cvt_pk_bf16_f32 v249, v242, v243
    v_mfma_f32_16x16x32_bf16 a[24:27], a[220:223], v[108:111], a[24:27]
    ds_read_b64_tr_b16 a[158:159], v28 offset:30720
    v_cvt_pk_bf16_f32 v250, v244, v245
    v_mfma_f32_16x16x32_bf16 a[20:23], a[224:227], v[48:51], a[20:23]
    ds_read_b64_tr_b16 a[160:161], v29 offset:0
    v_cvt_pk_bf16_f32 v251, v246, v247
    v_mfma_f32_16x16x32_bf16 a[28:31], a[224:227], v[80:83], a[28:31]
    s_mov_b32 s3, 7168
    buffer_load_dwordx4 v[212:215], v21, s[8:11], s3 offen offset:1088 sc1
    v_mfma_f32_16x16x32_bf16 a[20:23], a[228:231], v[52:55], a[20:23]
    s_add_u32 s38, s16, 0
    buffer_store_dwordx4 v[248:251], v2, s[8:11], s38 offen sc1
    v_mfma_f32_16x16x32_bf16 a[28:31], a[228:231], v[84:87], a[28:31]
    ds_read_b64_tr_b16 a[162:163], v29 offset:2048
    v_accvgpr_read_b32 v240, a8
    v_mfma_f32_16x16x32_bf16 a[20:23], a[232:235], v[56:59], a[20:23]
    ds_read_b64_tr_b16 a[164:165], v29 offset:4096
    ds_read_b64_tr_b16 a[166:167], v29 offset:6144
    v_accvgpr_read_b32 v241, a9
    v_mfma_f32_16x16x32_bf16 a[28:31], a[232:235], v[88:91], a[28:31]
    ds_read_b64_tr_b16 a[168:169], v29 offset:8192
    v_accvgpr_read_b32 v242, a10
    v_mfma_f32_16x16x32_bf16 a[20:23], a[236:239], v[60:63], a[20:23]
    ds_read_b64_tr_b16 a[170:171], v29 offset:10240
    v_accvgpr_read_b32 v243, a11
    v_mfma_f32_16x16x32_bf16 a[28:31], a[236:239], v[92:95], a[28:31]
    ds_read_b64_tr_b16 a[172:173], v29 offset:12288
    ds_read_b64_tr_b16 a[174:175], v29 offset:14336
    v_accvgpr_read_b32 v244, a12
    v_mfma_f32_16x16x32_bf16 a[20:23], a[240:243], v[64:67], a[20:23]
    ds_read_b64_tr_b16 a[176:177], v29 offset:16384
    v_accvgpr_read_b32 v245, a13
    v_mfma_f32_16x16x32_bf16 a[28:31], a[240:243], v[96:99], a[28:31]
    ds_read_b64_tr_b16 a[178:179], v29 offset:18432
    v_accvgpr_read_b32 v246, a14
    v_mfma_f32_16x16x32_bf16 a[20:23], a[244:247], v[68:71], a[20:23]
    s_waitcnt lgkmcnt(8)
    ds_read_b64_tr_b16 a[180:181], v29 offset:20480
    v_accvgpr_read_b32 v247, a15
    v_mfma_f32_16x16x32_bf16 a[28:31], a[244:247], v[100:103], a[28:31]
    ds_read_b64_tr_b16 a[182:183], v29 offset:22528
    ds_read_b64_tr_b16 a[184:185], v29 offset:24576
    v_cvt_pk_bf16_f32 v252, v240, v241
    v_mfma_f32_16x16x32_bf16 a[20:23], a[248:251], v[72:75], a[20:23]
    ds_read_b64_tr_b16 a[186:187], v29 offset:26624
    v_cvt_pk_bf16_f32 v253, v242, v243
    v_mfma_f32_16x16x32_bf16 a[28:31], a[248:251], v[104:107], a[28:31]
    ds_read_b64_tr_b16 a[188:189], v29 offset:28672
    v_cvt_pk_bf16_f32 v254, v244, v245
    v_mfma_f32_16x16x32_bf16 a[20:23], a[252:255], v[76:79], a[20:23]
    ds_read_b64_tr_b16 a[190:191], v29 offset:30720
    v_cvt_pk_bf16_f32 v255, v246, v247
    v_mfma_f32_16x16x32_bf16 a[28:31], a[252:255], v[108:111], a[28:31]
    s_add_u32 s38, s16, 14336
    buffer_store_dwordx4 v[252:255], v2, s[8:11], s38 offen sc1
    v_mfma_f32_16x16x32_bf16 a[32:35], a[128:131], v[48:51], a[32:35]
    ds_read_b64_tr_b16 a[192:193], v30 offset:0
    ds_read_b64_tr_b16 a[194:195], v30 offset:2048
    v_mfma_f32_16x16x32_bf16 a[40:43], a[128:131], v[80:83], a[40:43]
    ds_read_b64_tr_b16 a[196:197], v30 offset:4096
    v_mfma_f32_16x16x32_bf16 a[32:35], a[132:135], v[52:55], a[32:35]
    ds_read_b64_tr_b16 a[198:199], v30 offset:6144
    v_mfma_f32_16x16x32_bf16 a[40:43], a[132:135], v[84:87], a[40:43]
    ds_read_b64_tr_b16 a[200:201], v30 offset:8192
    v_accvgpr_read_b32 v240, a16
    v_mfma_f32_16x16x32_bf16 a[32:35], a[136:139], v[56:59], a[32:35]
    ds_read_b64_tr_b16 a[202:203], v30 offset:10240
    v_accvgpr_read_b32 v241, a17
    v_mfma_f32_16x16x32_bf16 a[40:43], a[136:139], v[88:91], a[40:43]
    ds_read_b64_tr_b16 a[204:205], v30 offset:12288
    v_accvgpr_read_b32 v242, a18
    v_mfma_f32_16x16x32_bf16 a[32:35], a[140:143], v[60:63], a[32:35]
    ds_read_b64_tr_b16 a[206:207], v30 offset:14336
    v_mfma_f32_16x16x32_bf16 a[40:43], a[140:143], v[92:95], a[40:43]
    ds_read_b64_tr_b16 a[208:209], v30 offset:16384
    v_accvgpr_read_b32 v243, a19
    v_mfma_f32_16x16x32_bf16 a[32:35], a[144:147], v[64:67], a[32:35]
    ds_read_b64_tr_b16 a[210:211], v30 offset:18432
    v_accvgpr_read_b32 v244, a20
    v_mfma_f32_16x16x32_bf16 a[40:43], a[144:147], v[96:99], a[40:43]
    ds_read_b64_tr_b16 a[212:213], v30 offset:20480
    v_accvgpr_read_b32 v245, a21
    v_mfma_f32_16x16x32_bf16 a[32:35], a[148:151], v[68:71], a[32:35]
    ds_read_b64_tr_b16 a[214:215], v30 offset:22528
    v_mfma_f32_16x16x32_bf16 a[40:43], a[148:151], v[100:103], a[40:43]
    ds_read_b64_tr_b16 a[216:217], v30 offset:24576
    v_accvgpr_read_b32 v246, a22
    v_mfma_f32_16x16x32_bf16 a[32:35], a[152:155], v[72:75], a[32:35]
    s_waitcnt lgkmcnt(8)
    ds_read_b64_tr_b16 a[218:219], v30 offset:26624
    v_accvgpr_read_b32 v247, a23
    v_mfma_f32_16x16x32_bf16 a[40:43], a[152:155], v[104:107], a[40:43]
    ds_read_b64_tr_b16 a[220:221], v30 offset:28672
    v_cvt_pk_bf16_f32 v248, v240, v241
    v_mfma_f32_16x16x32_bf16 a[32:35], a[156:159], v[76:79], a[32:35]
    ds_read_b64_tr_b16 a[222:223], v30 offset:30720
    v_mfma_f32_16x16x32_bf16 a[40:43], a[156:159], v[108:111], a[40:43]
    ds_read_b64_tr_b16 a[224:225], v31 offset:0
    ds_read_b64_tr_b16 a[226:227], v31 offset:2048
    v_cvt_pk_bf16_f32 v249, v242, v243
    v_mfma_f32_16x16x32_bf16 a[36:39], a[160:163], v[48:51], a[36:39]
    ds_read_b64_tr_b16 a[228:229], v31 offset:4096
    v_cvt_pk_bf16_f32 v250, v244, v245
    v_accvgpr_read_b32 v240, a24
    v_mfma_f32_16x16x32_bf16 a[44:47], a[160:163], v[80:83], a[44:47]
    ds_read_b64_tr_b16 a[230:231], v31 offset:6144
    v_cvt_pk_bf16_f32 v251, v246, v247
    v_accvgpr_read_b32 v241, a25
    v_mfma_f32_16x16x32_bf16 a[36:39], a[164:167], v[52:55], a[36:39]
    ds_read_b64_tr_b16 a[232:233], v31 offset:8192
    v_mfma_f32_16x16x32_bf16 a[44:47], a[164:167], v[84:87], a[44:47]
    ds_read_b64_tr_b16 a[234:235], v31 offset:10240
    v_accvgpr_read_b32 v242, a26
    v_accvgpr_read_b32 v243, a27
    v_mfma_f32_16x16x32_bf16 a[36:39], a[168:171], v[56:59], a[36:39]
    s_add_u32 s38, s16, 1024
    buffer_store_dwordx4 v[248:251], v2, s[8:11], s38 offen sc1
    v_mfma_f32_16x16x32_bf16 a[44:47], a[168:171], v[88:91], a[44:47]
    ds_read_b64_tr_b16 a[236:237], v31 offset:12288
    v_accvgpr_read_b32 v244, a28
    v_accvgpr_read_b32 v245, a29
    v_mfma_f32_16x16x32_bf16 a[36:39], a[172:175], v[60:63], a[36:39]
    ds_read_b64_tr_b16 a[238:239], v31 offset:14336
    v_mfma_f32_16x16x32_bf16 a[44:47], a[172:175], v[92:95], a[44:47]
    ds_read_b64_tr_b16 a[240:241], v31 offset:16384
    v_accvgpr_read_b32 v246, a30
    v_mfma_f32_16x16x32_bf16 a[36:39], a[176:179], v[64:67], a[36:39]
    s_add_u32 s25, s25, 0x8000
    ds_read_b64_tr_b16 a[242:243], v31 offset:18432
    v_accvgpr_read_b32 v247, a31
    v_mfma_f32_16x16x32_bf16 a[44:47], a[176:179], v[96:99], a[44:47]
    ds_read_b64_tr_b16 a[244:245], v31 offset:20480
    v_cvt_pk_bf16_f32 v252, v240, v241
    v_mfma_f32_16x16x32_bf16 a[36:39], a[180:183], v[68:71], a[36:39]
    ds_read_b64_tr_b16 a[246:247], v31 offset:22528
    v_mfma_f32_16x16x32_bf16 a[44:47], a[180:183], v[100:103], a[44:47]
    s_cmp_ge_u32 s25, 0x28000
    ds_read_b64_tr_b16 a[248:249], v31 offset:24576
    v_cvt_pk_bf16_f32 v253, v242, v243
    v_mfma_f32_16x16x32_bf16 a[36:39], a[184:187], v[72:75], a[36:39]
    s_cselect_b32 s25, 0, s25
    ds_read_b64_tr_b16 a[250:251], v31 offset:26624
    v_cvt_pk_bf16_f32 v254, v244, v245
    v_mfma_f32_16x16x32_bf16 a[44:47], a[184:187], v[104:107], a[44:47]
    ds_read_b64_tr_b16 a[252:253], v31 offset:28672
    v_cvt_pk_bf16_f32 v255, v246, v247
    v_mfma_f32_16x16x32_bf16 a[36:39], a[188:191], v[76:79], a[36:39]
    ds_read_b64_tr_b16 a[254:255], v31 offset:30720
    v_mfma_f32_16x16x32_bf16 a[44:47], a[188:191], v[108:111], a[44:47]
    s_add_u32 s38, s16, 15360
    buffer_store_dwordx4 v[252:255], v2, s[8:11], s38 offen sc1
    s_waitcnt vmcnt(19) lgkmcnt(8)
    s_barrier
    v_mfma_f32_16x16x32_bf16 a[48:51], a[192:195], v[48:51], a[48:51]
    v_add_u32 v28, s25, v24
    v_add_u32 v29, s25, v25
    v_mfma_f32_16x16x32_bf16 a[56:59], a[192:195], v[80:83], a[56:59]
    s_mov_b32 s3, 5376
    buffer_load_dwordx4 v[216:219], v21, s[8:11], s3 offen offset:0 sc1
    v_add_u32 v30, s25, v26
    v_mfma_f32_16x16x32_bf16 a[48:51], a[196:199], v[52:55], a[48:51]
    s_mov_b32 s3, 5376
    buffer_load_dwordx4 v[220:223], v21, s[8:11], s3 offen offset:64 sc1
    v_add_u32 v31, s25, v27
    v_mfma_f32_16x16x32_bf16 a[56:59], a[196:199], v[84:87], a[56:59]
    ds_read_b64_tr_b16 a[128:129], v28 offset:0
    ds_read_b64_tr_b16 a[130:131], v28 offset:2048
    v_mfma_f32_16x16x32_bf16 a[48:51], a[200:203], v[56:59], a[48:51]
    s_mov_b32 s3, 5376
    buffer_load_dwordx4 v[224:227], v21, s[8:11], s3 offen offset:1024 sc1
    v_mfma_f32_16x16x32_bf16 a[56:59], a[200:203], v[88:91], a[56:59]
    ds_read_b64_tr_b16 a[132:133], v28 offset:4096
    v_accvgpr_read_b32 v240, a32
    v_mfma_f32_16x16x32_bf16 a[48:51], a[204:207], v[60:63], a[48:51]
    ds_read_b64_tr_b16 a[134:135], v28 offset:6144
    v_accvgpr_read_b32 v241, a33
    v_mfma_f32_16x16x32_bf16 a[56:59], a[204:207], v[92:95], a[56:59]
    ds_read_b64_tr_b16 a[136:137], v28 offset:8192
    ds_read_b64_tr_b16 a[138:139], v28 offset:10240
    v_accvgpr_read_b32 v242, a34
    v_mfma_f32_16x16x32_bf16 a[48:51], a[208:211], v[64:67], a[48:51]
    ds_read_b64_tr_b16 a[140:141], v28 offset:12288
    v_accvgpr_read_b32 v243, a35
    v_mfma_f32_16x16x32_bf16 a[56:59], a[208:211], v[96:99], a[56:59]
    ds_read_b64_tr_b16 a[142:143], v28 offset:14336
    v_accvgpr_read_b32 v244, a36
    v_mfma_f32_16x16x32_bf16 a[48:51], a[212:215], v[68:71], a[48:51]
    ds_read_b64_tr_b16 a[144:145], v28 offset:16384
    v_accvgpr_read_b32 v245, a37
    v_mfma_f32_16x16x32_bf16 a[56:59], a[212:215], v[100:103], a[56:59]
    ds_read_b64_tr_b16 a[146:147], v28 offset:18432
    ds_read_b64_tr_b16 a[148:149], v28 offset:20480
    v_accvgpr_read_b32 v246, a38
    v_mfma_f32_16x16x32_bf16 a[48:51], a[216:219], v[72:75], a[48:51]
    s_waitcnt lgkmcnt(8)
    ds_read_b64_tr_b16 a[150:151], v28 offset:22528
    v_accvgpr_read_b32 v247, a39
    v_mfma_f32_16x16x32_bf16 a[56:59], a[216:219], v[104:107], a[56:59]
    ds_read_b64_tr_b16 a[152:153], v28 offset:24576
    v_cvt_pk_bf16_f32 v248, v240, v241
    v_mfma_f32_16x16x32_bf16 a[48:51], a[220:223], v[76:79], a[48:51]
    ds_read_b64_tr_b16 a[154:155], v28 offset:26624
    ds_read_b64_tr_b16 a[156:157], v28 offset:28672
    v_cvt_pk_bf16_f32 v249, v242, v243
    v_mfma_f32_16x16x32_bf16 a[56:59], a[220:223], v[108:111], a[56:59]
    ds_read_b64_tr_b16 a[158:159], v28 offset:30720
    v_cvt_pk_bf16_f32 v250, v244, v245
    v_mfma_f32_16x16x32_bf16 a[52:55], a[224:227], v[48:51], a[52:55]
    ds_read_b64_tr_b16 a[160:161], v29 offset:0
    v_cvt_pk_bf16_f32 v251, v246, v247
    v_mfma_f32_16x16x32_bf16 a[60:63], a[224:227], v[80:83], a[60:63]
    s_mov_b32 s3, 5376
    buffer_load_dwordx4 v[228:231], v21, s[8:11], s3 offen offset:1088 sc1
    v_mfma_f32_16x16x32_bf16 a[52:55], a[228:231], v[52:55], a[52:55]
    s_add_u32 s38, s16, 2048
    buffer_store_dwordx4 v[248:251], v2, s[8:11], s38 offen sc1
    v_mfma_f32_16x16x32_bf16 a[60:63], a[228:231], v[84:87], a[60:63]
    ds_read_b64_tr_b16 a[162:163], v29 offset:2048
    v_accvgpr_read_b32 v240, a40
    v_mfma_f32_16x16x32_bf16 a[52:55], a[232:235], v[56:59], a[52:55]
    ds_read_b64_tr_b16 a[164:165], v29 offset:4096
    ds_read_b64_tr_b16 a[166:167], v29 offset:6144
    v_accvgpr_read_b32 v241, a41
    v_mfma_f32_16x16x32_bf16 a[60:63], a[232:235], v[88:91], a[60:63]
    ds_read_b64_tr_b16 a[168:169], v29 offset:8192
    v_accvgpr_read_b32 v242, a42
    v_mfma_f32_16x16x32_bf16 a[52:55], a[236:239], v[60:63], a[52:55]
    ds_read_b64_tr_b16 a[170:171], v29 offset:10240
    v_accvgpr_read_b32 v243, a43
    v_mfma_f32_16x16x32_bf16 a[60:63], a[236:239], v[92:95], a[60:63]
    ds_read_b64_tr_b16 a[172:173], v29 offset:12288
    ds_read_b64_tr_b16 a[174:175], v29 offset:14336
    v_accvgpr_read_b32 v244, a44
    v_mfma_f32_16x16x32_bf16 a[52:55], a[240:243], v[64:67], a[52:55]
    ds_read_b64_tr_b16 a[176:177], v29 offset:16384
    v_accvgpr_read_b32 v245, a45
    v_mfma_f32_16x16x32_bf16 a[60:63], a[240:243], v[96:99], a[60:63]
    ds_read_b64_tr_b16 a[178:179], v29 offset:18432
    v_accvgpr_read_b32 v246, a46
    v_mfma_f32_16x16x32_bf16 a[52:55], a[244:247], v[68:71], a[52:55]
    s_waitcnt lgkmcnt(8)
    ds_read_b64_tr_b16 a[180:181], v29 offset:20480
    v_accvgpr_read_b32 v247, a47
    v_mfma_f32_16x16x32_bf16 a[60:63], a[244:247], v[100:103], a[60:63]
    ds_read_b64_tr_b16 a[182:183], v29 offset:22528
    ds_read_b64_tr_b16 a[184:185], v29 offset:24576
    v_cvt_pk_bf16_f32 v252, v240, v241
    v_mfma_f32_16x16x32_bf16 a[52:55], a[248:251], v[72:75], a[52:55]
    ds_read_b64_tr_b16 a[186:187], v29 offset:26624
    v_cvt_pk_bf16_f32 v253, v242, v243
    v_mfma_f32_16x16x32_bf16 a[60:63], a[248:251], v[104:107], a[60:63]
    ds_read_b64_tr_b16 a[188:189], v29 offset:28672
    v_cvt_pk_bf16_f32 v254, v244, v245
    v_mfma_f32_16x16x32_bf16 a[52:55], a[252:255], v[76:79], a[52:55]
    ds_read_b64_tr_b16 a[190:191], v29 offset:30720
    v_cvt_pk_bf16_f32 v255, v246, v247
    v_mfma_f32_16x16x32_bf16 a[60:63], a[252:255], v[108:111], a[60:63]
    s_add_u32 s38, s16, 16384
    buffer_store_dwordx4 v[252:255], v2, s[8:11], s38 offen sc1
    v_mfma_f32_16x16x32_bf16 a[64:67], a[128:131], v[48:51], a[64:67]
    ds_read_b64_tr_b16 a[192:193], v30 offset:0
    ds_read_b64_tr_b16 a[194:195], v30 offset:2048
    v_mfma_f32_16x16x32_bf16 a[72:75], a[128:131], v[80:83], a[72:75]
    ds_read_b64_tr_b16 a[196:197], v30 offset:4096
    v_mfma_f32_16x16x32_bf16 a[64:67], a[132:135], v[52:55], a[64:67]
    ds_read_b64_tr_b16 a[198:199], v30 offset:6144
    v_mfma_f32_16x16x32_bf16 a[72:75], a[132:135], v[84:87], a[72:75]
    ds_read_b64_tr_b16 a[200:201], v30 offset:8192
    v_accvgpr_read_b32 v240, a48
    v_mfma_f32_16x16x32_bf16 a[64:67], a[136:139], v[56:59], a[64:67]
    ds_read_b64_tr_b16 a[202:203], v30 offset:10240
    v_accvgpr_read_b32 v241, a49
    v_mfma_f32_16x16x32_bf16 a[72:75], a[136:139], v[88:91], a[72:75]
    ds_read_b64_tr_b16 a[204:205], v30 offset:12288
    v_accvgpr_read_b32 v242, a50
    v_mfma_f32_16x16x32_bf16 a[64:67], a[140:143], v[60:63], a[64:67]
    ds_read_b64_tr_b16 a[206:207], v30 offset:14336
    v_mfma_f32_16x16x32_bf16 a[72:75], a[140:143], v[92:95], a[72:75]
    ds_read_b64_tr_b16 a[208:209], v30 offset:16384
    v_accvgpr_read_b32 v243, a51
    v_mfma_f32_16x16x32_bf16 a[64:67], a[144:147], v[64:67], a[64:67]
    ds_read_b64_tr_b16 a[210:211], v30 offset:18432
    v_accvgpr_read_b32 v244, a52
    v_mfma_f32_16x16x32_bf16 a[72:75], a[144:147], v[96:99], a[72:75]
    ds_read_b64_tr_b16 a[212:213], v30 offset:20480
    v_accvgpr_read_b32 v245, a53
    v_mfma_f32_16x16x32_bf16 a[64:67], a[148:151], v[68:71], a[64:67]
    ds_read_b64_tr_b16 a[214:215], v30 offset:22528
    v_mfma_f32_16x16x32_bf16 a[72:75], a[148:151], v[100:103], a[72:75]
    ds_read_b64_tr_b16 a[216:217], v30 offset:24576
    v_accvgpr_read_b32 v246, a54
    v_mfma_f32_16x16x32_bf16 a[64:67], a[152:155], v[72:75], a[64:67]
    s_waitcnt lgkmcnt(8)
    ds_read_b64_tr_b16 a[218:219], v30 offset:26624
    v_accvgpr_read_b32 v247, a55
    v_mfma_f32_16x16x32_bf16 a[72:75], a[152:155], v[104:107], a[72:75]
    ds_read_b64_tr_b16 a[220:221], v30 offset:28672
    v_cvt_pk_bf16_f32 v248, v240, v241
    v_mfma_f32_16x16x32_bf16 a[64:67], a[156:159], v[76:79], a[64:67]
    ds_read_b64_tr_b16 a[222:223], v30 offset:30720
    v_mfma_f32_16x16x32_bf16 a[72:75], a[156:159], v[108:111], a[72:75]
    ds_read_b64_tr_b16 a[224:225], v31 offset:0
    ds_read_b64_tr_b16 a[226:227], v31 offset:2048
    v_cvt_pk_bf16_f32 v249, v242, v243
    v_mfma_f32_16x16x32_bf16 a[68:71], a[160:163], v[48:51], a[68:71]
    ds_read_b64_tr_b16 a[228:229], v31 offset:4096
    v_cvt_pk_bf16_f32 v250, v244, v245
    v_accvgpr_read_b32 v240, a56
    v_mfma_f32_16x16x32_bf16 a[76:79], a[160:163], v[80:83], a[76:79]
    ds_read_b64_tr_b16 a[230:231], v31 offset:6144
    v_cvt_pk_bf16_f32 v251, v246, v247
    v_accvgpr_read_b32 v241, a57
    v_mfma_f32_16x16x32_bf16 a[68:71], a[164:167], v[52:55], a[68:71]
    ds_read_b64_tr_b16 a[232:233], v31 offset:8192
    v_mfma_f32_16x16x32_bf16 a[76:79], a[164:167], v[84:87], a[76:79]
    ds_read_b64_tr_b16 a[234:235], v31 offset:10240
    v_accvgpr_read_b32 v242, a58
    v_accvgpr_read_b32 v243, a59
    v_mfma_f32_16x16x32_bf16 a[68:71], a[168:171], v[56:59], a[68:71]
    s_add_u32 s38, s16, 3072
    buffer_store_dwordx4 v[248:251], v2, s[8:11], s38 offen sc1
    v_mfma_f32_16x16x32_bf16 a[76:79], a[168:171], v[88:91], a[76:79]
    ds_read_b64_tr_b16 a[236:237], v31 offset:12288
    v_accvgpr_read_b32 v244, a60
    v_accvgpr_read_b32 v245, a61
    v_mfma_f32_16x16x32_bf16 a[68:71], a[172:175], v[60:63], a[68:71]
    ds_read_b64_tr_b16 a[238:239], v31 offset:14336
    v_mfma_f32_16x16x32_bf16 a[76:79], a[172:175], v[92:95], a[76:79]
    ds_read_b64_tr_b16 a[240:241], v31 offset:16384
    v_accvgpr_read_b32 v246, a62
    v_mfma_f32_16x16x32_bf16 a[68:71], a[176:179], v[64:67], a[68:71]
    s_add_u32 s25, s25, 0x8000
    ds_read_b64_tr_b16 a[242:243], v31 offset:18432
    v_accvgpr_read_b32 v247, a63
    v_mfma_f32_16x16x32_bf16 a[76:79], a[176:179], v[96:99], a[76:79]
    ds_read_b64_tr_b16 a[244:245], v31 offset:20480
    v_cvt_pk_bf16_f32 v252, v240, v241
    v_mfma_f32_16x16x32_bf16 a[68:71], a[180:183], v[68:71], a[68:71]
    ds_read_b64_tr_b16 a[246:247], v31 offset:22528
    v_mfma_f32_16x16x32_bf16 a[76:79], a[180:183], v[100:103], a[76:79]
    s_cmp_ge_u32 s25, 0x28000
    ds_read_b64_tr_b16 a[248:249], v31 offset:24576
    v_cvt_pk_bf16_f32 v253, v242, v243
    v_mfma_f32_16x16x32_bf16 a[68:71], a[184:187], v[72:75], a[68:71]
    s_cselect_b32 s25, 0, s25
    ds_read_b64_tr_b16 a[250:251], v31 offset:26624
    v_cvt_pk_bf16_f32 v254, v244, v245
    v_mfma_f32_16x16x32_bf16 a[76:79], a[184:187], v[104:107], a[76:79]
    ds_read_b64_tr_b16 a[252:253], v31 offset:28672
    v_cvt_pk_bf16_f32 v255, v246, v247
    v_mfma_f32_16x16x32_bf16 a[68:71], a[188:191], v[76:79], a[68:71]
    ds_read_b64_tr_b16 a[254:255], v31 offset:30720
    v_mfma_f32_16x16x32_bf16 a[76:79], a[188:191], v[108:111], a[76:79]
    s_add_u32 s38, s16, 17408
    buffer_store_dwordx4 v[252:255], v2, s[8:11], s38 offen sc1
    s_waitcnt vmcnt(4) lgkmcnt(8)
    s_barrier
    v_mfma_f32_16x16x32_bf16 a[80:83], a[192:195], v[48:51], a[80:83]
    v_mfma_f32_16x16x32_bf16 a[88:91], a[192:195], v[80:83], a[88:91]
    v_mfma_f32_16x16x32_bf16 a[80:83], a[196:199], v[52:55], a[80:83]
    v_mfma_f32_16x16x32_bf16 a[88:91], a[196:199], v[84:87], a[88:91]
    v_mfma_f32_16x16x32_bf16 a[80:83], a[200:203], v[56:59], a[80:83]
    v_mfma_f32_16x16x32_bf16 a[88:91], a[200:203], v[88:91], a[88:91]
    v_accvgpr_read_b32 v240, a64
    v_mfma_f32_16x16x32_bf16 a[80:83], a[204:207], v[60:63], a[80:83]
    v_accvgpr_read_b32 v241, a65
    v_mfma_f32_16x16x32_bf16 a[88:91], a[204:207], v[92:95], a[88:91]
    v_accvgpr_read_b32 v242, a66
    v_mfma_f32_16x16x32_bf16 a[80:83], a[208:211], v[64:67], a[80:83]
    v_accvgpr_read_b32 v243, a67
    v_mfma_f32_16x16x32_bf16 a[88:91], a[208:211], v[96:99], a[88:91]
    v_accvgpr_read_b32 v244, a68
    v_mfma_f32_16x16x32_bf16 a[80:83], a[212:215], v[68:71], a[80:83]
    v_accvgpr_read_b32 v245, a69
    v_mfma_f32_16x16x32_bf16 a[88:91], a[212:215], v[100:103], a[88:91]
    v_accvgpr_read_b32 v246, a70
    v_mfma_f32_16x16x32_bf16 a[80:83], a[216:219], v[72:75], a[80:83]
    s_waitcnt lgkmcnt(0)
    v_accvgpr_read_b32 v247, a71
    v_mfma_f32_16x16x32_bf16 a[88:91], a[216:219], v[104:107], a[88:91]
    v_cvt_pk_bf16_f32 v248, v240, v241
    v_mfma_f32_16x16x32_bf16 a[80:83], a[220:223], v[76:79], a[80:83]
    v_cvt_pk_bf16_f32 v249, v242, v243
    v_mfma_f32_16x16x32_bf16 a[88:91], a[220:223], v[108:111], a[88:91]
    v_cvt_pk_bf16_f32 v250, v244, v245
    v_mfma_f32_16x16x32_bf16 a[84:87], a[224:227], v[48:51], a[84:87]
    v_cvt_pk_bf16_f32 v251, v246, v247
    v_mfma_f32_16x16x32_bf16 a[92:95], a[224:227], v[80:83], a[92:95]
    v_mfma_f32_16x16x32_bf16 a[84:87], a[228:231], v[52:55], a[84:87]
    s_add_u32 s38, s16, 4096
    buffer_store_dwordx4 v[248:251], v2, s[8:11], s38 offen sc1
    v_mfma_f32_16x16x32_bf16 a[92:95], a[228:231], v[84:87], a[92:95]
    v_accvgpr_read_b32 v240, a72
    v_mfma_f32_16x16x32_bf16 a[84:87], a[232:235], v[56:59], a[84:87]
    v_accvgpr_read_b32 v241, a73
    v_mfma_f32_16x16x32_bf16 a[92:95], a[232:235], v[88:91], a[92:95]
    v_accvgpr_read_b32 v242, a74
    v_mfma_f32_16x16x32_bf16 a[84:87], a[236:239], v[60:63], a[84:87]
    v_accvgpr_read_b32 v243, a75
    v_mfma_f32_16x16x32_bf16 a[92:95], a[236:239], v[92:95], a[92:95]
    v_accvgpr_read_b32 v244, a76
    v_mfma_f32_16x16x32_bf16 a[84:87], a[240:243], v[64:67], a[84:87]
    v_accvgpr_read_b32 v245, a77
    v_mfma_f32_16x16x32_bf16 a[92:95], a[240:243], v[96:99], a[92:95]
    v_accvgpr_read_b32 v246, a78
    v_mfma_f32_16x16x32_bf16 a[84:87], a[244:247], v[68:71], a[84:87]
    v_accvgpr_read_b32 v247, a79
    v_mfma_f32_16x16x32_bf16 a[92:95], a[244:247], v[100:103], a[92:95]
    v_cvt_pk_bf16_f32 v252, v240, v241
    v_mfma_f32_16x16x32_bf16 a[84:87], a[248:251], v[72:75], a[84:87]
    v_cvt_pk_bf16_f32 v253, v242, v243
    v_mfma_f32_16x16x32_bf16 a[92:95], a[248:251], v[104:107], a[92:95]
    v_cvt_pk_bf16_f32 v254, v244, v245
    v_mfma_f32_16x16x32_bf16 a[84:87], a[252:255], v[76:79], a[84:87]
    v_cvt_pk_bf16_f32 v255, v246, v247
    v_mfma_f32_16x16x32_bf16 a[92:95], a[252:255], v[108:111], a[92:95]
    s_add_u32 s38, s16, 18432
    buffer_store_dwordx4 v[252:255], v2, s[8:11], s38 offen sc1
    v_accvgpr_read_b32 v240, a80
    v_accvgpr_read_b32 v241, a81
    v_accvgpr_read_b32 v242, a82
    v_accvgpr_read_b32 v243, a83
    v_accvgpr_read_b32 v244, a84
    v_accvgpr_read_b32 v245, a85
    v_accvgpr_read_b32 v246, a86
    v_accvgpr_read_b32 v247, a87
    v_cvt_pk_bf16_f32 v248, v240, v241
    v_cvt_pk_bf16_f32 v249, v242, v243
    v_cvt_pk_bf16_f32 v250, v244, v245
    v_cvt_pk_bf16_f32 v251, v246, v247
    s_add_u32 s38, s16, 5120
    buffer_store_dwordx4 v[248:251], v2, s[8:11], s38 offen sc1
    v_accvgpr_read_b32 v240, a88
    v_accvgpr_read_b32 v241, a89
    v_accvgpr_read_b32 v242, a90
    v_accvgpr_read_b32 v243, a91
    v_accvgpr_read_b32 v244, a92
    v_accvgpr_read_b32 v245, a93
    v_accvgpr_read_b32 v246, a94
    v_accvgpr_read_b32 v247, a95
    v_cvt_pk_bf16_f32 v252, v240, v241
    v_cvt_pk_bf16_f32 v253, v242, v243
    v_cvt_pk_bf16_f32 v254, v244, v245
    v_cvt_pk_bf16_f32 v255, v246, v247
    s_add_u32 s38, s16, 19456
    buffer_store_dwordx4 v[252:255], v2, s[8:11], s38 offen sc1
    v_mov_b32 v240, 0
    v_mov_b32 v241, 0
    v_mov_b32 v242, 0
    v_mov_b32 v243, 0
    v_mov_b32 v244, 0
    v_mov_b32 v245, 0
    v_mov_b32 v246, 0
    v_mov_b32 v247, 0
    v_mov_b32 v248, 0
    v_mov_b32 v249, 0
    v_mov_b32 v250, 0
    v_mov_b32 v251, 0
    v_mov_b32 v252, 0
    v_mov_b32 v253, 0
    v_mov_b32 v254, 0
    v_mov_b32 v255, 0
    s_mov_b32 s40, s25
    s_add_u32 s41, s40, 0x8000
    s_cmp_ge_u32 s41, 0x28000
    s_cselect_b32 s41, 0, s41
    s_add_u32 s42, s41, 0x8000
    s_cmp_ge_u32 s42, 0x28000
    s_cselect_b32 s42, 0, s42
    s_add_u32 s43, s42, 0x8000
    s_cmp_ge_u32 s43, 0x28000
    s_cselect_b32 s43, 0, s43
    s_add_u32 s44, s43, 0x8000
    s_cmp_ge_u32 s44, 0x28000
    s_cselect_b32 s44, 0, s44
    v_lshrrev_b32 v36, 3, v1
    v_bfe_u32 v37, v36, 1, 2
    v_lshlrev_b32 v37, 1, v37
    v_and_b32 v38, 7, v1
    v_xor_b32 v37, v37, v38
    v_lshlrev_b32 v37, 4, v37
    v_mul_u32_u24 v36, 896, v36
    v_add_u32 v3, v36, v37
    s_mov_b32 s12, s58
    s_and_b32 s13, s59, 0xffff
    s_mov_b32 s14, 0x188000
    s_mov_b32 s15, 0x20000
    s_cmp_lt_u32 s48, 14
    s_cselect_b32 s14, s14, 0
    s_lshr_b32 s28, s48, 1
    s_mul_i32 s35, s18, 401408
    s_lshl_b32 s3, s28, 7
    s_add_u32 s35, s35, s3
    s_cmp_eq_u32 s18, 3
    s_mov_b32 s34, 0x3c000000
    s_cselect_b32 s34, 0x3c800000, s34
    s_mov_b32 s26, 0x3f80
    s_mov_b32 s27, 0x3f800000
    s_waitcnt vmcnt(0)
    s_barrier
    s_cmp_lg_u32 s18, 0
    s_cbranch_scc1 T_SIGP
    v_mov_b32 v26, 1
    v_lshlrev_b32 v25, 7, s19
    s_mov_b64 exec, 1
    buffer_store_dword v26, v25, s[8:11], s30 offen sc1
T_SIGP_D:
    s_mov_b64 exec, -1
T_SIGP:
    s_lshl_b32 s3, s18, 12
    s_add_u32 s45, s40, s3
    s_add_u32 s46, s41, s3
    s_add_u32 s47, s42, s3
    s_add_u32 s16, s43, s3
    s_add_u32 s17, s44, s3
    s_sub_u32 s3, s20, 6
    s_cmp_lt_u32 s3, 0
    s_cbranch_scc0 T_NOW2
    s_lshr_b32 s32, s18, 1
    s_bitcmp1_b32 s18, 0
    s_cbranch_scc0 T_NOW2
    s_lshl_b32 s3, s3, 4
    s_add_u32 s3, s3, s19
    s_lshl_b32 s3, s3, 1
    s_add_u32 s3, s3, s32
    s_mul_i32 s3, s3, 8320
    v_lshlrev_b32 v29, 7, v1
    buffer_load_dword v30, v29, s[12:15], s3 offen
T_NOW2:
    s_cmp_eq_u32 s18, 0
    s_cbranch_scc1 T_XE0
    s_add_u32 m0, s24, 0
    s_nop 0
    buffer_load_dwordx4 v6, s[4:7], s21 offen sc1 lds
    s_add_u32 m0, s24, 4096
    s_nop 0
    buffer_load_dwordx4 v7, s[4:7], s21 offen sc1 lds
    s_add_u32 m0, s24, 8192
    s_nop 0
    buffer_load_dwordx4 v8, s[4:7], s21 offen sc1 lds
    s_add_u32 m0, s24, 12288
    s_nop 0
    buffer_load_dwordx4 v9, s[4:7], s21 offen sc1 lds
    s_add_u32 m0, s24, 16384
    s_nop 0
    buffer_load_dwordx4 v10, s[4:7], s21 offen sc1 lds
    s_add_u32 m0, s24, 20480
    s_nop 0
    buffer_load_dwordx4 v11, s[4:7], s21 offen sc1 lds
    s_add_u32 m0, s24, 24576
    s_nop 0
    buffer_load_dwordx4 v12, s[4:7], s21 offen sc1 lds
    s_add_u32 m0, s24, 28672
    s_nop 0
    buffer_load_dwordx4 v13, s[4:7], s21 offen sc1 lds
    s_add_u32 s21, s21, s22
    s_add_u32 s24, s24, 0x8000
    s_cmp_ge_u32 s24, 0x28000
    s_cselect_b32 s24, s49, s24
    s_add_u32 m0, s24, 0
    s_nop 0
    buffer_load_dwordx4 v6, s[4:7], s21 offen sc1 lds
    s_add_u32 m0, s24, 4096
    s_nop 0
    buffer_load_dwordx4 v7, s[4:7], s21 offen sc1 lds
    s_add_u32 m0, s24, 8192
    s_nop 0
    buffer_load_dwordx4 v8, s[4:7], s21 offen sc1 lds
    s_add_u32 m0, s24, 12288
    s_nop 0
    buffer_load_dwordx4 v9, s[4:7], s21 offen sc1 lds
    s_add_u32 m0, s24, 16384
    s_nop 0
    buffer_load_dwordx4 v10, s[4:7], s21 offen sc1 lds
    s_add_u32 m0, s24, 20480
    s_nop 0
    buffer_load_dwordx4 v11, s[4:7], s21 offen sc1 lds
    s_add_u32 m0, s24, 24576
    s_nop 0
    buffer_load_dwordx4 v12, s[4:7], s21 offen sc1 lds
    s_add_u32 m0, s24, 28672
    s_nop 0
    buffer_load_dwordx4 v13, s[4:7], s21 offen sc1 lds
    s_add_u32 s21, s21, s22
    s_add_u32 s24, s24, 0x8000
    s_cmp_ge_u32 s24, 0x28000
    s_cselect_b32 s24, s49, s24
    s_add_u32 m0, s24, 0
    s_nop 0
    buffer_load_dwordx4 v6, s[4:7], s21 offen sc1 lds
    s_add_u32 m0, s24, 4096
    s_nop 0
    buffer_load_dwordx4 v7, s[4:7], s21 offen sc1 lds
    s_add_u32 m0, s24, 8192
    s_nop 0
    buffer_load_dwordx4 v8, s[4:7], s21 offen sc1 lds
    s_add_u32 m0, s24, 12288
    s_nop 0
    buffer_load_dwordx4 v9, s[4:7], s21 offen sc1 lds
    s_add_u32 m0, s24, 16384
    s_nop 0
    buffer_load_dwordx4 v10, s[4:7], s21 offen sc1 lds
    s_add_u32 m0, s24, 20480
    s_nop 0
    buffer_load_dwordx4 v11, s[4:7], s21 offen sc1 lds
    s_add_u32 m0, s24, 24576
    s_nop 0
    buffer_load_dwordx4 v12, s[4:7], s21 offen sc1 lds
    s_add_u32 m0, s24, 28672
    s_nop 0
    buffer_load_dwordx4 v13, s[4:7], s21 offen sc1 lds
    s_add_u32 s21, s21, s22
    s_add_u32 s24, s24, 0x8000
    s_cmp_ge_u32 s24, 0x28000
    s_cselect_b32 s24, s49, s24
T_W1_3:
    s_add_u32 m0, s24, 0
    s_nop 0
    buffer_load_dwordx4 v6, s[4:7], s21 offen sc1 lds
    s_add_u32 m0, s24, 4096
    s_nop 0
    buffer_load_dwordx4 v7, s[4:7], s21 offen sc1 lds
    s_add_u32 m0, s24, 8192
    s_nop 0
    buffer_load_dwordx4 v8, s[4:7], s21 offen sc1 lds
    s_add_u32 m0, s24, 12288
    s_nop 0
    buffer_load_dwordx4 v9, s[4:7], s21 offen sc1 lds
    s_add_u32 m0, s17, 0
    s_add_u32 s36, s35, 0
    buffer_load_dwordx4 v3, s[12:15], s36 offen lds
    s_add_u32 m0, s17, 1024
    s_add_u32 s36, s35, 7168
    buffer_load_dwordx4 v3, s[12:15], s36 offen lds
    s_add_u32 m0, s17, 2048
    s_add_u32 s36, s35, 14336
    buffer_load_dwordx4 v3, s[12:15], s36 offen lds
    s_add_u32 m0, s17, 3072
    s_add_u32 s36, s35, 21504
    buffer_load_dwordx4 v3, s[12:15], s36 offen lds
    s_add_u32 m0, s17, 16384
    s_add_u32 s36, s35, 28672
    buffer_load_dwordx4 v3, s[12:15], s36 offen lds
    s_add_u32 m0, s17, 17408
    s_add_u32 s36, s35, 35840
    buffer_load_dwordx4 v3, s[12:15], s36 offen lds
    s_add_u32 m0, s17, 18432
    s_add_u32 s36, s35, 43008
    buffer_load_dwordx4 v3, s[12:15], s36 offen lds
    s_add_u32 m0, s17, 19456
    s_add_u32 s36, s35, 50176
    buffer_load_dwordx4 v3, s[12:15], s36 offen lds
T_XE0:
    s_cmp_lg_u32 s18, 0
    s_cbranch_scc1 T_POLLP_OK
    v_and_b32 v27, 15, v1
    v_lshlrev_b32 v27, 7, v27
    s_mov_b32 s33, 0
T_POLLP:
    buffer_load_dword v28, v27, s[8:11], s31 offen sc1
    s_waitcnt vmcnt(0)
    v_cmp_ne_u32 vcc, 0, v28
    s_nop 0
    s_and_b32 s32, vcc_lo, 0xffff
    s_cmp_eq_u32 s32, 0xffff
    s_cbranch_scc1 T_POLLP_OK
    s_sleep 1
    s_add_u32 s33, s33, 1
    s_cmp_lt_u32 s33, 0x40000
    s_cbranch_scc1 T_POLLP
T_POLLP_OK:
    s_barrier
    s_mov_b32 s3, 0x5000000
    buffer_load_dwordx4 v[48:51], v19, s[8:11], s3 offen sc1
    buffer_load_dwordx4 v[52:55], v22, s[8:11], s3 offen sc1
    s_add_u32 s3, s3, 0x1c0000
    buffer_load_dwordx4 v[56:59], v19, s[8:11], s3 offen sc1
    buffer_load_dwordx4 v[60:63], v22, s[8:11], s3 offen sc1
    s_add_u32 s3, s3, 0x1c0000
    buffer_load_dwordx4 v[64:67], v19, s[8:11], s3 offen sc1
    buffer_load_dwordx4 v[68:71], v22, s[8:11], s3 offen sc1
    s_add_u32 s3, s3, 0x1c0000
    buffer_load_dwordx4 v[72:75], v19, s[8:11], s3 offen sc1
    buffer_load_dwordx4 v[76:79], v22, s[8:11], s3 offen sc1
    s_add_u32 s3, s3, 0x1c0000
    buffer_load_dwordx4 v[80:83], v19, s[8:11], s3 offen sc1
    buffer_load_dwordx4 v[84:87], v22, s[8:11], s3 offen sc1
    s_add_u32 s3, s3, 0x1c0000
    buffer_load_dwordx4 v[88:91], v19, s[8:11], s3 offen sc1
    buffer_load_dwordx4 v[92:95], v22, s[8:11], s3 offen sc1
    s_add_u32 s3, s3, 0x1c0000
    buffer_load_dwordx4 v[96:99], v19, s[8:11], s3 offen sc1
    buffer_load_dwordx4 v[100:103], v22, s[8:11], s3 offen sc1
    s_add_u32 s3, s3, 0x1c0000
    buffer_load_dwordx4 v[104:107], v19, s[8:11], s3 offen sc1
    buffer_load_dwordx4 v[108:111], v22, s[8:11], s3 offen sc1
    s_add_u32 s3, s3, 0x1c0000
    s_waitcnt vmcnt(14)
    v_dot2c_f32_bf16 v240, s26, v48
    v_dot2c_f32_bf16 v241, s27, v48
    v_dot2c_f32_bf16 v242, s26, v49
    v_dot2c_f32_bf16 v243, s27, v49
    v_dot2c_f32_bf16 v244, s26, v50
    v_dot2c_f32_bf16 v245, s27, v50
    v_dot2c_f32_bf16 v246, s26, v51
    v_dot2c_f32_bf16 v247, s27, v51
    v_dot2c_f32_bf16 v248, s26, v52
    v_dot2c_f32_bf16 v249, s27, v52
    v_dot2c_f32_bf16 v250, s26, v53
    v_dot2c_f32_bf16 v251, s27, v53
    v_dot2c_f32_bf16 v252, s26, v54
    v_dot2c_f32_bf16 v253, s27, v54
    v_dot2c_f32_bf16 v254, s26, v55
    v_dot2c_f32_bf16 v255, s27, v55
    s_waitcnt vmcnt(12)
    v_dot2c_f32_bf16 v240, s26, v56
    v_dot2c_f32_bf16 v241, s27, v56
    v_dot2c_f32_bf16 v242, s26, v57
    v_dot2c_f32_bf16 v243, s27, v57
    v_dot2c_f32_bf16 v244, s26, v58
    v_dot2c_f32_bf16 v245, s27, v58
    v_dot2c_f32_bf16 v246, s26, v59
    v_dot2c_f32_bf16 v247, s27, v59
    v_dot2c_f32_bf16 v248, s26, v60
    v_dot2c_f32_bf16 v249, s27, v60
    v_dot2c_f32_bf16 v250, s26, v61
    v_dot2c_f32_bf16 v251, s27, v61
    v_dot2c_f32_bf16 v252, s26, v62
    v_dot2c_f32_bf16 v253, s27, v62
    v_dot2c_f32_bf16 v254, s26, v63
    v_dot2c_f32_bf16 v255, s27, v63
    s_waitcnt vmcnt(10)
    v_dot2c_f32_bf16 v240, s26, v64
    v_dot2c_f32_bf16 v241, s27, v64
    v_dot2c_f32_bf16 v242, s26, v65
    v_dot2c_f32_bf16 v243, s27, v65
    v_dot2c_f32_bf16 v244, s26, v66
    v_dot2c_f32_bf16 v245, s27, v66
    v_dot2c_f32_bf16 v246, s26, v67
    v_dot2c_f32_bf16 v247, s27, v67
    v_dot2c_f32_bf16 v248, s26, v68
    v_dot2c_f32_bf16 v249, s27, v68
    v_dot2c_f32_bf16 v250, s26, v69
    v_dot2c_f32_bf16 v251, s27, v69
    v_dot2c_f32_bf16 v252, s26, v70
    v_dot2c_f32_bf16 v253, s27, v70
    v_dot2c_f32_bf16 v254, s26, v71
    v_dot2c_f32_bf16 v255, s27, v71
    s_waitcnt vmcnt(8)
    v_dot2c_f32_bf16 v240, s26, v72
    v_dot2c_f32_bf16 v241, s27, v72
    v_dot2c_f32_bf16 v242, s26, v73
    v_dot2c_f32_bf16 v243, s27, v73
    v_dot2c_f32_bf16 v244, s26, v74
    v_dot2c_f32_bf16 v245, s27, v74
    v_dot2c_f32_bf16 v246, s26, v75
    v_dot2c_f32_bf16 v247, s27, v75
    v_dot2c_f32_bf16 v248, s26, v76
    v_dot2c_f32_bf16 v249, s27, v76
    v_dot2c_f32_bf16 v250, s26, v77
    v_dot2c_f32_bf16 v251, s27, v77
    v_dot2c_f32_bf16 v252, s26, v78
    v_dot2c_f32_bf16 v253, s27, v78
    v_dot2c_f32_bf16 v254, s26, v79
    v_dot2c_f32_bf16 v255, s27, v79
    s_waitcnt vmcnt(6)
    v_dot2c_f32_bf16 v240, s26, v80
    v_dot2c_f32_bf16 v241, s27, v80
    v_dot2c_f32_bf16 v242, s26, v81
    v_dot2c_f32_bf16 v243, s27, v81
    v_dot2c_f32_bf16 v244, s26, v82
    v_dot2c_f32_bf16 v245, s27, v82
    v_dot2c_f32_bf16 v246, s26, v83
    v_dot2c_f32_bf16 v247, s27, v83
    v_dot2c_f32_bf16 v248, s26, v84
    v_dot2c_f32_bf16 v249, s27, v84
    v_dot2c_f32_bf16 v250, s26, v85
    v_dot2c_f32_bf16 v251, s27, v85
    v_dot2c_f32_bf16 v252, s26, v86
    v_dot2c_f32_bf16 v253, s27, v86
    v_dot2c_f32_bf16 v254, s26, v87
    v_dot2c_f32_bf16 v255, s27, v87
    s_waitcnt vmcnt(4)
    v_dot2c_f32_bf16 v240, s26, v88
    v_dot2c_f32_bf16 v241, s27, v88
    v_dot2c_f32_bf16 v242, s26, v89
    v_dot2c_f32_bf16 v243, s27, v89
    v_dot2c_f32_bf16 v244, s26, v90
    v_dot2c_f32_bf16 v245, s27, v90
    v_dot2c_f32_bf16 v246, s26, v91
    v_dot2c_f32_bf16 v247, s27, v91
    v_dot2c_f32_bf16 v248, s26, v92
    v_dot2c_f32_bf16 v249, s27, v92
    v_dot2c_f32_bf16 v250, s26, v93
    v_dot2c_f32_bf16 v251, s27, v93
    v_dot2c_f32_bf16 v252, s26, v94
    v_dot2c_f32_bf16 v253, s27, v94
    v_dot2c_f32_bf16 v254, s26, v95
    v_dot2c_f32_bf16 v255, s27, v95
    s_waitcnt vmcnt(2)
    v_dot2c_f32_bf16 v240, s26, v96
    v_dot2c_f32_bf16 v241, s27, v96
    v_dot2c_f32_bf16 v242, s26, v97
    v_dot2c_f32_bf16 v243, s27, v97
    v_dot2c_f32_bf16 v244, s26, v98
    v_dot2c_f32_bf16 v245, s27, v98
    v_dot2c_f32_bf16 v246, s26, v99
    v_dot2c_f32_bf16 v247, s27, v99
    v_dot2c_f32_bf16 v248, s26, v100
    v_dot2c_f32_bf16 v249, s27, v100
    v_dot2c_f32_bf16 v250, s26, v101
    v_dot2c_f32_bf16 v251, s27, v101
    v_dot2c_f32_bf16 v252, s26, v102
    v_dot2c_f32_bf16 v253, s27, v102
    v_dot2c_f32_bf16 v254, s26, v103
    v_dot2c_f32_bf16 v255, s27, v103
    s_waitcnt vmcnt(0)
    v_dot2c_f32_bf16 v240, s26, v104
    v_dot2c_f32_bf16 v241, s27, v104
    v_dot2c_f32_bf16 v242, s26, v105
    v_dot2c_f32_bf16 v243, s27, v105
    v_dot2c_f32_bf16 v244, s26, v106
    v_dot2c_f32_bf16 v245, s27, v106
    v_dot2c_f32_bf16 v246, s26, v107
    v_dot2c_f32_bf16 v247, s27, v107
    v_dot2c_f32_bf16 v248, s26, v108
    v_dot2c_f32_bf16 v249, s27, v108
    v_dot2c_f32_bf16 v250, s26, v109
    v_dot2c_f32_bf16 v251, s27, v109
    v_dot2c_f32_bf16 v252, s26, v110
    v_dot2c_f32_bf16 v253, s27, v110
    v_dot2c_f32_bf16 v254, s26, v111
    v_dot2c_f32_bf16 v255, s27, v111
    s_cmp_eq_u32 s18, 0
    s_cbranch_scc0 T_XE1
    s_add_u32 m0, s24, 0
    s_nop 0
    buffer_load_dwordx4 v6, s[4:7], s21 offen sc1 lds
    s_add_u32 m0, s24, 4096
    s_nop 0
    buffer_load_dwordx4 v7, s[4:7], s21 offen sc1 lds
    s_add_u32 m0, s24, 8192
    s_nop 0
    buffer_load_dwordx4 v8, s[4:7], s21 offen sc1 lds
    s_add_u32 m0, s24, 12288
    s_nop 0
    buffer_load_dwordx4 v9, s[4:7], s21 offen sc1 lds
    s_add_u32 m0, s24, 16384
    s_nop 0
    buffer_load_dwordx4 v10, s[4:7], s21 offen sc1 lds
    s_add_u32 m0, s24, 20480
    s_nop 0
    buffer_load_dwordx4 v11, s[4:7], s21 offen sc1 lds
    s_add_u32 m0, s24, 24576
    s_nop 0
    buffer_load_dwordx4 v12, s[4:7], s21 offen sc1 lds
    s_add_u32 m0, s24, 28672
    s_nop 0
    buffer_load_dwordx4 v13, s[4:7], s21 offen sc1 lds
    s_add_u32 s21, s21, s22
    s_add_u32 s24, s24, 0x8000
    s_cmp_ge_u32 s24, 0x28000
    s_cselect_b32 s24, s49, s24
    s_add_u32 m0, s24, 0
    s_nop 0
    buffer_load_dwordx4 v6, s[4:7], s21 offen sc1 lds
    s_add_u32 m0, s24, 4096
    s_nop 0
    buffer_load_dwordx4 v7, s[4:7], s21 offen sc1 lds
    s_add_u32 m0, s24, 8192
    s_nop 0
    buffer_load_dwordx4 v8, s[4:7], s21 offen sc1 lds
    s_add_u32 m0, s24, 12288
    s_nop 0
    buffer_load_dwordx4 v9, s[4:7], s21 offen sc1 lds
    s_add_u32 m0, s24, 16384
    s_nop 0
    buffer_load_dwordx4 v10, s[4:7], s21 offen sc1 lds
    s_add_u32 m0, s24, 20480
    s_nop 0
    buffer_load_dwordx4 v11, s[4:7], s21 offen sc1 lds
    s_add_u32 m0, s24, 24576
    s_nop 0
    buffer_load_dwordx4 v12, s[4:7], s21 offen sc1 lds
    s_add_u32 m0, s24, 28672
    s_nop 0
    buffer_load_dwordx4 v13, s[4:7], s21 offen sc1 lds
    s_add_u32 s21, s21, s22
    s_add_u32 s24, s24, 0x8000
    s_cmp_ge_u32 s24, 0x28000
    s_cselect_b32 s24, s49, s24
    s_add_u32 m0, s24, 0
    s_nop 0
    buffer_load_dwordx4 v6, s[4:7], s21 offen sc1 lds
    s_add_u32 m0, s24, 4096
    s_nop 0
    buffer_load_dwordx4 v7, s[4:7], s21 offen sc1 lds
    s_add_u32 m0, s24, 8192
    s_nop 0
    buffer_load_dwordx4 v8, s[4:7], s21 offen sc1 lds
    s_add_u32 m0, s24, 12288
    s_nop 0
    buffer_load_dwordx4 v9, s[4:7], s21 offen sc1 lds
    s_add_u32 m0, s24, 16384
    s_nop 0
    buffer_load_dwordx4 v10, s[4:7], s21 offen sc1 lds
    s_add_u32 m0, s24, 20480
    s_nop 0
    buffer_load_dwordx4 v11, s[4:7], s21 offen sc1 lds
    s_add_u32 m0, s24, 24576
    s_nop 0
    buffer_load_dwordx4 v12, s[4:7], s21 offen sc1 lds
    s_add_u32 m0, s24, 28672
    s_nop 0
    buffer_load_dwordx4 v13, s[4:7], s21 offen sc1 lds
    s_add_u32 s21, s21, s22
    s_add_u32 s24, s24, 0x8000
    s_cmp_ge_u32 s24, 0x28000
    s_cselect_b32 s24, s49, s24
T_W1_4:
    s_add_u32 m0, s24, 0
    s_nop 0
    buffer_load_dwordx4 v6, s[4:7], s21 offen sc1 lds
    s_add_u32 m0, s24, 4096
    s_nop 0
    buffer_load_dwordx4 v7, s[4:7], s21 offen sc1 lds
    s_add_u32 m0, s24, 8192
    s_nop 0
    buffer_load_dwordx4 v8, s[4:7], s21 offen sc1 lds
    s_add_u32 m0, s24, 12288
    s_nop 0
    buffer_load_dwordx4 v9, s[4:7], s21 offen sc1 lds
    s_add_u32 m0, s17, 0
    s_add_u32 s36, s35, 0
    buffer_load_dwordx4 v3, s[12:15], s36 offen lds
    s_add_u32 m0, s17, 1024
    s_add_u32 s36, s35, 7168
    buffer_load_dwordx4 v3, s[12:15], s36 offen lds
    s_add_u32 m0, s17, 2048
    s_add_u32 s36, s35, 14336
    buffer_load_dwordx4 v3, s[12:15], s36 offen lds
    s_add_u32 m0, s17, 3072
    s_add_u32 s36, s35, 21504
    buffer_load_dwordx4 v3, s[12:15], s36 offen lds
    s_add_u32 m0, s17, 16384
    s_add_u32 s36, s35, 28672
    buffer_load_dwordx4 v3, s[12:15], s36 offen lds
    s_add_u32 m0, s17, 17408
    s_add_u32 s36, s35, 35840
    buffer_load_dwordx4 v3, s[12:15], s36 offen lds
    s_add_u32 m0, s17, 18432
    s_add_u32 s36, s35, 43008
    buffer_load_dwordx4 v3, s[12:15], s36 offen lds
    s_add_u32 m0, s17, 19456
    s_add_u32 s36, s35, 50176
    buffer_load_dwordx4 v3, s[12:15], s36 offen lds
T_XE1:
    v_lshlrev_b32 v48, 16, v176
    v_and_b32 v49, 0xffff0000, v176
    v_lshlrev_b32 v50, 16, v177
    v_and_b32 v51, 0xffff0000, v177
    v_lshlrev_b32 v52, 16, v178
    v_and_b32 v53, 0xffff0000, v178
    v_lshlrev_b32 v54, 16, v179
    v_and_b32 v55, 0xffff0000, v179
    v_lshlrev_b32 v56, 16, v180
    v_and_b32 v57, 0xffff0000, v180
    v_lshlrev_b32 v58, 16, v181
    v_and_b32 v59, 0xffff0000, v181
    v_lshlrev_b32 v60, 16, v182
    v_and_b32 v61, 0xffff0000, v182
    v_lshlrev_b32 v62, 16, v183
    v_and_b32 v63, 0xffff0000, v183
    s_add_u32 s3, s43, 16384
    v_lshl_add_u32 v25, v16, 5, s3
    s_lshl_b32 s3, s18, 3
    v_add_u32 v26, s3, v25
    v_pk_fma_f32 v[240:241], v[240:241], v[184:185], v[48:49]
    v_pk_fma_f32 v[242:243], v[242:243], v[186:187], v[50:51]
    v_pk_fma_f32 v[244:245], v[244:245], v[188:189], v[52:53]
    v_pk_fma_f32 v[246:247], v[246:247], v[190:191], v[54:55]
    v_pk_fma_f32 v[248:249], v[248:249], v[192:193], v[56:57]
    v_pk_fma_f32 v[250:251], v[250:251], v[194:195], v[58:59]
    v_pk_fma_f32 v[252:253], v[252:253], v[196:197], v[60:61]
    v_pk_fma_f32 v[254:255], v[254:255], v[198:199], v[62:63]
    v_cvt_pk_bf16_f32 v176, v240, v241
    v_cvt_pk_bf16_f32 v177, v242, v243
    v_cvt_pk_bf16_f32 v178, v244, v245
    v_cvt_pk_bf16_f32 v179, v246, v247
    v_cvt_pk_bf16_f32 v180, v248, v249
    v_cvt_pk_bf16_f32 v181, v250, v251
    v_cvt_pk_bf16_f32 v182, v252, v253
    v_cvt_pk_bf16_f32 v183, v254, v255
    s_mov_b32 s3, 0x400000
    buffer_store_dwordx4 v[176:179], v19, s[8:11], s3 offen sc1
    buffer_store_dwordx4 v[180:183], v22, s[8:11], s3 offen sc1
    v_lshlrev_b32 v240, 16, v176
    v_and_b32 v241, 0xffff0000, v176
    v_lshlrev_b32 v242, 16, v177
    v_and_b32 v243, 0xffff0000, v177
    v_lshlrev_b32 v244, 16, v178
    v_and_b32 v245, 0xffff0000, v178
    v_lshlrev_b32 v246, 16, v179
    v_and_b32 v247, 0xffff0000, v179
    v_lshlrev_b32 v248, 16, v180
    v_and_b32 v249, 0xffff0000, v180
    v_lshlrev_b32 v250, 16, v181
    v_and_b32 v251, 0xffff0000, v181
    v_lshlrev_b32 v252, 16, v182
    v_and_b32 v253, 0xffff0000, v182
    v_lshlrev_b32 v254, 16, v183
    v_and_b32 v255, 0xffff0000, v183
    v_pk_add_f32 v[36:37], v[240:241], v[242:243]
    v_pk_add_f32 v[36:37], v[36:37], v[244:245]
    v_pk_add_f32 v[36:37], v[36:37], v[246:247]
    v_pk_add_f32 v[36:37], v[36:37], v[248:249]
    v_pk_add_f32 v[36:37], v[36:37], v[250:251]
    v_pk_add_f32 v[36:37], v[36:37], v[252:253]
    v_pk_add_f32 v[36:37], v[36:37], v[254:255]
    v_add_f32 v36, v36, v37
    s_nop 1
    v_add_f32_dpp v36, v36, v36 row_ror:8 row_mask:0xf bank_mask:0xf
    v_mov_b32 v38, v36
    s_nop 1
    v_permlane16_swap_b32 v36, v38
    v_add_f32 v36, v36, v38
    v_mov_b32 v38, v36
    s_nop 1
    v_permlane32_swap_b32 v36, v38
    v_add_f32 v36, v36, v38
    v_mul_f32 v40, s34, v36
    v_mov_b32 v37, 0
    v_mov_b32 v39, 0
    v_sub_f32 v41, v240, v40
    v_fmac_f32 v37, v41, v41
    v_sub_f32 v41, v241, v40
    v_fmac_f32 v37, v41, v41
    v_sub_f32 v41, v242, v40
    v_fmac_f32 v37, v41, v41
    v_sub_f32 v41, v243, v40
    v_fmac_f32 v37, v41, v41
    v_sub_f32 v41, v244, v40
    v_fmac_f32 v37, v41, v41
    v_sub_f32 v41, v245, v40
    v_fmac_f32 v37, v41, v41
    v_sub_f32 v41, v246, v40
    v_fmac_f32 v37, v41, v41
    v_sub_f32 v41, v247, v40
    v_fmac_f32 v37, v41, v41
    v_sub_f32 v41, v248, v40
    v_fmac_f32 v39, v41, v41
    v_sub_f32 v41, v249, v40
    v_fmac_f32 v39, v41, v41
    v_sub_f32 v41, v250, v40
    v_fmac_f32 v39, v41, v41
    v_sub_f32 v41, v251, v40
    v_fmac_f32 v39, v41, v41
    v_sub_f32 v41, v252, v40
    v_fmac_f32 v39, v41, v41
    v_sub_f32 v41, v253, v40
    v_fmac_f32 v39, v41, v41
    v_sub_f32 v41, v254, v40
    v_fmac_f32 v39, v41, v41
    v_sub_f32 v41, v255, v40
    v_fmac_f32 v39, v41, v41
    v_fmac_f32 v37, s29, v39
    s_nop 1
    v_add_f32_dpp v37, v37, v37 row_ror:8 row_mask:0xf bank_mask:0xf
    v_mov_b32 v38, v37
    s_nop 1
    v_permlane16_swap_b32 v37, v38
    v_add_f32 v37, v37, v38
    v_mov_b32 v38, v37
    s_nop 1
    v_permlane32_swap_b32 v37, v38
    v_add_f32 v37, v37, v38
    ds_write_b64 v26, v[36:37]
    s_waitcnt lgkmcnt(0)
    s_barrier
    ds_read_b128 v[28:31], v25
    ds_read_b128 v[32:35], v25 offset:16
    s_waitcnt lgkmcnt(0)
    v_add_f32 v40, v28, v30
    v_add_f32 v41, v32, v34
    v_add_f32 v40, v40, v41
    v_mul_f32 v40, 0x3b124925, v40
    v_add_f32 v41, v29, v31
    v_add_f32 v42, v33, v35
    v_add_f32 v41, v41, v42
    v_mul_f32 v42, 0x3c000000, v28
    v_sub_f32 v42, v42, v40
    v_mul_f32 v42, v42, v42
    v_fmac_f32 v41, 0x43000000, v42
    v_mul_f32 v42, 0x3c000000, v30
    v_sub_f32 v42, v42, v40
    v_mul_f32 v42, v42, v42
    v_fmac_f32 v41, 0x43000000, v42
    v_mul_f32 v42, 0x3c000000, v32
    v_sub_f32 v42, v42, v40
    v_mul_f32 v42, v42, v42
    v_fmac_f32 v41, 0x43000000, v42
    v_mul_f32 v42, 0x3c800000, v34
    v_sub_f32 v42, v42, v40
    v_mul_f32 v42, v42, v42
    v_fmac_f32 v41, 0x42800000, v42
    v_mov_b32 v42, 0x3727c5ac
    v_fmac_f32 v42, 0x3b124925, v41
    v_rsq_f32 v42, v42
    v_pk_add_f32 v[240:241], v[240:241], v[40:41] op_sel_hi:[1,0] neg_lo:[0,1] neg_hi:[0,1]
    v_pk_add_f32 v[242:243], v[242:243], v[40:41] op_sel_hi:[1,0] neg_lo:[0,1] neg_hi:[0,1]
    v_pk_add_f32 v[244:245], v[244:245], v[40:41] op_sel_hi:[1,0] neg_lo:[0,1] neg_hi:[0,1]
    v_pk_add_f32 v[246:247], v[246:247], v[40:41] op_sel_hi:[1,0] neg_lo:[0,1] neg_hi:[0,1]
    v_pk_add_f32 v[248:249], v[248:249], v[40:41] op_sel_hi:[1,0] neg_lo:[0,1] neg_hi:[0,1]
    v_pk_add_f32 v[250:251], v[250:251], v[40:41] op_sel_hi:[1,0] neg_lo:[0,1] neg_hi:[0,1]
    v_pk_add_f32 v[252:253], v[252:253], v[40:41] op_sel_hi:[1,0] neg_lo:[0,1] neg_hi:[0,1]
    v_pk_add_f32 v[254:255], v[254:255], v[40:41] op_sel_hi:[1,0] neg_lo:[0,1] neg_hi:[0,1]
    v_pk_mul_f32 v[240:241], v[240:241], v[42:43] op_sel_hi:[1,0]
    v_pk_fma_f32 v[240:241], v[240:241], v[200:201], v[216:217]
    v_pk_mul_f32 v[242:243], v[242:243], v[42:43] op_sel_hi:[1,0]
    v_pk_fma_f32 v[242:243], v[242:243], v[202:203], v[218:219]
    v_pk_mul_f32 v[244:245], v[244:245], v[42:43] op_sel_hi:[1,0]
    v_pk_fma_f32 v[244:245], v[244:245], v[204:205], v[220:221]
    v_pk_mul_f32 v[246:247], v[246:247], v[42:43] op_sel_hi:[1,0]
    v_pk_fma_f32 v[246:247], v[246:247], v[206:207], v[222:223]
    v_pk_mul_f32 v[248:249], v[248:249], v[42:43] op_sel_hi:[1,0]
    v_pk_fma_f32 v[248:249], v[248:249], v[208:209], v[224:225]
    v_pk_mul_f32 v[250:251], v[250:251], v[42:43] op_sel_hi:[1,0]
    v_pk_fma_f32 v[250:251], v[250:251], v[210:211], v[226:227]
    v_pk_mul_f32 v[252:253], v[252:253], v[42:43] op_sel_hi:[1,0]
    v_pk_fma_f32 v[252:253], v[252:253], v[212:213], v[228:229]
    v_pk_mul_f32 v[254:255], v[254:255], v[42:43] op_sel_hi:[1,0]
    v_pk_fma_f32 v[254:255], v[254:255], v[214:215], v[230:231]
    v_cvt_pk_bf16_f32 v48, v240, v241
    v_cvt_pk_bf16_f32 v49, v242, v243
    v_cvt_pk_bf16_f32 v50, v244, v245
    v_cvt_pk_bf16_f32 v51, v246, v247
    v_cvt_pk_bf16_f32 v52, v248, v249
    v_cvt_pk_bf16_f32 v53, v250, v251
    v_cvt_pk_bf16_f32 v54, v252, v253
    v_cvt_pk_bf16_f32 v55, v254, v255
    s_mov_b32 s3, 0x800000
    buffer_store_dwordx4 v[48:51], v19, s[8:11], s3 offen sc1
    buffer_store_dwordx4 v[52:55], v22, s[8:11], s3 offen sc1
    s_and_b32 s3, s19, 14
    s_lshr_b32 s30, s97, 3
    s_add_u32 s3, s3, s30
    s_lshl_b32 s30, s3, 6
    s_add_u32 s30, s30, 0x4c00
    v_lshrrev_b32 v36, 2, v1
    v_and_b32 v38, 3, v1
    v_lshlrev_b32 v37, 8, v36
    v_lshl_add_u32 v37, v38, 3, v37
    v_and_b32 v39, 7, v36
    v_lshl_add_u32 v37, v39, 5, v37
    v_xor_b32 v16, 0, v37
    v_xor_b32 v17, 32, v37
    v_xor_b32 v18, 64, v37
    v_xor_b32 v19, 96, v37
    v_xor_b32 v20, 128, v37
    v_xor_b32 v21, 160, v37
    v_xor_b32 v22, 192, v37
    v_xor_b32 v23, 224, v37
    v_lshlrev_b32 v37, 7, v36
    v_lshl_add_u32 v37, v38, 3, v37
    v_bfe_u32 v39, v36, 1, 2
    v_lshl_add_u32 v37, v39, 5, v37
    v_xor_b32 v4, 0, v37
    v_xor_b32 v5, 32, v37
    v_xor_b32 v6, 64, v37
    v_xor_b32 v7, 96, v37
    s_waitcnt vmcnt(0)
    s_barrier
    s_cmp_lg_u32 s18, 0
    s_cbranch_scc1 T_SIGH2
    v_mov_b32 v36, 1
    v_lshlrev_b32 v38, 2, s48
    s_mov_b64 exec, 1
    s_cmp_eq_u32 s96, 1
    s_cbranch_scc0 T_SIGH2_S
    buffer_store_dword v36, v38, s[8:11], s30 offen
    s_branch T_SIGH2_D
T_SIGH2_S:
    buffer_store_dword v36, v38, s[8:11], s30 offen sc1
T_SIGH2_D:
    s_mov_b64 exec, -1
T_SIGH2:
    s_cmp_ge_u32 s48, 14
    s_cbranch_scc1 K_FIN
    v_add_u32 v24, s40, v16
    v_add_u32 v25, s40, v17
    v_add_u32 v26, s40, v18
    v_add_u32 v27, s40, v19
    v_add_u32 v28, s40, v20
    v_add_u32 v29, s40, v21
    v_add_u32 v30, s40, v22
    v_add_u32 v31, s40, v23
    v_add_u32 v8, s17, v4
    v_add_u32 v9, s17, v5
    v_add_u32 v10, s17, v6
    v_add_u32 v11, s17, v7
    ds_read_b64_tr_b16 a[0:1], v24 offset:0
    ds_read_b64_tr_b16 a[2:3], v24 offset:4096
    ds_read_b64_tr_b16 a[4:5], v25 offset:0
    ds_read_b64_tr_b16 a[6:7], v25 offset:4096
    ds_read_b64_tr_b16 a[8:9], v26 offset:0
    ds_read_b64_tr_b16 a[10:11], v26 offset:4096
    ds_read_b64_tr_b16 a[12:13], v27 offset:0
    ds_read_b64_tr_b16 a[14:15], v27 offset:4096
    ds_read_b64_tr_b16 a[16:17], v28 offset:0
    ds_read_b64_tr_b16 a[18:19], v28 offset:4096
    ds_read_b64_tr_b16 a[20:21], v29 offset:0
    ds_read_b64_tr_b16 a[22:23], v29 offset:4096
    ds_read_b64_tr_b16 a[24:25], v30 offset:0
    ds_read_b64_tr_b16 a[26:27], v30 offset:4096
    ds_read_b64_tr_b16 a[28:29], v31 offset:0
    ds_read_b64_tr_b16 a[30:31], v31 offset:4096
    ds_read_b64_tr_b16 a[32:33], v24 offset:8192
    ds_read_b64_tr_b16 a[34:35], v24 offset:12288
    ds_read_b64_tr_b16 a[36:37], v25 offset:8192
    ds_read_b64_tr_b16 a[38:39], v25 offset:12288
    ds_read_b64_tr_b16 a[40:41], v26 offset:8192
    ds_read_b64_tr_b16 a[42:43], v26 offset:12288
    ds_read_b64_tr_b16 a[44:45], v27 offset:8192
    ds_read_b64_tr_b16 a[46:47], v27 offset:12288
    ds_read_b64_tr_b16 a[48:49], v28 offset:8192
    ds_read_b64_tr_b16 a[50:51], v28 offset:12288
    ds_read_b64_tr_b16 a[52:53], v29 offset:8192
    ds_read_b64_tr_b16 a[54:55], v29 offset:12288
    ds_read_b64_tr_b16 a[56:57], v30 offset:8192
    ds_read_b64_tr_b16 a[58:59], v30 offset:12288
    ds_read_b64_tr_b16 a[60:61], v31 offset:8192
    ds_read_b64_tr_b16 a[62:63], v31 offset:12288
    ds_read_b64_tr_b16 a[128:129], v8 offset:0
    ds_read_b64_tr_b16 a[130:131], v8 offset:2048
    ds_read_b64_tr_b16 a[132:133], v9 offset:0
    ds_read_b64_tr_b16 a[134:135], v9 offset:2048
    ds_read_b64_tr_b16 a[136:137], v10 offset:0
    ds_read_b64_tr_b16 a[138:139], v10 offset:2048
    ds_read_b64_tr_b16 a[140:141], v11 offset:0
    ds_read_b64_tr_b16 a[142:143], v11 offset:2048
    ds_read_b64_tr_b16 a[144:145], v8 offset:16384
    ds_read_b64_tr_b16 a[146:147], v8 offset:18432
    ds_read_b64_tr_b16 a[148:149], v9 offset:16384
    ds_read_b64_tr_b16 a[150:151], v9 offset:18432
    ds_read_b64_tr_b16 a[152:153], v10 offset:16384
    ds_read_b64_tr_b16 a[154:155], v10 offset:18432
    ds_read_b64_tr_b16 a[156:157], v11 offset:16384
    ds_read_b64_tr_b16 a[158:159], v11 offset:18432
    s_lshl_b32 s22, s97, 3
    s_lshl_b32 s3, s18, 1
    s_add_u32 s22, s22, s3
    s_mul_i32 s26, s22, 14336
    s_add_u32 s26, s26, 0x800000
    v_and_b32 v38, 15, v1
    v_lshlrev_b32 v38, 2, v38
    s_mov_b32 s33, 0
T_POLLH2:
    buffer_load_dword v36, v38, s[8:11], s30 offen sc1
    s_waitcnt vmcnt(0)
    v_cmp_ne_u32 vcc, 0, v36
    s_nop 0
    s_and_b32 s32, vcc_lo, 0xffff
    s_cmp_eq_u32 s32, 0xffff
    s_cbranch_scc1 T_POLLH2_OK
    s_sleep 1
    s_add_u32 s33, s33, 1
    s_cmp_lt_u32 s33, 0x40000
    s_cbranch_scc1 T_POLLH2
T_POLLH2_OK:
    s_add_u32 s27, s26, 0
    buffer_load_dwordx4 v[48:51], v2, s[8:11], s27 offen offset:0 sc1
    s_add_u32 s27, s26, 12288
    buffer_load_dwordx4 v[52:55], v2, s[8:11], s27 offen offset:2048 sc1
    s_add_u32 s27, s26, 0
    buffer_load_dwordx4 v[56:59], v2, s[8:11], s27 offen offset:1024 sc1
    s_add_u32 s27, s26, 12288
    buffer_load_dwordx4 v[60:63], v2, s[8:11], s27 offen offset:3072 sc1
    s_add_u32 s27, s26, 0
    buffer_load_dwordx4 v[64:67], v2, s[8:11], s27 offen offset:2048 sc1
    s_add_u32 s27, s26, 16384
    buffer_load_dwordx4 v[68:71], v2, s[8:11], s27 offen offset:0 sc1
    s_add_u32 s27, s26, 0
    buffer_load_dwordx4 v[72:75], v2, s[8:11], s27 offen offset:3072 sc1
    s_add_u32 s27, s26, 16384
    buffer_load_dwordx4 v[76:79], v2, s[8:11], s27 offen offset:1024 sc1
    s_add_u32 s27, s26, 4096
    buffer_load_dwordx4 v[80:83], v2, s[8:11], s27 offen offset:0 sc1
    s_add_u32 s27, s26, 16384
    buffer_load_dwordx4 v[84:87], v2, s[8:11], s27 offen offset:2048 sc1
    s_add_u32 s27, s26, 4096
    buffer_load_dwordx4 v[88:91], v2, s[8:11], s27 offen offset:1024 sc1
    s_add_u32 s27, s26, 16384
    buffer_load_dwordx4 v[92:95], v2, s[8:11], s27 offen offset:3072 sc1
    s_waitcnt vmcnt(8) lgkmcnt(0)
    v_mfma_f32_16x16x32_bf16 v[160:163], a[0:3], v[48:51], 0
    ds_read_b64_tr_b16 a[64:65], v24 offset:16384
    ds_read_b64_tr_b16 a[66:67], v24 offset:20480
    v_mfma_f32_16x16x32_bf16 v[192:195], a[0:3], v[52:55], 0
    ds_read_b64_tr_b16 a[68:69], v25 offset:16384
    v_mfma_f32_16x16x32_bf16 v[164:167], a[4:7], v[48:51], 0
    s_add_u32 s27, s26, 4096
    buffer_load_dwordx4 v[96:99], v2, s[8:11], s27 offen offset:2048 sc1
    v_mfma_f32_16x16x32_bf16 v[196:199], a[4:7], v[52:55], 0
    ds_read_b64_tr_b16 a[70:71], v25 offset:20480
    v_mfma_f32_16x16x32_bf16 v[168:171], a[8:11], v[48:51], 0
    ds_read_b64_tr_b16 a[72:73], v26 offset:16384
    ds_read_b64_tr_b16 a[74:75], v26 offset:20480
    v_mfma_f32_16x16x32_bf16 v[200:203], a[8:11], v[52:55], 0
    ds_read_b64_tr_b16 a[76:77], v27 offset:16384
    v_mfma_f32_16x16x32_bf16 v[172:175], a[12:15], v[48:51], 0
    s_add_u32 s27, s26, 20480
    buffer_load_dwordx4 v[100:103], v2, s[8:11], s27 offen offset:0 sc1
    v_mfma_f32_16x16x32_bf16 v[204:207], a[12:15], v[52:55], 0
    ds_read_b64_tr_b16 a[78:79], v27 offset:20480
    v_mfma_f32_16x16x32_bf16 v[176:179], a[16:19], v[48:51], 0
    ds_read_b64_tr_b16 a[80:81], v28 offset:16384
    ds_read_b64_tr_b16 a[82:83], v28 offset:20480
    v_mfma_f32_16x16x32_bf16 v[208:211], a[16:19], v[52:55], 0
    ds_read_b64_tr_b16 a[84:85], v29 offset:16384
    v_mfma_f32_16x16x32_bf16 v[180:183], a[20:23], v[48:51], 0
    s_add_u32 s27, s26, 4096
    buffer_load_dwordx4 v[104:107], v2, s[8:11], s27 offen offset:3072 sc1
    v_mfma_f32_16x16x32_bf16 v[212:215], a[20:23], v[52:55], 0
    ds_read_b64_tr_b16 a[86:87], v29 offset:20480
    v_mfma_f32_16x16x32_bf16 v[184:187], a[24:27], v[48:51], 0
    s_waitcnt lgkmcnt(8)
    ds_read_b64_tr_b16 a[88:89], v30 offset:16384
    ds_read_b64_tr_b16 a[90:91], v30 offset:20480
    v_mfma_f32_16x16x32_bf16 v[216:219], a[24:27], v[52:55], 0
    ds_read_b64_tr_b16 a[92:93], v31 offset:16384
    v_mfma_f32_16x16x32_bf16 v[188:191], a[28:31], v[48:51], 0
    s_add_u32 s27, s26, 20480
    buffer_load_dwordx4 v[108:111], v2, s[8:11], s27 offen offset:1024 sc1
    v_mfma_f32_16x16x32_bf16 v[220:223], a[28:31], v[52:55], 0
    ds_read_b64_tr_b16 a[94:95], v31 offset:20480
    v_mfma_f32_16x16x32_bf16 v[160:163], a[32:35], v[56:59], v[160:163]
    ds_read_b64_tr_b16 a[96:97], v24 offset:24576
    ds_read_b64_tr_b16 a[98:99], v24 offset:28672
    v_mfma_f32_16x16x32_bf16 v[192:195], a[32:35], v[60:63], v[192:195]
    ds_read_b64_tr_b16 a[100:101], v25 offset:24576
    v_mfma_f32_16x16x32_bf16 v[164:167], a[36:39], v[56:59], v[164:167]
    s_add_u32 s27, s26, 8192
    buffer_load_dwordx4 v[112:115], v2, s[8:11], s27 offen offset:0 sc1
    v_mfma_f32_16x16x32_bf16 v[196:199], a[36:39], v[60:63], v[196:199]
    ds_read_b64_tr_b16 a[102:103], v25 offset:28672
    v_mfma_f32_16x16x32_bf16 v[168:171], a[40:43], v[56:59], v[168:171]
    ds_read_b64_tr_b16 a[104:105], v26 offset:24576
    ds_read_b64_tr_b16 a[106:107], v26 offset:28672
    v_mfma_f32_16x16x32_bf16 v[200:203], a[40:43], v[60:63], v[200:203]
    ds_read_b64_tr_b16 a[108:109], v27 offset:24576
    v_mfma_f32_16x16x32_bf16 v[172:175], a[44:47], v[56:59], v[172:175]
    s_add_u32 s27, s26, 20480
    buffer_load_dwordx4 v[116:119], v2, s[8:11], s27 offen offset:2048 sc1
    v_mfma_f32_16x16x32_bf16 v[204:207], a[44:47], v[60:63], v[204:207]
    ds_read_b64_tr_b16 a[110:111], v27 offset:28672
    v_mfma_f32_16x16x32_bf16 v[176:179], a[48:51], v[56:59], v[176:179]
    ds_read_b64_tr_b16 a[112:113], v28 offset:24576
    ds_read_b64_tr_b16 a[114:115], v28 offset:28672
    v_mfma_f32_16x16x32_bf16 v[208:211], a[48:51], v[60:63], v[208:211]
    ds_read_b64_tr_b16 a[116:117], v29 offset:24576
    v_mfma_f32_16x16x32_bf16 v[180:183], a[52:55], v[56:59], v[180:183]
    s_add_u32 s27, s26, 8192
    buffer_load_dwordx4 v[120:123], v2, s[8:11], s27 offen offset:1024 sc1
    v_mfma_f32_16x16x32_bf16 v[212:215], a[52:55], v[60:63], v[212:215]
    ds_read_b64_tr_b16 a[118:119], v29 offset:28672
    v_mfma_f32_16x16x32_bf16 v[184:187], a[56:59], v[56:59], v[184:187]
    ds_read_b64_tr_b16 a[120:121], v30 offset:24576
    ds_read_b64_tr_b16 a[122:123], v30 offset:28672
    v_mfma_f32_16x16x32_bf16 v[216:219], a[56:59], v[60:63], v[216:219]
    ds_read_b64_tr_b16 a[124:125], v31 offset:24576
    v_mfma_f32_16x16x32_bf16 v[188:191], a[60:63], v[56:59], v[188:191]
    s_add_u32 s27, s26, 20480
    buffer_load_dwordx4 v[124:127], v2, s[8:11], s27 offen offset:3072 sc1
    v_mfma_f32_16x16x32_bf16 v[220:223], a[60:63], v[60:63], v[220:223]
    ds_read_b64_tr_b16 a[126:127], v31 offset:28672
    s_waitcnt vmcnt(12) lgkmcnt(8)
    v_mfma_f32_16x16x32_bf16 v[160:163], a[64:67], v[64:67], v[160:163]
    v_add_u32 v24, s41, v16
    v_add_u32 v25, s41, v17
    v_mfma_f32_16x16x32_bf16 v[192:195], a[64:67], v[68:71], v[192:195]
    ds_read_b64_tr_b16 a[0:1], v24 offset:0
    ds_read_b64_tr_b16 a[2:3], v24 offset:4096
    v_add_u32 v26, s41, v18
    v_mfma_f32_16x16x32_bf16 v[164:167], a[68:71], v[64:67], v[164:167]
    s_add_u32 s27, s26, 8192
    buffer_load_dwordx4 v[128:131], v2, s[8:11], s27 offen offset:2048 sc1
    v_mfma_f32_16x16x32_bf16 v[196:199], a[68:71], v[68:71], v[196:199]
    ds_read_b64_tr_b16 a[4:5], v25 offset:0
    v_add_u32 v27, s41, v19
    v_mfma_f32_16x16x32_bf16 v[168:171], a[72:75], v[64:67], v[168:171]
    ds_read_b64_tr_b16 a[6:7], v25 offset:4096
    ds_read_b64_tr_b16 a[8:9], v26 offset:0
    v_add_u32 v28, s41, v20
    v_mfma_f32_16x16x32_bf16 v[200:203], a[72:75], v[68:71], v[200:203]
    ds_read_b64_tr_b16 a[10:11], v26 offset:4096
    v_add_u32 v29, s41, v21
    v_mfma_f32_16x16x32_bf16 v[172:175], a[76:79], v[64:67], v[172:175]
    s_add_u32 s27, s26, 24576
    buffer_load_dwordx4 v[132:135], v2, s[8:11], s27 offen offset:0 sc1
    v_mfma_f32_16x16x32_bf16 v[204:207], a[76:79], v[68:71], v[204:207]
    ds_read_b64_tr_b16 a[12:13], v27 offset:0
    v_add_u32 v30, s41, v22
    v_mfma_f32_16x16x32_bf16 v[176:179], a[80:83], v[64:67], v[176:179]
    ds_read_b64_tr_b16 a[14:15], v27 offset:4096
    ds_read_b64_tr_b16 a[16:17], v28 offset:0
    v_add_u32 v31, s41, v23
    v_mfma_f32_16x16x32_bf16 v[208:211], a[80:83], v[68:71], v[208:211]
    ds_read_b64_tr_b16 a[18:19], v28 offset:4096
    v_mfma_f32_16x16x32_bf16 v[180:183], a[84:87], v[64:67], v[180:183]
    s_add_u32 s27, s26, 8192
    buffer_load_dwordx4 v[136:139], v2, s[8:11], s27 offen offset:3072 sc1
    v_mfma_f32_16x16x32_bf16 v[212:215], a[84:87], v[68:71], v[212:215]
    ds_read_b64_tr_b16 a[20:21], v29 offset:0
    ds_read_b64_tr_b16 a[22:23], v29 offset:4096
    v_mfma_f32_16x16x32_bf16 v[184:187], a[88:91], v[64:67], v[184:187]
    s_waitcnt lgkmcnt(8)
    ds_read_b64_tr_b16 a[24:25], v30 offset:0
    v_mfma_f32_16x16x32_bf16 v[216:219], a[88:91], v[68:71], v[216:219]
    ds_read_b64_tr_b16 a[26:27], v30 offset:4096
    v_mfma_f32_16x16x32_bf16 v[188:191], a[92:95], v[64:67], v[188:191]
    s_add_u32 s27, s26, 24576
    buffer_load_dwordx4 v[140:143], v2, s[8:11], s27 offen offset:1024 sc1
    v_mfma_f32_16x16x32_bf16 v[220:223], a[92:95], v[68:71], v[220:223]
    ds_read_b64_tr_b16 a[28:29], v31 offset:0
    ds_read_b64_tr_b16 a[30:31], v31 offset:4096
    v_mfma_f32_16x16x32_bf16 v[160:163], a[96:99], v[72:75], v[160:163]
    ds_read_b64_tr_b16 a[32:33], v24 offset:8192
    v_mfma_f32_16x16x32_bf16 v[192:195], a[96:99], v[76:79], v[192:195]
    ds_read_b64_tr_b16 a[34:35], v24 offset:12288
    ds_read_b64_tr_b16 a[36:37], v25 offset:8192
    v_mfma_f32_16x16x32_bf16 v[164:167], a[100:103], v[72:75], v[164:167]
    s_add_u32 s27, s26, 12288
    buffer_load_dwordx4 v[144:147], v2, s[8:11], s27 offen offset:0 sc1
    v_mfma_f32_16x16x32_bf16 v[196:199], a[100:103], v[76:79], v[196:199]
    ds_read_b64_tr_b16 a[38:39], v25 offset:12288
    v_mfma_f32_16x16x32_bf16 v[168:171], a[104:107], v[72:75], v[168:171]
    ds_read_b64_tr_b16 a[40:41], v26 offset:8192
    v_mfma_f32_16x16x32_bf16 v[200:203], a[104:107], v[76:79], v[200:203]
    ds_read_b64_tr_b16 a[42:43], v26 offset:12288
    ds_read_b64_tr_b16 a[44:45], v27 offset:8192
    v_mfma_f32_16x16x32_bf16 v[172:175], a[108:111], v[72:75], v[172:175]
    s_add_u32 s27, s26, 24576
    buffer_load_dwordx4 v[148:151], v2, s[8:11], s27 offen offset:2048 sc1
    v_mfma_f32_16x16x32_bf16 v[204:207], a[108:111], v[76:79], v[204:207]
    ds_read_b64_tr_b16 a[46:47], v27 offset:12288
    v_mfma_f32_16x16x32_bf16 v[176:179], a[112:115], v[72:75], v[176:179]
    ds_read_b64_tr_b16 a[48:49], v28 offset:8192
    ds_read_b64_tr_b16 a[50:51], v28 offset:12288
    v_mfma_f32_16x16x32_bf16 v[208:211], a[112:115], v[76:79], v[208:211]
    ds_read_b64_tr_b16 a[52:53], v29 offset:8192
    v_mfma_f32_16x16x32_bf16 v[180:183], a[116:119], v[72:75], v[180:183]
    s_add_u32 s27, s26, 12288
    buffer_load_dwordx4 v[152:155], v2, s[8:11], s27 offen offset:1024 sc1
    v_mfma_f32_16x16x32_bf16 v[212:215], a[116:119], v[76:79], v[212:215]
    ds_read_b64_tr_b16 a[54:55], v29 offset:12288
    v_mfma_f32_16x16x32_bf16 v[184:187], a[120:123], v[72:75], v[184:187]
    ds_read_b64_tr_b16 a[56:57], v30 offset:8192
    ds_read_b64_tr_b16 a[58:59], v30 offset:12288
    v_mfma_f32_16x16x32_bf16 v[216:219], a[120:123], v[76:79], v[216:219]
    ds_read_b64_tr_b16 a[60:61], v31 offset:8192
    v_mfma_f32_16x16x32_bf16 v[188:191], a[124:127], v[72:75], v[188:191]
    s_add_u32 s27, s26, 24576
    buffer_load_dwordx4 v[156:159], v2, s[8:11], s27 offen offset:3072 sc1
    v_mfma_f32_16x16x32_bf16 v[220:223], a[124:127], v[76:79], v[220:223]
    ds_read_b64_tr_b16 a[62:63], v31 offset:12288
    s_waitcnt vmcnt(16) lgkmcnt(8)
    s_barrier
    v_mfma_f32_16x16x32_bf16 v[160:163], a[0:3], v[80:83], v[160:163]
    ds_read_b64_tr_b16 a[64:65], v24 offset:16384
    ds_read_b64_tr_b16 a[66:67], v24 offset:20480
    v_mfma_f32_16x16x32_bf16 v[192:195], a[0:3], v[84:87], v[192:195]
    s_add_u32 m0, s17, 0
    ds_read_b64_tr_b16 a[68:69], v25 offset:16384
    v_mfma_f32_16x16x32_bf16 v[164:167], a[4:7], v[80:83], v[164:167]
    s_add_u32 s36, s35, 57344
    buffer_load_dwordx4 v3, s[12:15], s36 offen lds
    v_mfma_f32_16x16x32_bf16 v[196:199], a[4:7], v[84:87], v[196:199]
    ds_read_b64_tr_b16 a[70:71], v25 offset:20480
    v_mfma_f32_16x16x32_bf16 v[168:171], a[8:11], v[80:83], v[168:171]
    ds_read_b64_tr_b16 a[72:73], v26 offset:16384
    ds_read_b64_tr_b16 a[74:75], v26 offset:20480
    v_mfma_f32_16x16x32_bf16 v[200:203], a[8:11], v[84:87], v[200:203]
    s_add_u32 m0, s17, 1024
    ds_read_b64_tr_b16 a[76:77], v27 offset:16384
    v_mfma_f32_16x16x32_bf16 v[172:175], a[12:15], v[80:83], v[172:175]
    s_add_u32 s36, s35, 64512
    buffer_load_dwordx4 v3, s[12:15], s36 offen lds
    v_mfma_f32_16x16x32_bf16 v[204:207], a[12:15], v[84:87], v[204:207]
    ds_read_b64_tr_b16 a[78:79], v27 offset:20480
    v_mfma_f32_16x16x32_bf16 v[176:179], a[16:19], v[80:83], v[176:179]
    ds_read_b64_tr_b16 a[80:81], v28 offset:16384
    ds_read_b64_tr_b16 a[82:83], v28 offset:20480
    v_mfma_f32_16x16x32_bf16 v[208:211], a[16:19], v[84:87], v[208:211]
    s_add_u32 m0, s17, 2048
    ds_read_b64_tr_b16 a[84:85], v29 offset:16384
    v_mfma_f32_16x16x32_bf16 v[180:183], a[20:23], v[80:83], v[180:183]
    s_add_u32 s36, s35, 71680
    buffer_load_dwordx4 v3, s[12:15], s36 offen lds
    v_mfma_f32_16x16x32_bf16 v[212:215], a[20:23], v[84:87], v[212:215]
    ds_read_b64_tr_b16 a[86:87], v29 offset:20480
    v_mfma_f32_16x16x32_bf16 v[184:187], a[24:27], v[80:83], v[184:187]
    s_waitcnt lgkmcnt(8)
    ds_read_b64_tr_b16 a[88:89], v30 offset:16384
    ds_read_b64_tr_b16 a[90:91], v30 offset:20480
    v_mfma_f32_16x16x32_bf16 v[216:219], a[24:27], v[84:87], v[216:219]
    s_add_u32 m0, s17, 3072
    ds_read_b64_tr_b16 a[92:93], v31 offset:16384
    v_mfma_f32_16x16x32_bf16 v[188:191], a[28:31], v[80:83], v[188:191]
    s_add_u32 s36, s35, 78848
    buffer_load_dwordx4 v3, s[12:15], s36 offen lds
    v_mfma_f32_16x16x32_bf16 v[220:223], a[28:31], v[84:87], v[220:223]
    ds_read_b64_tr_b16 a[94:95], v31 offset:20480
    v_mfma_f32_16x16x32_bf16 v[160:163], a[32:35], v[88:91], v[160:163]
    ds_read_b64_tr_b16 a[96:97], v24 offset:24576
    ds_read_b64_tr_b16 a[98:99], v24 offset:28672
    v_mfma_f32_16x16x32_bf16 v[192:195], a[32:35], v[92:95], v[192:195]
    s_add_u32 m0, s17, 16384
    ds_read_b64_tr_b16 a[100:101], v25 offset:24576
    v_mfma_f32_16x16x32_bf16 v[164:167], a[36:39], v[88:91], v[164:167]
    s_add_u32 s36, s35, 86016
    buffer_load_dwordx4 v3, s[12:15], s36 offen lds
    v_mfma_f32_16x16x32_bf16 v[196:199], a[36:39], v[92:95], v[196:199]
    ds_read_b64_tr_b16 a[102:103], v25 offset:28672
    v_mfma_f32_16x16x32_bf16 v[168:171], a[40:43], v[88:91], v[168:171]
    ds_read_b64_tr_b16 a[104:105], v26 offset:24576
    ds_read_b64_tr_b16 a[106:107], v26 offset:28672
    v_mfma_f32_16x16x32_bf16 v[200:203], a[40:43], v[92:95], v[200:203]
    s_add_u32 m0, s17, 17408
    ds_read_b64_tr_b16 a[108:109], v27 offset:24576
    v_mfma_f32_16x16x32_bf16 v[172:175], a[44:47], v[88:91], v[172:175]
    s_add_u32 s36, s35, 93184
    buffer_load_dwordx4 v3, s[12:15], s36 offen lds
    v_mfma_f32_16x16x32_bf16 v[204:207], a[44:47], v[92:95], v[204:207]
    ds_read_b64_tr_b16 a[110:111], v27 offset:28672
    v_mfma_f32_16x16x32_bf16 v[176:179], a[48:51], v[88:91], v[176:179]
    ds_read_b64_tr_b16 a[112:113], v28 offset:24576
    ds_read_b64_tr_b16 a[114:115], v28 offset:28672
    v_mfma_f32_16x16x32_bf16 v[208:211], a[48:51], v[92:95], v[208:211]
    s_add_u32 m0, s17, 18432
    ds_read_b64_tr_b16 a[116:117], v29 offset:24576
    v_mfma_f32_16x16x32_bf16 v[180:183], a[52:55], v[88:91], v[180:183]
    s_add_u32 s36, s35, 100352
    buffer_load_dwordx4 v3, s[12:15], s36 offen lds
    v_mfma_f32_16x16x32_bf16 v[212:215], a[52:55], v[92:95], v[212:215]
    ds_read_b64_tr_b16 a[118:119], v29 offset:28672
    v_mfma_f32_16x16x32_bf16 v[184:187], a[56:59], v[88:91], v[184:187]
    ds_read_b64_tr_b16 a[120:121], v30 offset:24576
    ds_read_b64_tr_b16 a[122:123], v30 offset:28672
    v_mfma_f32_16x16x32_bf16 v[216:219], a[56:59], v[92:95], v[216:219]
    s_add_u32 m0, s17, 19456
    ds_read_b64_tr_b16 a[124:125], v31 offset:24576
    v_mfma_f32_16x16x32_bf16 v[188:191], a[60:63], v[88:91], v[188:191]
    s_add_u32 s36, s35, 107520
    buffer_load_dwordx4 v3, s[12:15], s36 offen lds
    v_mfma_f32_16x16x32_bf16 v[220:223], a[60:63], v[92:95], v[220:223]
    ds_read_b64_tr_b16 a[126:127], v31 offset:28672
    s_waitcnt vmcnt(20) lgkmcnt(8)
    v_mfma_f32_16x16x32_bf16 v[160:163], a[64:67], v[96:99], v[160:163]
    v_add_u32 v24, s42, v16
    v_add_u32 v25, s42, v17
    v_mfma_f32_16x16x32_bf16 v[192:195], a[64:67], v[100:103], v[192:195]
    s_add_u32 m0, s16, 16384
    ds_read_b64_tr_b16 a[0:1], v24 offset:0
    ds_read_b64_tr_b16 a[2:3], v24 offset:4096
    v_add_u32 v26, s42, v18
    v_mfma_f32_16x16x32_bf16 v[164:167], a[68:71], v[96:99], v[164:167]
    s_add_u32 s36, s35, 114688
    buffer_load_dwordx4 v3, s[12:15], s36 offen lds
    v_mfma_f32_16x16x32_bf16 v[196:199], a[68:71], v[100:103], v[196:199]
    ds_read_b64_tr_b16 a[4:5], v25 offset:0
    v_add_u32 v27, s42, v19
    v_mfma_f32_16x16x32_bf16 v[168:171], a[72:75], v[96:99], v[168:171]
    ds_read_b64_tr_b16 a[6:7], v25 offset:4096
    ds_read_b64_tr_b16 a[8:9], v26 offset:0
    v_add_u32 v28, s42, v20
    v_mfma_f32_16x16x32_bf16 v[200:203], a[72:75], v[100:103], v[200:203]
    s_add_u32 m0, s16, 17408
    ds_read_b64_tr_b16 a[10:11], v26 offset:4096
    v_add_u32 v29, s42, v21
    v_mfma_f32_16x16x32_bf16 v[172:175], a[76:79], v[96:99], v[172:175]
    s_add_u32 s36, s35, 121856
    buffer_load_dwordx4 v3, s[12:15], s36 offen lds
    v_mfma_f32_16x16x32_bf16 v[204:207], a[76:79], v[100:103], v[204:207]
    ds_read_b64_tr_b16 a[12:13], v27 offset:0
    v_add_u32 v30, s42, v22
    v_mfma_f32_16x16x32_bf16 v[176:179], a[80:83], v[96:99], v[176:179]
    ds_read_b64_tr_b16 a[14:15], v27 offset:4096
    ds_read_b64_tr_b16 a[16:17], v28 offset:0
    v_add_u32 v31, s42, v23
    v_mfma_f32_16x16x32_bf16 v[208:211], a[80:83], v[100:103], v[208:211]
    s_add_u32 m0, s16, 18432
    ds_read_b64_tr_b16 a[18:19], v28 offset:4096
    v_mfma_f32_16x16x32_bf16 v[180:183], a[84:87], v[96:99], v[180:183]
    s_add_u32 s36, s35, 129024
    buffer_load_dwordx4 v3, s[12:15], s36 offen lds
    v_mfma_f32_16x16x32_bf16 v[212:215], a[84:87], v[100:103], v[212:215]
    ds_read_b64_tr_b16 a[20:21], v29 offset:0
    ds_read_b64_tr_b16 a[22:23], v29 offset:4096
    v_mfma_f32_16x16x32_bf16 v[184:187], a[88:91], v[96:99], v[184:187]
    s_waitcnt lgkmcnt(8)
    ds_read_b64_tr_b16 a[24:25], v30 offset:0
    v_mfma_f32_16x16x32_bf16 v[216:219], a[88:91], v[100:103], v[216:219]
    s_add_u32 m0, s16, 19456
    ds_read_b64_tr_b16 a[26:27], v30 offset:4096
    v_mfma_f32_16x16x32_bf16 v[188:191], a[92:95], v[96:99], v[188:191]
    s_add_u32 s36, s35, 136192
    buffer_load_dwordx4 v3, s[12:15], s36 offen lds
    v_mfma_f32_16x16x32_bf16 v[220:223], a[92:95], v[100:103], v[220:223]
    ds_read_b64_tr_b16 a[28:29], v31 offset:0
    ds_read_b64_tr_b16 a[30:31], v31 offset:4096
    v_mfma_f32_16x16x32_bf16 v[160:163], a[96:99], v[104:107], v[160:163]
    ds_read_b64_tr_b16 a[32:33], v24 offset:8192
    v_mfma_f32_16x16x32_bf16 v[192:195], a[96:99], v[108:111], v[192:195]
    s_add_u32 m0, s45, 0
    ds_read_b64_tr_b16 a[34:35], v24 offset:12288
    ds_read_b64_tr_b16 a[36:37], v25 offset:8192
    v_mfma_f32_16x16x32_bf16 v[164:167], a[100:103], v[104:107], v[164:167]
    s_add_u32 s36, s35, 143360
    buffer_load_dwordx4 v3, s[12:15], s36 offen lds
    v_mfma_f32_16x16x32_bf16 v[196:199], a[100:103], v[108:111], v[196:199]
    ds_read_b64_tr_b16 a[38:39], v25 offset:12288
    v_mfma_f32_16x16x32_bf16 v[168:171], a[104:107], v[104:107], v[168:171]
    ds_read_b64_tr_b16 a[40:41], v26 offset:8192
    v_mfma_f32_16x16x32_bf16 v[200:203], a[104:107], v[108:111], v[200:203]
    s_add_u32 m0, s45, 1024
    ds_read_b64_tr_b16 a[42:43], v26 offset:12288
    ds_read_b64_tr_b16 a[44:45], v27 offset:8192
    v_mfma_f32_16x16x32_bf16 v[172:175], a[108:111], v[104:107], v[172:175]
    s_add_u32 s36, s35, 150528
    buffer_load_dwordx4 v3, s[12:15], s36 offen lds
    v_mfma_f32_16x16x32_bf16 v[204:207], a[108:111], v[108:111], v[204:207]
    ds_read_b64_tr_b16 a[46:47], v27 offset:12288
    v_mfma_f32_16x16x32_bf16 v[176:179], a[112:115], v[104:107], v[176:179]
    ds_read_b64_tr_b16 a[48:49], v28 offset:8192
    ds_read_b64_tr_b16 a[50:51], v28 offset:12288
    v_mfma_f32_16x16x32_bf16 v[208:211], a[112:115], v[108:111], v[208:211]
    s_add_u32 m0, s45, 2048
    ds_read_b64_tr_b16 a[52:53], v29 offset:8192
    v_mfma_f32_16x16x32_bf16 v[180:183], a[116:119], v[104:107], v[180:183]
    s_add_u32 s36, s35, 157696
    buffer_load_dwordx4 v3, s[12:15], s36 offen lds
    v_mfma_f32_16x16x32_bf16 v[212:215], a[116:119], v[108:111], v[212:215]
    ds_read_b64_tr_b16 a[54:55], v29 offset:12288
    v_mfma_f32_16x16x32_bf16 v[184:187], a[120:123], v[104:107], v[184:187]
    ds_read_b64_tr_b16 a[56:57], v30 offset:8192
    ds_read_b64_tr_b16 a[58:59], v30 offset:12288
    v_mfma_f32_16x16x32_bf16 v[216:219], a[120:123], v[108:111], v[216:219]
    s_add_u32 m0, s45, 3072
    ds_read_b64_tr_b16 a[60:61], v31 offset:8192
    v_mfma_f32_16x16x32_bf16 v[188:191], a[124:127], v[104:107], v[188:191]
    s_add_u32 s36, s35, 164864
    buffer_load_dwordx4 v3, s[12:15], s36 offen lds
    v_mfma_f32_16x16x32_bf16 v[220:223], a[124:127], v[108:111], v[220:223]
    ds_read_b64_tr_b16 a[62:63], v31 offset:12288
    s_waitcnt vmcnt(24) lgkmcnt(8)
    s_barrier
    v_mfma_f32_16x16x32_bf16 v[160:163], a[0:3], v[112:115], v[160:163]
    ds_read_b64_tr_b16 a[64:65], v24 offset:16384
    ds_read_b64_tr_b16 a[66:67], v24 offset:20480
    v_mfma_f32_16x16x32_bf16 v[192:195], a[0:3], v[116:119], v[192:195]
    s_add_u32 m0, s45, 16384
    ds_read_b64_tr_b16 a[68:69], v25 offset:16384
    v_mfma_f32_16x16x32_bf16 v[164:167], a[4:7], v[112:115], v[164:167]
    s_add_u32 s36, s35, 172032
    buffer_load_dwordx4 v3, s[12:15], s36 offen lds
    v_mfma_f32_16x16x32_bf16 v[196:199], a[4:7], v[116:119], v[196:199]
    ds_read_b64_tr_b16 a[70:71], v25 offset:20480
    v_mfma_f32_16x16x32_bf16 v[168:171], a[8:11], v[112:115], v[168:171]
    ds_read_b64_tr_b16 a[72:73], v26 offset:16384
    ds_read_b64_tr_b16 a[74:75], v26 offset:20480
    v_mfma_f32_16x16x32_bf16 v[200:203], a[8:11], v[116:119], v[200:203]
    s_add_u32 m0, s45, 17408
    ds_read_b64_tr_b16 a[76:77], v27 offset:16384
    v_mfma_f32_16x16x32_bf16 v[172:175], a[12:15], v[112:115], v[172:175]
    s_add_u32 s36, s35, 179200
    buffer_load_dwordx4 v3, s[12:15], s36 offen lds
    v_mfma_f32_16x16x32_bf16 v[204:207], a[12:15], v[116:119], v[204:207]
    ds_read_b64_tr_b16 a[78:79], v27 offset:20480
    v_mfma_f32_16x16x32_bf16 v[176:179], a[16:19], v[112:115], v[176:179]
    ds_read_b64_tr_b16 a[80:81], v28 offset:16384
    ds_read_b64_tr_b16 a[82:83], v28 offset:20480
    v_mfma_f32_16x16x32_bf16 v[208:211], a[16:19], v[116:119], v[208:211]
    s_add_u32 m0, s45, 18432
    ds_read_b64_tr_b16 a[84:85], v29 offset:16384
    v_mfma_f32_16x16x32_bf16 v[180:183], a[20:23], v[112:115], v[180:183]
    s_add_u32 s36, s35, 186368
    buffer_load_dwordx4 v3, s[12:15], s36 offen lds
    v_mfma_f32_16x16x32_bf16 v[212:215], a[20:23], v[116:119], v[212:215]
    ds_read_b64_tr_b16 a[86:87], v29 offset:20480
    v_mfma_f32_16x16x32_bf16 v[184:187], a[24:27], v[112:115], v[184:187]
    s_waitcnt lgkmcnt(8)
    ds_read_b64_tr_b16 a[88:89], v30 offset:16384
    ds_read_b64_tr_b16 a[90:91], v30 offset:20480
    v_mfma_f32_16x16x32_bf16 v[216:219], a[24:27], v[116:119], v[216:219]
    s_add_u32 m0, s45, 19456
    ds_read_b64_tr_b16 a[92:93], v31 offset:16384
    v_mfma_f32_16x16x32_bf16 v[188:191], a[28:31], v[112:115], v[188:191]
    s_add_u32 s36, s35, 193536
    buffer_load_dwordx4 v3, s[12:15], s36 offen lds
    v_mfma_f32_16x16x32_bf16 v[220:223], a[28:31], v[116:119], v[220:223]
    ds_read_b64_tr_b16 a[94:95], v31 offset:20480
    v_mfma_f32_16x16x32_bf16 v[160:163], a[32:35], v[120:123], v[160:163]
    ds_read_b64_tr_b16 a[96:97], v24 offset:24576
    ds_read_b64_tr_b16 a[98:99], v24 offset:28672
    v_mfma_f32_16x16x32_bf16 v[192:195], a[32:35], v[124:127], v[192:195]
    s_add_u32 m0, s46, 0
    ds_read_b64_tr_b16 a[100:101], v25 offset:24576
    v_mfma_f32_16x16x32_bf16 v[164:167], a[36:39], v[120:123], v[164:167]
    s_add_u32 s36, s35, 200704
    buffer_load_dwordx4 v3, s[12:15], s36 offen lds
    v_mfma_f32_16x16x32_bf16 v[196:199], a[36:39], v[124:127], v[196:199]
    ds_read_b64_tr_b16 a[102:103], v25 offset:28672
    v_mfma_f32_16x16x32_bf16 v[168:171], a[40:43], v[120:123], v[168:171]
    ds_read_b64_tr_b16 a[104:105], v26 offset:24576
    ds_read_b64_tr_b16 a[106:107], v26 offset:28672
    v_mfma_f32_16x16x32_bf16 v[200:203], a[40:43], v[124:127], v[200:203]
    s_add_u32 m0, s46, 1024
    ds_read_b64_tr_b16 a[108:109], v27 offset:24576
    v_mfma_f32_16x16x32_bf16 v[172:175], a[44:47], v[120:123], v[172:175]
    s_add_u32 s36, s35, 207872
    buffer_load_dwordx4 v3, s[12:15], s36 offen lds
    v_mfma_f32_16x16x32_bf16 v[204:207], a[44:47], v[124:127], v[204:207]
    ds_read_b64_tr_b16 a[110:111], v27 offset:28672
    v_mfma_f32_16x16x32_bf16 v[176:179], a[48:51], v[120:123], v[176:179]
    ds_read_b64_tr_b16 a[112:113], v28 offset:24576
    ds_read_b64_tr_b16 a[114:115], v28 offset:28672
    v_mfma_f32_16x16x32_bf16 v[208:211], a[48:51], v[124:127], v[208:211]
    s_add_u32 m0, s46, 2048
    ds_read_b64_tr_b16 a[116:117], v29 offset:24576
    v_mfma_f32_16x16x32_bf16 v[180:183], a[52:55], v[120:123], v[180:183]
    s_add_u32 s36, s35, 215040
    buffer_load_dwordx4 v3, s[12:15], s36 offen lds
    v_mfma_f32_16x16x32_bf16 v[212:215], a[52:55], v[124:127], v[212:215]
    ds_read_b64_tr_b16 a[118:119], v29 offset:28672
    v_mfma_f32_16x16x32_bf16 v[184:187], a[56:59], v[120:123], v[184:187]
    ds_read_b64_tr_b16 a[120:121], v30 offset:24576
    ds_read_b64_tr_b16 a[122:123], v30 offset:28672
    v_mfma_f32_16x16x32_bf16 v[216:219], a[56:59], v[124:127], v[216:219]
    s_add_u32 m0, s46, 3072
    ds_read_b64_tr_b16 a[124:125], v31 offset:24576
    v_mfma_f32_16x16x32_bf16 v[188:191], a[60:63], v[120:123], v[188:191]
    s_add_u32 s36, s35, 222208
    buffer_load_dwordx4 v3, s[12:15], s36 offen lds
    v_mfma_f32_16x16x32_bf16 v[220:223], a[60:63], v[124:127], v[220:223]
    ds_read_b64_tr_b16 a[126:127], v31 offset:28672
    s_waitcnt vmcnt(28) lgkmcnt(8)
    v_mfma_f32_16x16x32_bf16 v[160:163], a[64:67], v[128:131], v[160:163]
    v_add_u32 v24, s43, v16
    v_add_u32 v25, s43, v17
    v_mfma_f32_16x16x32_bf16 v[192:195], a[64:67], v[132:135], v[192:195]
    s_add_u32 m0, s46, 16384
    ds_read_b64_tr_b16 a[0:1], v24 offset:0
    ds_read_b64_tr_b16 a[2:3], v24 offset:4096
    v_add_u32 v26, s43, v18
    v_mfma_f32_16x16x32_bf16 v[164:167], a[68:71], v[128:131], v[164:167]
    s_add_u32 s36, s35, 229376
    buffer_load_dwordx4 v3, s[12:15], s36 offen lds
    v_mfma_f32_16x16x32_bf16 v[196:199], a[68:71], v[132:135], v[196:199]
    ds_read_b64_tr_b16 a[4:5], v25 offset:0
    v_add_u32 v27, s43, v19
    v_mfma_f32_16x16x32_bf16 v[168:171], a[72:75], v[128:131], v[168:171]
    ds_read_b64_tr_b16 a[6:7], v25 offset:4096
    v_add_u32 v28, s43, v20
    v_mfma_f32_16x16x32_bf16 v[200:203], a[72:75], v[132:135], v[200:203]
    s_add_u32 m0, s46, 17408
    ds_read_b64_tr_b16 a[8:9], v26 offset:0
    v_add_u32 v29, s43, v21
    v_mfma_f32_16x16x32_bf16 v[172:175], a[76:79], v[128:131], v[172:175]
    s_add_u32 s36, s35, 236544
    buffer_load_dwordx4 v3, s[12:15], s36 offen lds
    v_mfma_f32_16x16x32_bf16 v[204:207], a[76:79], v[132:135], v[204:207]
    ds_read_b64_tr_b16 a[10:11], v26 offset:4096
    v_add_u32 v30, s43, v22
    v_mfma_f32_16x16x32_bf16 v[176:179], a[80:83], v[128:131], v[176:179]
    ds_read_b64_tr_b16 a[12:13], v27 offset:0
    ds_read_b64_tr_b16 a[14:15], v27 offset:4096
    v_add_u32 v31, s43, v23
    v_mfma_f32_16x16x32_bf16 v[208:211], a[80:83], v[132:135], v[208:211]
    s_add_u32 m0, s46, 18432
    ds_read_b64_tr_b16 a[16:17], v28 offset:0
    v_mfma_f32_16x16x32_bf16 v[180:183], a[84:87], v[128:131], v[180:183]
    s_add_u32 s36, s35, 243712
    buffer_load_dwordx4 v3, s[12:15], s36 offen lds
    v_mfma_f32_16x16x32_bf16 v[212:215], a[84:87], v[132:135], v[212:215]
    ds_read_b64_tr_b16 a[18:19], v28 offset:4096
    v_mfma_f32_16x16x32_bf16 v[184:187], a[88:91], v[128:131], v[184:187]
    s_waitcnt lgkmcnt(8)
    ds_read_b64_tr_b16 a[20:21], v29 offset:0
    v_mfma_f32_16x16x32_bf16 v[216:219], a[88:91], v[132:135], v[216:219]
    s_add_u32 m0, s46, 19456
    ds_read_b64_tr_b16 a[22:23], v29 offset:4096
    v_mfma_f32_16x16x32_bf16 v[188:191], a[92:95], v[128:131], v[188:191]
    s_add_u32 s36, s35, 250880
    buffer_load_dwordx4 v3, s[12:15], s36 offen lds
    v_mfma_f32_16x16x32_bf16 v[220:223], a[92:95], v[132:135], v[220:223]
    ds_read_b64_tr_b16 a[24:25], v30 offset:0
    ds_read_b64_tr_b16 a[26:27], v30 offset:4096
    v_mfma_f32_16x16x32_bf16 v[160:163], a[96:99], v[136:139], v[160:163]
    ds_read_b64_tr_b16 a[28:29], v31 offset:0
    v_mfma_f32_16x16x32_bf16 v[192:195], a[96:99], v[140:143], v[192:195]
    ds_read_b64_tr_b16 a[30:31], v31 offset:4096
    v_mfma_f32_16x16x32_bf16 v[164:167], a[100:103], v[136:139], v[164:167]
    ds_read_b64_tr_b16 a[32:33], v24 offset:8192
    v_mfma_f32_16x16x32_bf16 v[196:199], a[100:103], v[140:143], v[196:199]
    ds_read_b64_tr_b16 a[34:35], v24 offset:12288
    v_mfma_f32_16x16x32_bf16 v[168:171], a[104:107], v[136:139], v[168:171]
    ds_read_b64_tr_b16 a[36:37], v25 offset:8192
    v_mfma_f32_16x16x32_bf16 v[200:203], a[104:107], v[140:143], v[200:203]
    ds_read_b64_tr_b16 a[38:39], v25 offset:12288
    ds_read_b64_tr_b16 a[40:41], v26 offset:8192
    v_mfma_f32_16x16x32_bf16 v[172:175], a[108:111], v[136:139], v[172:175]
    ds_read_b64_tr_b16 a[42:43], v26 offset:12288
    v_mfma_f32_16x16x32_bf16 v[204:207], a[108:111], v[140:143], v[204:207]
    ds_read_b64_tr_b16 a[44:45], v27 offset:8192
    v_mfma_f32_16x16x32_bf16 v[176:179], a[112:115], v[136:139], v[176:179]
    ds_read_b64_tr_b16 a[46:47], v27 offset:12288
    v_mfma_f32_16x16x32_bf16 v[208:211], a[112:115], v[140:143], v[208:211]
    ds_read_b64_tr_b16 a[48:49], v28 offset:8192
    v_mfma_f32_16x16x32_bf16 v[180:183], a[116:119], v[136:139], v[180:183]
    ds_read_b64_tr_b16 a[50:51], v28 offset:12288
    ds_read_b64_tr_b16 a[52:53], v29 offset:8192
    v_mfma_f32_16x16x32_bf16 v[212:215], a[116:119], v[140:143], v[212:215]
    ds_read_b64_tr_b16 a[54:55], v29 offset:12288
    v_mfma_f32_16x16x32_bf16 v[184:187], a[120:123], v[136:139], v[184:187]
    ds_read_b64_tr_b16 a[56:57], v30 offset:8192
    v_mfma_f32_16x16x32_bf16 v[216:219], a[120:123], v[140:143], v[216:219]
    ds_read_b64_tr_b16 a[58:59], v30 offset:12288
    v_mfma_f32_16x16x32_bf16 v[188:191], a[124:127], v[136:139], v[188:191]
    ds_read_b64_tr_b16 a[60:61], v31 offset:8192
    v_mfma_f32_16x16x32_bf16 v[220:223], a[124:127], v[140:143], v[220:223]
    ds_read_b64_tr_b16 a[62:63], v31 offset:12288
    s_waitcnt vmcnt(28) lgkmcnt(8)
    s_barrier
    v_mfma_f32_16x16x32_bf16 v[160:163], a[0:3], v[144:147], v[160:163]
    v_mfma_f32_16x16x32_bf16 v[192:195], a[0:3], v[148:151], v[192:195]
    s_add_u32 m0, s47, 0
    v_mfma_f32_16x16x32_bf16 v[164:167], a[4:7], v[144:147], v[164:167]
    s_add_u32 s36, s35, 258048
    buffer_load_dwordx4 v3, s[12:15], s36 offen lds
    v_mfma_f32_16x16x32_bf16 v[196:199], a[4:7], v[148:151], v[196:199]
    v_mfma_f32_16x16x32_bf16 v[168:171], a[8:11], v[144:147], v[168:171]
    v_mfma_f32_16x16x32_bf16 v[200:203], a[8:11], v[148:151], v[200:203]
    s_add_u32 m0, s47, 1024
    v_mfma_f32_16x16x32_bf16 v[172:175], a[12:15], v[144:147], v[172:175]
    s_add_u32 s36, s35, 265216
    buffer_load_dwordx4 v3, s[12:15], s36 offen lds
    v_mfma_f32_16x16x32_bf16 v[204:207], a[12:15], v[148:151], v[204:207]
    v_mfma_f32_16x16x32_bf16 v[176:179], a[16:19], v[144:147], v[176:179]
    v_mfma_f32_16x16x32_bf16 v[208:211], a[16:19], v[148:151], v[208:211]
    s_add_u32 m0, s47, 2048
    v_mfma_f32_16x16x32_bf16 v[180:183], a[20:23], v[144:147], v[180:183]
    s_add_u32 s36, s35, 272384
    buffer_load_dwordx4 v3, s[12:15], s36 offen lds
    v_mfma_f32_16x16x32_bf16 v[212:215], a[20:23], v[148:151], v[212:215]
    v_mfma_f32_16x16x32_bf16 v[184:187], a[24:27], v[144:147], v[184:187]
    s_waitcnt lgkmcnt(0)
    v_mfma_f32_16x16x32_bf16 v[216:219], a[24:27], v[148:151], v[216:219]
    s_add_u32 m0, s47, 3072
    v_mfma_f32_16x16x32_bf16 v[188:191], a[28:31], v[144:147], v[188:191]
    s_add_u32 s36, s35, 279552
    buffer_load_dwordx4 v3, s[12:15], s36 offen lds
    v_mfma_f32_16x16x32_bf16 v[220:223], a[28:31], v[148:151], v[220:223]
    v_mfma_f32_16x16x32_bf16 v[160:163], a[32:35], v[152:155], v[160:163]
    s_waitcnt vmcnt(24)
    v_mfma_f32_16x16x32_bf16 v[192:195], a[32:35], v[156:159], v[192:195]
    s_add_u32 m0, s47, 16384
    ds_read_b64_tr_b16 a[160:161], v8 offset:0
    v_mfma_f32_16x16x32_bf16 v[164:167], a[36:39], v[152:155], v[164:167]
    s_add_u32 s36, s35, 286720
    buffer_load_dwordx4 v3, s[12:15], s36 offen lds
    v_mfma_f32_16x16x32_bf16 v[196:199], a[36:39], v[156:159], v[196:199]
    ds_read_b64_tr_b16 a[162:163], v8 offset:2048
    v_mfma_f32_16x16x32_bf16 v[168:171], a[40:43], v[152:155], v[168:171]
    ds_read_b64_tr_b16 a[164:165], v9 offset:0
    v_mfma_f32_16x16x32_bf16 v[200:203], a[40:43], v[156:159], v[200:203]
    s_add_u32 m0, s47, 17408
    ds_read_b64_tr_b16 a[166:167], v9 offset:2048
    v_mfma_f32_16x16x32_bf16 v[172:175], a[44:47], v[152:155], v[172:175]
    s_add_u32 s36, s35, 293888
    buffer_load_dwordx4 v3, s[12:15], s36 offen lds
    v_mfma_f32_16x16x32_bf16 v[204:207], a[44:47], v[156:159], v[204:207]
    ds_read_b64_tr_b16 a[168:169], v10 offset:0
    v_mfma_f32_16x16x32_bf16 v[176:179], a[48:51], v[152:155], v[176:179]
    ds_read_b64_tr_b16 a[170:171], v10 offset:2048
    v_mfma_f32_16x16x32_bf16 v[208:211], a[48:51], v[156:159], v[208:211]
    s_add_u32 m0, s47, 18432
    ds_read_b64_tr_b16 a[172:173], v11 offset:0
    ds_read_b64_tr_b16 a[190:191], v11 offset:18432
    v_mfma_f32_16x16x32_bf16 v[180:183], a[52:55], v[152:155], v[180:183]
    s_add_u32 s36, s35, 301056
    buffer_load_dwordx4 v3, s[12:15], s36 offen lds
    v_mfma_f32_16x16x32_bf16 v[212:215], a[52:55], v[156:159], v[212:215]
    ds_read_b64_tr_b16 a[174:175], v11 offset:2048
    ds_read_b64_tr_b16 a[188:189], v11 offset:16384
    v_mfma_f32_16x16x32_bf16 v[184:187], a[56:59], v[152:155], v[184:187]
    ds_read_b64_tr_b16 a[176:177], v8 offset:16384
    ds_read_b64_tr_b16 a[186:187], v10 offset:18432
    v_mfma_f32_16x16x32_bf16 v[216:219], a[56:59], v[156:159], v[216:219]
    s_add_u32 m0, s47, 19456
    ds_read_b64_tr_b16 a[178:179], v8 offset:18432
    ds_read_b64_tr_b16 a[184:185], v10 offset:16384
    v_mfma_f32_16x16x32_bf16 v[188:191], a[60:63], v[152:155], v[188:191]
    s_add_u32 s36, s35, 308224
    buffer_load_dwordx4 v3, s[12:15], s36 offen lds
    v_mfma_f32_16x16x32_bf16 v[220:223], a[60:63], v[156:159], v[220:223]
    ds_read_b64_tr_b16 a[180:181], v9 offset:16384
    ds_read_b64_tr_b16 a[182:183], v9 offset:18432
    s_mul_i32 s26, s22, 57344
    s_lshl_b32 s3, s48, 12
    s_add_u32 s26, s26, s3
    s_add_u32 s26, s26, 0xc00000
    s_add_u32 s27, s26, 57344
    s_waitcnt lgkmcnt(0)
    s_barrier
    s_add_u32 m0, s16, 0
    s_add_u32 s36, s35, 315392
    buffer_load_dwordx4 v3, s[12:15], s36 offen lds
    v_exp_f32 v48, -v160
    v_exp_f32 v49, -v161
    v_exp_f32 v50, -v162
    v_exp_f32 v51, -v163
    v_exp_f32 v52, -v164
    v_exp_f32 v53, -v165
    v_exp_f32 v54, -v166
    v_exp_f32 v55, -v167
    s_add_u32 m0, s16, 1024
    s_add_u32 s36, s35, 322560
    buffer_load_dwordx4 v3, s[12:15], s36 offen lds
    v_pk_add_f32 v[48:49], v[48:49], 1.0 op_sel_hi:[1,0]
    v_pk_add_f32 v[50:51], v[50:51], 1.0 op_sel_hi:[1,0]
    v_pk_add_f32 v[52:53], v[52:53], 1.0 op_sel_hi:[1,0]
    v_pk_add_f32 v[54:55], v[54:55], 1.0 op_sel_hi:[1,0]
    v_rcp_f32 v48, v48
    v_rcp_f32 v49, v49
    v_rcp_f32 v50, v50
    v_rcp_f32 v51, v51
    v_rcp_f32 v52, v52
    v_rcp_f32 v53, v53
    v_rcp_f32 v54, v54
    v_rcp_f32 v55, v55
    v_pk_mul_f32 v[48:49], v[48:49], v[160:161]
    v_pk_mul_f32 v[50:51], v[50:51], v[162:163]
    v_pk_mul_f32 v[52:53], v[52:53], v[164:165]
    v_pk_mul_f32 v[54:55], v[54:55], v[166:167]
    v_cvt_pk_bf16_f32 v56, v48, v49
    v_cvt_pk_bf16_f32 v57, v50, v51
    v_cvt_pk_bf16_f32 v58, v52, v53
    v_cvt_pk_bf16_f32 v59, v54, v55
    buffer_store_dwordx4 v[56:59], v2, s[8:11], s26 offen offset:0 sc1
    s_add_u32 m0, s16, 2048
    s_add_u32 s36, s35, 329728
    buffer_load_dwordx4 v3, s[12:15], s36 offen lds
    v_exp_f32 v64, -v168
    v_exp_f32 v65, -v169
    v_exp_f32 v66, -v170
    v_exp_f32 v67, -v171
    v_exp_f32 v68, -v172
    v_exp_f32 v69, -v173
    v_exp_f32 v70, -v174
    v_exp_f32 v71, -v175
    s_add_u32 m0, s16, 3072
    s_add_u32 s36, s35, 336896
    buffer_load_dwordx4 v3, s[12:15], s36 offen lds
    v_pk_add_f32 v[64:65], v[64:65], 1.0 op_sel_hi:[1,0]
    v_pk_add_f32 v[66:67], v[66:67], 1.0 op_sel_hi:[1,0]
    v_pk_add_f32 v[68:69], v[68:69], 1.0 op_sel_hi:[1,0]
    v_pk_add_f32 v[70:71], v[70:71], 1.0 op_sel_hi:[1,0]
    v_rcp_f32 v64, v64
    v_rcp_f32 v65, v65
    v_rcp_f32 v66, v66
    v_rcp_f32 v67, v67
    v_rcp_f32 v68, v68
    v_rcp_f32 v69, v69
    v_rcp_f32 v70, v70
    v_rcp_f32 v71, v71
    v_pk_mul_f32 v[64:65], v[64:65], v[168:169]
    v_pk_mul_f32 v[66:67], v[66:67], v[170:171]
    v_pk_mul_f32 v[68:69], v[68:69], v[172:173]
    v_pk_mul_f32 v[70:71], v[70:71], v[174:175]
    v_cvt_pk_bf16_f32 v72, v64, v65
    v_cvt_pk_bf16_f32 v73, v66, v67
    v_cvt_pk_bf16_f32 v74, v68, v69
    v_cvt_pk_bf16_f32 v75, v70, v71
    buffer_store_dwordx4 v[72:75], v2, s[8:11], s26 offen offset:1024 sc1
    s_add_u32 m0, s17, 0
    s_add_u32 s36, s35, 344064
    buffer_load_dwordx4 v3, s[12:15], s36 offen lds
    v_exp_f32 v48, -v176
    v_exp_f32 v49, -v177
    v_exp_f32 v50, -v178
    v_exp_f32 v51, -v179
    v_exp_f32 v52, -v180
    v_exp_f32 v53, -v181
    v_exp_f32 v54, -v182
    v_exp_f32 v55, -v183
    s_add_u32 m0, s17, 1024
    s_add_u32 s36, s35, 351232
    buffer_load_dwordx4 v3, s[12:15], s36 offen lds
    v_pk_add_f32 v[48:49], v[48:49], 1.0 op_sel_hi:[1,0]
    v_pk_add_f32 v[50:51], v[50:51], 1.0 op_sel_hi:[1,0]
    v_pk_add_f32 v[52:53], v[52:53], 1.0 op_sel_hi:[1,0]
    v_pk_add_f32 v[54:55], v[54:55], 1.0 op_sel_hi:[1,0]
    v_rcp_f32 v48, v48
    v_rcp_f32 v49, v49
    v_rcp_f32 v50, v50
    v_rcp_f32 v51, v51
    v_rcp_f32 v52, v52
    v_rcp_f32 v53, v53
    v_rcp_f32 v54, v54
    v_rcp_f32 v55, v55
    v_pk_mul_f32 v[48:49], v[48:49], v[176:177]
    v_pk_mul_f32 v[50:51], v[50:51], v[178:179]
    v_pk_mul_f32 v[52:53], v[52:53], v[180:181]
    v_pk_mul_f32 v[54:55], v[54:55], v[182:183]
    v_cvt_pk_bf16_f32 v56, v48, v49
    v_cvt_pk_bf16_f32 v57, v50, v51
    v_cvt_pk_bf16_f32 v58, v52, v53
    v_cvt_pk_bf16_f32 v59, v54, v55
    buffer_store_dwordx4 v[56:59], v2, s[8:11], s26 offen offset:2048 sc1
    s_add_u32 m0, s17, 2048
    s_add_u32 s36, s35, 358400
    buffer_load_dwordx4 v3, s[12:15], s36 offen lds
    v_exp_f32 v64, -v184
    v_exp_f32 v65, -v185
    v_exp_f32 v66, -v186
    v_exp_f32 v67, -v187
    v_exp_f32 v68, -v188
    v_exp_f32 v69, -v189
    v_exp_f32 v70, -v190
    v_exp_f32 v71, -v191
    s_add_u32 m0, s17, 3072
    s_add_u32 s36, s35, 365568
    buffer_load_dwordx4 v3, s[12:15], s36 offen lds
    v_pk_add_f32 v[64:65], v[64:65], 1.0 op_sel_hi:[1,0]
    v_pk_add_f32 v[66:67], v[66:67], 1.0 op_sel_hi:[1,0]
    v_pk_add_f32 v[68:69], v[68:69], 1.0 op_sel_hi:[1,0]
    v_pk_add_f32 v[70:71], v[70:71], 1.0 op_sel_hi:[1,0]
    v_rcp_f32 v64, v64
    v_rcp_f32 v65, v65
    v_rcp_f32 v66, v66
    v_rcp_f32 v67, v67
    v_rcp_f32 v68, v68
    v_rcp_f32 v69, v69
    v_rcp_f32 v70, v70
    v_rcp_f32 v71, v71
    v_pk_mul_f32 v[64:65], v[64:65], v[184:185]
    v_pk_mul_f32 v[66:67], v[66:67], v[186:187]
    v_pk_mul_f32 v[68:69], v[68:69], v[188:189]
    v_pk_mul_f32 v[70:71], v[70:71], v[190:191]
    v_cvt_pk_bf16_f32 v72, v64, v65
    v_cvt_pk_bf16_f32 v73, v66, v67
    v_cvt_pk_bf16_f32 v74, v68, v69
    v_cvt_pk_bf16_f32 v75, v70, v71
    buffer_store_dwordx4 v[72:75], v2, s[8:11], s26 offen offset:3072 sc1
    s_add_u32 m0, s17, 16384
    s_add_u32 s36, s35, 372736
    buffer_load_dwordx4 v3, s[12:15], s36 offen lds
    v_exp_f32 v48, -v192
    v_exp_f32 v49, -v193
    v_exp_f32 v50, -v194
    v_exp_f32 v51, -v195
    v_exp_f32 v52, -v196
    v_exp_f32 v53, -v197
    v_exp_f32 v54, -v198
    v_exp_f32 v55, -v199
    s_add_u32 m0, s17, 17408
    s_add_u32 s36, s35, 379904
    buffer_load_dwordx4 v3, s[12:15], s36 offen lds
    v_pk_add_f32 v[48:49], v[48:49], 1.0 op_sel_hi:[1,0]
    v_pk_add_f32 v[50:51], v[50:51], 1.0 op_sel_hi:[1,0]
    v_pk_add_f32 v[52:53], v[52:53], 1.0 op_sel_hi:[1,0]
    v_pk_add_f32 v[54:55], v[54:55], 1.0 op_sel_hi:[1,0]
    v_rcp_f32 v48, v48
    v_rcp_f32 v49, v49
    v_rcp_f32 v50, v50
    v_rcp_f32 v51, v51
    v_rcp_f32 v52, v52
    v_rcp_f32 v53, v53
    v_rcp_f32 v54, v54
    v_rcp_f32 v55, v55
    v_pk_mul_f32 v[48:49], v[48:49], v[192:193]
    v_pk_mul_f32 v[50:51], v[50:51], v[194:195]
    v_pk_mul_f32 v[52:53], v[52:53], v[196:197]
    v_pk_mul_f32 v[54:55], v[54:55], v[198:199]
    v_cvt_pk_bf16_f32 v56, v48, v49
    v_cvt_pk_bf16_f32 v57, v50, v51
    v_cvt_pk_bf16_f32 v58, v52, v53
    v_cvt_pk_bf16_f32 v59, v54, v55
    buffer_store_dwordx4 v[56:59], v2, s[8:11], s27 offen offset:0 sc1
    s_add_u32 m0, s17, 18432
    s_add_u32 s36, s35, 387072
    buffer_load_dwordx4 v3, s[12:15], s36 offen lds
    v_exp_f32 v64, -v200
    v_exp_f32 v65, -v201
    v_exp_f32 v66, -v202
    v_exp_f32 v67, -v203
    v_exp_f32 v68, -v204
    v_exp_f32 v69, -v205
    v_exp_f32 v70, -v206
    v_exp_f32 v71, -v207
    s_add_u32 m0, s17, 19456
    s_add_u32 s36, s35, 394240
    buffer_load_dwordx4 v3, s[12:15], s36 offen lds
    v_pk_add_f32 v[64:65], v[64:65], 1.0 op_sel_hi:[1,0]
    v_pk_add_f32 v[66:67], v[66:67], 1.0 op_sel_hi:[1,0]
    v_pk_add_f32 v[68:69], v[68:69], 1.0 op_sel_hi:[1,0]
    v_pk_add_f32 v[70:71], v[70:71], 1.0 op_sel_hi:[1,0]
    v_rcp_f32 v64, v64
    v_rcp_f32 v65, v65
    v_rcp_f32 v66, v66
    v_rcp_f32 v67, v67
    v_rcp_f32 v68, v68
    v_rcp_f32 v69, v69
    v_rcp_f32 v70, v70
    v_rcp_f32 v71, v71
    v_pk_mul_f32 v[64:65], v[64:65], v[200:201]
    v_pk_mul_f32 v[66:67], v[66:67], v[202:203]
    v_pk_mul_f32 v[68:69], v[68:69], v[204:205]
    v_pk_mul_f32 v[70:71], v[70:71], v[206:207]
    v_cvt_pk_bf16_f32 v72, v64, v65
    v_cvt_pk_bf16_f32 v73, v66, v67
    v_cvt_pk_bf16_f32 v74, v68, v69
    v_cvt_pk_bf16_f32 v75, v70, v71
    buffer_store_dwordx4 v[72:75], v2, s[8:11], s27 offen offset:1024 sc1
    v_exp_f32 v48, -v208
    v_exp_f32 v49, -v209
    v_exp_f32 v50, -v210
    v_exp_f32 v51, -v211
    v_exp_f32 v52, -v212
    v_exp_f32 v53, -v213
    v_exp_f32 v54, -v214
    v_exp_f32 v55, -v215
    v_pk_add_f32 v[48:49], v[48:49], 1.0 op_sel_hi:[1,0]
    v_pk_add_f32 v[50:51], v[50:51], 1.0 op_sel_hi:[1,0]
    v_pk_add_f32 v[52:53], v[52:53], 1.0 op_sel_hi:[1,0]
    v_pk_add_f32 v[54:55], v[54:55], 1.0 op_sel_hi:[1,0]
    v_rcp_f32 v48, v48
    v_rcp_f32 v49, v49
    v_rcp_f32 v50, v50
    v_rcp_f32 v51, v51
    v_rcp_f32 v52, v52
    v_rcp_f32 v53, v53
    v_rcp_f32 v54, v54
    v_rcp_f32 v55, v55
    v_pk_mul_f32 v[48:49], v[48:49], v[208:209]
    v_pk_mul_f32 v[50:51], v[50:51], v[210:211]
    v_pk_mul_f32 v[52:53], v[52:53], v[212:213]
    v_pk_mul_f32 v[54:55], v[54:55], v[214:215]
    v_cvt_pk_bf16_f32 v56, v48, v49
    v_cvt_pk_bf16_f32 v57, v50, v51
    v_cvt_pk_bf16_f32 v58, v52, v53
    v_cvt_pk_bf16_f32 v59, v54, v55
    buffer_store_dwordx4 v[56:59], v2, s[8:11], s27 offen offset:2048 sc1
    v_exp_f32 v64, -v216
    v_exp_f32 v65, -v217
    v_exp_f32 v66, -v218
    v_exp_f32 v67, -v219
    v_exp_f32 v68, -v220
    v_exp_f32 v69, -v221
    v_exp_f32 v70, -v222
    v_exp_f32 v71, -v223
    v_pk_add_f32 v[64:65], v[64:65], 1.0 op_sel_hi:[1,0]
    v_pk_add_f32 v[66:67], v[66:67], 1.0 op_sel_hi:[1,0]
    v_pk_add_f32 v[68:69], v[68:69], 1.0 op_sel_hi:[1,0]
    v_pk_add_f32 v[70:71], v[70:71], 1.0 op_sel_hi:[1,0]
    v_rcp_f32 v64, v64
    v_rcp_f32 v65, v65
    v_rcp_f32 v66, v66
    v_rcp_f32 v67, v67
    v_rcp_f32 v68, v68
    v_rcp_f32 v69, v69
    v_rcp_f32 v70, v70
    v_rcp_f32 v71, v71
    v_pk_mul_f32 v[64:65], v[64:65], v[216:217]
    v_pk_mul_f32 v[66:67], v[66:67], v[218:219]
    v_pk_mul_f32 v[68:69], v[68:69], v[220:221]
    v_pk_mul_f32 v[70:71], v[70:71], v[222:223]
    v_cvt_pk_bf16_f32 v72, v64, v65
    v_cvt_pk_bf16_f32 v73, v66, v67
    v_cvt_pk_bf16_f32 v74, v68, v69
    v_cvt_pk_bf16_f32 v75, v70, v71
    buffer_store_dwordx4 v[72:75], v2, s[8:11], s27 offen offset:3072 sc1
    s_and_b32 s3, s19, 14
    s_lshr_b32 s30, s97, 3
    s_add_u32 s3, s3, s30
    s_lshl_b32 s30, s3, 6
    s_add_u32 s30, s30, 0x5000
    s_lshl_b32 s22, s97, 3
    s_and_b32 s3, s48, 1
    s_lshl_b32 s3, s3, 2
    s_add_u32 s22, s22, s3
    s_mul_i32 s25, s22, 57344
    s_mul_i32 s3, s18, 14336
    s_add_u32 s25, s25, s3
    s_add_u32 s25, s25, 0xc00000
    s_add_u32 s3, s18, 0
    s_and_b32 s3, s3, 3
    s_mul_i32 s4, s3, 57344
    s_add_u32 s4, s4, s25
    s_add_u32 s3, s18, 1
    s_and_b32 s3, s3, 3
    s_mul_i32 s5, s3, 57344
    s_add_u32 s5, s5, s25
    s_add_u32 s3, s18, 2
    s_and_b32 s3, s3, 3
    s_mul_i32 s6, s3, 57344
    s_add_u32 s6, s6, s25
    s_add_u32 s3, s18, 3
    s_and_b32 s3, s3, 3
    s_mul_i32 s7, s3, 57344
    s_add_u32 s7, s7, s25
    s_add_u32 s22, s22, s18
    s_mul_i32 s26, s22, 14336
    s_lshl_b32 s3, s28, 11
    s_add_u32 s26, s26, s3
    s_add_u32 s26, s26, 0x400000
    buffer_load_dwordx4 v[128:131], v2, s[8:11], s26 offen sc1
    buffer_load_dwordx4 v[132:135], v2, s[8:11], s26 offen offset:1024 sc1
    v_lshrrev_b32 v13, 4, v1
    v_lshlrev_b32 v13, 4, v13
    s_lshl_b32 s3, s28, 8
    s_add_u32 s26, s3, 8960
    buffer_load_dwordx4 v[136:139], v13, s[8:11], s26 offen offset:0 sc1
    buffer_load_dwordx4 v[140:143], v13, s[8:11], s26 offen offset:64 sc1
    buffer_load_dwordx4 v[144:147], v13, s[8:11], s26 offen offset:128 sc1
    buffer_load_dwordx4 v[148:151], v13, s[8:11], s26 offen offset:192 sc1
    s_waitcnt vmcnt(6)
    s_barrier
    s_cmp_lg_u32 s18, 0
    s_cbranch_scc1 T_SIGA
    v_mov_b32 v36, 1
    v_lshlrev_b32 v38, 2, s48
    s_mov_b64 exec, 1
    s_cmp_eq_u32 s96, 1
    s_cbranch_scc0 T_SIGA_S
    buffer_store_dword v36, v38, s[8:11], s30 offen
    s_branch T_SIGA_D
T_SIGA_S:
    buffer_store_dword v36, v38, s[8:11], s30 offen sc1
T_SIGA_D:
    s_mov_b64 exec, -1
T_SIGA:
    s_mov_b32 s12, s60
    s_and_b32 s13, s61, 0xffff
    s_mov_b32 s14, 0x1c0000
    s_mov_b32 s15, 0x20000
    v_and_b32 v12, 15, v1
    s_lshl_b32 s3, s22, 4
    v_add_u32 v12, s3, v12
    v_mul_u32_u24 v12, 896, v12
    v_lshrrev_b32 v13, 1, v13
    v_add_u32 v12, v12, v13
    s_lshl_b32 s27, s28, 7
    v_and_b32 v38, 15, v1
    v_lshlrev_b32 v38, 2, v38
    s_mov_b32 s33, 0
T_POLLA:
    buffer_load_dword v36, v38, s[8:11], s30 offen sc1
    s_waitcnt vmcnt(0)
    v_cmp_ne_u32 vcc, 0, v36
    s_nop 0
    s_and_b32 s32, vcc_lo, 0x3fff
    s_cmp_eq_u32 s32, 0x3fff
    s_cbranch_scc1 T_POLLA_OK
    s_sleep 1
    s_add_u32 s33, s33, 1
    s_cmp_lt_u32 s33, 0x40000
    s_cbranch_scc1 T_POLLA
T_POLLA_OK:
    buffer_load_dwordx4 a[0:3], v2, s[8:11], s4 offen offset:0 sc1
    buffer_load_dwordx4 a[4:7], v2, s[8:11], s5 offen offset:0 sc1
    buffer_load_dwordx4 a[8:11], v2, s[8:11], s6 offen offset:0 sc1
    buffer_load_dwordx4 a[12:15], v2, s[8:11], s7 offen offset:0 sc1
    buffer_load_dwordx4 a[16:19], v2, s[8:11], s4 offen offset:1024 sc1
    buffer_load_dwordx4 a[20:23], v2, s[8:11], s5 offen offset:1024 sc1
    buffer_load_dwordx4 a[24:27], v2, s[8:11], s6 offen offset:1024 sc1
    buffer_load_dwordx4 a[28:31], v2, s[8:11], s7 offen offset:1024 sc1
    buffer_load_dwordx4 a[32:35], v2, s[8:11], s4 offen offset:2048 sc1
    buffer_load_dwordx4 a[36:39], v2, s[8:11], s5 offen offset:2048 sc1
    buffer_load_dwordx4 a[40:43], v2, s[8:11], s6 offen offset:2048 sc1
    buffer_load_dwordx4 a[44:47], v2, s[8:11], s7 offen offset:2048 sc1
    buffer_load_dwordx4 a[48:51], v2, s[8:11], s4 offen offset:3072 sc1
    buffer_load_dwordx4 a[52:55], v2, s[8:11], s5 offen offset:3072 sc1
    buffer_load_dwordx4 a[56:59], v2, s[8:11], s6 offen offset:3072 sc1
    buffer_load_dwordx4 a[60:63], v2, s[8:11], s7 offen offset:3072 sc1
    s_add_u32 s4, s4, 4096
    buffer_load_dwordx4 a[64:67], v2, s[8:11], s4 offen offset:0 sc1
    s_add_u32 s5, s5, 4096
    buffer_load_dwordx4 a[68:71], v2, s[8:11], s5 offen offset:0 sc1
    s_add_u32 s6, s6, 4096
    buffer_load_dwordx4 a[72:75], v2, s[8:11], s6 offen offset:0 sc1
    s_add_u32 s7, s7, 4096
    buffer_load_dwordx4 a[76:79], v2, s[8:11], s7 offen offset:0 sc1
    buffer_load_dwordx4 a[80:83], v2, s[8:11], s4 offen offset:1024 sc1
    buffer_load_dwordx4 a[84:87], v2, s[8:11], s5 offen offset:1024 sc1
    buffer_load_dwordx4 a[88:91], v2, s[8:11], s6 offen offset:1024 sc1
    buffer_load_dwordx4 a[92:95], v2, s[8:11], s7 offen offset:1024 sc1
    buffer_load_dwordx4 a[96:99], v2, s[8:11], s4 offen offset:2048 sc1
    buffer_load_dwordx4 a[100:103], v2, s[8:11], s5 offen offset:2048 sc1
    buffer_load_dwordx4 a[104:107], v2, s[8:11], s6 offen offset:2048 sc1
    buffer_load_dwordx4 a[108:111], v2, s[8:11], s7 offen offset:2048 sc1
    s_waitcnt vmcnt(24) lgkmcnt(15)
    v_mfma_f32_16x16x32_bf16 v[64:67], a[128:131], a[0:3], 0
    v_mfma_f32_16x16x32_bf16 v[80:83], a[128:131], a[4:7], 0
    v_mfma_f32_16x16x32_bf16 v[96:99], a[128:131], a[8:11], 0
    v_mfma_f32_16x16x32_bf16 v[112:115], a[128:131], a[12:15], 0
    buffer_load_dwordx4 a[112:115], v2, s[8:11], s4 offen offset:3072 sc1
    v_mfma_f32_16x16x32_bf16 v[68:71], a[132:135], a[0:3], 0
    v_mfma_f32_16x16x32_bf16 v[84:87], a[132:135], a[4:7], 0
    v_mfma_f32_16x16x32_bf16 v[100:103], a[132:135], a[8:11], 0
    buffer_load_dwordx4 a[116:119], v2, s[8:11], s5 offen offset:3072 sc1
    v_mfma_f32_16x16x32_bf16 v[116:119], a[132:135], a[12:15], 0
    v_mfma_f32_16x16x32_bf16 v[72:75], a[136:139], a[0:3], 0
    v_mfma_f32_16x16x32_bf16 v[88:91], a[136:139], a[4:7], 0
    buffer_load_dwordx4 a[120:123], v2, s[8:11], s6 offen offset:3072 sc1
    v_mfma_f32_16x16x32_bf16 v[104:107], a[136:139], a[8:11], 0
    v_mfma_f32_16x16x32_bf16 v[120:123], a[136:139], a[12:15], 0
    v_mfma_f32_16x16x32_bf16 v[76:79], a[140:143], a[0:3], 0
    buffer_load_dwordx4 a[124:127], v2, s[8:11], s7 offen offset:3072 sc1
    v_mfma_f32_16x16x32_bf16 v[92:95], a[140:143], a[4:7], 0
    v_mfma_f32_16x16x32_bf16 v[108:111], a[140:143], a[8:11], 0
    v_mfma_f32_16x16x32_bf16 v[124:127], a[140:143], a[12:15], 0
    s_waitcnt vmcnt(24) lgkmcnt(15)
    v_mfma_f32_16x16x32_bf16 v[64:67], a[144:147], a[16:19], v[64:67]
    v_mfma_f32_16x16x32_bf16 v[80:83], a[144:147], a[20:23], v[80:83]
    v_mfma_f32_16x16x32_bf16 v[96:99], a[144:147], a[24:27], v[96:99]
    v_mfma_f32_16x16x32_bf16 v[112:115], a[144:147], a[28:31], v[112:115]
    s_add_u32 s4, s4, 4096
    buffer_load_dwordx4 a[0:3], v2, s[8:11], s4 offen offset:0 sc1
    v_mfma_f32_16x16x32_bf16 v[68:71], a[148:151], a[16:19], v[68:71]
    v_mfma_f32_16x16x32_bf16 v[84:87], a[148:151], a[20:23], v[84:87]
    v_mfma_f32_16x16x32_bf16 v[100:103], a[148:151], a[24:27], v[100:103]
    s_add_u32 s5, s5, 4096
    buffer_load_dwordx4 a[4:7], v2, s[8:11], s5 offen offset:0 sc1
    v_mfma_f32_16x16x32_bf16 v[116:119], a[148:151], a[28:31], v[116:119]
    v_mfma_f32_16x16x32_bf16 v[72:75], a[152:155], a[16:19], v[72:75]
    v_mfma_f32_16x16x32_bf16 v[88:91], a[152:155], a[20:23], v[88:91]
    s_add_u32 s6, s6, 4096
    buffer_load_dwordx4 a[8:11], v2, s[8:11], s6 offen offset:0 sc1
    v_mfma_f32_16x16x32_bf16 v[104:107], a[152:155], a[24:27], v[104:107]
    v_mfma_f32_16x16x32_bf16 v[120:123], a[152:155], a[28:31], v[120:123]
    v_mfma_f32_16x16x32_bf16 v[76:79], a[156:159], a[16:19], v[76:79]
    s_add_u32 s7, s7, 4096
    buffer_load_dwordx4 a[12:15], v2, s[8:11], s7 offen offset:0 sc1
    v_mfma_f32_16x16x32_bf16 v[92:95], a[156:159], a[20:23], v[92:95]
    v_mfma_f32_16x16x32_bf16 v[108:111], a[156:159], a[24:27], v[108:111]
    v_mfma_f32_16x16x32_bf16 v[124:127], a[156:159], a[28:31], v[124:127]
    s_waitcnt vmcnt(24) lgkmcnt(15)
    v_mfma_f32_16x16x32_bf16 v[64:67], a[160:163], a[32:35], v[64:67]
    v_add_u32 v8, s16, v4
    v_add_u32 v9, s16, v5
    v_mfma_f32_16x16x32_bf16 v[80:83], a[160:163], a[36:39], v[80:83]
    v_add_u32 v10, s16, v6
    v_add_u32 v11, s16, v7
    v_mfma_f32_16x16x32_bf16 v[96:99], a[160:163], a[40:43], v[96:99]
    ds_read_b64_tr_b16 v[160:161], v8 offset:16384
    v_mfma_f32_16x16x32_bf16 v[112:115], a[160:163], a[44:47], v[112:115]
    buffer_load_dwordx4 a[16:19], v2, s[8:11], s4 offen offset:1024 sc1
    v_mfma_f32_16x16x32_bf16 v[68:71], a[164:167], a[32:35], v[68:71]
    ds_read_b64_tr_b16 v[162:163], v8 offset:18432
    v_mfma_f32_16x16x32_bf16 v[84:87], a[164:167], a[36:39], v[84:87]
    ds_read_b64_tr_b16 v[164:165], v9 offset:16384
    v_mfma_f32_16x16x32_bf16 v[100:103], a[164:167], a[40:43], v[100:103]
    buffer_load_dwordx4 a[20:23], v2, s[8:11], s5 offen offset:1024 sc1
    v_mfma_f32_16x16x32_bf16 v[116:119], a[164:167], a[44:47], v[116:119]
    ds_read_b64_tr_b16 v[166:167], v9 offset:18432
    v_mfma_f32_16x16x32_bf16 v[72:75], a[168:171], a[32:35], v[72:75]
    ds_read_b64_tr_b16 v[168:169], v10 offset:16384
    v_mfma_f32_16x16x32_bf16 v[88:91], a[168:171], a[36:39], v[88:91]
    buffer_load_dwordx4 a[24:27], v2, s[8:11], s6 offen offset:1024 sc1
    v_mfma_f32_16x16x32_bf16 v[104:107], a[168:171], a[40:43], v[104:107]
    ds_read_b64_tr_b16 v[170:171], v10 offset:18432
    v_mfma_f32_16x16x32_bf16 v[120:123], a[168:171], a[44:47], v[120:123]
    ds_read_b64_tr_b16 v[172:173], v11 offset:16384
    v_mfma_f32_16x16x32_bf16 v[76:79], a[172:175], a[32:35], v[76:79]
    buffer_load_dwordx4 a[28:31], v2, s[8:11], s7 offen offset:1024 sc1
    v_mfma_f32_16x16x32_bf16 v[92:95], a[172:175], a[36:39], v[92:95]
    ds_read_b64_tr_b16 v[174:175], v11 offset:18432
    v_mfma_f32_16x16x32_bf16 v[108:111], a[172:175], a[40:43], v[108:111]
    v_mfma_f32_16x16x32_bf16 v[124:127], a[172:175], a[44:47], v[124:127]
    s_waitcnt vmcnt(24) lgkmcnt(15)
    v_mfma_f32_16x16x32_bf16 v[64:67], a[176:179], a[48:51], v[64:67]
    v_add_u32 v8, s45, v4
    v_add_u32 v9, s45, v5
    v_mfma_f32_16x16x32_bf16 v[80:83], a[176:179], a[52:55], v[80:83]
    v_add_u32 v10, s45, v6
    v_add_u32 v11, s45, v7
    v_mfma_f32_16x16x32_bf16 v[96:99], a[176:179], a[56:59], v[96:99]
    ds_read_b64_tr_b16 v[176:177], v8 offset:0
    v_mfma_f32_16x16x32_bf16 v[112:115], a[176:179], a[60:63], v[112:115]
    buffer_load_dwordx4 a[32:35], v2, s[8:11], s4 offen offset:2048 sc1
    v_mfma_f32_16x16x32_bf16 v[68:71], a[180:183], a[48:51], v[68:71]
    ds_read_b64_tr_b16 v[178:179], v8 offset:2048
    v_mfma_f32_16x16x32_bf16 v[84:87], a[180:183], a[52:55], v[84:87]
    ds_read_b64_tr_b16 v[180:181], v9 offset:0
    v_mfma_f32_16x16x32_bf16 v[100:103], a[180:183], a[56:59], v[100:103]
    buffer_load_dwordx4 a[36:39], v2, s[8:11], s5 offen offset:2048 sc1
    v_mfma_f32_16x16x32_bf16 v[116:119], a[180:183], a[60:63], v[116:119]
    ds_read_b64_tr_b16 v[182:183], v9 offset:2048
    v_mfma_f32_16x16x32_bf16 v[72:75], a[184:187], a[48:51], v[72:75]
    ds_read_b64_tr_b16 v[184:185], v10 offset:0
    v_mfma_f32_16x16x32_bf16 v[88:91], a[184:187], a[52:55], v[88:91]
    buffer_load_dwordx4 a[40:43], v2, s[8:11], s6 offen offset:2048 sc1
    v_mfma_f32_16x16x32_bf16 v[104:107], a[184:187], a[56:59], v[104:107]
    ds_read_b64_tr_b16 v[186:187], v10 offset:2048
    v_mfma_f32_16x16x32_bf16 v[120:123], a[184:187], a[60:63], v[120:123]
    ds_read_b64_tr_b16 v[188:189], v11 offset:0
    v_mfma_f32_16x16x32_bf16 v[76:79], a[188:191], a[48:51], v[76:79]
    buffer_load_dwordx4 a[44:47], v2, s[8:11], s7 offen offset:2048 sc1
    v_mfma_f32_16x16x32_bf16 v[92:95], a[188:191], a[52:55], v[92:95]
    ds_read_b64_tr_b16 v[190:191], v11 offset:2048
    v_mfma_f32_16x16x32_bf16 v[108:111], a[188:191], a[56:59], v[108:111]
    v_mfma_f32_16x16x32_bf16 v[124:127], a[188:191], a[60:63], v[124:127]
    s_waitcnt vmcnt(24) lgkmcnt(8)
    v_mfma_f32_16x16x32_bf16 v[64:67], v[160:163], a[64:67], v[64:67]
    v_mfma_f32_16x16x32_bf16 v[80:83], v[160:163], a[68:71], v[80:83]
    v_mfma_f32_16x16x32_bf16 v[96:99], v[160:163], a[72:75], v[96:99]
    ds_read_b64_tr_b16 v[192:193], v8 offset:16384
    v_mfma_f32_16x16x32_bf16 v[112:115], v[160:163], a[76:79], v[112:115]
    buffer_load_dwordx4 a[48:51], v2, s[8:11], s4 offen offset:3072 sc1
    v_mfma_f32_16x16x32_bf16 v[68:71], v[164:167], a[64:67], v[68:71]
    ds_read_b64_tr_b16 v[194:195], v8 offset:18432
    v_mfma_f32_16x16x32_bf16 v[84:87], v[164:167], a[68:71], v[84:87]
    ds_read_b64_tr_b16 v[196:197], v9 offset:16384
    v_mfma_f32_16x16x32_bf16 v[100:103], v[164:167], a[72:75], v[100:103]
    buffer_load_dwordx4 a[52:55], v2, s[8:11], s5 offen offset:3072 sc1
    v_mfma_f32_16x16x32_bf16 v[116:119], v[164:167], a[76:79], v[116:119]
    ds_read_b64_tr_b16 v[198:199], v9 offset:18432
    v_mfma_f32_16x16x32_bf16 v[72:75], v[168:171], a[64:67], v[72:75]
    ds_read_b64_tr_b16 v[200:201], v10 offset:16384
    v_mfma_f32_16x16x32_bf16 v[88:91], v[168:171], a[68:71], v[88:91]
    buffer_load_dwordx4 a[56:59], v2, s[8:11], s6 offen offset:3072 sc1
    v_mfma_f32_16x16x32_bf16 v[104:107], v[168:171], a[72:75], v[104:107]
    ds_read_b64_tr_b16 v[202:203], v10 offset:18432
    v_mfma_f32_16x16x32_bf16 v[120:123], v[168:171], a[76:79], v[120:123]
    ds_read_b64_tr_b16 v[204:205], v11 offset:16384
    v_mfma_f32_16x16x32_bf16 v[76:79], v[172:175], a[64:67], v[76:79]
    buffer_load_dwordx4 a[60:63], v2, s[8:11], s7 offen offset:3072 sc1
    v_mfma_f32_16x16x32_bf16 v[92:95], v[172:175], a[68:71], v[92:95]
    ds_read_b64_tr_b16 v[206:207], v11 offset:18432
    v_mfma_f32_16x16x32_bf16 v[108:111], v[172:175], a[72:75], v[108:111]
    v_mfma_f32_16x16x32_bf16 v[124:127], v[172:175], a[76:79], v[124:127]
    s_waitcnt vmcnt(24) lgkmcnt(8)
    v_mfma_f32_16x16x32_bf16 v[64:67], v[176:179], a[80:83], v[64:67]
    v_add_u32 v8, s46, v4
    v_add_u32 v9, s46, v5
    v_mfma_f32_16x16x32_bf16 v[80:83], v[176:179], a[84:87], v[80:83]
    v_add_u32 v10, s46, v6
    v_add_u32 v11, s46, v7
    v_mfma_f32_16x16x32_bf16 v[96:99], v[176:179], a[88:91], v[96:99]
    ds_read_b64_tr_b16 v[208:209], v8 offset:0
    v_mfma_f32_16x16x32_bf16 v[112:115], v[176:179], a[92:95], v[112:115]
    s_add_u32 s4, s4, 4096
    buffer_load_dwordx4 a[64:67], v2, s[8:11], s4 offen offset:0 sc1
    v_mfma_f32_16x16x32_bf16 v[68:71], v[180:183], a[80:83], v[68:71]
    ds_read_b64_tr_b16 v[210:211], v8 offset:2048
    v_mfma_f32_16x16x32_bf16 v[84:87], v[180:183], a[84:87], v[84:87]
    ds_read_b64_tr_b16 v[212:213], v9 offset:0
    v_mfma_f32_16x16x32_bf16 v[100:103], v[180:183], a[88:91], v[100:103]
    s_add_u32 s5, s5, 4096
    buffer_load_dwordx4 a[68:71], v2, s[8:11], s5 offen offset:0 sc1
    v_mfma_f32_16x16x32_bf16 v[116:119], v[180:183], a[92:95], v[116:119]
    ds_read_b64_tr_b16 v[214:215], v9 offset:2048
    v_mfma_f32_16x16x32_bf16 v[72:75], v[184:187], a[80:83], v[72:75]
    ds_read_b64_tr_b16 v[216:217], v10 offset:0
    v_mfma_f32_16x16x32_bf16 v[88:91], v[184:187], a[84:87], v[88:91]
    s_add_u32 s6, s6, 4096
    buffer_load_dwordx4 a[72:75], v2, s[8:11], s6 offen offset:0 sc1
    v_mfma_f32_16x16x32_bf16 v[104:107], v[184:187], a[88:91], v[104:107]
    ds_read_b64_tr_b16 v[218:219], v10 offset:2048
    v_mfma_f32_16x16x32_bf16 v[120:123], v[184:187], a[92:95], v[120:123]
    ds_read_b64_tr_b16 v[220:221], v11 offset:0
    v_mfma_f32_16x16x32_bf16 v[76:79], v[188:191], a[80:83], v[76:79]
    s_add_u32 s7, s7, 4096
    buffer_load_dwordx4 a[76:79], v2, s[8:11], s7 offen offset:0 sc1
    v_mfma_f32_16x16x32_bf16 v[92:95], v[188:191], a[84:87], v[92:95]
    ds_read_b64_tr_b16 v[222:223], v11 offset:2048
    v_mfma_f32_16x16x32_bf16 v[108:111], v[188:191], a[88:91], v[108:111]
    v_mfma_f32_16x16x32_bf16 v[124:127], v[188:191], a[92:95], v[124:127]
    s_waitcnt vmcnt(24) lgkmcnt(8)
    v_mfma_f32_16x16x32_bf16 v[64:67], v[192:195], a[96:99], v[64:67]
    v_mfma_f32_16x16x32_bf16 v[80:83], v[192:195], a[100:103], v[80:83]
    v_mfma_f32_16x16x32_bf16 v[96:99], v[192:195], a[104:107], v[96:99]
    ds_read_b64_tr_b16 v[160:161], v8 offset:16384
    v_mfma_f32_16x16x32_bf16 v[112:115], v[192:195], a[108:111], v[112:115]
    buffer_load_dwordx4 a[80:83], v2, s[8:11], s4 offen offset:1024 sc1
    v_mfma_f32_16x16x32_bf16 v[68:71], v[196:199], a[96:99], v[68:71]
    ds_read_b64_tr_b16 v[162:163], v8 offset:18432
    v_mfma_f32_16x16x32_bf16 v[84:87], v[196:199], a[100:103], v[84:87]
    ds_read_b64_tr_b16 v[164:165], v9 offset:16384
    v_mfma_f32_16x16x32_bf16 v[100:103], v[196:199], a[104:107], v[100:103]
    buffer_load_dwordx4 a[84:87], v2, s[8:11], s5 offen offset:1024 sc1
    v_mfma_f32_16x16x32_bf16 v[116:119], v[196:199], a[108:111], v[116:119]
    ds_read_b64_tr_b16 v[166:167], v9 offset:18432
    v_mfma_f32_16x16x32_bf16 v[72:75], v[200:203], a[96:99], v[72:75]
    ds_read_b64_tr_b16 v[168:169], v10 offset:16384
    v_mfma_f32_16x16x32_bf16 v[88:91], v[200:203], a[100:103], v[88:91]
    buffer_load_dwordx4 a[88:91], v2, s[8:11], s6 offen offset:1024 sc1
    v_mfma_f32_16x16x32_bf16 v[104:107], v[200:203], a[104:107], v[104:107]
    ds_read_b64_tr_b16 v[170:171], v10 offset:18432
    v_mfma_f32_16x16x32_bf16 v[120:123], v[200:203], a[108:111], v[120:123]
    ds_read_b64_tr_b16 v[172:173], v11 offset:16384
    v_mfma_f32_16x16x32_bf16 v[76:79], v[204:207], a[96:99], v[76:79]
    buffer_load_dwordx4 a[92:95], v2, s[8:11], s7 offen offset:1024 sc1
    v_mfma_f32_16x16x32_bf16 v[92:95], v[204:207], a[100:103], v[92:95]
    ds_read_b64_tr_b16 v[174:175], v11 offset:18432
    v_mfma_f32_16x16x32_bf16 v[108:111], v[204:207], a[104:107], v[108:111]
    v_mfma_f32_16x16x32_bf16 v[124:127], v[204:207], a[108:111], v[124:127]
    s_waitcnt vmcnt(24) lgkmcnt(8)
    v_mfma_f32_16x16x32_bf16 v[64:67], v[208:211], a[112:115], v[64:67]
    v_add_u32 v8, s47, v4
    v_add_u32 v9, s47, v5
    v_mfma_f32_16x16x32_bf16 v[80:83], v[208:211], a[116:119], v[80:83]
    v_add_u32 v10, s47, v6
    v_add_u32 v11, s47, v7
    v_mfma_f32_16x16x32_bf16 v[96:99], v[208:211], a[120:123], v[96:99]
    ds_read_b64_tr_b16 v[176:177], v8 offset:0
    v_mfma_f32_16x16x32_bf16 v[112:115], v[208:211], a[124:127], v[112:115]
    v_mfma_f32_16x16x32_bf16 v[68:71], v[212:215], a[112:115], v[68:71]
    ds_read_b64_tr_b16 v[178:179], v8 offset:2048
    v_mfma_f32_16x16x32_bf16 v[84:87], v[212:215], a[116:119], v[84:87]
    ds_read_b64_tr_b16 v[180:181], v9 offset:0
    v_mfma_f32_16x16x32_bf16 v[100:103], v[212:215], a[120:123], v[100:103]
    v_mfma_f32_16x16x32_bf16 v[116:119], v[212:215], a[124:127], v[116:119]
    ds_read_b64_tr_b16 v[182:183], v9 offset:2048
    v_mfma_f32_16x16x32_bf16 v[72:75], v[216:219], a[112:115], v[72:75]
    ds_read_b64_tr_b16 v[184:185], v10 offset:0
    v_mfma_f32_16x16x32_bf16 v[88:91], v[216:219], a[116:119], v[88:91]
    v_mfma_f32_16x16x32_bf16 v[104:107], v[216:219], a[120:123], v[104:107]
    ds_read_b64_tr_b16 v[186:187], v10 offset:2048
    v_mfma_f32_16x16x32_bf16 v[120:123], v[216:219], a[124:127], v[120:123]
    ds_read_b64_tr_b16 v[188:189], v11 offset:0
    v_mfma_f32_16x16x32_bf16 v[76:79], v[220:223], a[112:115], v[76:79]
    v_mfma_f32_16x16x32_bf16 v[92:95], v[220:223], a[116:119], v[92:95]
    ds_read_b64_tr_b16 v[190:191], v11 offset:2048
    v_mfma_f32_16x16x32_bf16 v[108:111], v[220:223], a[120:123], v[108:111]
    v_mfma_f32_16x16x32_bf16 v[124:127], v[220:223], a[124:127], v[124:127]
    s_waitcnt vmcnt(20) lgkmcnt(8)
    v_mfma_f32_16x16x32_bf16 v[64:67], v[160:163], a[0:3], v[64:67]
    v_mfma_f32_16x16x32_bf16 v[80:83], v[160:163], a[4:7], v[80:83]
    v_mfma_f32_16x16x32_bf16 v[96:99], v[160:163], a[8:11], v[96:99]
    ds_read_b64_tr_b16 v[192:193], v8 offset:16384
    v_mfma_f32_16x16x32_bf16 v[112:115], v[160:163], a[12:15], v[112:115]
    v_mfma_f32_16x16x32_bf16 v[68:71], v[164:167], a[0:3], v[68:71]
    ds_read_b64_tr_b16 v[194:195], v8 offset:18432
    v_mfma_f32_16x16x32_bf16 v[84:87], v[164:167], a[4:7], v[84:87]
    ds_read_b64_tr_b16 v[196:197], v9 offset:16384
    v_mfma_f32_16x16x32_bf16 v[100:103], v[164:167], a[8:11], v[100:103]
    v_mfma_f32_16x16x32_bf16 v[116:119], v[164:167], a[12:15], v[116:119]
    ds_read_b64_tr_b16 v[198:199], v9 offset:18432
    v_mfma_f32_16x16x32_bf16 v[72:75], v[168:171], a[0:3], v[72:75]
    ds_read_b64_tr_b16 v[200:201], v10 offset:16384
    v_mfma_f32_16x16x32_bf16 v[88:91], v[168:171], a[4:7], v[88:91]
    v_mfma_f32_16x16x32_bf16 v[104:107], v[168:171], a[8:11], v[104:107]
    ds_read_b64_tr_b16 v[202:203], v10 offset:18432
    v_mfma_f32_16x16x32_bf16 v[120:123], v[168:171], a[12:15], v[120:123]
    ds_read_b64_tr_b16 v[204:205], v11 offset:16384
    v_mfma_f32_16x16x32_bf16 v[76:79], v[172:175], a[0:3], v[76:79]
    v_mfma_f32_16x16x32_bf16 v[92:95], v[172:175], a[4:7], v[92:95]
    ds_read_b64_tr_b16 v[206:207], v11 offset:18432
    v_mfma_f32_16x16x32_bf16 v[108:111], v[172:175], a[8:11], v[108:111]
    v_mfma_f32_16x16x32_bf16 v[124:127], v[172:175], a[12:15], v[124:127]
    s_waitcnt vmcnt(16) lgkmcnt(8)
    v_mfma_f32_16x16x32_bf16 v[64:67], v[176:179], a[16:19], v[64:67]
    v_add_u32 v8, s16, v4
    v_add_u32 v9, s16, v5
    v_mfma_f32_16x16x32_bf16 v[80:83], v[176:179], a[20:23], v[80:83]
    v_add_u32 v10, s16, v6
    v_add_u32 v11, s16, v7
    v_mfma_f32_16x16x32_bf16 v[96:99], v[176:179], a[24:27], v[96:99]
    ds_read_b64_tr_b16 v[208:209], v8 offset:0
    v_mfma_f32_16x16x32_bf16 v[112:115], v[176:179], a[28:31], v[112:115]
    v_mfma_f32_16x16x32_bf16 v[68:71], v[180:183], a[16:19], v[68:71]
    ds_read_b64_tr_b16 v[210:211], v8 offset:2048
    v_mfma_f32_16x16x32_bf16 v[84:87], v[180:183], a[20:23], v[84:87]
    ds_read_b64_tr_b16 v[212:213], v9 offset:0
    v_mfma_f32_16x16x32_bf16 v[100:103], v[180:183], a[24:27], v[100:103]
    v_mfma_f32_16x16x32_bf16 v[116:119], v[180:183], a[28:31], v[116:119]
    ds_read_b64_tr_b16 v[214:215], v9 offset:2048
    v_mfma_f32_16x16x32_bf16 v[72:75], v[184:187], a[16:19], v[72:75]
    ds_read_b64_tr_b16 v[216:217], v10 offset:0
    v_mfma_f32_16x16x32_bf16 v[88:91], v[184:187], a[20:23], v[88:91]
    v_mfma_f32_16x16x32_bf16 v[104:107], v[184:187], a[24:27], v[104:107]
    ds_read_b64_tr_b16 v[218:219], v10 offset:2048
    v_mfma_f32_16x16x32_bf16 v[120:123], v[184:187], a[28:31], v[120:123]
    ds_read_b64_tr_b16 v[220:221], v11 offset:0
    v_mfma_f32_16x16x32_bf16 v[76:79], v[188:191], a[16:19], v[76:79]
    v_mfma_f32_16x16x32_bf16 v[92:95], v[188:191], a[20:23], v[92:95]
    ds_read_b64_tr_b16 v[222:223], v11 offset:2048
    v_mfma_f32_16x16x32_bf16 v[108:111], v[188:191], a[24:27], v[108:111]
    v_mfma_f32_16x16x32_bf16 v[124:127], v[188:191], a[28:31], v[124:127]
    s_waitcnt vmcnt(12) lgkmcnt(8)
    v_mfma_f32_16x16x32_bf16 v[64:67], v[192:195], a[32:35], v[64:67]
    v_add_u32 v8, s17, v4
    v_add_u32 v9, s17, v5
    v_mfma_f32_16x16x32_bf16 v[80:83], v[192:195], a[36:39], v[80:83]
    v_add_u32 v10, s17, v6
    v_add_u32 v11, s17, v7
    v_mfma_f32_16x16x32_bf16 v[96:99], v[192:195], a[40:43], v[96:99]
    ds_read_b64_tr_b16 v[160:161], v8 offset:0
    v_mfma_f32_16x16x32_bf16 v[112:115], v[192:195], a[44:47], v[112:115]
    v_mfma_f32_16x16x32_bf16 v[68:71], v[196:199], a[32:35], v[68:71]
    ds_read_b64_tr_b16 v[162:163], v8 offset:2048
    v_mfma_f32_16x16x32_bf16 v[84:87], v[196:199], a[36:39], v[84:87]
    ds_read_b64_tr_b16 v[164:165], v9 offset:0
    v_mfma_f32_16x16x32_bf16 v[100:103], v[196:199], a[40:43], v[100:103]
    v_mfma_f32_16x16x32_bf16 v[116:119], v[196:199], a[44:47], v[116:119]
    ds_read_b64_tr_b16 v[166:167], v9 offset:2048
    v_mfma_f32_16x16x32_bf16 v[72:75], v[200:203], a[32:35], v[72:75]
    ds_read_b64_tr_b16 v[168:169], v10 offset:0
    v_mfma_f32_16x16x32_bf16 v[88:91], v[200:203], a[36:39], v[88:91]
    v_mfma_f32_16x16x32_bf16 v[104:107], v[200:203], a[40:43], v[104:107]
    ds_read_b64_tr_b16 v[170:171], v10 offset:2048
    v_mfma_f32_16x16x32_bf16 v[120:123], v[200:203], a[44:47], v[120:123]
    ds_read_b64_tr_b16 v[172:173], v11 offset:0
    v_mfma_f32_16x16x32_bf16 v[76:79], v[204:207], a[32:35], v[76:79]
    v_mfma_f32_16x16x32_bf16 v[92:95], v[204:207], a[36:39], v[92:95]
    ds_read_b64_tr_b16 v[174:175], v11 offset:2048
    v_mfma_f32_16x16x32_bf16 v[108:111], v[204:207], a[40:43], v[108:111]
    v_mfma_f32_16x16x32_bf16 v[124:127], v[204:207], a[44:47], v[124:127]
    s_waitcnt vmcnt(8) lgkmcnt(8)
    v_mfma_f32_16x16x32_bf16 v[64:67], v[208:211], a[48:51], v[64:67]
    v_mfma_f32_16x16x32_bf16 v[80:83], v[208:211], a[52:55], v[80:83]
    v_mfma_f32_16x16x32_bf16 v[96:99], v[208:211], a[56:59], v[96:99]
    ds_read_b64_tr_b16 v[176:177], v8 offset:16384
    v_mfma_f32_16x16x32_bf16 v[112:115], v[208:211], a[60:63], v[112:115]
    v_mfma_f32_16x16x32_bf16 v[68:71], v[212:215], a[48:51], v[68:71]
    ds_read_b64_tr_b16 v[178:179], v8 offset:18432
    v_mfma_f32_16x16x32_bf16 v[84:87], v[212:215], a[52:55], v[84:87]
    ds_read_b64_tr_b16 v[180:181], v9 offset:16384
    v_mfma_f32_16x16x32_bf16 v[100:103], v[212:215], a[56:59], v[100:103]
    v_mfma_f32_16x16x32_bf16 v[116:119], v[212:215], a[60:63], v[116:119]
    ds_read_b64_tr_b16 v[182:183], v9 offset:18432
    v_mfma_f32_16x16x32_bf16 v[72:75], v[216:219], a[48:51], v[72:75]
    ds_read_b64_tr_b16 v[184:185], v10 offset:16384
    v_mfma_f32_16x16x32_bf16 v[88:91], v[216:219], a[52:55], v[88:91]
    v_mfma_f32_16x16x32_bf16 v[104:107], v[216:219], a[56:59], v[104:107]
    ds_read_b64_tr_b16 v[186:187], v10 offset:18432
    v_mfma_f32_16x16x32_bf16 v[120:123], v[216:219], a[60:63], v[120:123]
    ds_read_b64_tr_b16 v[188:189], v11 offset:16384
    v_mfma_f32_16x16x32_bf16 v[76:79], v[220:223], a[48:51], v[76:79]
    v_mfma_f32_16x16x32_bf16 v[92:95], v[220:223], a[52:55], v[92:95]
    ds_read_b64_tr_b16 v[190:191], v11 offset:18432
    v_mfma_f32_16x16x32_bf16 v[108:111], v[220:223], a[56:59], v[108:111]
    v_mfma_f32_16x16x32_bf16 v[124:127], v[220:223], a[60:63], v[124:127]
    s_waitcnt vmcnt(4) lgkmcnt(8)
    v_mfma_f32_16x16x32_bf16 v[64:67], v[160:163], a[64:67], v[64:67]
    v_mfma_f32_16x16x32_bf16 v[80:83], v[160:163], a[68:71], v[80:83]
    v_mfma_f32_16x16x32_bf16 v[96:99], v[160:163], a[72:75], v[96:99]
    v_mfma_f32_16x16x32_bf16 v[112:115], v[160:163], a[76:79], v[112:115]
    v_mfma_f32_16x16x32_bf16 v[68:71], v[164:167], a[64:67], v[68:71]
    v_mfma_f32_16x16x32_bf16 v[84:87], v[164:167], a[68:71], v[84:87]
    v_mfma_f32_16x16x32_bf16 v[100:103], v[164:167], a[72:75], v[100:103]
    v_mfma_f32_16x16x32_bf16 v[116:119], v[164:167], a[76:79], v[116:119]
    v_mfma_f32_16x16x32_bf16 v[72:75], v[168:171], a[64:67], v[72:75]
    v_mfma_f32_16x16x32_bf16 v[88:91], v[168:171], a[68:71], v[88:91]
    v_mfma_f32_16x16x32_bf16 v[104:107], v[168:171], a[72:75], v[104:107]
    v_mfma_f32_16x16x32_bf16 v[120:123], v[168:171], a[76:79], v[120:123]
    v_mfma_f32_16x16x32_bf16 v[76:79], v[172:175], a[64:67], v[76:79]
    v_mfma_f32_16x16x32_bf16 v[92:95], v[172:175], a[68:71], v[92:95]
    v_mfma_f32_16x16x32_bf16 v[108:111], v[172:175], a[72:75], v[108:111]
    v_mfma_f32_16x16x32_bf16 v[124:127], v[172:175], a[76:79], v[124:127]
    s_waitcnt vmcnt(0) lgkmcnt(0)
    v_mfma_f32_16x16x32_bf16 v[64:67], v[176:179], a[80:83], v[64:67]
    v_mfma_f32_16x16x32_bf16 v[80:83], v[176:179], a[84:87], v[80:83]
    v_mfma_f32_16x16x32_bf16 v[96:99], v[176:179], a[88:91], v[96:99]
    v_mfma_f32_16x16x32_bf16 v[112:115], v[176:179], a[92:95], v[112:115]
    v_mfma_f32_16x16x32_bf16 v[68:71], v[180:183], a[80:83], v[68:71]
    v_mfma_f32_16x16x32_bf16 v[84:87], v[180:183], a[84:87], v[84:87]
    v_mfma_f32_16x16x32_bf16 v[100:103], v[180:183], a[88:91], v[100:103]
    v_mfma_f32_16x16x32_bf16 v[116:119], v[180:183], a[92:95], v[116:119]
    v_mfma_f32_16x16x32_bf16 v[72:75], v[184:187], a[80:83], v[72:75]
    v_mfma_f32_16x16x32_bf16 v[88:91], v[184:187], a[84:87], v[88:91]
    v_mfma_f32_16x16x32_bf16 v[104:107], v[184:187], a[88:91], v[104:107]
    v_mfma_f32_16x16x32_bf16 v[120:123], v[184:187], a[92:95], v[120:123]
    v_mfma_f32_16x16x32_bf16 v[76:79], v[188:191], a[80:83], v[76:79]
    v_mfma_f32_16x16x32_bf16 v[92:95], v[188:191], a[84:87], v[92:95]
    v_mfma_f32_16x16x32_bf16 v[108:111], v[188:191], a[88:91], v[108:111]
    v_mfma_f32_16x16x32_bf16 v[124:127], v[188:191], a[92:95], v[124:127]
    s_barrier
    s_add_u32 s3, s18, 1
    s_and_b32 s3, s3, 3
    s_mul_i32 s3, s3, 12288
    v_add_u32 v9, s3, v2
    ds_write_b128 v9, v[80:83] offset:0
    ds_write_b128 v9, v[84:87] offset:1024
    ds_write_b128 v9, v[88:91] offset:2048
    ds_write_b128 v9, v[92:95] offset:3072
    s_add_u32 s3, s18, 2
    s_and_b32 s3, s3, 3
    s_mul_i32 s3, s3, 12288
    v_add_u32 v10, s3, v2
    ds_write_b128 v10, v[96:99] offset:4096
    ds_write_b128 v10, v[100:103] offset:5120
    ds_write_b128 v10, v[104:107] offset:6144
    ds_write_b128 v10, v[108:111] offset:7168
    s_add_u32 s3, s18, 3
    s_and_b32 s3, s3, 3
    s_mul_i32 s3, s3, 12288
    v_add_u32 v11, s3, v2
    ds_write_b128 v11, v[112:115] offset:8192
    ds_write_b128 v11, v[116:119] offset:9216
    ds_write_b128 v11, v[120:123] offset:10240
    ds_write_b128 v11, v[124:127] offset:11264
    s_mul_i32 s3, s18, 12288
    v_add_u32 v8, s3, v2
    v_lshlrev_b32 v160, 16, v128
    v_and_b32 v161, 0xffff0000, v128
    v_lshlrev_b32 v162, 16, v129
    v_and_b32 v163, 0xffff0000, v129
    v_lshlrev_b32 v164, 16, v130
    v_and_b32 v165, 0xffff0000, v130
    v_lshlrev_b32 v166, 16, v131
    v_and_b32 v167, 0xffff0000, v131
    v_lshlrev_b32 v168, 16, v132
    v_and_b32 v169, 0xffff0000, v132
    v_lshlrev_b32 v170, 16, v133
    v_and_b32 v171, 0xffff0000, v133
    v_lshlrev_b32 v172, 16, v134
    v_and_b32 v173, 0xffff0000, v134
    v_lshlrev_b32 v174, 16, v135
    v_and_b32 v175, 0xffff0000, v135
    s_waitcnt lgkmcnt(0)
    s_barrier
    ds_read_b128 v[80:83], v8 offset:0
    ds_read_b128 v[84:87], v8 offset:1024
    ds_read_b128 v[88:91], v8 offset:2048
    ds_read_b128 v[92:95], v8 offset:3072
    ds_read_b128 v[96:99], v8 offset:4096
    ds_read_b128 v[100:103], v8 offset:5120
    ds_read_b128 v[104:107], v8 offset:6144
    ds_read_b128 v[108:111], v8 offset:7168
    ds_read_b128 v[112:115], v8 offset:8192
    ds_read_b128 v[116:119], v8 offset:9216
    ds_read_b128 v[120:123], v8 offset:10240
    ds_read_b128 v[124:127], v8 offset:11264
    s_waitcnt lgkmcnt(0)
    v_pk_add_f32 v[64:65], v[64:65], v[80:81]
    v_pk_add_f32 v[96:97], v[96:97], v[112:113]
    v_pk_add_f32 v[64:65], v[64:65], v[96:97]
    v_pk_fma_f32 v[64:65], v[64:65], v[136:137], v[160:161]
    v_pk_add_f32 v[66:67], v[66:67], v[82:83]
    v_pk_add_f32 v[98:99], v[98:99], v[114:115]
    v_pk_add_f32 v[66:67], v[66:67], v[98:99]
    v_pk_fma_f32 v[66:67], v[66:67], v[138:139], v[162:163]
    v_cvt_pk_bf16_f32 v16, v64, v65
    v_cvt_pk_bf16_f32 v17, v66, v67
    buffer_store_dwordx2 v[16:17], v12, s[12:15], s27 offen offset:0 nt
    v_pk_add_f32 v[68:69], v[68:69], v[84:85]
    v_pk_add_f32 v[100:101], v[100:101], v[116:117]
    v_pk_add_f32 v[68:69], v[68:69], v[100:101]
    v_pk_fma_f32 v[68:69], v[68:69], v[140:141], v[164:165]
    v_pk_add_f32 v[70:71], v[70:71], v[86:87]
    v_pk_add_f32 v[102:103], v[102:103], v[118:119]
    v_pk_add_f32 v[70:71], v[70:71], v[102:103]
    v_pk_fma_f32 v[70:71], v[70:71], v[142:143], v[166:167]
    v_cvt_pk_bf16_f32 v18, v68, v69
    v_cvt_pk_bf16_f32 v19, v70, v71
    buffer_store_dwordx2 v[18:19], v12, s[12:15], s27 offen offset:32 nt
    v_pk_add_f32 v[72:73], v[72:73], v[88:89]
    v_pk_add_f32 v[104:105], v[104:105], v[120:121]
    v_pk_add_f32 v[72:73], v[72:73], v[104:105]
    v_pk_fma_f32 v[72:73], v[72:73], v[144:145], v[168:169]
    v_pk_add_f32 v[74:75], v[74:75], v[90:91]
    v_pk_add_f32 v[106:107], v[106:107], v[122:123]
    v_pk_add_f32 v[74:75], v[74:75], v[106:107]
    v_pk_fma_f32 v[74:75], v[74:75], v[146:147], v[170:171]
    v_cvt_pk_bf16_f32 v20, v72, v73
    v_cvt_pk_bf16_f32 v21, v74, v75
    buffer_store_dwordx2 v[20:21], v12, s[12:15], s27 offen offset:64 nt
    v_pk_add_f32 v[76:77], v[76:77], v[92:93]
    v_pk_add_f32 v[108:109], v[108:109], v[124:125]
    v_pk_add_f32 v[76:77], v[76:77], v[108:109]
    v_pk_fma_f32 v[76:77], v[76:77], v[148:149], v[172:173]
    v_pk_add_f32 v[78:79], v[78:79], v[94:95]
    v_pk_add_f32 v[110:111], v[110:111], v[126:127]
    v_pk_add_f32 v[78:79], v[78:79], v[110:111]
    v_pk_fma_f32 v[78:79], v[78:79], v[150:151], v[174:175]
    v_cvt_pk_bf16_f32 v22, v76, v77
    v_cvt_pk_bf16_f32 v23, v78, v79
    buffer_store_dwordx2 v[22:23], v12, s[12:15], s27 offen offset:96 nt
K_FIN:
K_END:
    s_endpgm
.p2align 6
AT_FAST:
    v_mfma_f32_16x16x32_bf16 v[64:67], a[128:131], v[112:115], v[48:51]
    ds_read_b128 a[192:195], v14 offset:0
    v_cvt_pk_bf16_f32 v56, v80, v81
    v_mfma_f32_16x16x32_bf16 v[68:71], a[128:131], v[144:147], v[52:55]
    s_add_u32 m0, s24, 0
    ds_read_b128 a[196:199], v14 offset:1024
    v_cvt_pk_bf16_f32 v57, v82, v83
    v_mfma_f32_16x16x32_bf16 v[64:67], a[132:135], v[116:119], v[64:67]
    buffer_load_dwordx4 v6, s[4:7], s21 offen sc1 lds
    v_mfma_f32_16x16x32_bf16 v[68:71], a[132:135], v[148:151], v[68:71]
    ds_read_b128 a[200:203], v14 offset:2048
    v_cvt_pk_bf16_f32 v60, v84, v85
    v_mfma_f32_16x16x32_bf16 v[64:67], a[136:139], v[120:123], v[64:67]
    ds_read_b128 a[204:207], v14 offset:3072
    v_cvt_pk_bf16_f32 v61, v86, v87
    v_mfma_f32_16x16x32_bf16 v[68:71], a[136:139], v[152:155], v[68:71]
    s_add_u32 m0, s24, 4096
    ds_read_b128 a[208:211], v14 offset:4096
    v_cvt_pk_bf16_f32 v58, v88, v89
    v_mfma_f32_16x16x32_bf16 v[64:67], a[140:143], v[124:127], v[64:67]
    buffer_load_dwordx4 v7, s[4:7], s21 offen sc1 lds
    v_mfma_f32_16x16x32_bf16 v[68:71], a[140:143], v[156:159], v[68:71]
    ds_read_b128 a[212:215], v14 offset:5120
    v_cvt_pk_bf16_f32 v59, v90, v91
    v_mfma_f32_16x16x32_bf16 v[64:67], a[144:147], v[128:131], v[64:67]
    ds_read_b128 a[216:219], v14 offset:6144
    v_cvt_pk_bf16_f32 v62, v92, v93
    v_mfma_f32_16x16x32_bf16 v[68:71], a[144:147], v[160:163], v[68:71]
    s_add_u32 m0, s24, 8192
    ds_read_b128 a[220:223], v14 offset:7168
    v_cvt_pk_bf16_f32 v63, v94, v95
    v_mfma_f32_16x16x32_bf16 v[64:67], a[148:151], v[132:135], v[64:67]
    buffer_load_dwordx4 v8, s[4:7], s21 offen sc1 lds
    v_mfma_f32_16x16x32_bf16 v[68:71], a[148:151], v[164:167], v[68:71]
    ds_read_b128 a[224:227], v14 offset:8192
    v_add_f32 v38, v38, v40
    v_mfma_f32_16x16x32_bf16 v[64:67], a[152:155], v[136:139], v[64:67]
    ds_read_b128 a[228:231], v14 offset:9216
    v_add_f32 v39, v39, v41
    v_mfma_f32_16x16x32_bf16 v[68:71], a[152:155], v[168:171], v[68:71]
    s_add_u32 m0, s24, 12288
    ds_read_b128 a[232:235], v14 offset:10240
    v_mfma_f32_16x16x32_bf16 v[64:67], a[156:159], v[140:143], v[64:67]
    buffer_load_dwordx4 v9, s[4:7], s21 offen sc1 lds
    v_mfma_f32_16x16x32_bf16 v[68:71], a[156:159], v[172:175], v[68:71]
    ds_read_b128 a[236:239], v14 offset:11264
    v_mfma_f32_16x16x32_bf16 v[72:75], a[160:163], v[112:115], v[48:51]
    ds_read_b128 a[240:243], v14 offset:12288
    v_mfma_f32_16x16x32_bf16 v[76:79], a[160:163], v[144:147], v[52:55]
    s_add_u32 m0, s24, 16384
    ds_read_b128 a[244:247], v14 offset:13312
    v_mfma_f32_16x16x32_bf16 v[72:75], a[164:167], v[116:119], v[72:75]
    buffer_load_dwordx4 v10, s[4:7], s21 offen sc1 lds
    v_mfma_f32_16x16x32_bf16 v[76:79], a[164:167], v[148:151], v[76:79]
    ds_read_b128 a[248:251], v14 offset:14336
    v_mfma_f32_16x16x32_bf16 v[72:75], a[168:171], v[120:123], v[72:75]
    ds_read_b128 a[252:255], v14 offset:15360
    v_mfma_f32_16x16x32_bf16 v[76:79], a[168:171], v[152:155], v[76:79]
    s_add_u32 m0, s24, 20480
    v_exp_f32 v80, v64
    v_mfma_f32_16x16x32_bf16 v[72:75], a[172:175], v[124:127], v[72:75]
    buffer_load_dwordx4 v11, s[4:7], s21 offen sc1 lds
    v_mfma_f32_16x16x32_bf16 v[76:79], a[172:175], v[156:159], v[76:79]
    s_add_u32 s25, s25, 0x8000
    v_exp_f32 v81, v65
    v_mfma_f32_16x16x32_bf16 v[72:75], a[176:179], v[128:131], v[72:75]
    v_exp_f32 v82, v66
    v_mfma_f32_16x16x32_bf16 v[76:79], a[176:179], v[160:163], v[76:79]
    s_add_u32 m0, s24, 24576
    v_exp_f32 v83, v67
    v_mfma_f32_16x16x32_bf16 v[72:75], a[180:183], v[132:135], v[72:75]
    buffer_load_dwordx4 v12, s[4:7], s21 offen sc1 lds
    v_mfma_f32_16x16x32_bf16 v[76:79], a[180:183], v[164:167], v[76:79]
    s_cmp_ge_u32 s25, 0x28000
    v_exp_f32 v84, v68
    v_mfma_f32_16x16x32_bf16 v[72:75], a[184:187], v[136:139], v[72:75]
    s_cselect_b32 s25, 0, s25
    v_exp_f32 v85, v69
    v_mfma_f32_16x16x32_bf16 v[76:79], a[184:187], v[168:171], v[76:79]
    s_add_u32 m0, s24, 28672
    v_exp_f32 v86, v70
    v_mfma_f32_16x16x32_bf16 v[72:75], a[188:191], v[140:143], v[72:75]
    buffer_load_dwordx4 v13, s[4:7], s21 offen sc1 lds
    v_mfma_f32_16x16x32_bf16 v[76:79], a[188:191], v[172:175], v[76:79]
    s_waitcnt vmcnt(16) lgkmcnt(0)
    v_exp_f32 v87, v71
    v_mfma_f32_16x16x32_bf16 a[0:3], a[192:195], v[56:59], a[0:3]
    s_barrier
    v_add_u32 v14, s25, v2
    v_add_f32 v40, v80, v81
    v_mfma_f32_16x16x32_bf16 a[4:7], a[192:195], v[60:63], a[4:7]
    ds_read_b128 a[128:131], v14 offset:16384
    v_add_f32 v40, v40, v82
    v_mfma_f32_16x16x32_bf16 a[8:11], a[196:199], v[56:59], a[8:11]
    ds_read_b128 a[132:135], v14 offset:17408
    v_add_f32 v40, v40, v83
    v_mfma_f32_16x16x32_bf16 a[12:15], a[196:199], v[60:63], a[12:15]
    ds_read_b128 a[136:139], v14 offset:18432
    v_add_f32 v41, v84, v85
    v_mfma_f32_16x16x32_bf16 a[16:19], a[200:203], v[56:59], a[16:19]
    s_add_u32 s21, s21, s22
    v_exp_f32 v88, v72
    v_mfma_f32_16x16x32_bf16 a[20:23], a[200:203], v[60:63], a[20:23]
    s_add_u32 s24, s24, 0x8000
    ds_read_b128 a[140:143], v14 offset:19456
    v_add_f32 v41, v41, v86
    v_mfma_f32_16x16x32_bf16 a[24:27], a[204:207], v[56:59], a[24:27]
    s_cmp_ge_u32 s24, 0x28000
    v_exp_f32 v89, v73
    v_mfma_f32_16x16x32_bf16 a[28:31], a[204:207], v[60:63], a[28:31]
    s_cselect_b32 s24, s49, s24
    ds_read_b128 a[144:147], v14 offset:20480
    v_add_f32 v41, v41, v87
    v_mfma_f32_16x16x32_bf16 a[32:35], a[208:211], v[56:59], a[32:35]
    v_exp_f32 v90, v74
    v_mfma_f32_16x16x32_bf16 a[36:39], a[208:211], v[60:63], a[36:39]
    ds_read_b128 a[148:151], v14 offset:21504
    v_add_f32 v40, v40, v88
    v_mfma_f32_16x16x32_bf16 a[40:43], a[212:215], v[56:59], a[40:43]
    v_exp_f32 v91, v75
    v_mfma_f32_16x16x32_bf16 a[44:47], a[212:215], v[60:63], a[44:47]
    ds_read_b128 a[152:155], v14 offset:22528
    v_add_f32 v40, v40, v89
    v_mfma_f32_16x16x32_bf16 a[48:51], a[216:219], v[56:59], a[48:51]
    v_exp_f32 v92, v76
    v_mfma_f32_16x16x32_bf16 a[52:55], a[216:219], v[60:63], a[52:55]
    ds_read_b128 a[156:159], v14 offset:23552
    v_add_f32 v40, v40, v90
    v_mfma_f32_16x16x32_bf16 a[56:59], a[220:223], v[56:59], a[56:59]
    v_exp_f32 v93, v77
    v_mfma_f32_16x16x32_bf16 a[60:63], a[220:223], v[60:63], a[60:63]
    ds_read_b128 a[160:163], v14 offset:24576
    v_add_f32 v40, v40, v91
    v_mfma_f32_16x16x32_bf16 a[64:67], a[224:227], v[56:59], a[64:67]
    v_exp_f32 v94, v78
    v_mfma_f32_16x16x32_bf16 a[68:71], a[224:227], v[60:63], a[68:71]
    ds_read_b128 a[164:167], v14 offset:25600
    v_add_f32 v41, v41, v92
    v_mfma_f32_16x16x32_bf16 a[72:75], a[228:231], v[56:59], a[72:75]
    v_exp_f32 v95, v79
    v_mfma_f32_16x16x32_bf16 a[76:79], a[228:231], v[60:63], a[76:79]
    ds_read_b128 a[168:171], v14 offset:26624
    v_add_f32 v41, v41, v93
    v_mfma_f32_16x16x32_bf16 a[80:83], a[232:235], v[56:59], a[80:83]
    ds_read_b128 a[172:175], v14 offset:27648
    v_add_f32 v41, v41, v94
    v_mfma_f32_16x16x32_bf16 a[84:87], a[232:235], v[60:63], a[84:87]
    ds_read_b128 a[176:179], v14 offset:28672
    v_add_f32 v41, v41, v95
    v_mfma_f32_16x16x32_bf16 a[88:91], a[236:239], v[56:59], a[88:91]
    ds_read_b128 a[180:183], v14 offset:29696
    v_max_f32 v42, v40, v41
    v_mfma_f32_16x16x32_bf16 a[92:95], a[236:239], v[60:63], a[92:95]
    ds_read_b128 a[184:187], v14 offset:30720
    v_cmp_lt_f32 vcc, s48, v42
    v_mfma_f32_16x16x32_bf16 a[96:99], a[240:243], v[56:59], a[96:99]
    ds_read_b128 a[188:191], v14 offset:31744
    v_mfma_f32_16x16x32_bf16 a[100:103], a[240:243], v[60:63], a[100:103]
    v_mfma_f32_16x16x32_bf16 a[104:107], a[244:247], v[56:59], a[104:107]
    s_add_u32 s33, s33, 1
    v_mfma_f32_16x16x32_bf16 a[108:111], a[244:247], v[60:63], a[108:111]
    s_sub_u32 s32, s32, 1
    v_mfma_f32_16x16x32_bf16 a[112:115], a[248:251], v[56:59], a[112:115]
    s_cmp_gt_u32 s32, 4
    v_mfma_f32_16x16x32_bf16 a[116:119], a[248:251], v[60:63], a[116:119]
    s_waitcnt lgkmcnt(0)
    v_mfma_f32_16x16x32_bf16 a[120:123], a[252:255], v[56:59], a[120:123]
    v_mfma_f32_16x16x32_bf16 a[124:127], a[252:255], v[60:63], a[124:127]
    s_cbranch_vccnz AT_RARE
    s_cbranch_scc1 AT_FAST
    s_branch AT_LOOP
AT_EARLY:
    v_mfma_f32_16x16x32_bf16 a[0:3], a[128:131], v[56:59], a[0:3]
    v_mfma_f32_16x16x32_bf16 a[4:7], a[128:131], v[60:63], a[4:7]
    s_add_u32 m0, s24, 0
    v_mfma_f32_16x16x32_bf16 a[8:11], a[132:135], v[56:59], a[8:11]
    buffer_load_dwordx4 v6, s[4:7], s21 offen sc1 lds
    v_mfma_f32_16x16x32_bf16 a[12:15], a[132:135], v[60:63], a[12:15]
    v_mfma_f32_16x16x32_bf16 a[16:19], a[136:139], v[56:59], a[16:19]
    v_mfma_f32_16x16x32_bf16 a[20:23], a[136:139], v[60:63], a[20:23]
    s_add_u32 m0, s24, 4096
    v_mfma_f32_16x16x32_bf16 a[24:27], a[140:143], v[56:59], a[24:27]
    buffer_load_dwordx4 v7, s[4:7], s21 offen sc1 lds
    v_mfma_f32_16x16x32_bf16 a[28:31], a[140:143], v[60:63], a[28:31]
    v_mfma_f32_16x16x32_bf16 a[32:35], a[144:147], v[56:59], a[32:35]
    v_mfma_f32_16x16x32_bf16 a[36:39], a[144:147], v[60:63], a[36:39]
    s_add_u32 m0, s24, 8192
    v_mfma_f32_16x16x32_bf16 a[40:43], a[148:151], v[56:59], a[40:43]
    buffer_load_dwordx4 v8, s[4:7], s21 offen sc1 lds
    v_mfma_f32_16x16x32_bf16 a[44:47], a[148:151], v[60:63], a[44:47]
    v_mfma_f32_16x16x32_bf16 a[48:51], a[152:155], v[56:59], a[48:51]
    v_mfma_f32_16x16x32_bf16 a[52:55], a[152:155], v[60:63], a[52:55]
    s_add_u32 m0, s24, 12288
    v_mfma_f32_16x16x32_bf16 a[56:59], a[156:159], v[56:59], a[56:59]
    buffer_load_dwordx4 v9, s[4:7], s21 offen sc1 lds
    v_mfma_f32_16x16x32_bf16 a[60:63], a[156:159], v[60:63], a[60:63]
    v_mfma_f32_16x16x32_bf16 a[64:67], a[160:163], v[56:59], a[64:67]
    v_mfma_f32_16x16x32_bf16 a[68:71], a[160:163], v[60:63], a[68:71]
    s_add_u32 m0, s24, 16384
    v_mfma_f32_16x16x32_bf16 a[72:75], a[164:167], v[56:59], a[72:75]
    buffer_load_dwordx4 v10, s[4:7], s21 offen sc1 lds
    v_mfma_f32_16x16x32_bf16 a[76:79], a[164:167], v[60:63], a[76:79]
    v_mfma_f32_16x16x32_bf16 a[80:83], a[168:171], v[56:59], a[80:83]
    v_mfma_f32_16x16x32_bf16 a[84:87], a[168:171], v[60:63], a[84:87]
    s_add_u32 m0, s24, 20480
    v_mfma_f32_16x16x32_bf16 a[88:91], a[172:175], v[56:59], a[88:91]
    buffer_load_dwordx4 v11, s[4:7], s21 offen sc1 lds
    v_mfma_f32_16x16x32_bf16 a[92:95], a[172:175], v[60:63], a[92:95]
    v_mfma_f32_16x16x32_bf16 a[96:99], a[176:179], v[56:59], a[96:99]
    v_mfma_f32_16x16x32_bf16 a[100:103], a[176:179], v[60:63], a[100:103]
    s_add_u32 m0, s24, 24576
    v_mfma_f32_16x16x32_bf16 a[104:107], a[180:183], v[56:59], a[104:107]
    buffer_load_dwordx4 v12, s[4:7], s21 offen sc1 lds
    v_mfma_f32_16x16x32_bf16 a[108:111], a[180:183], v[60:63], a[108:111]
    v_mfma_f32_16x16x32_bf16 a[112:115], a[184:187], v[56:59], a[112:115]
    v_mfma_f32_16x16x32_bf16 a[116:119], a[184:187], v[60:63], a[116:119]
    s_add_u32 m0, s24, 28672
    v_mfma_f32_16x16x32_bf16 a[120:123], a[188:191], v[56:59], a[120:123]
    buffer_load_dwordx4 v13, s[4:7], s21 offen sc1 lds
    v_mfma_f32_16x16x32_bf16 a[124:127], a[188:191], v[60:63], a[124:127]
    s_branch AT_IDLE1
AT_IDLE:
    s_add_u32 m0, s24, 0
    s_nop 0
    buffer_load_dwordx4 v6, s[4:7], s21 offen sc1 lds
    s_add_u32 m0, s24, 4096
    s_nop 0
    buffer_load_dwordx4 v7, s[4:7], s21 offen sc1 lds
    s_add_u32 m0, s24, 8192
    s_nop 0
    buffer_load_dwordx4 v8, s[4:7], s21 offen sc1 lds
    s_add_u32 m0, s24, 12288
    s_nop 0
    buffer_load_dwordx4 v9, s[4:7], s21 offen sc1 lds
    s_add_u32 m0, s24, 16384
    s_nop 0
    buffer_load_dwordx4 v10, s[4:7], s21 offen sc1 lds
    s_add_u32 m0, s24, 20480
    s_nop 0
    buffer_load_dwordx4 v11, s[4:7], s21 offen sc1 lds
    s_add_u32 m0, s24, 24576
    s_nop 0
    buffer_load_dwordx4 v12, s[4:7], s21 offen sc1 lds
    s_add_u32 m0, s24, 28672
    s_nop 0
    buffer_load_dwordx4 v13, s[4:7], s21 offen sc1 lds
AT_IDLE1:
    s_waitcnt vmcnt(16)
    s_barrier
    s_add_u32 s21, s21, s22
    s_add_u32 s24, s24, 0x8000
    s_cmp_ge_u32 s24, 0x28000
    s_cselect_b32 s24, s49, s24
    s_add_u32 s25, s25, 0x8000
    s_cmp_ge_u32 s25, 0x28000
    s_cselect_b32 s25, 0, s25
    s_sub_u32 s32, s32, 1
    s_cmp_lg_u32 s32, 0
    s_cbranch_scc1 AT_IDLE
    s_waitcnt vmcnt(8)
    s_barrier
    s_add_u32 m0, s24, 0
    s_nop 0
    buffer_load_dwordx4 v6, s[4:7], s21 offen sc1 lds
    s_add_u32 m0, s24, 4096
    s_nop 0
    buffer_load_dwordx4 v7, s[4:7], s21 offen sc1 lds
    s_add_u32 m0, s24, 8192
    s_nop 0
    buffer_load_dwordx4 v8, s[4:7], s21 offen sc1 lds
    s_add_u32 m0, s24, 12288
    s_nop 0
    buffer_load_dwordx4 v9, s[4:7], s21 offen sc1 lds
    s_add_u32 m0, s24, 16384
    s_nop 0
    buffer_load_dwordx4 v10, s[4:7], s21 offen sc1 lds
    s_add_u32 m0, s24, 20480
    s_nop 0
    buffer_load_dwordx4 v11, s[4:7], s21 offen sc1 lds
    s_add_u32 m0, s24, 24576
    s_nop 0
    buffer_load_dwordx4 v12, s[4:7], s21 offen sc1 lds
    s_add_u32 m0, s24, 28672
    s_nop 0
    buffer_load_dwordx4 v13, s[4:7], s21 offen sc1 lds
    s_add_u32 s21, s21, s22
    s_add_u32 s24, s24, 0x8000
    s_cmp_ge_u32 s24, 0x28000
    s_cselect_b32 s24, s49, s24
    s_cmp_eq_u32 s29, 3
    s_cbranch_scc1 AT_IDLE_KV
    v_add_u32 v28, s25, v24
    v_add_u32 v29, s25, v25
    v_add_u32 v30, s25, v26
    v_add_u32 v31, s25, v27
    ds_read_b64_tr_b16 a[128:129], v28 offset:0
    ds_read_b64_tr_b16 a[130:131], v28 offset:2048
    ds_read_b64_tr_b16 a[132:133], v28 offset:4096
    ds_read_b64_tr_b16 a[134:135], v28 offset:6144
    ds_read_b64_tr_b16 a[136:137], v28 offset:8192
    ds_read_b64_tr_b16 a[138:139], v28 offset:10240
    ds_read_b64_tr_b16 a[140:141], v28 offset:12288
    ds_read_b64_tr_b16 a[142:143], v28 offset:14336
    ds_read_b64_tr_b16 a[144:145], v28 offset:16384
    ds_read_b64_tr_b16 a[146:147], v28 offset:18432
    ds_read_b64_tr_b16 a[148:149], v28 offset:20480
    ds_read_b64_tr_b16 a[150:151], v28 offset:22528
    ds_read_b64_tr_b16 a[152:153], v28 offset:24576
    ds_read_b64_tr_b16 a[154:155], v28 offset:26624
    ds_read_b64_tr_b16 a[156:157], v28 offset:28672
    ds_read_b64_tr_b16 a[158:159], v28 offset:30720
    ds_read_b64_tr_b16 a[160:161], v29 offset:0
    ds_read_b64_tr_b16 a[162:163], v29 offset:2048
    ds_read_b64_tr_b16 a[164:165], v29 offset:4096
    ds_read_b64_tr_b16 a[166:167], v29 offset:6144
    ds_read_b64_tr_b16 a[168:169], v29 offset:8192
    ds_read_b64_tr_b16 a[170:171], v29 offset:10240
    ds_read_b64_tr_b16 a[172:173], v29 offset:12288
    ds_read_b64_tr_b16 a[174:175], v29 offset:14336
    ds_read_b64_tr_b16 a[176:177], v29 offset:16384
    ds_read_b64_tr_b16 a[178:179], v29 offset:18432
    ds_read_b64_tr_b16 a[180:181], v29 offset:20480
    ds_read_b64_tr_b16 a[182:183], v29 offset:22528
    ds_read_b64_tr_b16 a[184:185], v29 offset:24576
    ds_read_b64_tr_b16 a[186:187], v29 offset:26624
    ds_read_b64_tr_b16 a[188:189], v29 offset:28672
    ds_read_b64_tr_b16 a[190:191], v29 offset:30720
    v_lshrrev_b32 v240, 3, v0
    s_and_b32 s3, s19, 1
    v_bfe_u32 v241, v240, 1, 2
    v_lshlrev_b32 v241, 1, v241
    v_and_b32 v242, 7, v1
    v_xor_b32 v241, v241, v242
    v_mul_u32_u24 v240, 896, v240
    v_and_b32 v242, 3, v241
    v_lshl_add_u32 v240, v242, 4, v240
    v_lshrrev_b32 v241, 2, v241
    v_xor_b32 v241, s3, v241
    s_lshl_b32 s3, s3, 6
    v_mul_u32_u24 v241, 229376, v241
    s_and_b32 s21, s19, 14
    v_add_u32 v6, v240, v241
    s_mul_i32 s21, s21, 229376
    v_add_u32 v7, 0x7000, v6
    s_add_u32 s21, s21, s3
    v_add_u32 v8, 0xe000, v6
    s_add_u32 s21, s21, 384
    v_add_u32 v9, 0x15000, v6
    v_add_u32 v10, 0x1c000, v6
    v_add_u32 v11, 0x23000, v6
    v_add_u32 v12, 0x2a000, v6
    v_add_u32 v13, 0x31000, v6
    s_branch AT_LAST_DONE
AT_IDLE_KV:
    v_add_u32 v14, s25, v2
    ds_read_b128 a[128:131], v14 offset:16384
    ds_read_b128 a[132:135], v14 offset:17408
    ds_read_b128 a[136:139], v14 offset:18432
    ds_read_b128 a[140:143], v14 offset:19456
    ds_read_b128 a[144:147], v14 offset:20480
    ds_read_b128 a[148:151], v14 offset:21504
    ds_read_b128 a[152:155], v14 offset:22528
    ds_read_b128 a[156:159], v14 offset:23552
    ds_read_b128 a[160:163], v14 offset:24576
    ds_read_b128 a[164:167], v14 offset:25600
    ds_read_b128 a[168:171], v14 offset:26624
    ds_read_b128 a[172:175], v14 offset:27648
    ds_read_b128 a[176:179], v14 offset:28672
    ds_read_b128 a[180:183], v14 offset:29696
    ds_read_b128 a[184:187], v14 offset:30720
    ds_read_b128 a[188:191], v14 offset:31744
    s_branch AT_LAST_DONE
AT_MASK0:
    v_cmp_gt_i32 s[40:41], 0, v37
    v_cmp_gt_i32 s[42:43], 1, v37
    v_cmp_gt_i32 s[44:45], 2, v37
    v_cmp_gt_i32 s[46:47], 3, v37
    v_cndmask_b32 v64, v64, v15, s[40:41]
    v_cndmask_b32 v65, v65, v15, s[42:43]
    v_cndmask_b32 v66, v66, v15, s[44:45]
    v_cndmask_b32 v67, v67, v15, s[46:47]
    v_cmp_gt_i32 s[40:41], -16, v37
    v_cmp_gt_i32 s[42:43], -15, v37
    v_cmp_gt_i32 s[44:45], -14, v37
    v_cmp_gt_i32 s[46:47], -13, v37
    v_cndmask_b32 v68, v68, v15, s[40:41]
    v_cndmask_b32 v69, v69, v15, s[42:43]
    v_cndmask_b32 v70, v70, v15, s[44:45]
    v_cndmask_b32 v71, v71, v15, s[46:47]
    s_branch AT_MASK0_RET
AT_MASK1:
    v_cmp_gt_i32 s[40:41], 16, v37
    v_cmp_gt_i32 s[42:43], 17, v37
    v_cmp_gt_i32 s[44:45], 18, v37
    v_cmp_gt_i32 s[46:47], 19, v37
    v_cndmask_b32 v72, v72, v15, s[40:41]
    v_cndmask_b32 v73, v73, v15, s[42:43]
    v_cndmask_b32 v74, v74, v15, s[44:45]
    v_cndmask_b32 v75, v75, v15, s[46:47]
    v_cmp_gt_i32 s[40:41], 0, v37
    v_cmp_gt_i32 s[42:43], 1, v37
    v_cmp_gt_i32 s[44:45], 2, v37
    v_cmp_gt_i32 s[46:47], 3, v37
    v_cndmask_b32 v76, v76, v15, s[40:41]
    v_cndmask_b32 v77, v77, v15, s[42:43]
    v_cndmask_b32 v78, v78, v15, s[44:45]
    v_cndmask_b32 v79, v79, v15, s[46:47]
    v_subrev_u32 v37, 32, v37
    s_branch AT_MASK1_RET
AT_KVCHK:
    v_and_b32 v107, 15, v1
    v_lshlrev_b32 v107, 2, v107
    s_cmp_eq_u32 s37, 0
    s_cbranch_scc0 AT_KVCHK2
    buffer_load_dword v106, v107, s[8:11], s35 offen sc1
    s_cmp_eq_u32 s29, 1
    s_cbranch_scc0 AT_KVCHK_RET
    s_lshl_b32 s3, s19, 6
    s_add_u32 s3, s3, 0x5400
    s_cmp_lg_u32 s18, 0
    s_cbranch_scc1 AT_SIGQ
    v_mov_b32 v108, 1
    v_lshlrev_b32 v109, 2, s20
    s_mov_b64 exec, 1
    s_cmp_eq_u32 s96, 1
    s_cbranch_scc0 AT_SIGQ_S
    buffer_store_dword v108, v109, s[8:11], s3 offen
    s_branch AT_SIGQ_D
AT_SIGQ_S:
    buffer_store_dword v108, v109, s[8:11], s3 offen sc1
AT_SIGQ_D:
    s_mov_b64 exec, -1
AT_SIGQ:
    s_branch AT_KVCHK_RET
AT_KVCHK2:
    s_waitcnt vmcnt(8)
    s_mov_b32 s42, 0
    s_branch AT_POLLKV_CHK
AT_POLLKV:
    buffer_load_dword v106, v107, s[8:11], s35 offen sc1
    s_waitcnt vmcnt(0)
AT_POLLKV_CHK:
    v_cmp_ne_u32 s[40:41], 0, v106
    s_nop 0
    s_and_b32 s40, s40, 0xffff
    s_cmp_eq_u32 s40, 0xffff
    s_cbranch_scc1 AT_POLLKV_OK
    s_sleep 1
    s_add_u32 s42, s42, 1
    s_cmp_lt_u32 s42, 0x40000
    s_cbranch_scc1 AT_POLLKV
AT_POLLKV_OK:
    s_sub_u32 s37, s20, 12
    s_cmp_lt_u32 s37, 3
    s_cbranch_scc0 AT_KVCHK_RET
    s_lshl_b32 s38, s19, 2
    s_add_u32 s38, s38, s18
    s_lshl_b32 s38, s38, 13
    s_cmp_eq_u32 s37, 1
    s_cselect_b32 s12, s56, s54
    s_cselect_b32 s13, s57, s55
    s_mov_b32 s14, 0x380000
    s_cselect_b32 s14, 0x188000, s14
    s_and_b32 s13, s13, 0xffff
    s_cmp_eq_u32 s37, 2
    s_cselect_b32 s37, 0x300000, 0
    s_add_u32 s37, s37, s38
    v_lshlrev_b32 v100, 7, v1
    buffer_load_dword v101, v100, s[12:15], s37 offen
    s_add_u32 s37, s37, 0x80000
    buffer_load_dword v101, v100, s[12:15], s37 offen
    s_add_u32 s37, s37, 0x80000
    buffer_load_dword v101, v100, s[12:15], s37 offen
    s_add_u32 s37, s37, 0x80000
    buffer_load_dword v101, v100, s[12:15], s37 offen
    s_add_u32 s37, s37, 0x80000
    buffer_load_dword v101, v100, s[12:15], s37 offen
    s_add_u32 s37, s37, 0x80000
    buffer_load_dword v101, v100, s[12:15], s37 offen
    s_add_u32 s37, s37, 0x80000
    s_branch AT_KVCHK_RET
AT_SWITCH:
    s_cmp_eq_u32 s32, 3
    s_cbranch_scc1 AT_SW3
    s_cmp_eq_u32 s32, 2
    s_cbranch_scc1 AT_SW2
    v_mov_b32 v10, v6
    v_mov_b32 v11, v7
    v_mov_b32 v12, v8
    v_mov_b32 v13, v9
    s_cmp_eq_u32 s29, 3
    s_cbranch_scc0 AT_SWITCH_RET
    s_lshl_b32 s39, s19, 6
    s_add_u32 s39, s39, 0x5400
    s_lshl_b32 s3, s20, 2
    s_add_u32 s39, s39, s3
    s_add_u32 s39, s39, -24
    buffer_load_dword v43, v44, s[8:11], s39 offen sc1
    s_branch AT_SWITCH_RET
AT_SW3:
    s_cmp_eq_u32 s29, 3
    s_cbranch_scc1 AT_SW_Q
    s_mov_b32 s4, s54
    s_and_b32 s5, s55, 0xffff
    s_mov_b32 s6, 0x380000
    s_mov_b32 s22, 0x80
    s_mul_i32 s21, s19, 229376
    s_and_b32 s3, s19, 1
    s_lshl_b32 s3, s3, 9
    s_add_u32 s21, s21, s3
    v_mov_b32 v6, v5
    v_add_u32 v7, 0x7000, v5
    v_add_u32 v8, 0xe000, v5
    v_add_u32 v9, 0x15000, v5
    v_add_u32 v10, 0x1c000, v5
    v_add_u32 v11, 0x23000, v5
    v_add_u32 v12, 0x2a000, v5
    v_add_u32 v13, 0x31000, v5
    s_getpc_b64 s[12:13]
CT_101:
    s_sub_u32 s12, s12, CT_101-K_START
    s_subb_u32 s13, s13, 0
    s_and_b32 s13, s13, 0xffff
    s_mov_b32 s14, K_LAST-K_START
    s_mov_b32 s15, 0x20000
    s_lshr_b32 s3, s2, 3
    s_lshl_b32 s3, s3, 2
    s_add_u32 s3, s3, s18
    s_mul_i32 s3, s3, 640
    v_min_u32 v100, 4, v1
    v_lshlrev_b32 v100, 7, v100
    buffer_load_dword v101, v100, s[12:15], s3 offen
    s_cmp_eq_u32 s29, 1
    s_cbranch_scc0 AT_SWITCH_RET
    s_lshl_b32 s39, s19, 6
    s_add_u32 s39, s39, 0x5400
    s_lshl_b32 s3, s20, 2
    s_add_u32 s39, s39, s3
    s_add_u32 s39, s39, 24
    buffer_load_dword v43, v44, s[8:11], s39 offen sc1
    s_branch AT_SWITCH_RET
AT_SW2:
    s_cmp_eq_u32 s29, 1
    s_cbranch_scc0 AT_SWITCH_RET
    s_waitcnt vmcnt(8)
    s_mov_b32 s38, 0
    s_branch AT_POLLP_CHK
AT_POLLP:
    buffer_load_dword v43, v44, s[8:11], s39 offen sc1
    s_waitcnt vmcnt(0)
AT_POLLP_CHK:
    v_readfirstlane_b32 s37, v43
    s_nop 0
    s_cmp_ge_u32 s37, 1
    s_cbranch_scc1 AT_POLLP_OK
    s_add_u32 s38, s38, 1
    s_cmp_ge_u32 s38, 0x40000
    s_cbranch_scc1 AT_POLLP_OK
    s_sleep 2
    s_branch AT_POLLP
AT_POLLP_OK:
    s_mul_i32 s37, s36, 0x12000
    s_mul_i32 s38, s18, 17408
    s_add_u32 s37, s37, s38
    s_add_u32 s37, s37, 0x8000000
    s_add_u32 s38, s37, 16384
    buffer_load_dwordx4 v[96:99], v2, s[8:11], s38 offen sc1
AT_SW_LD:
    buffer_load_dwordx4 v[176:179], v2, s[8:11], s37 offen offset:0 sc1
    buffer_load_dwordx4 v[180:183], v2, s[8:11], s37 offen offset:1024 sc1
    buffer_load_dwordx4 v[184:187], v2, s[8:11], s37 offen offset:2048 sc1
    buffer_load_dwordx4 v[188:191], v2, s[8:11], s37 offen offset:3072 sc1
    s_add_u32 s37, s37, 4096
    buffer_load_dwordx4 v[192:195], v2, s[8:11], s37 offen offset:0 sc1
    buffer_load_dwordx4 v[196:199], v2, s[8:11], s37 offen offset:1024 sc1
    buffer_load_dwordx4 v[200:203], v2, s[8:11], s37 offen offset:2048 sc1
    buffer_load_dwordx4 v[204:207], v2, s[8:11], s37 offen offset:3072 sc1
    s_add_u32 s37, s37, 4096
    buffer_load_dwordx4 v[208:211], v2, s[8:11], s37 offen offset:0 sc1
    buffer_load_dwordx4 v[212:215], v2, s[8:11], s37 offen offset:1024 sc1
    buffer_load_dwordx4 v[216:219], v2, s[8:11], s37 offen offset:2048 sc1
    buffer_load_dwordx4 v[220:223], v2, s[8:11], s37 offen offset:3072 sc1
    s_add_u32 s37, s37, 4096
    buffer_load_dwordx4 v[224:227], v2, s[8:11], s37 offen offset:0 sc1
    buffer_load_dwordx4 v[228:231], v2, s[8:11], s37 offen offset:1024 sc1
    buffer_load_dwordx4 v[232:235], v2, s[8:11], s37 offen offset:2048 sc1
    buffer_load_dwordx4 v[236:239], v2, s[8:11], s37 offen offset:3072 sc1
    s_branch AT_SWITCH_RET
AT_SW_Q:
    s_cmp_gt_u32 s33, 3
    s_cbranch_scc1 AT_POLLKV2_OK
    v_and_b32 v111, 15, v1
    v_lshlrev_b32 v111, 2, v111
    s_mov_b32 s38, 0
AT_POLLKV2:
    buffer_load_dword v110, v111, s[8:11], s35 offen sc1
    s_waitcnt vmcnt(0)
    v_cmp_ne_u32 vcc, 0, v110
    s_nop 0
    s_and_b32 s37, vcc_lo, 0xffff
    s_cmp_eq_u32 s37, 0xffff
    s_cbranch_scc1 AT_POLLKV2_OK
    s_sleep 1
    s_add_u32 s38, s38, 1
    s_cmp_lt_u32 s38, 0x40000
    s_cbranch_scc1 AT_POLLKV2
AT_POLLKV2_OK:
    s_lshl_b32 s39, s19, 6
    s_add_u32 s39, s39, 0x5400
    s_lshl_b32 s3, s20, 2
    s_add_u32 s39, s39, s3
    s_add_u32 s39, s39, -24
    s_waitcnt vmcnt(8)
    s_mov_b32 s38, 0
    s_branch AT_POLLQ_CHK
AT_POLLQ:
    buffer_load_dword v43, v44, s[8:11], s39 offen sc1
    s_waitcnt vmcnt(0)
AT_POLLQ_CHK:
    v_readfirstlane_b32 s37, v43
    s_nop 0
    s_cmp_ge_u32 s37, 1
    s_cbranch_scc1 AT_POLLQ_OK
    s_add_u32 s38, s38, 1
    s_cmp_ge_u32 s38, 0x40000
    s_cbranch_scc1 AT_POLLQ_OK
    s_sleep 2
    s_branch AT_POLLQ
AT_POLLQ_OK:
    s_lshl_b32 s21, s19, 21
    s_add_u32 s21, s21, 0x213c000
    v_add_u32 v10, 0x4000, v3
    v_add_u32 v11, 0x5000, v3
    v_add_u32 v12, 0x6000, v3
    v_add_u32 v13, 0x7000, v3
    s_lshl_b32 s37, s36, 2
    s_add_u32 s37, s37, s18
    s_lshl_b32 s37, s37, 14
    s_add_u32 s37, s37, 0xa000000
    s_branch AT_SW_LD
AT_RARE:
    s_nop 7
    v_max3_f32 v240, v64, v65, v66
    v_max3_f32 v240, v240, v67, v72
    v_max3_f32 v240, v240, v73, v74
    v_max_f32 v240, v240, v75
    v_mov_b32 v255, v240
    s_nop 1
    v_permlane16_swap_b32 v240, v255
    v_max_f32 v240, v240, v255
    v_mov_b32 v255, v240
    s_nop 1
    v_permlane32_swap_b32 v240, v255
    v_max_f32 v240, v240, v255
    v_max_f32 v240, 0, v240
    v_sub_f32 v242, 0, v240
    v_exp_f32 v242, v242
    v_sub_f32 v48, v48, v240
    v_sub_f32 v49, v49, v240
    v_sub_f32 v50, v50, v240
    v_sub_f32 v51, v51, v240
    v_mul_f32 v38, v38, v242
    v_sub_f32 v64, v64, v240
    v_sub_f32 v65, v65, v240
    v_sub_f32 v66, v66, v240
    v_sub_f32 v67, v67, v240
    v_sub_f32 v72, v72, v240
    v_sub_f32 v73, v73, v240
    v_sub_f32 v74, v74, v240
    v_sub_f32 v75, v75, v240
    v_max3_f32 v241, v68, v69, v70
    v_max3_f32 v241, v241, v71, v76
    v_max3_f32 v241, v241, v77, v78
    v_max_f32 v241, v241, v79
    v_mov_b32 v255, v241
    s_nop 1
    v_permlane16_swap_b32 v241, v255
    v_max_f32 v241, v241, v255
    v_mov_b32 v255, v241
    s_nop 1
    v_permlane32_swap_b32 v241, v255
    v_max_f32 v241, v241, v255
    v_max_f32 v241, 0, v241
    v_sub_f32 v243, 0, v241
    v_exp_f32 v243, v243
    v_sub_f32 v52, v52, v241
    v_sub_f32 v53, v53, v241
    v_sub_f32 v54, v54, v241
    v_sub_f32 v55, v55, v241
    v_mul_f32 v39, v39, v243
    v_sub_f32 v68, v68, v241
    v_sub_f32 v69, v69, v241
    v_sub_f32 v70, v70, v241
    v_sub_f32 v71, v71, v241
    v_sub_f32 v76, v76, v241
    v_sub_f32 v77, v77, v241
    v_sub_f32 v78, v78, v241
    v_sub_f32 v79, v79, v241
    v_accvgpr_read_b32 v244, a0
    v_accvgpr_read_b32 v245, a1
    v_accvgpr_read_b32 v246, a2
    v_accvgpr_read_b32 v247, a3
    v_mul_f32 v244, v244, v242
    v_mul_f32 v245, v245, v242
    v_mul_f32 v246, v246, v242
    v_mul_f32 v247, v247, v242
    v_accvgpr_write_b32 a0, v244
    v_accvgpr_write_b32 a1, v245
    v_accvgpr_write_b32 a2, v246
    v_accvgpr_write_b32 a3, v247
    v_accvgpr_read_b32 v244, a4
    v_accvgpr_read_b32 v245, a5
    v_accvgpr_read_b32 v246, a6
    v_accvgpr_read_b32 v247, a7
    v_mul_f32 v244, v244, v243
    v_mul_f32 v245, v245, v243
    v_mul_f32 v246, v246, v243
    v_mul_f32 v247, v247, v243
    v_accvgpr_write_b32 a4, v244
    v_accvgpr_write_b32 a5, v245
    v_accvgpr_write_b32 a6, v246
    v_accvgpr_write_b32 a7, v247
    v_accvgpr_read_b32 v244, a8
    v_accvgpr_read_b32 v245, a9
    v_accvgpr_read_b32 v246, a10
    v_accvgpr_read_b32 v247, a11
    v_mul_f32 v244, v244, v242
    v_mul_f32 v245, v245, v242
    v_mul_f32 v246, v246, v242
    v_mul_f32 v247, v247, v242
    v_accvgpr_write_b32 a8, v244
    v_accvgpr_write_b32 a9, v245
    v_accvgpr_write_b32 a10, v246
    v_accvgpr_write_b32 a11, v247
    v_accvgpr_read_b32 v244, a12
    v_accvgpr_read_b32 v245, a13
    v_accvgpr_read_b32 v246, a14
    v_accvgpr_read_b32 v247, a15
    v_mul_f32 v244, v244, v243
    v_mul_f32 v245, v245, v243
    v_mul_f32 v246, v246, v243
    v_mul_f32 v247, v247, v243
    v_accvgpr_write_b32 a12, v244
    v_accvgpr_write_b32 a13, v245
    v_accvgpr_write_b32 a14, v246
    v_accvgpr_write_b32 a15, v247
    v_accvgpr_read_b32 v244, a16
    v_accvgpr_read_b32 v245, a17
    v_accvgpr_read_b32 v246, a18
    v_accvgpr_read_b32 v247, a19
    v_mul_f32 v244, v244, v242
    v_mul_f32 v245, v245, v242
    v_mul_f32 v246, v246, v242
    v_mul_f32 v247, v247, v242
    v_accvgpr_write_b32 a16, v244
    v_accvgpr_write_b32 a17, v245
    v_accvgpr_write_b32 a18, v246
    v_accvgpr_write_b32 a19, v247
    v_accvgpr_read_b32 v244, a20
    v_accvgpr_read_b32 v245, a21
    v_accvgpr_read_b32 v246, a22
    v_accvgpr_read_b32 v247, a23
    v_mul_f32 v244, v244, v243
    v_mul_f32 v245, v245, v243
    v_mul_f32 v246, v246, v243
    v_mul_f32 v247, v247, v243
    v_accvgpr_write_b32 a20, v244
    v_accvgpr_write_b32 a21, v245
    v_accvgpr_write_b32 a22, v246
    v_accvgpr_write_b32 a23, v247
    v_accvgpr_read_b32 v244, a24
    v_accvgpr_read_b32 v245, a25
    v_accvgpr_read_b32 v246, a26
    v_accvgpr_read_b32 v247, a27
    v_mul_f32 v244, v244, v242
    v_mul_f32 v245, v245, v242
    v_mul_f32 v246, v246, v242
    v_mul_f32 v247, v247, v242
    v_accvgpr_write_b32 a24, v244
    v_accvgpr_write_b32 a25, v245
    v_accvgpr_write_b32 a26, v246
    v_accvgpr_write_b32 a27, v247
    v_accvgpr_read_b32 v244, a28
    v_accvgpr_read_b32 v245, a29
    v_accvgpr_read_b32 v246, a30
    v_accvgpr_read_b32 v247, a31
    v_mul_f32 v244, v244, v243
    v_mul_f32 v245, v245, v243
    v_mul_f32 v246, v246, v243
    v_mul_f32 v247, v247, v243
    v_accvgpr_write_b32 a28, v244
    v_accvgpr_write_b32 a29, v245
    v_accvgpr_write_b32 a30, v246
    v_accvgpr_write_b32 a31, v247
    v_accvgpr_read_b32 v244, a32
    v_accvgpr_read_b32 v245, a33
    v_accvgpr_read_b32 v246, a34
    v_accvgpr_read_b32 v247, a35
    v_mul_f32 v244, v244, v242
    v_mul_f32 v245, v245, v242
    v_mul_f32 v246, v246, v242
    v_mul_f32 v247, v247, v242
    v_accvgpr_write_b32 a32, v244
    v_accvgpr_write_b32 a33, v245
    v_accvgpr_write_b32 a34, v246
    v_accvgpr_write_b32 a35, v247
    v_accvgpr_read_b32 v244, a36
    v_accvgpr_read_b32 v245, a37
    v_accvgpr_read_b32 v246, a38
    v_accvgpr_read_b32 v247, a39
    v_mul_f32 v244, v244, v243
    v_mul_f32 v245, v245, v243
    v_mul_f32 v246, v246, v243
    v_mul_f32 v247, v247, v243
    v_accvgpr_write_b32 a36, v244
    v_accvgpr_write_b32 a37, v245
    v_accvgpr_write_b32 a38, v246
    v_accvgpr_write_b32 a39, v247
    v_accvgpr_read_b32 v244, a40
    v_accvgpr_read_b32 v245, a41
    v_accvgpr_read_b32 v246, a42
    v_accvgpr_read_b32 v247, a43
    v_mul_f32 v244, v244, v242
    v_mul_f32 v245, v245, v242
    v_mul_f32 v246, v246, v242
    v_mul_f32 v247, v247, v242
    v_accvgpr_write_b32 a40, v244
    v_accvgpr_write_b32 a41, v245
    v_accvgpr_write_b32 a42, v246
    v_accvgpr_write_b32 a43, v247
    v_accvgpr_read_b32 v244, a44
    v_accvgpr_read_b32 v245, a45
    v_accvgpr_read_b32 v246, a46
    v_accvgpr_read_b32 v247, a47
    v_mul_f32 v244, v244, v243
    v_mul_f32 v245, v245, v243
    v_mul_f32 v246, v246, v243
    v_mul_f32 v247, v247, v243
    v_accvgpr_write_b32 a44, v244
    v_accvgpr_write_b32 a45, v245
    v_accvgpr_write_b32 a46, v246
    v_accvgpr_write_b32 a47, v247
    v_accvgpr_read_b32 v244, a48
    v_accvgpr_read_b32 v245, a49
    v_accvgpr_read_b32 v246, a50
    v_accvgpr_read_b32 v247, a51
    v_mul_f32 v244, v244, v242
    v_mul_f32 v245, v245, v242
    v_mul_f32 v246, v246, v242
    v_mul_f32 v247, v247, v242
    v_accvgpr_write_b32 a48, v244
    v_accvgpr_write_b32 a49, v245
    v_accvgpr_write_b32 a50, v246
    v_accvgpr_write_b32 a51, v247
    v_accvgpr_read_b32 v244, a52
    v_accvgpr_read_b32 v245, a53
    v_accvgpr_read_b32 v246, a54
    v_accvgpr_read_b32 v247, a55
    v_mul_f32 v244, v244, v243
    v_mul_f32 v245, v245, v243
    v_mul_f32 v246, v246, v243
    v_mul_f32 v247, v247, v243
    v_accvgpr_write_b32 a52, v244
    v_accvgpr_write_b32 a53, v245
    v_accvgpr_write_b32 a54, v246
    v_accvgpr_write_b32 a55, v247
    v_accvgpr_read_b32 v244, a56
    v_accvgpr_read_b32 v245, a57
    v_accvgpr_read_b32 v246, a58
    v_accvgpr_read_b32 v247, a59
    v_mul_f32 v244, v244, v242
    v_mul_f32 v245, v245, v242
    v_mul_f32 v246, v246, v242
    v_mul_f32 v247, v247, v242
    v_accvgpr_write_b32 a56, v244
    v_accvgpr_write_b32 a57, v245
    v_accvgpr_write_b32 a58, v246
    v_accvgpr_write_b32 a59, v247
    v_accvgpr_read_b32 v244, a60
    v_accvgpr_read_b32 v245, a61
    v_accvgpr_read_b32 v246, a62
    v_accvgpr_read_b32 v247, a63
    v_mul_f32 v244, v244, v243
    v_mul_f32 v245, v245, v243
    v_mul_f32 v246, v246, v243
    v_mul_f32 v247, v247, v243
    v_accvgpr_write_b32 a60, v244
    v_accvgpr_write_b32 a61, v245
    v_accvgpr_write_b32 a62, v246
    v_accvgpr_write_b32 a63, v247
    v_accvgpr_read_b32 v244, a64
    v_accvgpr_read_b32 v245, a65
    v_accvgpr_read_b32 v246, a66
    v_accvgpr_read_b32 v247, a67
    v_mul_f32 v244, v244, v242
    v_mul_f32 v245, v245, v242
    v_mul_f32 v246, v246, v242
    v_mul_f32 v247, v247, v242
    v_accvgpr_write_b32 a64, v244
    v_accvgpr_write_b32 a65, v245
    v_accvgpr_write_b32 a66, v246
    v_accvgpr_write_b32 a67, v247
    v_accvgpr_read_b32 v244, a68
    v_accvgpr_read_b32 v245, a69
    v_accvgpr_read_b32 v246, a70
    v_accvgpr_read_b32 v247, a71
    v_mul_f32 v244, v244, v243
    v_mul_f32 v245, v245, v243
    v_mul_f32 v246, v246, v243
    v_mul_f32 v247, v247, v243
    v_accvgpr_write_b32 a68, v244
    v_accvgpr_write_b32 a69, v245
    v_accvgpr_write_b32 a70, v246
    v_accvgpr_write_b32 a71, v247
    v_accvgpr_read_b32 v244, a72
    v_accvgpr_read_b32 v245, a73
    v_accvgpr_read_b32 v246, a74
    v_accvgpr_read_b32 v247, a75
    v_mul_f32 v244, v244, v242
    v_mul_f32 v245, v245, v242
    v_mul_f32 v246, v246, v242
    v_mul_f32 v247, v247, v242
    v_accvgpr_write_b32 a72, v244
    v_accvgpr_write_b32 a73, v245
    v_accvgpr_write_b32 a74, v246
    v_accvgpr_write_b32 a75, v247
    v_accvgpr_read_b32 v244, a76
    v_accvgpr_read_b32 v245, a77
    v_accvgpr_read_b32 v246, a78
    v_accvgpr_read_b32 v247, a79
    v_mul_f32 v244, v244, v243
    v_mul_f32 v245, v245, v243
    v_mul_f32 v246, v246, v243
    v_mul_f32 v247, v247, v243
    v_accvgpr_write_b32 a76, v244
    v_accvgpr_write_b32 a77, v245
    v_accvgpr_write_b32 a78, v246
    v_accvgpr_write_b32 a79, v247
    v_accvgpr_read_b32 v244, a80
    v_accvgpr_read_b32 v245, a81
    v_accvgpr_read_b32 v246, a82
    v_accvgpr_read_b32 v247, a83
    v_mul_f32 v244, v244, v242
    v_mul_f32 v245, v245, v242
    v_mul_f32 v246, v246, v242
    v_mul_f32 v247, v247, v242
    v_accvgpr_write_b32 a80, v244
    v_accvgpr_write_b32 a81, v245
    v_accvgpr_write_b32 a82, v246
    v_accvgpr_write_b32 a83, v247
    v_accvgpr_read_b32 v244, a84
    v_accvgpr_read_b32 v245, a85
    v_accvgpr_read_b32 v246, a86
    v_accvgpr_read_b32 v247, a87
    v_mul_f32 v244, v244, v243
    v_mul_f32 v245, v245, v243
    v_mul_f32 v246, v246, v243
    v_mul_f32 v247, v247, v243
    v_accvgpr_write_b32 a84, v244
    v_accvgpr_write_b32 a85, v245
    v_accvgpr_write_b32 a86, v246
    v_accvgpr_write_b32 a87, v247
    v_accvgpr_read_b32 v244, a88
    v_accvgpr_read_b32 v245, a89
    v_accvgpr_read_b32 v246, a90
    v_accvgpr_read_b32 v247, a91
    v_mul_f32 v244, v244, v242
    v_mul_f32 v245, v245, v242
    v_mul_f32 v246, v246, v242
    v_mul_f32 v247, v247, v242
    v_accvgpr_write_b32 a88, v244
    v_accvgpr_write_b32 a89, v245
    v_accvgpr_write_b32 a90, v246
    v_accvgpr_write_b32 a91, v247
    v_accvgpr_read_b32 v244, a92
    v_accvgpr_read_b32 v245, a93
    v_accvgpr_read_b32 v246, a94
    v_accvgpr_read_b32 v247, a95
    v_mul_f32 v244, v244, v243
    v_mul_f32 v245, v245, v243
    v_mul_f32 v246, v246, v243
    v_mul_f32 v247, v247, v243
    v_accvgpr_write_b32 a92, v244
    v_accvgpr_write_b32 a93, v245
    v_accvgpr_write_b32 a94, v246
    v_accvgpr_write_b32 a95, v247
    v_accvgpr_read_b32 v244, a96
    v_accvgpr_read_b32 v245, a97
    v_accvgpr_read_b32 v246, a98
    v_accvgpr_read_b32 v247, a99
    v_mul_f32 v244, v244, v242
    v_mul_f32 v245, v245, v242
    v_mul_f32 v246, v246, v242
    v_mul_f32 v247, v247, v242
    v_accvgpr_write_b32 a96, v244
    v_accvgpr_write_b32 a97, v245
    v_accvgpr_write_b32 a98, v246
    v_accvgpr_write_b32 a99, v247
    v_accvgpr_read_b32 v244, a100
    v_accvgpr_read_b32 v245, a101
    v_accvgpr_read_b32 v246, a102
    v_accvgpr_read_b32 v247, a103
    v_mul_f32 v244, v244, v243
    v_mul_f32 v245, v245, v243
    v_mul_f32 v246, v246, v243
    v_mul_f32 v247, v247, v243
    v_accvgpr_write_b32 a100, v244
    v_accvgpr_write_b32 a101, v245
    v_accvgpr_write_b32 a102, v246
    v_accvgpr_write_b32 a103, v247
    v_accvgpr_read_b32 v244, a104
    v_accvgpr_read_b32 v245, a105
    v_accvgpr_read_b32 v246, a106
    v_accvgpr_read_b32 v247, a107
    v_mul_f32 v244, v244, v242
    v_mul_f32 v245, v245, v242
    v_mul_f32 v246, v246, v242
    v_mul_f32 v247, v247, v242
    v_accvgpr_write_b32 a104, v244
    v_accvgpr_write_b32 a105, v245
    v_accvgpr_write_b32 a106, v246
    v_accvgpr_write_b32 a107, v247
    v_accvgpr_read_b32 v244, a108
    v_accvgpr_read_b32 v245, a109
    v_accvgpr_read_b32 v246, a110
    v_accvgpr_read_b32 v247, a111
    v_mul_f32 v244, v244, v243
    v_mul_f32 v245, v245, v243
    v_mul_f32 v246, v246, v243
    v_mul_f32 v247, v247, v243
    v_accvgpr_write_b32 a108, v244
    v_accvgpr_write_b32 a109, v245
    v_accvgpr_write_b32 a110, v246
    v_accvgpr_write_b32 a111, v247
    v_accvgpr_read_b32 v244, a112
    v_accvgpr_read_b32 v245, a113
    v_accvgpr_read_b32 v246, a114
    v_accvgpr_read_b32 v247, a115
    v_mul_f32 v244, v244, v242
    v_mul_f32 v245, v245, v242
    v_mul_f32 v246, v246, v242
    v_mul_f32 v247, v247, v242
    v_accvgpr_write_b32 a112, v244
    v_accvgpr_write_b32 a113, v245
    v_accvgpr_write_b32 a114, v246
    v_accvgpr_write_b32 a115, v247
    v_accvgpr_read_b32 v244, a116
    v_accvgpr_read_b32 v245, a117
    v_accvgpr_read_b32 v246, a118
    v_accvgpr_read_b32 v247, a119
    v_mul_f32 v244, v244, v243
    v_mul_f32 v245, v245, v243
    v_mul_f32 v246, v246, v243
    v_mul_f32 v247, v247, v243
    v_accvgpr_write_b32 a116, v244
    v_accvgpr_write_b32 a117, v245
    v_accvgpr_write_b32 a118, v246
    v_accvgpr_write_b32 a119, v247
    v_accvgpr_read_b32 v244, a120
    v_accvgpr_read_b32 v245, a121
    v_accvgpr_read_b32 v246, a122
    v_accvgpr_read_b32 v247, a123
    v_mul_f32 v244, v244, v242
    v_mul_f32 v245, v245, v242
    v_mul_f32 v246, v246, v242
    v_mul_f32 v247, v247, v242
    v_accvgpr_write_b32 a120, v244
    v_accvgpr_write_b32 a121, v245
    v_accvgpr_write_b32 a122, v246
    v_accvgpr_write_b32 a123, v247
    v_accvgpr_read_b32 v244, a124
    v_accvgpr_read_b32 v245, a125
    v_accvgpr_read_b32 v246, a126
    v_accvgpr_read_b32 v247, a127
    v_mul_f32 v244, v244, v243
    v_mul_f32 v245, v245, v243
    v_mul_f32 v246, v246, v243
    v_mul_f32 v247, v247, v243
    v_accvgpr_write_b32 a124, v244
    v_accvgpr_write_b32 a125, v245
    v_accvgpr_write_b32 a126, v246
    v_accvgpr_write_b32 a127, v247
    v_exp_f32 v80, v64
    v_exp_f32 v81, v65
    v_exp_f32 v82, v66
    v_exp_f32 v83, v67
    v_exp_f32 v84, v68
    v_exp_f32 v85, v69
    v_exp_f32 v86, v70
    v_exp_f32 v87, v71
    v_exp_f32 v88, v72
    v_exp_f32 v89, v73
    v_exp_f32 v90, v74
    v_exp_f32 v91, v75
    v_exp_f32 v92, v76
    v_exp_f32 v93, v77
    v_exp_f32 v94, v78
    v_exp_f32 v95, v79
    v_add_f32 v40, v80, v81
    v_add_f32 v40, v40, v82
    v_add_f32 v40, v40, v83
    v_add_f32 v41, v84, v85
    v_add_f32 v41, v41, v86
    v_add_f32 v41, v41, v87
    v_add_f32 v40, v40, v88
    v_add_f32 v40, v40, v89
    v_add_f32 v40, v40, v90
    v_add_f32 v40, v40, v91
    v_add_f32 v41, v41, v92
    v_add_f32 v41, v41, v93
    v_add_f32 v41, v41, v94
    v_add_f32 v41, v41, v95
    s_branch AT_RARE_RET
K_LAST:
.section .rodata,"a"
.p2align 6
.amdhsa_kernel adaLN_cond__compressed_kv_cla__dense_activation_silu__prompt_kernel
  .amdhsa_next_free_vgpr 512
  .amdhsa_next_free_sgpr 98
  .amdhsa_accum_offset 256
  .amdhsa_group_segment_fixed_size 0
  .amdhsa_kernarg_size 112
  .amdhsa_user_sgpr_count 2
  .amdhsa_user_sgpr_kernarg_segment_ptr 1
  .amdhsa_system_sgpr_workgroup_id_x 1
.end_amdhsa_kernel
```
